```python
import torch

def _softmax(x, axis=-1):
    return torch.softmax(x, dim=axis)
def _gelu(x):
    return torch.nn.functional.gelu(x, approximate="tanh")
def _silu(x):
    return torch.nn.functional.silu(x)
def _sigmoid(x):
    return torch.sigmoid(x)
def _layernorm(x, axis=-1, eps=1e-5):
    m = x.mean(dim=axis, keepdim=True)
    v = x.var(dim=axis, keepdim=True, unbiased=False)
    return (x - m) / torch.sqrt(v + eps)
def _scatter_add(tgt, idx, src, axis=0):
    return tgt.clone().index_add_(axis, idx, src)
def _segment_sum(src, seg, n):
    out = torch.zeros((n,) + src.shape[1:], dtype=src.dtype)
    return out.index_add_(0, seg, src)
def _pad(x, pw):
    flat = tuple(v for pair in reversed(pw) for v in pair)
    return torch.nn.functional.pad(x, flat)

kernel_name = 'concat_heads__gqa_block_cached__mha_block_cached__near_ridge'

def setup_inputs():

    _w = (lambda a: (lambda t: t.to(torch.bfloat16) if t.is_floating_point() else t)(torch.as_tensor(a)))
    def _A_setup():
        B, Sq, D = 16, 160, 640
        Hq, Hkv, Sk, Dh = 32, 32, 512, 192
        assert Hq % Hkv == 0, (Hq, Hkv)
        return {
            "x": _w((lambda *s: torch.randn(*s, dtype=torch.bfloat16) * 0.8)(B, Sq, D)),
            "k_cache": _w((lambda *s: torch.randn(*s, dtype=torch.bfloat16) * 0.8)(B, Hkv, Sk, Dh)),
            "v_cache": _w((lambda *s: torch.randn(*s, dtype=torch.bfloat16) * 0.05)(B, Hkv, Sk, Dh)),
            "wq": _w((lambda *s: torch.randn(*s, dtype=torch.bfloat16) * 0.8)(D, Hq * Dh) * (D ** -0.5)),
            "wo": _w((lambda *s: torch.randn(*s, dtype=torch.bfloat16) * 0.05)(Hq * Dh, D) * ((Hq * Dh) ** -0.5)),
        }
    _A_in = _A_setup()

    def _B_setup():
        B, Sq, D = 16, 160, 640
        H, Sk, Dh = 32, 512, 192
        return {
            "x": _w((lambda *s: torch.randn(*s, dtype=torch.bfloat16) * 0.8)(B, Sq, D)),
            "k_cache": _w((lambda *s: torch.randn(*s, dtype=torch.bfloat16) * 0.8)(B, H, Sk, Dh)),
            "v_cache": _w((lambda *s: torch.randn(*s, dtype=torch.bfloat16) * 0.05)(B, H, Sk, Dh)),
            "wq": _w((lambda *s: torch.randn(*s, dtype=torch.bfloat16) * 0.8)(D, H * Dh) * (D ** -0.5)),
            "wo": _w((lambda *s: torch.randn(*s, dtype=torch.bfloat16) * 0.05)(H * Dh, D) * ((H * Dh) ** -0.5)),
        }
    _B_in = _B_setup()

    return {
        "A_x": _A_in["x"],
        "A_k_cache": _A_in["k_cache"],
        "A_v_cache": _A_in["v_cache"],
        "A_wq": _A_in["wq"],
        "A_wo": _A_in["wo"],
        "B_x": _B_in["x"],
        "B_k_cache": _B_in["k_cache"],
        "B_v_cache": _B_in["v_cache"],
        "B_wq": _B_in["wq"],
        "B_wo": _B_in["wo"],
    }

def reference(A_x, A_k_cache, A_v_cache, A_wq, A_wo, B_x, B_k_cache, B_v_cache, B_wq, B_wo):
    def _A_ref(x, k_cache, v_cache, wq, wo):
        B, Sq, D = x.shape
        Hq, Dh = 32, 192
        Hkv = k_cache.shape[1]
        rep = Hq // Hkv
        q = (lambda x, *d: x.permute(*d))((x @ wq).reshape(B, Sq, Hq, Dh), 0, 2, 1, 3)
        k = (lambda x, n, axis: torch.repeat_interleave(x, n, dim=axis))(k_cache, rep, axis=1)
        v = (lambda x, n, axis: torch.repeat_interleave(x, n, dim=axis))(v_cache, rep, axis=1)
        scores = torch.einsum("bhqd,bhkd->bhqk", q, k) * (Dh ** -0.5)
        p = _softmax(scores, axis=-1)
        o = torch.einsum("bhqk,bhkd->bhqd", p, v)
        return (lambda x, *d: x.permute(*d))(o, 0, 2, 1, 3).reshape(B, Sq, Hq * Dh) @ wo

    def _B_ref(x, k_cache, v_cache, wq, wo):
        B, Sq, D = x.shape
        H, Dh = 32, 192
        q = (lambda x, *d: x.permute(*d))((x @ wq).reshape(B, Sq, H, Dh), 0, 2, 1, 3)
        scores = torch.einsum("bhqd,bhkd->bhqk", q, k_cache) * (Dh ** -0.5)
        p = _softmax(scores, axis=-1)
        o = torch.einsum("bhqk,bhkd->bhqd", p, v_cache)
        return (lambda x, *d: x.permute(*d))(o, 0, 2, 1, 3).reshape(B, Sq, H * Dh) @ wo

    a = _A_ref(A_x, A_k_cache, A_v_cache, A_wq, A_wo)
    b = _B_ref(B_x, B_k_cache, B_v_cache, B_wq, B_wo)
    return torch.concatenate([a, b], axis=-1)
```

```asm
; @launch grid=(256,1,1) block=(256,1,1) lds=163840
.amdgcn_target "amdgcn-amd-amdhsa--gfx950"
.text
.globl concat_heads__gqa_block_cached__mha_block_cached__near_ridge_kernel
.p2align 8
.type concat_heads__gqa_block_cached__mha_block_cached__near_ridge_kernel,@function
concat_heads__gqa_block_cached__mha_block_cached__near_ridge_kernel:
L_setup:
    s_cmp_ge_u32 s2, 256
    s_cbranch_scc1 L_end
    s_load_dwordx16 s[64:79], s[0:1], 0
    s_load_dwordx8 s[80:87], s[0:1], 64
    s_load_dwordx2 s[88:89], s[0:1], 96
    v_readfirstlane_b32 s28, v0
    v_and_b32 v20, 63, v0
    s_bfe_u32 s90, s2, 65538
    s_bfe_u32 s98, s2, 131077
    s_bfe_u32 s3, s2, 131075
    s_bfe_u32 s91, s2, 131075
    s_and_b32 s100, s2, 1
    s_lshl_b32 s100, s100, 2
    s_add_u32 s91, s91, s100
    s_and_b32 s99, s2, 2
    s_lshr_b32 s100, s2, 7
    s_add_u32 s99, s99, s100
    s_lshr_b32 s28, s28, 6
    s_lshr_b32 s33, s2, 5
    s_add_u32 s33, s33, s3
    s_add_u32 s52, s33, 0
    s_mul_i32 s101, s52, 52
    s_lshr_b32 s101, s101, 8
    s_mul_i32 s101, s101, 5
    s_sub_u32 s52, s52, s101
    s_lshl_b32 s52, s52, 7
    s_lshr_b32 s92, s28, 1
    s_and_b32 s93, s28, 1
    s_lshl_b32 s94, s91, 1
    s_add_u32 s94, s94, s92
    s_lshl_b32 s38, s28, 11
    s_add_u32 s38, s38, 8192
    v_lshrrev_b32 v22, 4, v20
    v_lshrrev_b32 v25, 3, v20
    v_mul_u32_u24 v25, 1280, v25
    v_and_b32 v26, 7, v20
    v_lshlrev_b32 v27, 1, v22
    v_xor_b32 v26, v26, v27
    v_lshl_add_u32 v1, v26, 4, v25
    s_mul_i32 s100, s94, 204800
    s_mul_i32 s101, s93, 102400
    s_add_u32 s100, s100, s101
    s_cmp_eq_u32 s90, 0
    s_waitcnt lgkmcnt(0)
    s_cselect_b64 s[64:65], s[64:65], s[74:75]
    s_cselect_b64 s[66:67], s[66:67], s[76:77]
    s_cselect_b64 s[68:69], s[68:69], s[78:79]
    s_cselect_b64 s[70:71], s[70:71], s[80:81]
    s_cselect_b64 s[72:73], s[72:73], s[82:83]
    s_add_u32 s8, s64, s100
    s_addc_u32 s9, s65, 0
    s_mov_b32 s10, 102400
    s_mov_b32 s11, 0x20000
    s_mul_i32 s0, s99, 20480
    s_add_u32 m0, s38, 0
    s_add_u32 s39, s52, s0
    buffer_load_dwordx4 v1, s[8:11], s39 offen lds
    s_add_u32 s39, s39, 9216
    buffer_load_dwordx4 v1, s[8:11], s39 offen offset:1024 lds
    s_mov_b32 s5, s87
    s_add_u32 s100, s99, 1
    s_and_b32 s100, s100, 3
    s_mul_i32 s1, s100, 20480
    s_add_u32 s100, s99, 2
    s_and_b32 s100, s100, 3
    s_mul_i32 s63, s100, 20480
    s_add_u32 s100, s99, 3
    s_and_b32 s100, s100, 3
    s_mul_i32 s87, s100, 20480
    s_getpc_b64 s[40:41]
    s_add_u32 s40, s40, L_q0-.
    s_addc_u32 s41, s41, 0
    s_lshr_b32 s29, s2, 3
    s_lshl_b32 s29, s29, 2
    s_add_u32 s29, s29, s28
    s_mul_i32 s29, s29, 8
    s_mov_b32 s30, L_w1-L_q0
    v_min_u32 v32, 7, v20
    v_add_u32 v32, s29, v32
    v_lshlrev_b32 v32, 7, v32
    v_min_u32 v32, s30, v32
    v_mov_b32 v33, s41
    v_add_co_u32 v32, vcc, s40, v32
    s_nop 1
    v_addc_co_u32 v33, vcc, 0, v33, vcc
    global_load_dword a239, v[32:33], off
    s_add_u32 m0, s38, 8192
    s_add_u32 s39, s52, s1
    buffer_load_dwordx4 v1, s[8:11], s39 offen lds
    s_lshl_b32 s95, s99, 3
    s_add_u32 s95, s95, s98
    s_mul_i32 s31, s28, 3080
    s_add_u32 s31, s31, 98304
    s_mul_i32 s100, s95, 384
    s_sub_u32 s101, 7864320, s100
    s_add_u32 s12, s70, s100
    s_addc_u32 s13, s71, 0
    s_mov_b32 s14, s101
    s_mov_b32 s15, 0x20000
    s_xor_b32 s62, s3, s98
    s_lshl_b32 s62, s62, 0
    s_add_u32 s39, s39, 9216
    buffer_load_dwordx4 v1, s[8:11], s39 offen offset:1024 lds
    s_add_u32 s53, s33, 1
    s_mul_i32 s101, s53, 52
    s_lshr_b32 s101, s101, 8
    s_mul_i32 s101, s101, 5
    s_sub_u32 s53, s53, s101
    s_lshl_b32 s53, s53, 7
    s_add_u32 s54, s33, 2
    s_mul_i32 s101, s54, 52
    s_lshr_b32 s101, s101, 8
    s_mul_i32 s101, s101, 5
    s_sub_u32 s54, s54, s101
    s_lshl_b32 s54, s54, 7
    s_add_u32 m0, s38, 16384
    s_add_u32 s39, s52, s63
    buffer_load_dwordx4 v1, s[8:11], s39 offen lds
    s_add_u32 s55, s33, 3
    s_mul_i32 s101, s55, 52
    s_lshr_b32 s101, s101, 8
    s_mul_i32 s101, s101, 5
    s_sub_u32 s55, s55, s101
    s_lshl_b32 s55, s55, 7
    s_add_u32 s56, s33, 4
    s_mul_i32 s101, s56, 52
    s_lshr_b32 s101, s101, 8
    s_mul_i32 s101, s101, 5
    s_sub_u32 s56, s56, s101
    s_lshl_b32 s56, s56, 7
    s_add_u32 s39, s39, 9216
    buffer_load_dwordx4 v1, s[8:11], s39 offen offset:1024 lds
    s_add_u32 s57, s52, 640
    s_add_u32 s58, s53, 640
    s_add_u32 s59, s54, 640
    s_add_u32 s60, s55, 640
    s_add_u32 s61, s56, 640
    v_and_b32 v21, 15, v20
    v_bfe_u32 v23, v20, 2, 2
    v_and_b32 v24, 3, v20
    s_mul_i32 s100, s28, 98304
    s_mul_i32 s101, s93, 6144
    v_add_u32 v26, 0, v20
    v_mul_u32_u24 v25, 2731, v26
    s_add_u32 m0, s38, 24576
    s_add_u32 s39, s52, s87
    buffer_load_dwordx4 v1, s[8:11], s39 offen lds
    v_lshrrev_b32 v25, 16, v25
    v_mul_u32_u24 v30, 24, v25
    v_sub_u32 v26, v26, v30
    v_bfe_u32 v27, v25, 1, 1
    v_lshlrev_b32 v27, 2, v27
    v_xor_b32 v27, v27, v26
    v_mul_u32_u24 v28, 12288, v25
    v_lshl_add_u32 v28, v27, 4, v28
    v_add_u32 v28, s100, v28
    v_subrev_u32 v2, 0, v28
    v_bfe_u32 v27, v25, 1, 2
    v_lshlrev_b32 v27, 1, v27
    s_add_u32 s39, s39, 9216
    buffer_load_dwordx4 v1, s[8:11], s39 offen offset:1024 lds
    v_xor_b32 v27, v27, v20
    v_lshlrev_b32 v27, 4, v27
    v_add_u32 v7, s101, v27
    v_add_u32 v26, 64, v20
    v_mul_u32_u24 v25, 2731, v26
    v_lshrrev_b32 v25, 16, v25
    v_mul_u32_u24 v30, 24, v25
    v_sub_u32 v26, v26, v30
    v_bfe_u32 v27, v25, 1, 1
    v_lshlrev_b32 v27, 2, v27
    v_xor_b32 v27, v27, v26
    v_mul_u32_u24 v28, 12288, v25
    s_add_u32 m0, s38, 32768
    s_add_u32 s39, s52, 81920
    buffer_load_dwordx4 v1, s[8:11], s39 offen lds
    v_lshl_add_u32 v28, v27, 4, v28
    v_add_u32 v28, s100, v28
    v_subrev_u32 v3, 1024, v28
    v_bfe_u32 v27, v25, 1, 2
    v_lshlrev_b32 v27, 1, v27
    v_xor_b32 v27, v27, v20
    v_lshlrev_b32 v27, 4, v27
    v_add_u32 v8, s101, v27
    v_add_u32 v26, 128, v20
    v_mul_u32_u24 v25, 2731, v26
    v_lshrrev_b32 v25, 16, v25
    v_mul_u32_u24 v30, 24, v25
    s_add_u32 s39, s39, 9216
    buffer_load_dwordx4 v1, s[8:11], s39 offen offset:1024 lds
    v_sub_u32 v26, v26, v30
    v_bfe_u32 v27, v25, 1, 1
    v_lshlrev_b32 v27, 2, v27
    v_xor_b32 v27, v27, v26
    v_mul_u32_u24 v28, 12288, v25
    v_lshl_add_u32 v28, v27, 4, v28
    v_add_u32 v28, s100, v28
    v_subrev_u32 v4, 2048, v28
    v_bfe_u32 v27, v25, 1, 2
    v_lshlrev_b32 v27, 1, v27
    v_xor_b32 v27, v27, v20
    v_lshlrev_b32 v27, 4, v27
    v_add_u32 v9, s101, v27
    s_add_u32 m0, s31, 0
    s_mul_i32 s32, s52, 6144
    buffer_load_dwordx4 v2, s[12:15], s32 offen lds
    s_lshl_b32 s100, s94, 5
    s_add_u32 s3, s100, s95
    s_mul_i32 s100, s3, 196608
    s_add_u32 s16, s66, s100
    s_addc_u32 s17, s67, 0
    s_mov_b32 s18, 196608
    s_mov_b32 s19, 0x20000
    s_add_u32 s20, s68, s100
    s_addc_u32 s21, s69, 0
    s_mov_b32 s22, 196608
    buffer_load_dwordx4 v3, s[12:15], s32 offen offset:1024 lds
    s_mov_b32 s23, 0x20000
    s_lshl_b32 s100, s90, 9
    s_add_u32 s100, s100, s3
    s_mul_i32 s100, s100, 61440
    s_mul_i32 s101, s93, 5120
    s_add_u32 s100, s100, s101
    s_add_u32 s100, s100, 0
    s_add_u32 s24, s88, s100
    s_addc_u32 s25, s89, 0
    s_mov_b32 s26, 56320
    buffer_load_dwordx4 v4, s[12:15], s32 offen offset:2048 lds
    s_mov_b32 s27, 0x20000
    s_mul_i32 s101, s98, 61440
    s_sub_u32 s100, s100, s101
    s_add_u32 s44, s88, s100
    s_addc_u32 s45, s89, 0
    s_mov_b32 s46, 486400
    s_mov_b32 s47, 0x20000
    s_lshl_b32 s3, s90, 3
    s_add_u32 s3, s3, s91
    s_lshl_b32 s100, s3, 4
    s_add_u32 m0, s31, 12320
    s_add_u32 s32, s32, 393216
    buffer_load_dwordx4 v2, s[12:15], s32 offen lds
    s_add_u32 s4, s86, s100
    s_addc_u32 s5, s5, 0
    s_mov_b32 s6, 0
    s_mov_b32 s7, 0x20000
    s_add_u32 s48, s88, 89128960
    s_addc_u32 s49, s89, 0
    s_mov_b32 s50, 0
    s_mov_b32 s51, 0x20000
    s_mul_i32 s100, s98, 320
    s_and_b32 s29, s98, 1
    buffer_load_dwordx4 v3, s[12:15], s32 offen offset:1024 lds
    s_lshl_b32 s101, s29, 6
    s_sub_u32 s100, s100, s101
    s_sub_u32 s101, 1966080, s100
    s_mul_i32 s30, s99, 1966080
    s_add_u32 s100, s100, s30
    s_add_u32 s64, s72, s100
    s_addc_u32 s65, s73, 0
    s_mov_b32 s66, s101
    s_mov_b32 s67, 0x20000
    s_lshl_b32 s3, s3, 2
    buffer_load_dwordx4 v4, s[12:15], s32 offen offset:2048 lds
    s_add_u32 s30, s3, s98
    s_mul_i32 s100, s30, 409600
    s_mul_i32 s101, s28, 25600
    s_add_u32 s100, s100, s101
    s_add_u32 s100, s100, 62914560
    s_add_u32 s68, s88, s100
    s_addc_u32 s69, s89, 0
    s_mov_b32 s70, 332800
    s_mov_b32 s71, 0x20000
    s_lshl_b32 s100, s94, 1
    s_add_u32 m0, s38, 40960
    s_add_u32 s39, s53, s0
    buffer_load_dwordx4 v1, s[8:11], s39 offen lds
    s_add_u32 s100, s100, s93
    s_mul_i32 s100, s100, 204800
    s_mul_i32 s101, s90, 1280
    s_add_u32 s100, s100, s101
    s_mul_i32 s101, s98, 320
    s_add_u32 s100, s100, s101
    s_add_u32 s72, s84, s100
    s_addc_u32 s73, s85, 0
    s_mov_b32 s74, 202560
    s_mov_b32 s75, 0x20000
    s_add_u32 s39, s39, 9216
    buffer_load_dwordx4 v1, s[8:11], s39 offen offset:1024 lds
    s_add_u32 s76, s88, 89128960
    s_addc_u32 s77, s89, 0
    s_mov_b32 s78, 0
    s_mov_b32 s79, 0x20000
    s_mov_b32 s80, s99
    s_mov_b32 s81, s29
    s_add_u32 s82, s3, s99
    s_lshl_b32 s82, s82, 7
    s_lshl_b32 s83, s30, 2
    s_add_u32 s83, s83, s28
    s_add_u32 m0, s38, 49152
    s_add_u32 s39, s53, s1
    buffer_load_dwordx4 v1, s[8:11], s39 offen lds
    s_lshl_b32 s83, s83, 7
    s_add_u32 s83, s83, 8192
    s_lshl_b32 s84, s98, 2
    s_add_u32 s84, s84, s82
    s_lshl_b32 s85, s99, 4
    s_add_u32 s85, s85, s83
    s_cmp_eq_u32 s28, 0
    s_cselect_b32 s37, 4, 0
    v_lshlrev_b32 v0, 4, v20
    v_mov_b32 v14, 0
    s_add_u32 s39, s39, 9216
    buffer_load_dwordx4 v1, s[8:11], s39 offen offset:1024 lds
    v_mov_b32 v36, 0
    v_mov_b32 v37, 0
    v_mov_b32 v38, 0
    v_mov_b32 v39, 0
    s_add_u32 s78, s84, s37
    buffer_store_dword v14, v0, s[76:79], s84 offen sc1
    s_add_u32 s78, s85, 16
    buffer_store_dwordx4 v[36:39], v0, s[76:79], s85 offen sc1
    s_mul_i32 s33, s28, 6144
    s_add_u32 s34, s33, 73728
    s_add_u32 m0, s38, 57344
    s_add_u32 s39, s53, s63
    buffer_load_dwordx4 v1, s[8:11], s39 offen lds
    s_add_u32 s33, s33, 0
    s_mov_b32 s42, 0x3dd53b95
    s_mov_b32 s43, 0x3dd53b95
    s_mov_b32 s30, 0
    v_lshlrev_b32 v25, 7, v21
    v_add_u32 v25, s38, v25
    v_bfe_u32 v26, v21, 1, 2
    v_lshlrev_b32 v26, 1, v26
    v_xor_b32 v26, v26, v22
    v_lshl_add_u32 v12, v26, 4, v25
    s_add_u32 s39, s39, 9216
    buffer_load_dwordx4 v1, s[8:11], s39 offen offset:1024 lds
    v_xor_b32 v13, 64, v12
    v_mov_b32 v14, 1
    v_mul_u32_u24 v25, 3080, v22
    v_mul_u32_u24 v26, 384, v23
    v_add_u32 v25, v25, v26
    v_add_u32 v25, 98304, v25
    v_lshrrev_b32 v26, 1, v23
    v_lshlrev_b32 v26, 2, v26
    v_or_b32 v27, 0, v24
    v_xor_b32 v27, v27, v26
    s_add_u32 m0, s31, 24640
    s_mul_i32 s32, s53, 6144
    buffer_load_dwordx4 v2, s[12:15], s32 offen lds
    v_lshl_add_u32 v5, v27, 4, v25
    v_or_b32 v27, 4, v24
    v_xor_b32 v27, v27, v26
    v_lshl_add_u32 v6, v27, 4, v25
    s_mul_i32 s100, s92, 12288
    s_add_u32 s101, s100, 73728
    s_add_u32 s100, s100, 0
    v_mul_u32_u24 v25, 384, v21
    v_add_u32 v25, s100, v25
    v_bfe_u32 v26, v21, 1, 2
    buffer_load_dwordx4 v3, s[12:15], s32 offen offset:1024 lds
    v_lshlrev_b32 v26, 1, v26
    v_xor_b32 v27, v22, v26
    v_lshl_add_u32 v10, v27, 4, v25
    v_lshrrev_b32 v28, 2, v20
    v_mul_u32_u24 v25, 384, v28
    v_add_u32 v25, s101, v25
    v_and_b32 v27, 1, v24
    v_lshl_add_u32 v25, v27, 3, v25
    v_bfe_u32 v26, v28, 1, 2
    v_lshlrev_b32 v26, 1, v26
    buffer_load_dwordx4 v4, s[12:15], s32 offen offset:2048 lds
    v_lshrrev_b32 v29, 1, v24
    v_xor_b32 v27, v29, v26
    v_lshl_add_u32 v11, v27, 4, v25
    s_mul_i32 s99, s2, 3
    s_lshr_b32 s99, s99, 6
    s_add_u32 s98, s99, 6
    s_sub_u32 s100, s98, 12
    s_cselect_b32 s98, s98, s100
    s_add_u32 s98, s98, 1
    s_add_u32 s99, s99, 1
    v_xor_b32 v13, 64, v12
    s_waitcnt vmcnt(14)
    ds_read_b128 a[60:63], v13 offset:0
    ds_read_b128 a[64:67], v13 offset:8192
    ds_read_b128 a[68:71], v13 offset:16384
    ds_read_b128 a[72:75], v13 offset:24576
    ds_read_b128 a[76:79], v13 offset:32768
    s_waitcnt vmcnt(11)
    s_waitcnt lgkmcnt(2)
    s_barrier
    ds_read_b64_tr_b16 a[240:241], v5 offset:0
    ds_read_b64_tr_b16 a[242:243], v5 offset:1536
    ds_read_b64_tr_b16 a[244:245], v5 offset:12320
    ds_read_b64_tr_b16 a[246:247], v5 offset:13856
    ds_read_b64_tr_b16 a[248:249], v5 offset:8
    ds_read_b64_tr_b16 a[250:251], v5 offset:1544
    ds_read_b64_tr_b16 a[252:253], v5 offset:12328
    ds_read_b64_tr_b16 a[254:255], v5 offset:13864
    ds_read_b128 a[20:23], v12 offset:0
    ds_read_b128 a[24:27], v12 offset:8192
    ds_read_b128 a[28:31], v12 offset:16384
    ds_read_b128 a[32:35], v12 offset:24576
    ds_read_b128 a[36:39], v12 offset:32768
    s_add_u32 m0, s31, 36960
    s_add_u32 s32, s32, 393216
    buffer_load_dwordx4 v2, s[12:15], s32 offen lds
    buffer_load_dwordx4 v3, s[12:15], s32 offen offset:1024 lds
    buffer_load_dwordx4 v4, s[12:15], s32 offen offset:2048 lds
L_q0:
    s_waitcnt lgkmcnt(0)
    v_mfma_f32_16x16x32_bf16 v[16:19], a[240:243], a[20:23], 0
    s_add_u32 m0, s38, 0
    ds_read_b64_tr_b16 a[12:13], v6 offset:0
    v_mfma_f32_16x16x32_bf16 v[16:19], a[244:247], a[60:63], v[16:19]
    s_add_u32 s39, s53, s87
    ds_read_b64_tr_b16 a[14:15], v6 offset:1536
    v_mfma_f32_16x16x32_bf16 v[24:27], a[244:247], a[64:67], 0
    v_mfma_f32_16x16x32_bf16 v[24:27], a[240:243], a[24:27], v[24:27]
    buffer_load_dwordx4 v1, s[8:11], s39 offen lds
    v_mfma_f32_16x16x32_bf16 v[32:35], a[240:243], a[28:31], 0
    v_mfma_f32_16x16x32_bf16 v[32:35], a[244:247], a[68:71], v[32:35]
    s_add_u32 s39, s39, 9216
    ds_read_b64_tr_b16 a[16:17], v6 offset:12320
    v_mfma_f32_16x16x32_bf16 v[40:43], a[244:247], a[72:75], 0
    ds_read_b64_tr_b16 a[18:19], v6 offset:13856
    v_mfma_f32_16x16x32_bf16 v[40:43], a[240:243], a[32:35], v[40:43]
    v_mfma_f32_16x16x32_bf16 v[48:51], a[240:243], a[36:39], 0
    buffer_load_dwordx4 v1, s[8:11], s39 offen offset:1024 lds
    v_mfma_f32_16x16x32_bf16 v[48:51], a[244:247], a[76:79], v[48:51]
    v_mfma_f32_16x16x32_bf16 v[52:55], a[252:255], a[76:79], 0
    s_add_u32 m0, s38, 8192
    ds_read_b64_tr_b16 a[240:241], v6 offset:8
    v_mfma_f32_16x16x32_bf16 v[52:55], a[248:251], a[36:39], v[52:55]
    s_add_u32 s39, s53, 81920
    ds_read_b64_tr_b16 a[242:243], v6 offset:1544
    v_mfma_f32_16x16x32_bf16 v[44:47], a[248:251], a[32:35], 0
    v_mfma_f32_16x16x32_bf16 v[44:47], a[252:255], a[72:75], v[44:47]
    buffer_load_dwordx4 v1, s[8:11], s39 offen lds
    v_mfma_f32_16x16x32_bf16 v[36:39], a[252:255], a[68:71], 0
    v_mfma_f32_16x16x32_bf16 v[36:39], a[248:251], a[28:31], v[36:39]
    s_add_u32 s39, s39, 9216
    ds_read_b64_tr_b16 a[244:245], v6 offset:12328
    v_mfma_f32_16x16x32_bf16 v[28:31], a[248:251], a[24:27], 0
    ds_read_b64_tr_b16 a[246:247], v6 offset:13864
    v_mfma_f32_16x16x32_bf16 v[28:31], a[252:255], a[64:67], v[28:31]
    v_mfma_f32_16x16x32_bf16 v[20:23], a[252:255], a[60:63], 0
    buffer_load_dwordx4 v1, s[8:11], s39 offen offset:1024 lds
    v_mfma_f32_16x16x32_bf16 v[20:23], a[248:251], a[20:23], v[20:23]
    s_waitcnt lgkmcnt(4)
    v_mfma_f32_16x16x32_bf16 v[56:59], a[12:15], a[20:23], 0
    s_add_u32 m0, s31, 49280
    ds_read_b64_tr_b16 a[248:249], v5 offset:128
    v_mfma_f32_16x16x32_bf16 v[56:59], a[16:19], a[60:63], v[56:59]
    s_mul_i32 s32, s54, 6144
    ds_read_b64_tr_b16 a[250:251], v5 offset:1664
    v_mfma_f32_16x16x32_bf16 v[64:67], a[16:19], a[64:67], 0
    v_mfma_f32_16x16x32_bf16 v[64:67], a[12:15], a[24:27], v[64:67]
    buffer_load_dwordx4 v2, s[12:15], s32 offen lds
    v_mfma_f32_16x16x32_bf16 v[72:75], a[12:15], a[28:31], 0
    v_mfma_f32_16x16x32_bf16 v[72:75], a[16:19], a[68:71], v[72:75]
    ds_read_b64_tr_b16 a[252:253], v5 offset:12448
    v_mfma_f32_16x16x32_bf16 v[80:83], a[16:19], a[72:75], 0
    ds_read_b64_tr_b16 a[254:255], v5 offset:13984
    v_mfma_f32_16x16x32_bf16 v[80:83], a[12:15], a[32:35], v[80:83]
    v_mfma_f32_16x16x32_bf16 v[88:91], a[12:15], a[36:39], 0
    buffer_load_dwordx4 v3, s[12:15], s32 offen offset:1024 lds
    v_mfma_f32_16x16x32_bf16 v[88:91], a[16:19], a[76:79], v[88:91]
    s_waitcnt lgkmcnt(4)
    v_mfma_f32_16x16x32_bf16 v[92:95], a[244:247], a[76:79], 0
    ds_read_b64_tr_b16 a[12:13], v5 offset:136
    v_mfma_f32_16x16x32_bf16 v[92:95], a[240:243], a[36:39], v[92:95]
    ds_read_b64_tr_b16 a[14:15], v5 offset:1672
    v_mfma_f32_16x16x32_bf16 v[84:87], a[240:243], a[32:35], 0
    s_waitcnt vmcnt(18)
    ds_read_b128 a[0:3], v12 offset:40960
    v_mfma_f32_16x16x32_bf16 v[84:87], a[244:247], a[72:75], v[84:87]
    buffer_load_dwordx4 v4, s[12:15], s32 offen offset:2048 lds
    v_mfma_f32_16x16x32_bf16 v[76:79], a[244:247], a[68:71], 0
    v_mfma_f32_16x16x32_bf16 v[76:79], a[240:243], a[28:31], v[76:79]
    s_add_u32 m0, s38, 16384
    ds_read_b64_tr_b16 a[16:17], v5 offset:12456
    v_mfma_f32_16x16x32_bf16 v[68:71], a[240:243], a[24:27], 0
    s_add_u32 s39, s54, s0
    ds_read_b64_tr_b16 a[18:19], v5 offset:13992
    v_mfma_f32_16x16x32_bf16 v[68:71], a[244:247], a[64:67], v[68:71]
    ds_read_b128 a[4:7], v13 offset:40960
    v_mfma_f32_16x16x32_bf16 v[60:63], a[244:247], a[60:63], 0
    buffer_load_dwordx4 v1, s[8:11], s39 offen lds
    v_mfma_f32_16x16x32_bf16 v[60:63], a[240:243], a[20:23], v[60:63]
    s_waitcnt lgkmcnt(6)
    v_mfma_f32_16x16x32_bf16 v[96:99], a[248:251], a[20:23], 0
    s_add_u32 s39, s39, 9216
    ds_read_b64_tr_b16 a[240:241], v6 offset:128
    v_mfma_f32_16x16x32_bf16 v[96:99], a[252:255], a[60:63], v[96:99]
    ds_read_b64_tr_b16 a[242:243], v6 offset:1664
    v_mfma_f32_16x16x32_bf16 v[104:107], a[252:255], a[64:67], 0
    s_waitcnt vmcnt(18)
    ds_read_b128 a[8:11], v12 offset:49152
    v_mfma_f32_16x16x32_bf16 v[104:107], a[248:251], a[24:27], v[104:107]
    buffer_load_dwordx4 v1, s[8:11], s39 offen offset:1024 lds
    v_mfma_f32_16x16x32_bf16 v[112:115], a[248:251], a[28:31], 0
    v_mfma_f32_16x16x32_bf16 v[112:115], a[252:255], a[68:71], v[112:115]
    s_add_u32 m0, s38, 24576
    ds_read_b64_tr_b16 a[244:245], v6 offset:12448
    v_mfma_f32_16x16x32_bf16 v[120:123], a[252:255], a[72:75], 0
    s_add_u32 s39, s54, s1
    ds_read_b64_tr_b16 a[246:247], v6 offset:13984
    v_mfma_f32_16x16x32_bf16 v[120:123], a[248:251], a[32:35], v[120:123]
    ds_read_b128 a[40:43], v13 offset:49152
    v_mfma_f32_16x16x32_bf16 v[128:131], a[248:251], a[36:39], 0
    buffer_load_dwordx4 v1, s[8:11], s39 offen lds
    v_mfma_f32_16x16x32_bf16 v[128:131], a[252:255], a[76:79], v[128:131]
    s_waitcnt lgkmcnt(7)
    v_mfma_f32_16x16x32_bf16 v[132:135], a[16:19], a[76:79], 0
    s_add_u32 s39, s39, 9216
    ds_read_b64_tr_b16 a[248:249], v6 offset:136
    v_mfma_f32_16x16x32_bf16 v[132:135], a[12:15], a[36:39], v[132:135]
    ds_read_b64_tr_b16 a[250:251], v6 offset:1672
    v_mfma_f32_16x16x32_bf16 v[124:127], a[12:15], a[32:35], 0
    s_waitcnt vmcnt(16)
    ds_read_b128 a[44:47], v12 offset:57344
    v_mfma_f32_16x16x32_bf16 v[124:127], a[16:19], a[72:75], v[124:127]
    buffer_load_dwordx4 v1, s[8:11], s39 offen offset:1024 lds
    v_mfma_f32_16x16x32_bf16 v[116:119], a[16:19], a[68:71], 0
    v_mfma_f32_16x16x32_bf16 v[116:119], a[12:15], a[28:31], v[116:119]
    s_add_u32 m0, s38, 32768
    ds_read_b64_tr_b16 a[252:253], v6 offset:12456
    v_mfma_f32_16x16x32_bf16 v[108:111], a[12:15], a[24:27], 0
    s_add_u32 s39, s54, s63
    ds_read_b64_tr_b16 a[254:255], v6 offset:13992
    v_mfma_f32_16x16x32_bf16 v[108:111], a[16:19], a[64:67], v[108:111]
    ds_read_b128 a[48:51], v13 offset:57344
    v_mfma_f32_16x16x32_bf16 v[100:103], a[16:19], a[60:63], 0
    buffer_load_dwordx4 v1, s[8:11], s39 offen lds
    v_mfma_f32_16x16x32_bf16 v[100:103], a[12:15], a[20:23], v[100:103]
    s_waitcnt lgkmcnt(7)
    v_mfma_f32_16x16x32_bf16 v[136:139], a[240:243], a[20:23], 0
    s_add_u32 s39, s39, 9216
    ds_read_b64_tr_b16 a[12:13], v5 offset:256
    v_mfma_f32_16x16x32_bf16 v[136:139], a[244:247], a[60:63], v[136:139]
    ds_read_b64_tr_b16 a[14:15], v5 offset:1792
    v_mfma_f32_16x16x32_bf16 v[144:147], a[244:247], a[64:67], 0
    v_mfma_f32_16x16x32_bf16 v[144:147], a[240:243], a[24:27], v[144:147]
    buffer_load_dwordx4 v1, s[8:11], s39 offen offset:1024 lds
    v_mfma_f32_16x16x32_bf16 v[152:155], a[240:243], a[28:31], 0
    v_mfma_f32_16x16x32_bf16 v[152:155], a[244:247], a[68:71], v[152:155]
    s_add_u32 m0, s38, 40960
    ds_read_b64_tr_b16 a[16:17], v5 offset:12576
    v_mfma_f32_16x16x32_bf16 v[160:163], a[244:247], a[72:75], 0
    s_add_u32 s39, s54, s87
    ds_read_b64_tr_b16 a[18:19], v5 offset:14112
    v_mfma_f32_16x16x32_bf16 v[160:163], a[240:243], a[32:35], v[160:163]
    v_mfma_f32_16x16x32_bf16 v[168:171], a[240:243], a[36:39], 0
    buffer_load_dwordx4 v1, s[8:11], s39 offen lds
    v_mfma_f32_16x16x32_bf16 v[168:171], a[244:247], a[76:79], v[168:171]
    s_waitcnt lgkmcnt(5)
    v_mfma_f32_16x16x32_bf16 v[172:175], a[252:255], a[76:79], 0
    s_add_u32 s39, s39, 9216
    ds_read_b64_tr_b16 a[240:241], v5 offset:264
    v_mfma_f32_16x16x32_bf16 v[172:175], a[248:251], a[36:39], v[172:175]
    ds_read_b64_tr_b16 a[242:243], v5 offset:1800
    v_mfma_f32_16x16x32_bf16 v[164:167], a[248:251], a[32:35], 0
    v_mfma_f32_16x16x32_bf16 v[164:167], a[252:255], a[72:75], v[164:167]
    buffer_load_dwordx4 v1, s[8:11], s39 offen offset:1024 lds
    v_mfma_f32_16x16x32_bf16 v[156:159], a[252:255], a[68:71], 0
    v_mfma_f32_16x16x32_bf16 v[156:159], a[248:251], a[28:31], v[156:159]
    s_add_u32 m0, s38, 49152
    ds_read_b64_tr_b16 a[244:245], v5 offset:12584
    v_mfma_f32_16x16x32_bf16 v[148:151], a[248:251], a[24:27], 0
    s_add_u32 s39, s54, 81920
    ds_read_b64_tr_b16 a[246:247], v5 offset:14120
    v_mfma_f32_16x16x32_bf16 v[148:151], a[252:255], a[64:67], v[148:151]
    v_mfma_f32_16x16x32_bf16 v[140:143], a[252:255], a[60:63], 0
    buffer_load_dwordx4 v1, s[8:11], s39 offen lds
    v_mfma_f32_16x16x32_bf16 v[140:143], a[248:251], a[20:23], v[140:143]
    s_waitcnt lgkmcnt(4)
    v_mfma_f32_16x16x32_bf16 v[176:179], a[12:15], a[20:23], 0
    s_add_u32 s39, s39, 9216
    ds_read_b64_tr_b16 a[248:249], v6 offset:256
    v_mfma_f32_16x16x32_bf16 v[176:179], a[16:19], a[60:63], v[176:179]
    ds_read_b64_tr_b16 a[250:251], v6 offset:1792
    v_mfma_f32_16x16x32_bf16 v[184:187], a[16:19], a[64:67], 0
    s_waitcnt vmcnt(14)
    ds_read_b128 a[52:55], v12 offset:0
    v_mfma_f32_16x16x32_bf16 v[184:187], a[12:15], a[24:27], v[184:187]
    buffer_load_dwordx4 v1, s[8:11], s39 offen offset:1024 lds
    v_mfma_f32_16x16x32_bf16 v[192:195], a[12:15], a[28:31], 0
    v_mfma_f32_16x16x32_bf16 v[192:195], a[16:19], a[68:71], v[192:195]
    s_add_u32 m0, s38, 57344
    ds_read_b64_tr_b16 a[252:253], v6 offset:12576
    v_mfma_f32_16x16x32_bf16 v[200:203], a[16:19], a[72:75], 0
    s_add_u32 s39, s55, s0
    ds_read_b64_tr_b16 a[254:255], v6 offset:14112
    v_mfma_f32_16x16x32_bf16 v[200:203], a[12:15], a[32:35], v[200:203]
    ds_read_b128 a[56:59], v13 offset:0
    v_mfma_f32_16x16x32_bf16 v[208:211], a[12:15], a[36:39], 0
    buffer_load_dwordx4 v1, s[8:11], s39 offen lds
    v_mfma_f32_16x16x32_bf16 v[208:211], a[16:19], a[76:79], v[208:211]
    s_waitcnt lgkmcnt(6)
    v_mfma_f32_16x16x32_bf16 v[212:215], a[244:247], a[76:79], 0
    s_add_u32 s39, s39, 9216
    ds_read_b64_tr_b16 a[12:13], v6 offset:264
    v_mfma_f32_16x16x32_bf16 v[212:215], a[240:243], a[36:39], v[212:215]
    ds_read_b64_tr_b16 a[14:15], v6 offset:1800
    v_mfma_f32_16x16x32_bf16 v[204:207], a[240:243], a[32:35], 0
    s_waitcnt vmcnt(14)
    ds_read_b128 a[80:83], v12 offset:8192
    v_mfma_f32_16x16x32_bf16 v[204:207], a[244:247], a[72:75], v[204:207]
    buffer_load_dwordx4 v1, s[8:11], s39 offen offset:1024 lds
    v_mfma_f32_16x16x32_bf16 v[196:199], a[244:247], a[68:71], 0
    v_mfma_f32_16x16x32_bf16 v[196:199], a[240:243], a[28:31], v[196:199]
    ds_read_b64_tr_b16 a[16:17], v6 offset:12584
    v_mfma_f32_16x16x32_bf16 v[188:191], a[240:243], a[24:27], 0
    ds_read_b64_tr_b16 a[18:19], v6 offset:14120
    v_mfma_f32_16x16x32_bf16 v[188:191], a[244:247], a[64:67], v[188:191]
    ds_read_b128 a[84:87], v13 offset:8192
    v_mfma_f32_16x16x32_bf16 v[180:183], a[244:247], a[60:63], 0
    v_mfma_f32_16x16x32_bf16 v[180:183], a[240:243], a[20:23], v[180:183]
    s_waitcnt lgkmcnt(7)
    s_waitcnt vmcnt(19)
    s_barrier
    v_mfma_f32_16x16x32_bf16 v[216:219], a[248:251], a[20:23], 0
    ds_read_b64_tr_b16 a[240:241], v5 offset:24640
    v_mfma_f32_16x16x32_bf16 v[216:219], a[252:255], a[60:63], v[216:219]
    ds_read_b64_tr_b16 a[242:243], v5 offset:26176
    v_mfma_f32_16x16x32_bf16 v[224:227], a[252:255], a[64:67], 0
    v_mfma_f32_16x16x32_bf16 v[224:227], a[248:251], a[24:27], v[224:227]
    v_mfma_f32_16x16x32_bf16 v[232:235], a[248:251], a[28:31], 0
    v_mfma_f32_16x16x32_bf16 v[232:235], a[252:255], a[68:71], v[232:235]
    ds_read_b64_tr_b16 a[244:245], v5 offset:36960
    v_mfma_f32_16x16x32_bf16 v[240:243], a[252:255], a[72:75], 0
    ds_read_b64_tr_b16 a[246:247], v5 offset:38496
    v_mfma_f32_16x16x32_bf16 v[240:243], a[248:251], a[32:35], v[240:243]
    v_mfma_f32_16x16x32_bf16 v[248:251], a[248:251], a[36:39], 0
    v_mfma_f32_16x16x32_bf16 v[248:251], a[252:255], a[76:79], v[248:251]
    s_waitcnt lgkmcnt(5)
    s_barrier
    v_mfma_f32_16x16x32_bf16 v[252:255], a[16:19], a[76:79], 0
    s_add_u32 m0, s31, 0
    ds_read_b64_tr_b16 a[248:249], v5 offset:24648
    v_mfma_f32_16x16x32_bf16 v[252:255], a[12:15], a[36:39], v[252:255]
    s_add_u32 s32, s32, 393216
    ds_read_b64_tr_b16 a[250:251], v5 offset:26184
    v_mfma_f32_16x16x32_bf16 v[244:247], a[12:15], a[32:35], 0
    v_mfma_f32_16x16x32_bf16 v[244:247], a[16:19], a[72:75], v[244:247]
    buffer_load_dwordx4 v2, s[12:15], s32 offen lds
    v_mfma_f32_16x16x32_bf16 v[236:239], a[16:19], a[68:71], 0
    v_mfma_f32_16x16x32_bf16 v[236:239], a[12:15], a[28:31], v[236:239]
    ds_read_b64_tr_b16 a[252:253], v5 offset:36968
    v_mfma_f32_16x16x32_bf16 v[228:231], a[12:15], a[24:27], 0
    ds_read_b64_tr_b16 a[254:255], v5 offset:38504
    v_mfma_f32_16x16x32_bf16 v[228:231], a[16:19], a[64:67], v[228:231]
    s_waitcnt vmcnt(11)
    ds_read_b128 a[88:91], v12 offset:16384
    v_mfma_f32_16x16x32_bf16 v[220:223], a[16:19], a[60:63], 0
    buffer_load_dwordx4 v3, s[12:15], s32 offen offset:1024 lds
    v_mfma_f32_16x16x32_bf16 v[220:223], a[12:15], a[20:23], v[220:223]
    s_waitcnt lgkmcnt(5)
    v_mfma_f32_16x16x32_bf16 v[16:19], a[240:243], a[0:3], v[16:19]
    ds_read_b64_tr_b16 a[12:13], v6 offset:24640
    v_mfma_f32_16x16x32_bf16 v[16:19], a[244:247], a[4:7], v[16:19]
    ds_read_b64_tr_b16 a[14:15], v6 offset:26176
    v_mfma_f32_16x16x32_bf16 v[24:27], a[244:247], a[40:43], v[24:27]
    ds_read_b128 a[92:95], v13 offset:16384
    v_mfma_f32_16x16x32_bf16 v[24:27], a[240:243], a[8:11], v[24:27]
    buffer_load_dwordx4 v4, s[12:15], s32 offen offset:2048 lds
    v_mfma_f32_16x16x32_bf16 v[32:35], a[240:243], a[44:47], v[32:35]
    v_mfma_f32_16x16x32_bf16 v[32:35], a[244:247], a[48:51], v[32:35]
    s_add_u32 m0, s31, 12320
    ds_read_b64_tr_b16 a[16:17], v6 offset:36960
    v_mfma_f32_16x16x32_bf16 v[40:43], a[244:247], a[56:59], v[40:43]
    s_mul_i32 s32, s55, 6144
    ds_read_b64_tr_b16 a[18:19], v6 offset:38496
    v_mfma_f32_16x16x32_bf16 v[40:43], a[240:243], a[52:55], v[40:43]
    s_waitcnt vmcnt(11)
    ds_read_b128 a[96:99], v12 offset:24576
    v_mfma_f32_16x16x32_bf16 v[48:51], a[240:243], a[80:83], v[48:51]
    buffer_load_dwordx4 v2, s[12:15], s32 offen lds
    v_mfma_f32_16x16x32_bf16 v[48:51], a[244:247], a[84:87], v[48:51]
    s_waitcnt lgkmcnt(7)
    v_mfma_f32_16x16x32_bf16 v[52:55], a[252:255], a[84:87], v[52:55]
    ds_read_b64_tr_b16 a[240:241], v6 offset:24648
    v_mfma_f32_16x16x32_bf16 v[52:55], a[248:251], a[80:83], v[52:55]
    ds_read_b64_tr_b16 a[242:243], v6 offset:26184
    v_mfma_f32_16x16x32_bf16 v[44:47], a[248:251], a[52:55], v[44:47]
    ds_read_b128 a[100:103], v13 offset:24576
    v_mfma_f32_16x16x32_bf16 v[44:47], a[252:255], a[56:59], v[44:47]
    buffer_load_dwordx4 v3, s[12:15], s32 offen offset:1024 lds
    v_mfma_f32_16x16x32_bf16 v[36:39], a[252:255], a[48:51], v[36:39]
    v_mfma_f32_16x16x32_bf16 v[36:39], a[248:251], a[44:47], v[36:39]
    ds_read_b64_tr_b16 a[244:245], v6 offset:36968
    v_mfma_f32_16x16x32_bf16 v[28:31], a[248:251], a[8:11], v[28:31]
    ds_read_b64_tr_b16 a[246:247], v6 offset:38504
    v_mfma_f32_16x16x32_bf16 v[28:31], a[252:255], a[40:43], v[28:31]
    s_waitcnt vmcnt(11)
    ds_read_b128 a[104:107], v12 offset:32768
    v_mfma_f32_16x16x32_bf16 v[20:23], a[252:255], a[4:7], v[20:23]
    buffer_load_dwordx4 v4, s[12:15], s32 offen offset:2048 lds
    v_mfma_f32_16x16x32_bf16 v[20:23], a[248:251], a[0:3], v[20:23]
    s_waitcnt lgkmcnt(7)
    v_mfma_f32_16x16x32_bf16 v[56:59], a[12:15], a[0:3], v[56:59]
    s_add_u32 m0, s38, 0
    ds_read_b64_tr_b16 a[248:249], v5 offset:24768
    v_mfma_f32_16x16x32_bf16 v[56:59], a[16:19], a[4:7], v[56:59]
    s_add_u32 s39, s55, s1
    ds_read_b64_tr_b16 a[250:251], v5 offset:26304
    v_mfma_f32_16x16x32_bf16 v[64:67], a[16:19], a[40:43], v[64:67]
    ds_read_b128 a[108:111], v13 offset:32768
    v_mfma_f32_16x16x32_bf16 v[64:67], a[12:15], a[8:11], v[64:67]
    buffer_load_dwordx4 v1, s[8:11], s39 offen lds
    v_mfma_f32_16x16x32_bf16 v[72:75], a[12:15], a[44:47], v[72:75]
    v_mfma_f32_16x16x32_bf16 v[72:75], a[16:19], a[48:51], v[72:75]
    s_add_u32 s39, s39, 9216
    ds_read_b64_tr_b16 a[252:253], v5 offset:37088
    v_mfma_f32_16x16x32_bf16 v[80:83], a[16:19], a[56:59], v[80:83]
    ds_read_b64_tr_b16 a[254:255], v5 offset:38624
    v_mfma_f32_16x16x32_bf16 v[80:83], a[12:15], a[52:55], v[80:83]
    s_waitcnt vmcnt(11)
    ds_read_b128 a[112:115], v12 offset:40960
    v_mfma_f32_16x16x32_bf16 v[88:91], a[12:15], a[80:83], v[88:91]
    buffer_load_dwordx4 v1, s[8:11], s39 offen offset:1024 lds
    v_mfma_f32_16x16x32_bf16 v[88:91], a[16:19], a[84:87], v[88:91]
    s_waitcnt lgkmcnt(7)
    v_mfma_f32_16x16x32_bf16 v[92:95], a[244:247], a[84:87], v[92:95]
    s_add_u32 m0, s38, 8192
    ds_read_b64_tr_b16 a[12:13], v5 offset:24776
    v_mfma_f32_16x16x32_bf16 v[92:95], a[240:243], a[80:83], v[92:95]
    s_add_u32 s39, s55, s63
    ds_read_b64_tr_b16 a[14:15], v5 offset:26312
    v_mfma_f32_16x16x32_bf16 v[84:87], a[240:243], a[52:55], v[84:87]
    ds_read_b128 a[116:119], v13 offset:40960
    v_mfma_f32_16x16x32_bf16 v[84:87], a[244:247], a[56:59], v[84:87]
    buffer_load_dwordx4 v1, s[8:11], s39 offen lds
    v_mfma_f32_16x16x32_bf16 v[76:79], a[244:247], a[48:51], v[76:79]
    v_mfma_f32_16x16x32_bf16 v[76:79], a[240:243], a[44:47], v[76:79]
    s_add_u32 s39, s39, 9216
    ds_read_b64_tr_b16 a[16:17], v5 offset:37096
    v_mfma_f32_16x16x32_bf16 v[68:71], a[240:243], a[8:11], v[68:71]
    ds_read_b64_tr_b16 a[18:19], v5 offset:38632
    v_mfma_f32_16x16x32_bf16 v[68:71], a[244:247], a[40:43], v[68:71]
    s_waitcnt vmcnt(11)
    ds_read_b128 a[120:123], v12 offset:49152
    v_mfma_f32_16x16x32_bf16 v[60:63], a[244:247], a[4:7], v[60:63]
    buffer_load_dwordx4 v1, s[8:11], s39 offen offset:1024 lds
    v_mfma_f32_16x16x32_bf16 v[60:63], a[240:243], a[0:3], v[60:63]
    s_waitcnt lgkmcnt(7)
    v_mfma_f32_16x16x32_bf16 v[96:99], a[248:251], a[0:3], v[96:99]
    s_add_u32 m0, s38, 16384
    ds_read_b64_tr_b16 a[240:241], v6 offset:24768
    v_mfma_f32_16x16x32_bf16 v[96:99], a[252:255], a[4:7], v[96:99]
    s_add_u32 s39, s55, s87
    ds_read_b64_tr_b16 a[242:243], v6 offset:26304
    v_mfma_f32_16x16x32_bf16 v[104:107], a[252:255], a[40:43], v[104:107]
    ds_read_b128 a[124:127], v13 offset:49152
    v_mfma_f32_16x16x32_bf16 v[104:107], a[248:251], a[8:11], v[104:107]
    buffer_load_dwordx4 v1, s[8:11], s39 offen lds
    v_mfma_f32_16x16x32_bf16 v[112:115], a[248:251], a[44:47], v[112:115]
    v_mfma_f32_16x16x32_bf16 v[112:115], a[252:255], a[48:51], v[112:115]
    s_add_u32 s39, s39, 9216
    ds_read_b64_tr_b16 a[244:245], v6 offset:37088
    v_mfma_f32_16x16x32_bf16 v[120:123], a[252:255], a[56:59], v[120:123]
    ds_read_b64_tr_b16 a[246:247], v6 offset:38624
    v_mfma_f32_16x16x32_bf16 v[120:123], a[248:251], a[52:55], v[120:123]
    s_waitcnt vmcnt(11)
    ds_read_b128 a[128:131], v12 offset:57344
    v_mfma_f32_16x16x32_bf16 v[128:131], a[248:251], a[80:83], v[128:131]
    buffer_load_dwordx4 v1, s[8:11], s39 offen offset:1024 lds
    v_mfma_f32_16x16x32_bf16 v[128:131], a[252:255], a[84:87], v[128:131]
    s_waitcnt lgkmcnt(7)
    v_mfma_f32_16x16x32_bf16 v[132:135], a[16:19], a[84:87], v[132:135]
    s_add_u32 m0, s38, 24576
    ds_read_b64_tr_b16 a[248:249], v6 offset:24776
    v_mfma_f32_16x16x32_bf16 v[132:135], a[12:15], a[80:83], v[132:135]
    s_add_u32 s39, s55, 81920
    ds_read_b64_tr_b16 a[250:251], v6 offset:26312
    v_mfma_f32_16x16x32_bf16 v[124:127], a[12:15], a[52:55], v[124:127]
    ds_read_b128 a[132:135], v13 offset:57344
    v_mfma_f32_16x16x32_bf16 v[124:127], a[16:19], a[56:59], v[124:127]
    buffer_load_dwordx4 v1, s[8:11], s39 offen lds
    v_mfma_f32_16x16x32_bf16 v[116:119], a[16:19], a[48:51], v[116:119]
    v_mfma_f32_16x16x32_bf16 v[116:119], a[12:15], a[44:47], v[116:119]
    s_add_u32 s39, s39, 9216
    ds_read_b64_tr_b16 a[252:253], v6 offset:37096
    v_mfma_f32_16x16x32_bf16 v[108:111], a[12:15], a[8:11], v[108:111]
    ds_read_b64_tr_b16 a[254:255], v6 offset:38632
    v_mfma_f32_16x16x32_bf16 v[108:111], a[16:19], a[40:43], v[108:111]
    v_mfma_f32_16x16x32_bf16 v[100:103], a[16:19], a[4:7], v[100:103]
    buffer_load_dwordx4 v1, s[8:11], s39 offen offset:1024 lds
    v_mfma_f32_16x16x32_bf16 v[100:103], a[12:15], a[0:3], v[100:103]
    s_waitcnt lgkmcnt(6)
    v_mfma_f32_16x16x32_bf16 v[136:139], a[240:243], a[0:3], v[136:139]
    s_add_u32 m0, s34, 0
    ds_read_b64_tr_b16 a[12:13], v5 offset:24896
    v_mfma_f32_16x16x32_bf16 v[136:139], a[244:247], a[4:7], v[136:139]
    s_mov_b32 s36, 0
    ds_read_b64_tr_b16 a[14:15], v5 offset:26432
    v_mfma_f32_16x16x32_bf16 v[144:147], a[244:247], a[40:43], v[144:147]
    v_mfma_f32_16x16x32_bf16 v[144:147], a[240:243], a[8:11], v[144:147]
    buffer_load_dwordx4 v7, s[20:23], s36 offen nt lds
    v_mfma_f32_16x16x32_bf16 v[152:155], a[240:243], a[44:47], v[152:155]
    v_mfma_f32_16x16x32_bf16 v[152:155], a[244:247], a[48:51], v[152:155]
    s_add_u32 m0, s34, 0
    ds_read_b64_tr_b16 a[16:17], v5 offset:37216
    v_mfma_f32_16x16x32_bf16 v[160:163], a[244:247], a[56:59], v[160:163]
    s_mov_b32 s36, 0
    ds_read_b64_tr_b16 a[18:19], v5 offset:38752
    v_mfma_f32_16x16x32_bf16 v[160:163], a[240:243], a[52:55], v[160:163]
    v_mfma_f32_16x16x32_bf16 v[168:171], a[240:243], a[80:83], v[168:171]
    buffer_load_dwordx4 v8, s[20:23], s36 offen offset:1024 nt lds
    v_mfma_f32_16x16x32_bf16 v[168:171], a[244:247], a[84:87], v[168:171]
    s_waitcnt lgkmcnt(4)
    v_mfma_f32_16x16x32_bf16 v[172:175], a[252:255], a[84:87], v[172:175]
    s_add_u32 m0, s34, 0
    ds_read_b64_tr_b16 a[240:241], v5 offset:24904
    v_mfma_f32_16x16x32_bf16 v[172:175], a[248:251], a[80:83], v[172:175]
    s_mov_b32 s36, 0
    ds_read_b64_tr_b16 a[242:243], v5 offset:26440
    v_mfma_f32_16x16x32_bf16 v[164:167], a[248:251], a[52:55], v[164:167]
    v_mfma_f32_16x16x32_bf16 v[164:167], a[252:255], a[56:59], v[164:167]
    buffer_load_dwordx4 v9, s[20:23], s36 offen offset:2048 nt lds
    v_mfma_f32_16x16x32_bf16 v[156:159], a[252:255], a[48:51], v[156:159]
    v_mfma_f32_16x16x32_bf16 v[156:159], a[248:251], a[44:47], v[156:159]
    s_add_u32 m0, s34, 3072
    ds_read_b64_tr_b16 a[244:245], v5 offset:37224
    v_mfma_f32_16x16x32_bf16 v[148:151], a[248:251], a[8:11], v[148:151]
    s_mov_b32 s36, 3072
    ds_read_b64_tr_b16 a[246:247], v5 offset:38760
    v_mfma_f32_16x16x32_bf16 v[148:151], a[252:255], a[40:43], v[148:151]
    v_mfma_f32_16x16x32_bf16 v[140:143], a[252:255], a[4:7], v[140:143]
    buffer_load_dwordx4 v7, s[20:23], s36 offen nt lds
    v_mfma_f32_16x16x32_bf16 v[140:143], a[248:251], a[0:3], v[140:143]
    s_waitcnt lgkmcnt(4)
    v_mfma_f32_16x16x32_bf16 v[176:179], a[12:15], a[0:3], v[176:179]
    s_add_u32 m0, s34, 3072
    ds_read_b64_tr_b16 a[248:249], v6 offset:24896
    v_mfma_f32_16x16x32_bf16 v[176:179], a[16:19], a[4:7], v[176:179]
    s_mov_b32 s36, 3072
    ds_read_b64_tr_b16 a[250:251], v6 offset:26432
    v_mfma_f32_16x16x32_bf16 v[184:187], a[16:19], a[40:43], v[184:187]
    v_mfma_f32_16x16x32_bf16 v[184:187], a[12:15], a[8:11], v[184:187]
    buffer_load_dwordx4 v8, s[20:23], s36 offen offset:1024 nt lds
    v_mfma_f32_16x16x32_bf16 v[192:195], a[12:15], a[44:47], v[192:195]
    v_mfma_f32_16x16x32_bf16 v[192:195], a[16:19], a[48:51], v[192:195]
    s_add_u32 m0, s34, 3072
    ds_read_b64_tr_b16 a[252:253], v6 offset:37216
    v_mfma_f32_16x16x32_bf16 v[200:203], a[16:19], a[56:59], v[200:203]
    s_mov_b32 s36, 3072
    ds_read_b64_tr_b16 a[254:255], v6 offset:38752
    v_mfma_f32_16x16x32_bf16 v[200:203], a[12:15], a[52:55], v[200:203]
    v_mfma_f32_16x16x32_bf16 v[208:211], a[12:15], a[80:83], v[208:211]
    buffer_load_dwordx4 v9, s[20:23], s36 offen offset:2048 nt lds
    v_mfma_f32_16x16x32_bf16 v[208:211], a[16:19], a[84:87], v[208:211]
    s_waitcnt lgkmcnt(4)
    v_mfma_f32_16x16x32_bf16 v[212:215], a[244:247], a[84:87], v[212:215]
    s_add_u32 m0, s38, 32768
    ds_read_b64_tr_b16 a[12:13], v6 offset:24904
    v_mfma_f32_16x16x32_bf16 v[212:215], a[240:243], a[80:83], v[212:215]
    s_add_u32 s39, s56, s0
    ds_read_b64_tr_b16 a[14:15], v6 offset:26440
    v_mfma_f32_16x16x32_bf16 v[204:207], a[240:243], a[52:55], v[204:207]
    v_mfma_f32_16x16x32_bf16 v[204:207], a[244:247], a[56:59], v[204:207]
    buffer_load_dwordx4 v1, s[8:11], s39 offen lds
    v_mfma_f32_16x16x32_bf16 v[196:199], a[244:247], a[48:51], v[196:199]
    v_mfma_f32_16x16x32_bf16 v[196:199], a[240:243], a[44:47], v[196:199]
    s_add_u32 s39, s39, 9216
    ds_read_b64_tr_b16 a[16:17], v6 offset:37224
    v_mfma_f32_16x16x32_bf16 v[188:191], a[240:243], a[8:11], v[188:191]
    ds_read_b64_tr_b16 a[18:19], v6 offset:38760
    v_mfma_f32_16x16x32_bf16 v[188:191], a[244:247], a[40:43], v[188:191]
    v_mfma_f32_16x16x32_bf16 v[180:183], a[244:247], a[4:7], v[180:183]
    buffer_load_dwordx4 v1, s[8:11], s39 offen offset:1024 lds
    v_mfma_f32_16x16x32_bf16 v[180:183], a[240:243], a[0:3], v[180:183]
    s_waitcnt lgkmcnt(4)
    s_waitcnt vmcnt(19)
    s_barrier
    v_mfma_f32_16x16x32_bf16 v[216:219], a[248:251], a[0:3], v[216:219]
    s_add_u32 m0, s38, 40960
    ds_read_b64_tr_b16 a[240:241], v5 offset:49280
    v_mfma_f32_16x16x32_bf16 v[216:219], a[252:255], a[4:7], v[216:219]
    s_add_u32 s39, s56, s1
    ds_read_b64_tr_b16 a[242:243], v5 offset:50816
    v_mfma_f32_16x16x32_bf16 v[224:227], a[252:255], a[40:43], v[224:227]
    s_waitcnt vmcnt(14)
    ds_read_b128 a[136:139], v12 offset:0
    v_mfma_f32_16x16x32_bf16 v[224:227], a[248:251], a[8:11], v[224:227]
    buffer_load_dwordx4 v1, s[8:11], s39 offen lds
    v_mfma_f32_16x16x32_bf16 v[232:235], a[248:251], a[44:47], v[232:235]
    v_mfma_f32_16x16x32_bf16 v[232:235], a[252:255], a[48:51], v[232:235]
    s_add_u32 s39, s39, 9216
    ds_read_b64_tr_b16 a[244:245], v5 offset:0
    v_mfma_f32_16x16x32_bf16 v[240:243], a[252:255], a[56:59], v[240:243]
    ds_read_b64_tr_b16 a[246:247], v5 offset:1536
    v_mfma_f32_16x16x32_bf16 v[240:243], a[248:251], a[52:55], v[240:243]
    ds_read_b128 a[140:143], v13 offset:0
    v_mfma_f32_16x16x32_bf16 v[248:251], a[248:251], a[80:83], v[248:251]
    buffer_load_dwordx4 v1, s[8:11], s39 offen offset:1024 lds
    v_mfma_f32_16x16x32_bf16 v[248:251], a[252:255], a[84:87], v[248:251]
    s_waitcnt lgkmcnt(6)
    s_barrier
    v_mfma_f32_16x16x32_bf16 v[252:255], a[16:19], a[84:87], v[252:255]
    s_add_u32 m0, s31, 24640
    ds_read_b64_tr_b16 a[248:249], v5 offset:49288
    v_mfma_f32_16x16x32_bf16 v[252:255], a[12:15], a[80:83], v[252:255]
    s_add_u32 s32, s32, 393216
    ds_read_b64_tr_b16 a[250:251], v5 offset:50824
    v_mfma_f32_16x16x32_bf16 v[244:247], a[12:15], a[52:55], v[244:247]
    s_waitcnt vmcnt(14)
    ds_read_b128 a[144:147], v12 offset:8192
    v_mfma_f32_16x16x32_bf16 v[244:247], a[16:19], a[56:59], v[244:247]
    buffer_load_dwordx4 v2, s[12:15], s32 offen lds
    v_mfma_f32_16x16x32_bf16 v[236:239], a[16:19], a[48:51], v[236:239]
    v_mfma_f32_16x16x32_bf16 v[236:239], a[12:15], a[44:47], v[236:239]
    ds_read_b64_tr_b16 a[252:253], v5 offset:8
    v_mfma_f32_16x16x32_bf16 v[228:231], a[12:15], a[8:11], v[228:231]
    ds_read_b64_tr_b16 a[254:255], v5 offset:1544
    v_mfma_f32_16x16x32_bf16 v[228:231], a[16:19], a[40:43], v[228:231]
    ds_read_b128 a[148:151], v13 offset:8192
    v_mfma_f32_16x16x32_bf16 v[220:223], a[16:19], a[4:7], v[220:223]
    buffer_load_dwordx4 v3, s[12:15], s32 offen offset:1024 lds
    v_mfma_f32_16x16x32_bf16 v[220:223], a[12:15], a[0:3], v[220:223]
    s_waitcnt lgkmcnt(7)
    v_mfma_f32_16x16x32_bf16 v[16:19], a[240:243], a[88:91], v[16:19]
    ds_read_b64_tr_b16 a[12:13], v6 offset:49280
    v_mfma_f32_16x16x32_bf16 v[16:19], a[244:247], a[92:95], v[16:19]
    ds_read_b64_tr_b16 a[14:15], v6 offset:50816
    v_mfma_f32_16x16x32_bf16 v[24:27], a[244:247], a[100:103], v[24:27]
    s_waitcnt vmcnt(14)
    ds_read_b128 a[152:155], v12 offset:16384
    v_mfma_f32_16x16x32_bf16 v[24:27], a[240:243], a[96:99], v[24:27]
    buffer_load_dwordx4 v4, s[12:15], s32 offen offset:2048 lds
    v_mfma_f32_16x16x32_bf16 v[32:35], a[240:243], a[104:107], v[32:35]
    v_mfma_f32_16x16x32_bf16 v[32:35], a[244:247], a[108:111], v[32:35]
    s_add_u32 m0, s31, 36960
    ds_read_b64_tr_b16 a[16:17], v6 offset:0
    v_mfma_f32_16x16x32_bf16 v[40:43], a[244:247], a[116:119], v[40:43]
    s_mul_i32 s32, s56, 6144
    ds_read_b64_tr_b16 a[18:19], v6 offset:1536
    v_mfma_f32_16x16x32_bf16 v[40:43], a[240:243], a[112:115], v[40:43]
    ds_read_b128 a[156:159], v13 offset:16384
    v_mfma_f32_16x16x32_bf16 v[48:51], a[240:243], a[120:123], v[48:51]
    buffer_load_dwordx4 v2, s[12:15], s32 offen lds
    v_mfma_f32_16x16x32_bf16 v[48:51], a[244:247], a[124:127], v[48:51]
    s_waitcnt lgkmcnt(7)
    v_mfma_f32_16x16x32_bf16 v[52:55], a[252:255], a[124:127], v[52:55]
    ds_read_b64_tr_b16 a[240:241], v6 offset:49288
    v_mfma_f32_16x16x32_bf16 v[52:55], a[248:251], a[120:123], v[52:55]
    ds_read_b64_tr_b16 a[242:243], v6 offset:50824
    v_mfma_f32_16x16x32_bf16 v[44:47], a[248:251], a[112:115], v[44:47]
    s_waitcnt vmcnt(14)
    ds_read_b128 a[160:163], v12 offset:24576
    v_mfma_f32_16x16x32_bf16 v[44:47], a[252:255], a[116:119], v[44:47]
    buffer_load_dwordx4 v3, s[12:15], s32 offen offset:1024 lds
    v_mfma_f32_16x16x32_bf16 v[36:39], a[252:255], a[108:111], v[36:39]
    v_mfma_f32_16x16x32_bf16 v[36:39], a[248:251], a[104:107], v[36:39]
    ds_read_b64_tr_b16 a[244:245], v6 offset:8
    v_mfma_f32_16x16x32_bf16 v[28:31], a[248:251], a[96:99], v[28:31]
    ds_read_b64_tr_b16 a[246:247], v6 offset:1544
    v_mfma_f32_16x16x32_bf16 v[28:31], a[252:255], a[100:103], v[28:31]
    ds_read_b128 a[164:167], v13 offset:24576
    v_mfma_f32_16x16x32_bf16 v[20:23], a[252:255], a[92:95], v[20:23]
    buffer_load_dwordx4 v4, s[12:15], s32 offen offset:2048 lds
    v_mfma_f32_16x16x32_bf16 v[20:23], a[248:251], a[88:91], v[20:23]
    s_waitcnt lgkmcnt(7)
    v_mfma_f32_16x16x32_bf16 v[56:59], a[12:15], a[88:91], v[56:59]
    s_add_u32 m0, s38, 49152
    ds_read_b64_tr_b16 a[248:249], v5 offset:49408
    v_mfma_f32_16x16x32_bf16 v[56:59], a[16:19], a[92:95], v[56:59]
    s_add_u32 s39, s56, s63
    ds_read_b64_tr_b16 a[250:251], v5 offset:50944
    v_mfma_f32_16x16x32_bf16 v[64:67], a[16:19], a[100:103], v[64:67]
    v_mfma_f32_16x16x32_bf16 v[64:67], a[12:15], a[96:99], v[64:67]
    buffer_load_dwordx4 v1, s[8:11], s39 offen lds
    v_mfma_f32_16x16x32_bf16 v[72:75], a[12:15], a[104:107], v[72:75]
    v_mfma_f32_16x16x32_bf16 v[72:75], a[16:19], a[108:111], v[72:75]
    s_add_u32 s39, s39, 9216
    ds_read_b64_tr_b16 a[252:253], v5 offset:128
    v_mfma_f32_16x16x32_bf16 v[80:83], a[16:19], a[116:119], v[80:83]
    ds_read_b64_tr_b16 a[254:255], v5 offset:1664
    v_mfma_f32_16x16x32_bf16 v[80:83], a[12:15], a[112:115], v[80:83]
    v_mfma_f32_16x16x32_bf16 v[88:91], a[12:15], a[120:123], v[88:91]
    buffer_load_dwordx4 v1, s[8:11], s39 offen offset:1024 lds
    v_mfma_f32_16x16x32_bf16 v[88:91], a[16:19], a[124:127], v[88:91]
    s_waitcnt lgkmcnt(5)
    v_mfma_f32_16x16x32_bf16 v[92:95], a[244:247], a[124:127], v[92:95]
    s_add_u32 m0, s38, 57344
    ds_read_b64_tr_b16 a[12:13], v5 offset:49416
    v_mfma_f32_16x16x32_bf16 v[92:95], a[240:243], a[120:123], v[92:95]
    s_add_u32 s39, s56, s87
    ds_read_b64_tr_b16 a[14:15], v5 offset:50952
    v_mfma_f32_16x16x32_bf16 v[84:87], a[240:243], a[112:115], v[84:87]
    v_mfma_f32_16x16x32_bf16 v[84:87], a[244:247], a[116:119], v[84:87]
    buffer_load_dwordx4 v1, s[8:11], s39 offen lds
    v_mfma_f32_16x16x32_bf16 v[76:79], a[244:247], a[108:111], v[76:79]
    v_mfma_f32_16x16x32_bf16 v[76:79], a[240:243], a[104:107], v[76:79]
    s_add_u32 s39, s39, 9216
    ds_read_b64_tr_b16 a[16:17], v5 offset:136
    v_mfma_f32_16x16x32_bf16 v[68:71], a[240:243], a[96:99], v[68:71]
    ds_read_b64_tr_b16 a[18:19], v5 offset:1672
    v_mfma_f32_16x16x32_bf16 v[68:71], a[244:247], a[100:103], v[68:71]
    v_mfma_f32_16x16x32_bf16 v[60:63], a[244:247], a[92:95], v[60:63]
    buffer_load_dwordx4 v1, s[8:11], s39 offen offset:1024 lds
    v_mfma_f32_16x16x32_bf16 v[60:63], a[240:243], a[88:91], v[60:63]
    s_waitcnt lgkmcnt(4)
    v_mfma_f32_16x16x32_bf16 v[96:99], a[248:251], a[88:91], v[96:99]
    s_add_u32 m0, s38, 0
    ds_read_b64_tr_b16 a[240:241], v6 offset:49408
    v_mfma_f32_16x16x32_bf16 v[96:99], a[252:255], a[92:95], v[96:99]
    s_add_u32 s39, s56, 81920
    ds_read_b64_tr_b16 a[242:243], v6 offset:50944
    v_mfma_f32_16x16x32_bf16 v[104:107], a[252:255], a[100:103], v[104:107]
    v_mfma_f32_16x16x32_bf16 v[104:107], a[248:251], a[96:99], v[104:107]
    buffer_load_dwordx4 v1, s[8:11], s39 offen lds
    v_mfma_f32_16x16x32_bf16 v[112:115], a[248:251], a[104:107], v[112:115]
    v_mfma_f32_16x16x32_bf16 v[112:115], a[252:255], a[108:111], v[112:115]
    s_add_u32 s39, s39, 9216
    ds_read_b64_tr_b16 a[244:245], v6 offset:128
    v_mfma_f32_16x16x32_bf16 v[120:123], a[252:255], a[116:119], v[120:123]
    ds_read_b64_tr_b16 a[246:247], v6 offset:1664
    v_mfma_f32_16x16x32_bf16 v[120:123], a[248:251], a[112:115], v[120:123]
    v_mfma_f32_16x16x32_bf16 v[128:131], a[248:251], a[120:123], v[128:131]
    buffer_load_dwordx4 v1, s[8:11], s39 offen offset:1024 lds
    v_mfma_f32_16x16x32_bf16 v[128:131], a[252:255], a[124:127], v[128:131]
    s_waitcnt lgkmcnt(4)
    v_mfma_f32_16x16x32_bf16 v[132:135], a[16:19], a[124:127], v[132:135]
    s_add_u32 m0, s38, 8192
    ds_read_b64_tr_b16 a[248:249], v6 offset:49416
    v_mfma_f32_16x16x32_bf16 v[132:135], a[12:15], a[120:123], v[132:135]
    s_add_u32 s39, s57, s0
    ds_read_b64_tr_b16 a[250:251], v6 offset:50952
    v_mfma_f32_16x16x32_bf16 v[124:127], a[12:15], a[112:115], v[124:127]
    s_waitcnt vmcnt(14)
    ds_read_b128 a[168:171], v12 offset:32768
    v_mfma_f32_16x16x32_bf16 v[124:127], a[16:19], a[116:119], v[124:127]
    buffer_load_dwordx4 v1, s[8:11], s39 offen lds
    v_mfma_f32_16x16x32_bf16 v[116:119], a[16:19], a[108:111], v[116:119]
    v_mfma_f32_16x16x32_bf16 v[116:119], a[12:15], a[104:107], v[116:119]
    s_add_u32 s39, s39, 9216
    ds_read_b64_tr_b16 a[252:253], v6 offset:136
    v_mfma_f32_16x16x32_bf16 v[108:111], a[12:15], a[96:99], v[108:111]
    ds_read_b64_tr_b16 a[254:255], v6 offset:1672
    v_mfma_f32_16x16x32_bf16 v[108:111], a[16:19], a[100:103], v[108:111]
    ds_read_b128 a[172:175], v13 offset:32768
    v_mfma_f32_16x16x32_bf16 v[100:103], a[16:19], a[92:95], v[100:103]
    buffer_load_dwordx4 v1, s[8:11], s39 offen offset:1024 lds
    v_mfma_f32_16x16x32_bf16 v[100:103], a[12:15], a[88:91], v[100:103]
    s_waitcnt lgkmcnt(6)
    v_mfma_f32_16x16x32_bf16 v[136:139], a[240:243], a[88:91], v[136:139]
    s_add_u32 m0, s38, 16384
    ds_read_b64_tr_b16 a[12:13], v5 offset:49536
    v_mfma_f32_16x16x32_bf16 v[136:139], a[244:247], a[92:95], v[136:139]
    s_add_u32 s39, s57, s1
    ds_read_b64_tr_b16 a[14:15], v5 offset:51072
    v_mfma_f32_16x16x32_bf16 v[144:147], a[244:247], a[100:103], v[144:147]
    s_waitcnt vmcnt(14)
    ds_read_b128 a[176:179], v12 offset:40960
    v_mfma_f32_16x16x32_bf16 v[144:147], a[240:243], a[96:99], v[144:147]
    buffer_load_dwordx4 v1, s[8:11], s39 offen lds
    v_mfma_f32_16x16x32_bf16 v[152:155], a[240:243], a[104:107], v[152:155]
    v_mfma_f32_16x16x32_bf16 v[152:155], a[244:247], a[108:111], v[152:155]
    s_add_u32 s39, s39, 9216
    ds_read_b64_tr_b16 a[16:17], v5 offset:256
    v_mfma_f32_16x16x32_bf16 v[160:163], a[244:247], a[116:119], v[160:163]
    ds_read_b64_tr_b16 a[18:19], v5 offset:1792
    v_mfma_f32_16x16x32_bf16 v[160:163], a[240:243], a[112:115], v[160:163]
    ds_read_b128 a[180:183], v13 offset:40960
    v_mfma_f32_16x16x32_bf16 v[168:171], a[240:243], a[120:123], v[168:171]
    buffer_load_dwordx4 v1, s[8:11], s39 offen offset:1024 lds
    v_mfma_f32_16x16x32_bf16 v[168:171], a[244:247], a[124:127], v[168:171]
    s_waitcnt lgkmcnt(7)
    v_mfma_f32_16x16x32_bf16 v[172:175], a[252:255], a[124:127], v[172:175]
    s_add_u32 m0, s38, 24576
    ds_read_b64_tr_b16 a[240:241], v5 offset:49544
    v_mfma_f32_16x16x32_bf16 v[172:175], a[248:251], a[120:123], v[172:175]
    s_add_u32 s39, s57, s63
    ds_read_b64_tr_b16 a[242:243], v5 offset:51080
    v_mfma_f32_16x16x32_bf16 v[164:167], a[248:251], a[112:115], v[164:167]
    v_mfma_f32_16x16x32_bf16 v[164:167], a[252:255], a[116:119], v[164:167]
    buffer_load_dwordx4 v1, s[8:11], s39 offen lds
    v_mfma_f32_16x16x32_bf16 v[156:159], a[252:255], a[108:111], v[156:159]
    v_mfma_f32_16x16x32_bf16 v[156:159], a[248:251], a[104:107], v[156:159]
    s_add_u32 s39, s39, 9216
    ds_read_b64_tr_b16 a[244:245], v5 offset:264
    v_mfma_f32_16x16x32_bf16 v[148:151], a[248:251], a[96:99], v[148:151]
    ds_read_b64_tr_b16 a[246:247], v5 offset:1800
    v_mfma_f32_16x16x32_bf16 v[148:151], a[252:255], a[100:103], v[148:151]
    v_mfma_f32_16x16x32_bf16 v[140:143], a[252:255], a[92:95], v[140:143]
    buffer_load_dwordx4 v1, s[8:11], s39 offen offset:1024 lds
    v_mfma_f32_16x16x32_bf16 v[140:143], a[248:251], a[88:91], v[140:143]
    s_waitcnt lgkmcnt(5)
    v_mfma_f32_16x16x32_bf16 v[176:179], a[12:15], a[88:91], v[176:179]
    s_add_u32 m0, s38, 32768
    ds_read_b64_tr_b16 a[248:249], v6 offset:49536
    v_mfma_f32_16x16x32_bf16 v[176:179], a[16:19], a[92:95], v[176:179]
    s_add_u32 s39, s57, s87
    ds_read_b64_tr_b16 a[250:251], v6 offset:51072
    v_mfma_f32_16x16x32_bf16 v[184:187], a[16:19], a[100:103], v[184:187]
    v_mfma_f32_16x16x32_bf16 v[184:187], a[12:15], a[96:99], v[184:187]
    buffer_load_dwordx4 v1, s[8:11], s39 offen lds
    v_mfma_f32_16x16x32_bf16 v[192:195], a[12:15], a[104:107], v[192:195]
    v_mfma_f32_16x16x32_bf16 v[192:195], a[16:19], a[108:111], v[192:195]
    s_add_u32 s39, s39, 9216
    ds_read_b64_tr_b16 a[252:253], v6 offset:256
    v_mfma_f32_16x16x32_bf16 v[200:203], a[16:19], a[116:119], v[200:203]
    ds_read_b64_tr_b16 a[254:255], v6 offset:1792
    v_mfma_f32_16x16x32_bf16 v[200:203], a[12:15], a[112:115], v[200:203]
    v_mfma_f32_16x16x32_bf16 v[208:211], a[12:15], a[120:123], v[208:211]
    buffer_load_dwordx4 v1, s[8:11], s39 offen offset:1024 lds
    v_mfma_f32_16x16x32_bf16 v[208:211], a[16:19], a[124:127], v[208:211]
    s_waitcnt lgkmcnt(4)
    v_mfma_f32_16x16x32_bf16 v[212:215], a[244:247], a[124:127], v[212:215]
    s_add_u32 m0, s38, 40960
    ds_read_b64_tr_b16 a[12:13], v6 offset:49544
    v_mfma_f32_16x16x32_bf16 v[212:215], a[240:243], a[120:123], v[212:215]
    s_add_u32 s39, s57, 81920
    ds_read_b64_tr_b16 a[14:15], v6 offset:51080
    v_mfma_f32_16x16x32_bf16 v[204:207], a[240:243], a[112:115], v[204:207]
    v_mfma_f32_16x16x32_bf16 v[204:207], a[244:247], a[116:119], v[204:207]
    buffer_load_dwordx4 v1, s[8:11], s39 offen lds
    v_mfma_f32_16x16x32_bf16 v[196:199], a[244:247], a[108:111], v[196:199]
    v_mfma_f32_16x16x32_bf16 v[196:199], a[240:243], a[104:107], v[196:199]
    s_add_u32 s39, s39, 9216
    ds_read_b64_tr_b16 a[16:17], v6 offset:264
    v_mfma_f32_16x16x32_bf16 v[188:191], a[240:243], a[96:99], v[188:191]
    ds_read_b64_tr_b16 a[18:19], v6 offset:1800
    v_mfma_f32_16x16x32_bf16 v[188:191], a[244:247], a[100:103], v[188:191]
    v_mfma_f32_16x16x32_bf16 v[180:183], a[244:247], a[92:95], v[180:183]
    buffer_load_dwordx4 v1, s[8:11], s39 offen offset:1024 lds
    v_mfma_f32_16x16x32_bf16 v[180:183], a[240:243], a[88:91], v[180:183]
    s_waitcnt lgkmcnt(4)
    s_waitcnt vmcnt(19)
    s_barrier
    v_mfma_f32_16x16x32_bf16 v[216:219], a[248:251], a[88:91], v[216:219]
    ds_read_b64_tr_b16 a[240:241], v5 offset:12320
    v_mfma_f32_16x16x32_bf16 v[216:219], a[252:255], a[92:95], v[216:219]
    ds_read_b64_tr_b16 a[242:243], v5 offset:13856
    v_mfma_f32_16x16x32_bf16 v[224:227], a[252:255], a[100:103], v[224:227]
    s_waitcnt vmcnt(14)
    ds_read_b128 a[184:187], v12 offset:49152
    v_mfma_f32_16x16x32_bf16 v[224:227], a[248:251], a[96:99], v[224:227]
    v_mfma_f32_16x16x32_bf16 v[232:235], a[248:251], a[104:107], v[232:235]
    v_mfma_f32_16x16x32_bf16 v[232:235], a[252:255], a[108:111], v[232:235]
    ds_read_b64_tr_b16 a[244:245], v5 offset:24640
    v_mfma_f32_16x16x32_bf16 v[240:243], a[252:255], a[116:119], v[240:243]
    ds_read_b64_tr_b16 a[246:247], v5 offset:26176
    v_mfma_f32_16x16x32_bf16 v[240:243], a[248:251], a[112:115], v[240:243]
    ds_read_b128 a[188:191], v13 offset:49152
    v_mfma_f32_16x16x32_bf16 v[248:251], a[248:251], a[120:123], v[248:251]
    v_mfma_f32_16x16x32_bf16 v[248:251], a[252:255], a[124:127], v[248:251]
    s_waitcnt lgkmcnt(6)
    s_barrier
    v_mfma_f32_16x16x32_bf16 v[252:255], a[16:19], a[124:127], v[252:255]
    s_add_u32 m0, s31, 49280
    ds_read_b64_tr_b16 a[248:249], v5 offset:12328
    v_mfma_f32_16x16x32_bf16 v[252:255], a[12:15], a[120:123], v[252:255]
    s_add_u32 s32, s32, 393216
    ds_read_b64_tr_b16 a[250:251], v5 offset:13864
    v_mfma_f32_16x16x32_bf16 v[244:247], a[12:15], a[112:115], v[244:247]
    s_waitcnt vmcnt(12)
    ds_read_b128 a[192:195], v12 offset:57344
    v_mfma_f32_16x16x32_bf16 v[244:247], a[16:19], a[116:119], v[244:247]
    buffer_load_dwordx4 v2, s[12:15], s32 offen lds
    v_mfma_f32_16x16x32_bf16 v[236:239], a[16:19], a[108:111], v[236:239]
    v_mfma_f32_16x16x32_bf16 v[236:239], a[12:15], a[104:107], v[236:239]
    ds_read_b64_tr_b16 a[252:253], v5 offset:24648
    v_mfma_f32_16x16x32_bf16 v[228:231], a[12:15], a[96:99], v[228:231]
    ds_read_b64_tr_b16 a[254:255], v5 offset:26184
    v_mfma_f32_16x16x32_bf16 v[228:231], a[16:19], a[100:103], v[228:231]
    ds_read_b128 a[196:199], v13 offset:57344
    v_mfma_f32_16x16x32_bf16 v[220:223], a[16:19], a[92:95], v[220:223]
    buffer_load_dwordx4 v3, s[12:15], s32 offen offset:1024 lds
    v_mfma_f32_16x16x32_bf16 v[220:223], a[12:15], a[88:91], v[220:223]
    s_waitcnt lgkmcnt(7)
    v_mfma_f32_16x16x32_bf16 v[16:19], a[240:243], a[128:131], v[16:19]
    ds_read_b64_tr_b16 a[12:13], v6 offset:12320
    v_mfma_f32_16x16x32_bf16 v[16:19], a[244:247], a[132:135], v[16:19]
    ds_read_b64_tr_b16 a[14:15], v6 offset:13856
    v_mfma_f32_16x16x32_bf16 v[24:27], a[244:247], a[140:143], v[24:27]
    s_waitcnt vmcnt(12)
    ds_read_b128 a[200:203], v12 offset:0
    v_mfma_f32_16x16x32_bf16 v[24:27], a[240:243], a[136:139], v[24:27]
    buffer_load_dwordx4 v4, s[12:15], s32 offen offset:2048 lds
    v_mfma_f32_16x16x32_bf16 v[32:35], a[240:243], a[144:147], v[32:35]
    v_mfma_f32_16x16x32_bf16 v[32:35], a[244:247], a[148:151], v[32:35]
    s_add_u32 m0, s31, 0
    ds_read_b64_tr_b16 a[16:17], v6 offset:24640
    v_mfma_f32_16x16x32_bf16 v[40:43], a[244:247], a[156:159], v[40:43]
    s_mul_i32 s32, s57, 6144
    ds_read_b64_tr_b16 a[18:19], v6 offset:26176
    v_mfma_f32_16x16x32_bf16 v[40:43], a[240:243], a[152:155], v[40:43]
    ds_read_b128 a[204:207], v13 offset:0
    v_mfma_f32_16x16x32_bf16 v[48:51], a[240:243], a[160:163], v[48:51]
    buffer_load_dwordx4 v2, s[12:15], s32 offen lds
    v_mfma_f32_16x16x32_bf16 v[48:51], a[244:247], a[164:167], v[48:51]
    s_waitcnt lgkmcnt(7)
    v_mfma_f32_16x16x32_bf16 v[52:55], a[252:255], a[164:167], v[52:55]
    ds_read_b64_tr_b16 a[240:241], v6 offset:12328
    v_mfma_f32_16x16x32_bf16 v[52:55], a[248:251], a[160:163], v[52:55]
    ds_read_b64_tr_b16 a[242:243], v6 offset:13864
    v_mfma_f32_16x16x32_bf16 v[44:47], a[248:251], a[152:155], v[44:47]
    s_waitcnt vmcnt(12)
    ds_read_b128 a[208:211], v12 offset:8192
    v_mfma_f32_16x16x32_bf16 v[44:47], a[252:255], a[156:159], v[44:47]
    buffer_load_dwordx4 v3, s[12:15], s32 offen offset:1024 lds
    v_mfma_f32_16x16x32_bf16 v[36:39], a[252:255], a[148:151], v[36:39]
    v_mfma_f32_16x16x32_bf16 v[36:39], a[248:251], a[144:147], v[36:39]
    ds_read_b64_tr_b16 a[244:245], v6 offset:24648
    v_mfma_f32_16x16x32_bf16 v[28:31], a[248:251], a[136:139], v[28:31]
    ds_read_b64_tr_b16 a[246:247], v6 offset:26184
    v_mfma_f32_16x16x32_bf16 v[28:31], a[252:255], a[140:143], v[28:31]
    ds_read_b128 a[212:215], v13 offset:8192
    v_mfma_f32_16x16x32_bf16 v[20:23], a[252:255], a[132:135], v[20:23]
    buffer_load_dwordx4 v4, s[12:15], s32 offen offset:2048 lds
    v_mfma_f32_16x16x32_bf16 v[20:23], a[248:251], a[128:131], v[20:23]
    s_waitcnt lgkmcnt(7)
    v_mfma_f32_16x16x32_bf16 v[56:59], a[12:15], a[128:131], v[56:59]
    s_add_u32 m0, s38, 49152
    ds_read_b64_tr_b16 a[248:249], v5 offset:12448
    v_mfma_f32_16x16x32_bf16 v[56:59], a[16:19], a[132:135], v[56:59]
    s_add_u32 s39, s58, s0
    ds_read_b64_tr_b16 a[250:251], v5 offset:13984
    v_mfma_f32_16x16x32_bf16 v[64:67], a[16:19], a[140:143], v[64:67]
    s_waitcnt vmcnt(12)
    ds_read_b128 a[216:219], v12 offset:16384
    v_mfma_f32_16x16x32_bf16 v[64:67], a[12:15], a[136:139], v[64:67]
    buffer_load_dwordx4 v1, s[8:11], s39 offen lds
    v_mfma_f32_16x16x32_bf16 v[72:75], a[12:15], a[144:147], v[72:75]
    v_mfma_f32_16x16x32_bf16 v[72:75], a[16:19], a[148:151], v[72:75]
    s_add_u32 s39, s39, 9216
    ds_read_b64_tr_b16 a[252:253], v5 offset:24768
    v_mfma_f32_16x16x32_bf16 v[80:83], a[16:19], a[156:159], v[80:83]
    ds_read_b64_tr_b16 a[254:255], v5 offset:26304
    v_mfma_f32_16x16x32_bf16 v[80:83], a[12:15], a[152:155], v[80:83]
    ds_read_b128 a[220:223], v13 offset:16384
    v_mfma_f32_16x16x32_bf16 v[88:91], a[12:15], a[160:163], v[88:91]
    buffer_load_dwordx4 v1, s[8:11], s39 offen offset:1024 lds
    v_mfma_f32_16x16x32_bf16 v[88:91], a[16:19], a[164:167], v[88:91]
    s_waitcnt lgkmcnt(7)
    v_mfma_f32_16x16x32_bf16 v[92:95], a[244:247], a[164:167], v[92:95]
    s_add_u32 m0, s38, 57344
    ds_read_b64_tr_b16 a[12:13], v5 offset:12456
    v_mfma_f32_16x16x32_bf16 v[92:95], a[240:243], a[160:163], v[92:95]
    s_add_u32 s39, s58, s1
    ds_read_b64_tr_b16 a[14:15], v5 offset:13992
    v_mfma_f32_16x16x32_bf16 v[84:87], a[240:243], a[152:155], v[84:87]
    s_waitcnt vmcnt(12)
    ds_read_b128 a[224:227], v12 offset:24576
    v_mfma_f32_16x16x32_bf16 v[84:87], a[244:247], a[156:159], v[84:87]
    buffer_load_dwordx4 v1, s[8:11], s39 offen lds
    v_mfma_f32_16x16x32_bf16 v[76:79], a[244:247], a[148:151], v[76:79]
    v_mfma_f32_16x16x32_bf16 v[76:79], a[240:243], a[144:147], v[76:79]
    s_add_u32 s39, s39, 9216
    ds_read_b64_tr_b16 a[16:17], v5 offset:24776
    v_mfma_f32_16x16x32_bf16 v[68:71], a[240:243], a[136:139], v[68:71]
    ds_read_b64_tr_b16 a[18:19], v5 offset:26312
    v_mfma_f32_16x16x32_bf16 v[68:71], a[244:247], a[140:143], v[68:71]
    ds_read_b128 a[228:231], v13 offset:24576
    v_mfma_f32_16x16x32_bf16 v[60:63], a[244:247], a[132:135], v[60:63]
    buffer_load_dwordx4 v1, s[8:11], s39 offen offset:1024 lds
    v_mfma_f32_16x16x32_bf16 v[60:63], a[240:243], a[128:131], v[60:63]
    s_waitcnt lgkmcnt(7)
    v_mfma_f32_16x16x32_bf16 v[96:99], a[248:251], a[128:131], v[96:99]
    s_add_u32 m0, s38, 0
    ds_read_b64_tr_b16 a[240:241], v6 offset:12448
    v_mfma_f32_16x16x32_bf16 v[96:99], a[252:255], a[132:135], v[96:99]
    s_add_u32 s39, s58, s63
    ds_read_b64_tr_b16 a[242:243], v6 offset:13984
    v_mfma_f32_16x16x32_bf16 v[104:107], a[252:255], a[140:143], v[104:107]
    s_waitcnt vmcnt(12)
    ds_read_b128 a[232:235], v12 offset:32768
    v_mfma_f32_16x16x32_bf16 v[104:107], a[248:251], a[136:139], v[104:107]
    buffer_load_dwordx4 v1, s[8:11], s39 offen lds
    v_mfma_f32_16x16x32_bf16 v[112:115], a[248:251], a[144:147], v[112:115]
    v_mfma_f32_16x16x32_bf16 v[112:115], a[252:255], a[148:151], v[112:115]
    s_add_u32 s39, s39, 9216
    ds_read_b64_tr_b16 a[244:245], v6 offset:24768
    v_mfma_f32_16x16x32_bf16 v[120:123], a[252:255], a[156:159], v[120:123]
    ds_read_b64_tr_b16 a[246:247], v6 offset:26304
    v_mfma_f32_16x16x32_bf16 v[120:123], a[248:251], a[152:155], v[120:123]
    ds_read_b128 a[20:23], v13 offset:32768
    v_mfma_f32_16x16x32_bf16 v[128:131], a[248:251], a[160:163], v[128:131]
    buffer_load_dwordx4 v1, s[8:11], s39 offen offset:1024 lds
    v_mfma_f32_16x16x32_bf16 v[128:131], a[252:255], a[164:167], v[128:131]
    s_waitcnt lgkmcnt(7)
    v_mfma_f32_16x16x32_bf16 v[132:135], a[16:19], a[164:167], v[132:135]
    s_add_u32 m0, s38, 8192
    ds_read_b64_tr_b16 a[248:249], v6 offset:12456
    v_mfma_f32_16x16x32_bf16 v[132:135], a[12:15], a[160:163], v[132:135]
    s_add_u32 s39, s58, s87
    ds_read_b64_tr_b16 a[250:251], v6 offset:13992
    v_mfma_f32_16x16x32_bf16 v[124:127], a[12:15], a[152:155], v[124:127]
    s_waitcnt vmcnt(12)
    ds_read_b128 a[24:27], v12 offset:40960
    v_mfma_f32_16x16x32_bf16 v[124:127], a[16:19], a[156:159], v[124:127]
    buffer_load_dwordx4 v1, s[8:11], s39 offen lds
    v_mfma_f32_16x16x32_bf16 v[116:119], a[16:19], a[148:151], v[116:119]
    v_mfma_f32_16x16x32_bf16 v[116:119], a[12:15], a[144:147], v[116:119]
    s_add_u32 s39, s39, 9216
    ds_read_b64_tr_b16 a[252:253], v6 offset:24776
    v_mfma_f32_16x16x32_bf16 v[108:111], a[12:15], a[136:139], v[108:111]
    ds_read_b64_tr_b16 a[254:255], v6 offset:26312
    v_mfma_f32_16x16x32_bf16 v[108:111], a[16:19], a[140:143], v[108:111]
    ds_read_b128 a[28:31], v13 offset:40960
    v_mfma_f32_16x16x32_bf16 v[100:103], a[16:19], a[132:135], v[100:103]
    buffer_load_dwordx4 v1, s[8:11], s39 offen offset:1024 lds
    v_mfma_f32_16x16x32_bf16 v[100:103], a[12:15], a[128:131], v[100:103]
    s_waitcnt lgkmcnt(7)
    v_mfma_f32_16x16x32_bf16 v[136:139], a[240:243], a[128:131], v[136:139]
    s_add_u32 m0, s38, 16384
    ds_read_b64_tr_b16 a[12:13], v5 offset:12576
    v_mfma_f32_16x16x32_bf16 v[136:139], a[244:247], a[132:135], v[136:139]
    s_add_u32 s39, s58, 81920
    ds_read_b64_tr_b16 a[14:15], v5 offset:14112
    v_mfma_f32_16x16x32_bf16 v[144:147], a[244:247], a[140:143], v[144:147]
    v_mfma_f32_16x16x32_bf16 v[144:147], a[240:243], a[136:139], v[144:147]
    buffer_load_dwordx4 v1, s[8:11], s39 offen lds
    v_mfma_f32_16x16x32_bf16 v[152:155], a[240:243], a[144:147], v[152:155]
    v_mfma_f32_16x16x32_bf16 v[152:155], a[244:247], a[148:151], v[152:155]
    s_add_u32 s39, s39, 9216
    ds_read_b64_tr_b16 a[16:17], v5 offset:24896
    v_mfma_f32_16x16x32_bf16 v[160:163], a[244:247], a[156:159], v[160:163]
    ds_read_b64_tr_b16 a[18:19], v5 offset:26432
    v_mfma_f32_16x16x32_bf16 v[160:163], a[240:243], a[152:155], v[160:163]
    v_mfma_f32_16x16x32_bf16 v[168:171], a[240:243], a[160:163], v[168:171]
    buffer_load_dwordx4 v1, s[8:11], s39 offen offset:1024 lds
    v_mfma_f32_16x16x32_bf16 v[168:171], a[244:247], a[164:167], v[168:171]
    s_waitcnt lgkmcnt(5)
    v_mfma_f32_16x16x32_bf16 v[172:175], a[252:255], a[164:167], v[172:175]
    s_add_u32 m0, s38, 24576
    ds_read_b64_tr_b16 a[240:241], v5 offset:12584
    v_mfma_f32_16x16x32_bf16 v[172:175], a[248:251], a[160:163], v[172:175]
    s_add_u32 s39, s59, s0
    ds_read_b64_tr_b16 a[242:243], v5 offset:14120
    v_mfma_f32_16x16x32_bf16 v[164:167], a[248:251], a[152:155], v[164:167]
    v_mfma_f32_16x16x32_bf16 v[164:167], a[252:255], a[156:159], v[164:167]
    buffer_load_dwordx4 v1, s[8:11], s39 offen lds
    v_mfma_f32_16x16x32_bf16 v[156:159], a[252:255], a[148:151], v[156:159]
    v_mfma_f32_16x16x32_bf16 v[156:159], a[248:251], a[144:147], v[156:159]
    s_add_u32 s39, s39, 9216
    ds_read_b64_tr_b16 a[244:245], v5 offset:24904
    v_mfma_f32_16x16x32_bf16 v[148:151], a[248:251], a[136:139], v[148:151]
    ds_read_b64_tr_b16 a[246:247], v5 offset:26440
    v_mfma_f32_16x16x32_bf16 v[148:151], a[252:255], a[140:143], v[148:151]
    v_mfma_f32_16x16x32_bf16 v[140:143], a[252:255], a[132:135], v[140:143]
    buffer_load_dwordx4 v1, s[8:11], s39 offen offset:1024 lds
    v_mfma_f32_16x16x32_bf16 v[140:143], a[248:251], a[128:131], v[140:143]
    s_waitcnt lgkmcnt(4)
    v_mfma_f32_16x16x32_bf16 v[176:179], a[12:15], a[128:131], v[176:179]
    s_add_u32 m0, s38, 32768
    ds_read_b64_tr_b16 a[248:249], v6 offset:12576
    v_mfma_f32_16x16x32_bf16 v[176:179], a[16:19], a[132:135], v[176:179]
    s_add_u32 s39, s59, s1
    ds_read_b64_tr_b16 a[250:251], v6 offset:14112
    v_mfma_f32_16x16x32_bf16 v[184:187], a[16:19], a[140:143], v[184:187]
    v_mfma_f32_16x16x32_bf16 v[184:187], a[12:15], a[136:139], v[184:187]
    buffer_load_dwordx4 v1, s[8:11], s39 offen lds
    v_mfma_f32_16x16x32_bf16 v[192:195], a[12:15], a[144:147], v[192:195]
    v_mfma_f32_16x16x32_bf16 v[192:195], a[16:19], a[148:151], v[192:195]
    s_add_u32 s39, s39, 9216
    ds_read_b64_tr_b16 a[252:253], v6 offset:24896
    v_mfma_f32_16x16x32_bf16 v[200:203], a[16:19], a[156:159], v[200:203]
    ds_read_b64_tr_b16 a[254:255], v6 offset:26432
    v_mfma_f32_16x16x32_bf16 v[200:203], a[12:15], a[152:155], v[200:203]
    v_mfma_f32_16x16x32_bf16 v[208:211], a[12:15], a[160:163], v[208:211]
    buffer_load_dwordx4 v1, s[8:11], s39 offen offset:1024 lds
    v_mfma_f32_16x16x32_bf16 v[208:211], a[16:19], a[164:167], v[208:211]
    s_waitcnt lgkmcnt(4)
    v_mfma_f32_16x16x32_bf16 v[212:215], a[244:247], a[164:167], v[212:215]
    s_add_u32 m0, s38, 40960
    ds_read_b64_tr_b16 a[12:13], v6 offset:12584
    v_mfma_f32_16x16x32_bf16 v[212:215], a[240:243], a[160:163], v[212:215]
    s_add_u32 s39, s59, s63
    ds_read_b64_tr_b16 a[14:15], v6 offset:14120
    v_mfma_f32_16x16x32_bf16 v[204:207], a[240:243], a[152:155], v[204:207]
    v_mfma_f32_16x16x32_bf16 v[204:207], a[244:247], a[156:159], v[204:207]
    buffer_load_dwordx4 v1, s[8:11], s39 offen lds
    v_mfma_f32_16x16x32_bf16 v[196:199], a[244:247], a[148:151], v[196:199]
    v_mfma_f32_16x16x32_bf16 v[196:199], a[240:243], a[144:147], v[196:199]
    s_add_u32 s39, s39, 9216
    ds_read_b64_tr_b16 a[16:17], v6 offset:24904
    v_mfma_f32_16x16x32_bf16 v[188:191], a[240:243], a[136:139], v[188:191]
    ds_read_b64_tr_b16 a[18:19], v6 offset:26440
    v_mfma_f32_16x16x32_bf16 v[188:191], a[244:247], a[140:143], v[188:191]
    v_mfma_f32_16x16x32_bf16 v[180:183], a[244:247], a[132:135], v[180:183]
    buffer_load_dwordx4 v1, s[8:11], s39 offen offset:1024 lds
    v_mfma_f32_16x16x32_bf16 v[180:183], a[240:243], a[128:131], v[180:183]
    s_waitcnt lgkmcnt(4)
    s_waitcnt vmcnt(19)
    s_barrier
    v_mfma_f32_16x16x32_bf16 v[216:219], a[248:251], a[128:131], v[216:219]
    ds_read_b64_tr_b16 a[240:241], v5 offset:36960
    v_mfma_f32_16x16x32_bf16 v[216:219], a[252:255], a[132:135], v[216:219]
    ds_read_b64_tr_b16 a[242:243], v5 offset:38496
    v_mfma_f32_16x16x32_bf16 v[224:227], a[252:255], a[140:143], v[224:227]
    s_waitcnt vmcnt(14)
    ds_read_b128 a[32:35], v12 offset:49152
    v_mfma_f32_16x16x32_bf16 v[224:227], a[248:251], a[136:139], v[224:227]
    v_mfma_f32_16x16x32_bf16 v[232:235], a[248:251], a[144:147], v[232:235]
    v_mfma_f32_16x16x32_bf16 v[232:235], a[252:255], a[148:151], v[232:235]
    ds_read_b64_tr_b16 a[244:245], v5 offset:49280
    v_mfma_f32_16x16x32_bf16 v[240:243], a[252:255], a[156:159], v[240:243]
    ds_read_b64_tr_b16 a[246:247], v5 offset:50816
    v_mfma_f32_16x16x32_bf16 v[240:243], a[248:251], a[152:155], v[240:243]
    ds_read_b128 a[36:39], v13 offset:49152
    v_mfma_f32_16x16x32_bf16 v[248:251], a[248:251], a[160:163], v[248:251]
    v_mfma_f32_16x16x32_bf16 v[248:251], a[252:255], a[164:167], v[248:251]
    s_waitcnt lgkmcnt(6)
    s_barrier
    v_mfma_f32_16x16x32_bf16 v[252:255], a[16:19], a[164:167], v[252:255]
    s_add_u32 m0, s31, 12320
    ds_read_b64_tr_b16 a[248:249], v5 offset:36968
    v_mfma_f32_16x16x32_bf16 v[252:255], a[12:15], a[160:163], v[252:255]
    s_add_u32 s32, s32, 393216
    ds_read_b64_tr_b16 a[250:251], v5 offset:38504
    v_mfma_f32_16x16x32_bf16 v[244:247], a[12:15], a[152:155], v[244:247]
    s_waitcnt vmcnt(12)
    ds_read_b128 a[60:63], v12 offset:57344
    v_mfma_f32_16x16x32_bf16 v[244:247], a[16:19], a[156:159], v[244:247]
    buffer_load_dwordx4 v2, s[12:15], s32 offen lds
    v_mfma_f32_16x16x32_bf16 v[236:239], a[16:19], a[148:151], v[236:239]
    v_mfma_f32_16x16x32_bf16 v[236:239], a[12:15], a[144:147], v[236:239]
    ds_read_b64_tr_b16 a[252:253], v5 offset:49288
    v_mfma_f32_16x16x32_bf16 v[228:231], a[12:15], a[136:139], v[228:231]
    ds_read_b64_tr_b16 a[254:255], v5 offset:50824
    v_mfma_f32_16x16x32_bf16 v[228:231], a[16:19], a[140:143], v[228:231]
    ds_read_b128 a[64:67], v13 offset:57344
    v_mfma_f32_16x16x32_bf16 v[220:223], a[16:19], a[132:135], v[220:223]
    buffer_load_dwordx4 v3, s[12:15], s32 offen offset:1024 lds
    v_mfma_f32_16x16x32_bf16 v[220:223], a[12:15], a[128:131], v[220:223]
    s_waitcnt lgkmcnt(7)
    v_mfma_f32_16x16x32_bf16 v[16:19], a[240:243], a[168:171], v[16:19]
    ds_read_b64_tr_b16 a[12:13], v6 offset:36960
    v_mfma_f32_16x16x32_bf16 v[16:19], a[244:247], a[172:175], v[16:19]
    ds_read_b64_tr_b16 a[14:15], v6 offset:38496
    v_mfma_f32_16x16x32_bf16 v[24:27], a[244:247], a[180:183], v[24:27]
    s_waitcnt vmcnt(12)
    ds_read_b128 a[68:71], v12 offset:0
    v_mfma_f32_16x16x32_bf16 v[24:27], a[240:243], a[176:179], v[24:27]
    buffer_load_dwordx4 v4, s[12:15], s32 offen offset:2048 lds
    v_mfma_f32_16x16x32_bf16 v[32:35], a[240:243], a[184:187], v[32:35]
    v_mfma_f32_16x16x32_bf16 v[32:35], a[244:247], a[188:191], v[32:35]
    s_add_u32 m0, s31, 24640
    ds_read_b64_tr_b16 a[16:17], v6 offset:49280
    v_mfma_f32_16x16x32_bf16 v[40:43], a[244:247], a[196:199], v[40:43]
    s_mul_i32 s32, s58, 6144
    ds_read_b64_tr_b16 a[18:19], v6 offset:50816
    v_mfma_f32_16x16x32_bf16 v[40:43], a[240:243], a[192:195], v[40:43]
    ds_read_b128 a[72:75], v13 offset:0
    v_mfma_f32_16x16x32_bf16 v[48:51], a[240:243], a[200:203], v[48:51]
    buffer_load_dwordx4 v2, s[12:15], s32 offen lds
    v_mfma_f32_16x16x32_bf16 v[48:51], a[244:247], a[204:207], v[48:51]
    s_waitcnt lgkmcnt(7)
    v_mfma_f32_16x16x32_bf16 v[52:55], a[252:255], a[204:207], v[52:55]
    ds_read_b64_tr_b16 a[240:241], v6 offset:36968
    v_mfma_f32_16x16x32_bf16 v[52:55], a[248:251], a[200:203], v[52:55]
    ds_read_b64_tr_b16 a[242:243], v6 offset:38504
    v_mfma_f32_16x16x32_bf16 v[44:47], a[248:251], a[192:195], v[44:47]
    s_waitcnt vmcnt(12)
    ds_read_b128 a[76:79], v12 offset:8192
    v_mfma_f32_16x16x32_bf16 v[44:47], a[252:255], a[196:199], v[44:47]
    buffer_load_dwordx4 v3, s[12:15], s32 offen offset:1024 lds
    v_mfma_f32_16x16x32_bf16 v[36:39], a[252:255], a[188:191], v[36:39]
    v_mfma_f32_16x16x32_bf16 v[36:39], a[248:251], a[184:187], v[36:39]
    ds_read_b64_tr_b16 a[244:245], v6 offset:49288
    v_mfma_f32_16x16x32_bf16 v[28:31], a[248:251], a[176:179], v[28:31]
    ds_read_b64_tr_b16 a[246:247], v6 offset:50824
    v_mfma_f32_16x16x32_bf16 v[28:31], a[252:255], a[180:183], v[28:31]
    ds_read_b128 a[0:3], v13 offset:8192
    v_mfma_f32_16x16x32_bf16 v[20:23], a[252:255], a[172:175], v[20:23]
    buffer_load_dwordx4 v4, s[12:15], s32 offen offset:2048 lds
    v_mfma_f32_16x16x32_bf16 v[20:23], a[248:251], a[168:171], v[20:23]
    s_waitcnt lgkmcnt(7)
    v_mfma_f32_16x16x32_bf16 v[56:59], a[12:15], a[168:171], v[56:59]
    s_add_u32 m0, s38, 49152
    ds_read_b64_tr_b16 a[248:249], v5 offset:37088
    v_mfma_f32_16x16x32_bf16 v[56:59], a[16:19], a[172:175], v[56:59]
    s_add_u32 s39, s59, s87
    ds_read_b64_tr_b16 a[250:251], v5 offset:38624
    v_mfma_f32_16x16x32_bf16 v[64:67], a[16:19], a[180:183], v[64:67]
    s_waitcnt vmcnt(12)
    ds_read_b128 a[4:7], v12 offset:16384
    v_mfma_f32_16x16x32_bf16 v[64:67], a[12:15], a[176:179], v[64:67]
    buffer_load_dwordx4 v1, s[8:11], s39 offen lds
    v_mfma_f32_16x16x32_bf16 v[72:75], a[12:15], a[184:187], v[72:75]
    v_mfma_f32_16x16x32_bf16 v[72:75], a[16:19], a[188:191], v[72:75]
    s_add_u32 s39, s39, 9216
    ds_read_b64_tr_b16 a[252:253], v5 offset:49408
    v_mfma_f32_16x16x32_bf16 v[80:83], a[16:19], a[196:199], v[80:83]
    ds_read_b64_tr_b16 a[254:255], v5 offset:50944
    v_mfma_f32_16x16x32_bf16 v[80:83], a[12:15], a[192:195], v[80:83]
    ds_read_b128 a[8:11], v13 offset:16384
    v_mfma_f32_16x16x32_bf16 v[88:91], a[12:15], a[200:203], v[88:91]
    buffer_load_dwordx4 v1, s[8:11], s39 offen offset:1024 lds
    v_mfma_f32_16x16x32_bf16 v[88:91], a[16:19], a[204:207], v[88:91]
    s_waitcnt lgkmcnt(7)
    v_mfma_f32_16x16x32_bf16 v[92:95], a[244:247], a[204:207], v[92:95]
    s_add_u32 m0, s38, 57344
    ds_read_b64_tr_b16 a[12:13], v5 offset:37096
    v_mfma_f32_16x16x32_bf16 v[92:95], a[240:243], a[200:203], v[92:95]
    s_add_u32 s39, s59, 81920
    ds_read_b64_tr_b16 a[14:15], v5 offset:38632
    v_mfma_f32_16x16x32_bf16 v[84:87], a[240:243], a[192:195], v[84:87]
    s_waitcnt vmcnt(12)
    ds_read_b128 a[40:43], v12 offset:24576
    v_mfma_f32_16x16x32_bf16 v[84:87], a[244:247], a[196:199], v[84:87]
    buffer_load_dwordx4 v1, s[8:11], s39 offen lds
    v_mfma_f32_16x16x32_bf16 v[76:79], a[244:247], a[188:191], v[76:79]
    v_mfma_f32_16x16x32_bf16 v[76:79], a[240:243], a[184:187], v[76:79]
    s_add_u32 s39, s39, 9216
    ds_read_b64_tr_b16 a[16:17], v5 offset:49416
    v_mfma_f32_16x16x32_bf16 v[68:71], a[240:243], a[176:179], v[68:71]
    ds_read_b64_tr_b16 a[18:19], v5 offset:50952
    v_mfma_f32_16x16x32_bf16 v[68:71], a[244:247], a[180:183], v[68:71]
    ds_read_b128 a[44:47], v13 offset:24576
    v_mfma_f32_16x16x32_bf16 v[60:63], a[244:247], a[172:175], v[60:63]
    buffer_load_dwordx4 v1, s[8:11], s39 offen offset:1024 lds
    v_mfma_f32_16x16x32_bf16 v[60:63], a[240:243], a[168:171], v[60:63]
    s_waitcnt lgkmcnt(7)
    v_mfma_f32_16x16x32_bf16 v[96:99], a[248:251], a[168:171], v[96:99]
    s_add_u32 m0, s38, 0
    ds_read_b64_tr_b16 a[240:241], v6 offset:37088
    v_mfma_f32_16x16x32_bf16 v[96:99], a[252:255], a[172:175], v[96:99]
    s_add_u32 s39, s60, s0
    ds_read_b64_tr_b16 a[242:243], v6 offset:38624
    v_mfma_f32_16x16x32_bf16 v[104:107], a[252:255], a[180:183], v[104:107]
    s_waitcnt vmcnt(12)
    ds_read_b128 a[48:51], v12 offset:32768
    v_mfma_f32_16x16x32_bf16 v[104:107], a[248:251], a[176:179], v[104:107]
    buffer_load_dwordx4 v1, s[8:11], s39 offen lds
    v_mfma_f32_16x16x32_bf16 v[112:115], a[248:251], a[184:187], v[112:115]
    v_mfma_f32_16x16x32_bf16 v[112:115], a[252:255], a[188:191], v[112:115]
    s_add_u32 s39, s39, 9216
    ds_read_b64_tr_b16 a[244:245], v6 offset:49408
    v_mfma_f32_16x16x32_bf16 v[120:123], a[252:255], a[196:199], v[120:123]
    ds_read_b64_tr_b16 a[246:247], v6 offset:50944
    v_mfma_f32_16x16x32_bf16 v[120:123], a[248:251], a[192:195], v[120:123]
    ds_read_b128 a[52:55], v13 offset:32768
    v_mfma_f32_16x16x32_bf16 v[128:131], a[248:251], a[200:203], v[128:131]
    buffer_load_dwordx4 v1, s[8:11], s39 offen offset:1024 lds
    v_mfma_f32_16x16x32_bf16 v[128:131], a[252:255], a[204:207], v[128:131]
    s_waitcnt lgkmcnt(7)
    v_mfma_f32_16x16x32_bf16 v[132:135], a[16:19], a[204:207], v[132:135]
    s_add_u32 m0, s38, 8192
    ds_read_b64_tr_b16 a[248:249], v6 offset:37096
    v_mfma_f32_16x16x32_bf16 v[132:135], a[12:15], a[200:203], v[132:135]
    s_add_u32 s39, s60, s1
    ds_read_b64_tr_b16 a[250:251], v6 offset:38632
    v_mfma_f32_16x16x32_bf16 v[124:127], a[12:15], a[192:195], v[124:127]
    s_waitcnt vmcnt(12)
    ds_read_b128 a[56:59], v12 offset:40960
    v_mfma_f32_16x16x32_bf16 v[124:127], a[16:19], a[196:199], v[124:127]
    buffer_load_dwordx4 v1, s[8:11], s39 offen lds
    v_mfma_f32_16x16x32_bf16 v[116:119], a[16:19], a[188:191], v[116:119]
    v_mfma_f32_16x16x32_bf16 v[116:119], a[12:15], a[184:187], v[116:119]
    s_add_u32 s39, s39, 9216
    ds_read_b64_tr_b16 a[252:253], v6 offset:49416
    v_mfma_f32_16x16x32_bf16 v[108:111], a[12:15], a[176:179], v[108:111]
    ds_read_b64_tr_b16 a[254:255], v6 offset:50952
    v_mfma_f32_16x16x32_bf16 v[108:111], a[16:19], a[180:183], v[108:111]
    ds_read_b128 a[80:83], v13 offset:40960
    v_mfma_f32_16x16x32_bf16 v[100:103], a[16:19], a[172:175], v[100:103]
    buffer_load_dwordx4 v1, s[8:11], s39 offen offset:1024 lds
    v_mfma_f32_16x16x32_bf16 v[100:103], a[12:15], a[168:171], v[100:103]
    s_waitcnt lgkmcnt(7)
    v_mfma_f32_16x16x32_bf16 v[136:139], a[240:243], a[168:171], v[136:139]
    s_add_u32 m0, s38, 16384
    ds_read_b64_tr_b16 a[12:13], v5 offset:37216
    v_mfma_f32_16x16x32_bf16 v[136:139], a[244:247], a[172:175], v[136:139]
    s_add_u32 s39, s60, s63
    ds_read_b64_tr_b16 a[14:15], v5 offset:38752
    v_mfma_f32_16x16x32_bf16 v[144:147], a[244:247], a[180:183], v[144:147]
    v_mfma_f32_16x16x32_bf16 v[144:147], a[240:243], a[176:179], v[144:147]
    buffer_load_dwordx4 v1, s[8:11], s39 offen lds
    v_mfma_f32_16x16x32_bf16 v[152:155], a[240:243], a[184:187], v[152:155]
    v_mfma_f32_16x16x32_bf16 v[152:155], a[244:247], a[188:191], v[152:155]
    s_add_u32 s39, s39, 9216
    ds_read_b64_tr_b16 a[16:17], v5 offset:49536
    v_mfma_f32_16x16x32_bf16 v[160:163], a[244:247], a[196:199], v[160:163]
    ds_read_b64_tr_b16 a[18:19], v5 offset:51072
    v_mfma_f32_16x16x32_bf16 v[160:163], a[240:243], a[192:195], v[160:163]
    v_mfma_f32_16x16x32_bf16 v[168:171], a[240:243], a[200:203], v[168:171]
    buffer_load_dwordx4 v1, s[8:11], s39 offen offset:1024 lds
    v_mfma_f32_16x16x32_bf16 v[168:171], a[244:247], a[204:207], v[168:171]
    s_waitcnt lgkmcnt(5)
    v_mfma_f32_16x16x32_bf16 v[172:175], a[252:255], a[204:207], v[172:175]
    s_add_u32 m0, s38, 24576
    ds_read_b64_tr_b16 a[240:241], v5 offset:37224
    v_mfma_f32_16x16x32_bf16 v[172:175], a[248:251], a[200:203], v[172:175]
    s_add_u32 s39, s60, s87
    ds_read_b64_tr_b16 a[242:243], v5 offset:38760
    v_mfma_f32_16x16x32_bf16 v[164:167], a[248:251], a[192:195], v[164:167]
    v_mfma_f32_16x16x32_bf16 v[164:167], a[252:255], a[196:199], v[164:167]
    buffer_load_dwordx4 v1, s[8:11], s39 offen lds
    v_mfma_f32_16x16x32_bf16 v[156:159], a[252:255], a[188:191], v[156:159]
    v_mfma_f32_16x16x32_bf16 v[156:159], a[248:251], a[184:187], v[156:159]
    s_add_u32 s39, s39, 9216
    ds_read_b64_tr_b16 a[244:245], v5 offset:49544
    v_mfma_f32_16x16x32_bf16 v[148:151], a[248:251], a[176:179], v[148:151]
    ds_read_b64_tr_b16 a[246:247], v5 offset:51080
    v_mfma_f32_16x16x32_bf16 v[148:151], a[252:255], a[180:183], v[148:151]
    v_mfma_f32_16x16x32_bf16 v[140:143], a[252:255], a[172:175], v[140:143]
    buffer_load_dwordx4 v1, s[8:11], s39 offen offset:1024 lds
    v_mfma_f32_16x16x32_bf16 v[140:143], a[248:251], a[168:171], v[140:143]
    s_waitcnt lgkmcnt(4)
    v_mfma_f32_16x16x32_bf16 v[176:179], a[12:15], a[168:171], v[176:179]
    s_add_u32 m0, s38, 32768
    ds_read_b64_tr_b16 a[248:249], v6 offset:37216
    v_mfma_f32_16x16x32_bf16 v[176:179], a[16:19], a[172:175], v[176:179]
    s_add_u32 s39, s60, 81920
    ds_read_b64_tr_b16 a[250:251], v6 offset:38752
    v_mfma_f32_16x16x32_bf16 v[184:187], a[16:19], a[180:183], v[184:187]
    v_mfma_f32_16x16x32_bf16 v[184:187], a[12:15], a[176:179], v[184:187]
    buffer_load_dwordx4 v1, s[8:11], s39 offen lds
    v_mfma_f32_16x16x32_bf16 v[192:195], a[12:15], a[184:187], v[192:195]
    v_mfma_f32_16x16x32_bf16 v[192:195], a[16:19], a[188:191], v[192:195]
    s_add_u32 s39, s39, 9216
    ds_read_b64_tr_b16 a[252:253], v6 offset:49536
    v_mfma_f32_16x16x32_bf16 v[200:203], a[16:19], a[196:199], v[200:203]
    ds_read_b64_tr_b16 a[254:255], v6 offset:51072
    v_mfma_f32_16x16x32_bf16 v[200:203], a[12:15], a[192:195], v[200:203]
    v_mfma_f32_16x16x32_bf16 v[208:211], a[12:15], a[200:203], v[208:211]
    buffer_load_dwordx4 v1, s[8:11], s39 offen offset:1024 lds
    v_mfma_f32_16x16x32_bf16 v[208:211], a[16:19], a[204:207], v[208:211]
    s_waitcnt lgkmcnt(4)
    v_mfma_f32_16x16x32_bf16 v[212:215], a[244:247], a[204:207], v[212:215]
    s_add_u32 m0, s38, 40960
    ds_read_b64_tr_b16 a[12:13], v6 offset:37224
    v_mfma_f32_16x16x32_bf16 v[212:215], a[240:243], a[200:203], v[212:215]
    s_add_u32 s39, s61, s0
    ds_read_b64_tr_b16 a[14:15], v6 offset:38760
    v_mfma_f32_16x16x32_bf16 v[204:207], a[240:243], a[192:195], v[204:207]
    v_mfma_f32_16x16x32_bf16 v[204:207], a[244:247], a[196:199], v[204:207]
    buffer_load_dwordx4 v1, s[8:11], s39 offen lds
    v_mfma_f32_16x16x32_bf16 v[196:199], a[244:247], a[188:191], v[196:199]
    v_mfma_f32_16x16x32_bf16 v[196:199], a[240:243], a[184:187], v[196:199]
    s_add_u32 s39, s39, 9216
    ds_read_b64_tr_b16 a[16:17], v6 offset:49544
    v_mfma_f32_16x16x32_bf16 v[188:191], a[240:243], a[176:179], v[188:191]
    ds_read_b64_tr_b16 a[18:19], v6 offset:51080
    v_mfma_f32_16x16x32_bf16 v[188:191], a[244:247], a[180:183], v[188:191]
    v_mfma_f32_16x16x32_bf16 v[180:183], a[244:247], a[172:175], v[180:183]
    buffer_load_dwordx4 v1, s[8:11], s39 offen offset:1024 lds
    v_mfma_f32_16x16x32_bf16 v[180:183], a[240:243], a[168:171], v[180:183]
    s_waitcnt lgkmcnt(4)
    s_waitcnt vmcnt(19)
    s_barrier
    v_mfma_f32_16x16x32_bf16 v[216:219], a[248:251], a[168:171], v[216:219]
    ds_read_b64_tr_b16 a[240:241], v5 offset:0
    v_mfma_f32_16x16x32_bf16 v[216:219], a[252:255], a[172:175], v[216:219]
    ds_read_b64_tr_b16 a[242:243], v5 offset:1536
    v_mfma_f32_16x16x32_bf16 v[224:227], a[252:255], a[180:183], v[224:227]
    s_waitcnt vmcnt(14)
    ds_read_b128 a[84:87], v12 offset:49152
    v_mfma_f32_16x16x32_bf16 v[224:227], a[248:251], a[176:179], v[224:227]
    v_mfma_f32_16x16x32_bf16 v[232:235], a[248:251], a[184:187], v[232:235]
    v_mfma_f32_16x16x32_bf16 v[232:235], a[252:255], a[188:191], v[232:235]
    ds_read_b64_tr_b16 a[244:245], v5 offset:12320
    v_mfma_f32_16x16x32_bf16 v[240:243], a[252:255], a[196:199], v[240:243]
    ds_read_b64_tr_b16 a[246:247], v5 offset:13856
    v_mfma_f32_16x16x32_bf16 v[240:243], a[248:251], a[192:195], v[240:243]
    ds_read_b128 a[88:91], v13 offset:49152
    v_mfma_f32_16x16x32_bf16 v[248:251], a[248:251], a[200:203], v[248:251]
    v_mfma_f32_16x16x32_bf16 v[248:251], a[252:255], a[204:207], v[248:251]
    s_waitcnt lgkmcnt(6)
    s_barrier
    v_mfma_f32_16x16x32_bf16 v[252:255], a[16:19], a[204:207], v[252:255]
    s_add_u32 m0, s31, 36960
    ds_read_b64_tr_b16 a[248:249], v5 offset:8
    v_mfma_f32_16x16x32_bf16 v[252:255], a[12:15], a[200:203], v[252:255]
    s_add_u32 s32, s32, 393216
    ds_read_b64_tr_b16 a[250:251], v5 offset:1544
    v_mfma_f32_16x16x32_bf16 v[244:247], a[12:15], a[192:195], v[244:247]
    s_waitcnt vmcnt(12)
    ds_read_b128 a[92:95], v12 offset:57344
    v_mfma_f32_16x16x32_bf16 v[244:247], a[16:19], a[196:199], v[244:247]
    buffer_load_dwordx4 v2, s[12:15], s32 offen lds
    v_mfma_f32_16x16x32_bf16 v[236:239], a[16:19], a[188:191], v[236:239]
    v_mfma_f32_16x16x32_bf16 v[236:239], a[12:15], a[184:187], v[236:239]
    ds_read_b64_tr_b16 a[252:253], v5 offset:12328
    v_mfma_f32_16x16x32_bf16 v[228:231], a[12:15], a[176:179], v[228:231]
    ds_read_b64_tr_b16 a[254:255], v5 offset:13864
    v_mfma_f32_16x16x32_bf16 v[228:231], a[16:19], a[180:183], v[228:231]
    ds_read_b128 a[96:99], v13 offset:57344
    v_mfma_f32_16x16x32_bf16 v[220:223], a[16:19], a[172:175], v[220:223]
    buffer_load_dwordx4 v3, s[12:15], s32 offen offset:1024 lds
    v_mfma_f32_16x16x32_bf16 v[220:223], a[12:15], a[168:171], v[220:223]
    s_waitcnt lgkmcnt(7)
    v_mfma_f32_16x16x32_bf16 v[16:19], a[240:243], a[208:211], v[16:19]
    ds_read_b64_tr_b16 a[12:13], v6 offset:0
    v_mfma_f32_16x16x32_bf16 v[16:19], a[244:247], a[212:215], v[16:19]
    ds_read_b64_tr_b16 a[14:15], v6 offset:1536
    v_mfma_f32_16x16x32_bf16 v[24:27], a[244:247], a[220:223], v[24:27]
    s_waitcnt vmcnt(12)
    ds_read_b128 a[100:103], v12 offset:0
    v_mfma_f32_16x16x32_bf16 v[24:27], a[240:243], a[216:219], v[24:27]
    buffer_load_dwordx4 v4, s[12:15], s32 offen offset:2048 lds
    v_mfma_f32_16x16x32_bf16 v[32:35], a[240:243], a[224:227], v[32:35]
    v_mfma_f32_16x16x32_bf16 v[32:35], a[244:247], a[228:231], v[32:35]
    s_add_u32 m0, s31, 49280
    ds_read_b64_tr_b16 a[16:17], v6 offset:12320
    v_mfma_f32_16x16x32_bf16 v[40:43], a[244:247], a[20:23], v[40:43]
    s_mul_i32 s32, s59, 6144
    ds_read_b64_tr_b16 a[18:19], v6 offset:13856
    v_mfma_f32_16x16x32_bf16 v[40:43], a[240:243], a[232:235], v[40:43]
    ds_read_b128 a[104:107], v13 offset:0
    v_mfma_f32_16x16x32_bf16 v[48:51], a[240:243], a[24:27], v[48:51]
    buffer_load_dwordx4 v2, s[12:15], s32 offen lds
    v_mfma_f32_16x16x32_bf16 v[48:51], a[244:247], a[28:31], v[48:51]
    s_waitcnt lgkmcnt(7)
    v_mfma_f32_16x16x32_bf16 v[52:55], a[252:255], a[28:31], v[52:55]
    ds_read_b64_tr_b16 a[240:241], v6 offset:8
    v_mfma_f32_16x16x32_bf16 v[52:55], a[248:251], a[24:27], v[52:55]
    ds_read_b64_tr_b16 a[242:243], v6 offset:1544
    v_mfma_f32_16x16x32_bf16 v[44:47], a[248:251], a[232:235], v[44:47]
    s_waitcnt vmcnt(12)
    ds_read_b128 a[108:111], v12 offset:8192
    v_mfma_f32_16x16x32_bf16 v[44:47], a[252:255], a[20:23], v[44:47]
    buffer_load_dwordx4 v3, s[12:15], s32 offen offset:1024 lds
    v_mfma_f32_16x16x32_bf16 v[36:39], a[252:255], a[228:231], v[36:39]
    v_mfma_f32_16x16x32_bf16 v[36:39], a[248:251], a[224:227], v[36:39]
    ds_read_b64_tr_b16 a[244:245], v6 offset:12328
    v_mfma_f32_16x16x32_bf16 v[28:31], a[248:251], a[216:219], v[28:31]
    ds_read_b64_tr_b16 a[246:247], v6 offset:13864
    v_mfma_f32_16x16x32_bf16 v[28:31], a[252:255], a[220:223], v[28:31]
    ds_read_b128 a[112:115], v13 offset:8192
    v_mfma_f32_16x16x32_bf16 v[20:23], a[252:255], a[212:215], v[20:23]
    buffer_load_dwordx4 v4, s[12:15], s32 offen offset:2048 lds
    v_mfma_f32_16x16x32_bf16 v[20:23], a[248:251], a[208:211], v[20:23]
    s_waitcnt lgkmcnt(7)
    v_mfma_f32_16x16x32_bf16 v[56:59], a[12:15], a[208:211], v[56:59]
    s_add_u32 m0, s38, 49152
    ds_read_b64_tr_b16 a[248:249], v5 offset:128
    v_mfma_f32_16x16x32_bf16 v[56:59], a[16:19], a[212:215], v[56:59]
    s_add_u32 s39, s61, s1
    ds_read_b64_tr_b16 a[250:251], v5 offset:1664
    v_mfma_f32_16x16x32_bf16 v[64:67], a[16:19], a[220:223], v[64:67]
    s_waitcnt vmcnt(12)
    ds_read_b128 a[116:119], v12 offset:16384
    v_mfma_f32_16x16x32_bf16 v[64:67], a[12:15], a[216:219], v[64:67]
    buffer_load_dwordx4 v1, s[8:11], s39 offen lds
    v_mfma_f32_16x16x32_bf16 v[72:75], a[12:15], a[224:227], v[72:75]
    v_mfma_f32_16x16x32_bf16 v[72:75], a[16:19], a[228:231], v[72:75]
    s_add_u32 s39, s39, 9216
    ds_read_b64_tr_b16 a[252:253], v5 offset:12448
    v_mfma_f32_16x16x32_bf16 v[80:83], a[16:19], a[20:23], v[80:83]
    ds_read_b64_tr_b16 a[254:255], v5 offset:13984
    v_mfma_f32_16x16x32_bf16 v[80:83], a[12:15], a[232:235], v[80:83]
    ds_read_b128 a[120:123], v13 offset:16384
    v_mfma_f32_16x16x32_bf16 v[88:91], a[12:15], a[24:27], v[88:91]
    buffer_load_dwordx4 v1, s[8:11], s39 offen offset:1024 lds
    v_mfma_f32_16x16x32_bf16 v[88:91], a[16:19], a[28:31], v[88:91]
    s_waitcnt lgkmcnt(7)
    v_mfma_f32_16x16x32_bf16 v[92:95], a[244:247], a[28:31], v[92:95]
    s_add_u32 m0, s38, 57344
    ds_read_b64_tr_b16 a[12:13], v5 offset:136
    v_mfma_f32_16x16x32_bf16 v[92:95], a[240:243], a[24:27], v[92:95]
    s_add_u32 s39, s61, s63
    ds_read_b64_tr_b16 a[14:15], v5 offset:1672
    v_mfma_f32_16x16x32_bf16 v[84:87], a[240:243], a[232:235], v[84:87]
    s_waitcnt vmcnt(12)
    ds_read_b128 a[124:127], v12 offset:24576
    v_mfma_f32_16x16x32_bf16 v[84:87], a[244:247], a[20:23], v[84:87]
    buffer_load_dwordx4 v1, s[8:11], s39 offen lds
    v_mfma_f32_16x16x32_bf16 v[76:79], a[244:247], a[228:231], v[76:79]
    v_mfma_f32_16x16x32_bf16 v[76:79], a[240:243], a[224:227], v[76:79]
    s_add_u32 s39, s39, 9216
    ds_read_b64_tr_b16 a[16:17], v5 offset:12456
    v_mfma_f32_16x16x32_bf16 v[68:71], a[240:243], a[216:219], v[68:71]
    ds_read_b64_tr_b16 a[18:19], v5 offset:13992
    v_mfma_f32_16x16x32_bf16 v[68:71], a[244:247], a[220:223], v[68:71]
    ds_read_b128 a[128:131], v13 offset:24576
    v_mfma_f32_16x16x32_bf16 v[60:63], a[244:247], a[212:215], v[60:63]
    buffer_load_dwordx4 v1, s[8:11], s39 offen offset:1024 lds
    v_mfma_f32_16x16x32_bf16 v[60:63], a[240:243], a[208:211], v[60:63]
    s_waitcnt lgkmcnt(7)
    v_mfma_f32_16x16x32_bf16 v[96:99], a[248:251], a[208:211], v[96:99]
    s_add_u32 m0, s38, 0
    ds_read_b64_tr_b16 a[240:241], v6 offset:128
    v_mfma_f32_16x16x32_bf16 v[96:99], a[252:255], a[212:215], v[96:99]
    s_add_u32 s39, s61, s87
    ds_read_b64_tr_b16 a[242:243], v6 offset:1664
    v_mfma_f32_16x16x32_bf16 v[104:107], a[252:255], a[220:223], v[104:107]
    s_waitcnt vmcnt(12)
    ds_read_b128 a[132:135], v12 offset:32768
    v_mfma_f32_16x16x32_bf16 v[104:107], a[248:251], a[216:219], v[104:107]
    buffer_load_dwordx4 v1, s[8:11], s39 offen lds
    v_mfma_f32_16x16x32_bf16 v[112:115], a[248:251], a[224:227], v[112:115]
    s_bfe_u32 s100, s2, 131075
    v_mfma_f32_16x16x32_bf16 v[112:115], a[252:255], a[228:231], v[112:115]
    s_add_u32 s39, s39, 9216
    ds_read_b64_tr_b16 a[244:245], v6 offset:12448
    v_mfma_f32_16x16x32_bf16 v[120:123], a[252:255], a[20:23], v[120:123]
    s_and_b32 s101, s2, 1
    ds_read_b64_tr_b16 a[246:247], v6 offset:13984
    v_mfma_f32_16x16x32_bf16 v[120:123], a[248:251], a[232:235], v[120:123]
    s_lshl_b32 s101, s101, 2
    ds_read_b128 a[136:139], v13 offset:32768
    v_mfma_f32_16x16x32_bf16 v[128:131], a[248:251], a[24:27], v[128:131]
    s_add_u32 s100, s100, s101
    buffer_load_dwordx4 v1, s[8:11], s39 offen offset:1024 lds
    v_mfma_f32_16x16x32_bf16 v[128:131], a[252:255], a[28:31], v[128:131]
    s_waitcnt lgkmcnt(7)
    v_mfma_f32_16x16x32_bf16 v[132:135], a[16:19], a[28:31], v[132:135]
    s_add_u32 m0, s38, 8192
    ds_read_b64_tr_b16 a[248:249], v6 offset:136
    v_mfma_f32_16x16x32_bf16 v[132:135], a[12:15], a[24:27], v[132:135]
    s_add_u32 s39, s61, 81920
    ds_read_b64_tr_b16 a[250:251], v6 offset:1672
    v_mfma_f32_16x16x32_bf16 v[124:127], a[12:15], a[232:235], v[124:127]
    s_waitcnt vmcnt(12)
    ds_read_b128 a[140:143], v12 offset:40960
    v_mfma_f32_16x16x32_bf16 v[124:127], a[16:19], a[20:23], v[124:127]
    s_lshl_b32 s100, s100, 2
    buffer_load_dwordx4 v1, s[8:11], s39 offen lds
    v_mfma_f32_16x16x32_bf16 v[116:119], a[16:19], a[228:231], v[116:119]
    s_bfe_u32 s101, s2, 131077
    v_mfma_f32_16x16x32_bf16 v[116:119], a[12:15], a[224:227], v[116:119]
    s_add_u32 s39, s39, 9216
    ds_read_b64_tr_b16 a[252:253], v6 offset:12456
    v_min_u32 v14, 224, v0
    v_mfma_f32_16x16x32_bf16 v[108:111], a[12:15], a[216:219], v[108:111]
    s_add_u32 s100, s100, s101
    ds_read_b64_tr_b16 a[254:255], v6 offset:13992
    v_lshlrev_b32 v14, 3, v14
    v_mfma_f32_16x16x32_bf16 v[108:111], a[16:19], a[220:223], v[108:111]
    s_lshl_b32 s100, s100, 2
    ds_read_b128 a[144:147], v13 offset:40960
    v_mfma_f32_16x16x32_bf16 v[100:103], a[16:19], a[212:215], v[100:103]
    s_add_u32 s100, s100, s28
    buffer_load_dwordx4 v1, s[8:11], s39 offen offset:1024 lds
    v_mfma_f32_16x16x32_bf16 v[100:103], a[12:15], a[208:211], v[100:103]
    s_waitcnt lgkmcnt(7)
    v_mfma_f32_16x16x32_bf16 v[136:139], a[240:243], a[208:211], v[136:139]
    s_mul_i32 s100, s100, 7680
    ds_read_b64_tr_b16 a[12:13], v5 offset:256
    v_mfma_f32_16x16x32_bf16 v[136:139], a[244:247], a[212:215], v[136:139]
    s_add_u32 s100, s100, s66
    ds_read_b64_tr_b16 a[14:15], v5 offset:1792
    v_mfma_f32_16x16x32_bf16 v[144:147], a[244:247], a[220:223], v[144:147]
    s_sub_u32 s89, s100, 1966080
    v_mfma_f32_16x16x32_bf16 v[144:147], a[240:243], a[216:219], v[144:147]
    buffer_load_dword a239, v14, s[64:67], s89 offen
    v_mfma_f32_16x16x32_bf16 v[152:155], a[240:243], a[224:227], v[152:155]
    s_add_u32 s89, s89, 1920
    v_mfma_f32_16x16x32_bf16 v[152:155], a[244:247], a[228:231], v[152:155]
    ds_read_b64_tr_b16 a[16:17], v5 offset:12576
    v_mfma_f32_16x16x32_bf16 v[160:163], a[244:247], a[20:23], v[160:163]
    ds_read_b64_tr_b16 a[18:19], v5 offset:14112
    v_mfma_f32_16x16x32_bf16 v[160:163], a[240:243], a[232:235], v[160:163]
    v_mfma_f32_16x16x32_bf16 v[168:171], a[240:243], a[24:27], v[168:171]
    v_mfma_f32_16x16x32_bf16 v[168:171], a[244:247], a[28:31], v[168:171]
    s_waitcnt lgkmcnt(5)
    v_mfma_f32_16x16x32_bf16 v[172:175], a[252:255], a[28:31], v[172:175]
    ds_read_b64_tr_b16 a[240:241], v5 offset:264
    v_mfma_f32_16x16x32_bf16 v[172:175], a[248:251], a[24:27], v[172:175]
    ds_read_b64_tr_b16 a[242:243], v5 offset:1800
    v_mfma_f32_16x16x32_bf16 v[164:167], a[248:251], a[232:235], v[164:167]
    v_mfma_f32_16x16x32_bf16 v[164:167], a[252:255], a[20:23], v[164:167]
    v_mfma_f32_16x16x32_bf16 v[156:159], a[252:255], a[228:231], v[156:159]
    v_mfma_f32_16x16x32_bf16 v[156:159], a[248:251], a[224:227], v[156:159]
    ds_read_b64_tr_b16 a[244:245], v5 offset:12584
    v_mfma_f32_16x16x32_bf16 v[148:151], a[248:251], a[216:219], v[148:151]
    ds_read_b64_tr_b16 a[246:247], v5 offset:14120
    v_mfma_f32_16x16x32_bf16 v[148:151], a[252:255], a[220:223], v[148:151]
    v_mfma_f32_16x16x32_bf16 v[140:143], a[252:255], a[212:215], v[140:143]
    v_mfma_f32_16x16x32_bf16 v[140:143], a[248:251], a[208:211], v[140:143]
    s_waitcnt lgkmcnt(4)
    v_mfma_f32_16x16x32_bf16 v[176:179], a[12:15], a[208:211], v[176:179]
    ds_read_b64_tr_b16 a[248:249], v6 offset:256
    v_mfma_f32_16x16x32_bf16 v[176:179], a[16:19], a[212:215], v[176:179]
    ds_read_b64_tr_b16 a[250:251], v6 offset:1792
    v_mfma_f32_16x16x32_bf16 v[184:187], a[16:19], a[220:223], v[184:187]
    v_mfma_f32_16x16x32_bf16 v[184:187], a[12:15], a[216:219], v[184:187]
    v_mfma_f32_16x16x32_bf16 v[192:195], a[12:15], a[224:227], v[192:195]
    v_mfma_f32_16x16x32_bf16 v[192:195], a[16:19], a[228:231], v[192:195]
    ds_read_b64_tr_b16 a[252:253], v6 offset:12576
    v_mfma_f32_16x16x32_bf16 v[200:203], a[16:19], a[20:23], v[200:203]
    ds_read_b64_tr_b16 a[254:255], v6 offset:14112
    v_mfma_f32_16x16x32_bf16 v[200:203], a[12:15], a[232:235], v[200:203]
    v_mfma_f32_16x16x32_bf16 v[208:211], a[12:15], a[24:27], v[208:211]
    buffer_load_dword a239, v14, s[64:67], s89 offen
    v_mfma_f32_16x16x32_bf16 v[208:211], a[16:19], a[28:31], v[208:211]
    s_waitcnt lgkmcnt(4)
    s_add_u32 s89, s89, 1920
    v_mfma_f32_16x16x32_bf16 v[212:215], a[244:247], a[28:31], v[212:215]
    ds_read_b64_tr_b16 a[12:13], v6 offset:264
    v_mfma_f32_16x16x32_bf16 v[212:215], a[240:243], a[24:27], v[212:215]
    ds_read_b64_tr_b16 a[14:15], v6 offset:1800
    v_mfma_f32_16x16x32_bf16 v[204:207], a[240:243], a[232:235], v[204:207]
    v_mfma_f32_16x16x32_bf16 v[204:207], a[244:247], a[20:23], v[204:207]
    v_mfma_f32_16x16x32_bf16 v[196:199], a[244:247], a[228:231], v[196:199]
    v_mfma_f32_16x16x32_bf16 v[196:199], a[240:243], a[224:227], v[196:199]
    ds_read_b64_tr_b16 a[16:17], v6 offset:12584
    v_mfma_f32_16x16x32_bf16 v[188:191], a[240:243], a[216:219], v[188:191]
    ds_read_b64_tr_b16 a[18:19], v6 offset:14120
    v_mfma_f32_16x16x32_bf16 v[188:191], a[244:247], a[220:223], v[188:191]
    v_mfma_f32_16x16x32_bf16 v[180:183], a[244:247], a[212:215], v[180:183]
    v_mfma_f32_16x16x32_bf16 v[180:183], a[240:243], a[208:211], v[180:183]
    s_waitcnt lgkmcnt(4)
    s_waitcnt vmcnt(13)
    s_barrier
    v_mfma_f32_16x16x32_bf16 v[216:219], a[248:251], a[208:211], v[216:219]
    ds_read_b64_tr_b16 a[240:241], v5 offset:24640
    v_mfma_f32_16x16x32_bf16 v[216:219], a[252:255], a[212:215], v[216:219]
    ds_read_b64_tr_b16 a[242:243], v5 offset:26176
    v_mfma_f32_16x16x32_bf16 v[224:227], a[252:255], a[220:223], v[224:227]
    s_waitcnt vmcnt(8)
    ds_read_b128 a[148:151], v12 offset:49152
    v_mfma_f32_16x16x32_bf16 v[224:227], a[248:251], a[216:219], v[224:227]
    v_mfma_f32_16x16x32_bf16 v[232:235], a[248:251], a[224:227], v[232:235]
    v_mfma_f32_16x16x32_bf16 v[232:235], a[252:255], a[228:231], v[232:235]
    ds_read_b64_tr_b16 a[244:245], v5 offset:36960
    v_mfma_f32_16x16x32_bf16 v[240:243], a[252:255], a[20:23], v[240:243]
    ds_read_b64_tr_b16 a[246:247], v5 offset:38496
    v_mfma_f32_16x16x32_bf16 v[240:243], a[248:251], a[232:235], v[240:243]
    ds_read_b128 a[152:155], v13 offset:49152
    v_mfma_f32_16x16x32_bf16 v[248:251], a[248:251], a[24:27], v[248:251]
    v_mfma_f32_16x16x32_bf16 v[248:251], a[252:255], a[28:31], v[248:251]
    s_waitcnt lgkmcnt(6)
    s_barrier
    v_mfma_f32_16x16x32_bf16 v[252:255], a[16:19], a[28:31], v[252:255]
    s_add_u32 m0, s31, 0
    ds_read_b64_tr_b16 a[248:249], v5 offset:24648
    v_mfma_f32_16x16x32_bf16 v[252:255], a[12:15], a[24:27], v[252:255]
    s_add_u32 s32, s32, 393216
    ds_read_b64_tr_b16 a[250:251], v5 offset:26184
    v_mfma_f32_16x16x32_bf16 v[244:247], a[12:15], a[232:235], v[244:247]
    s_waitcnt vmcnt(6)
    ds_read_b128 a[156:159], v12 offset:57344
    v_mfma_f32_16x16x32_bf16 v[244:247], a[16:19], a[20:23], v[244:247]
    buffer_load_dwordx4 v2, s[12:15], s32 offen lds
    v_mfma_f32_16x16x32_bf16 v[236:239], a[16:19], a[228:231], v[236:239]
    v_mfma_f32_16x16x32_bf16 v[236:239], a[12:15], a[224:227], v[236:239]
    ds_read_b64_tr_b16 a[252:253], v5 offset:36968
    v_mfma_f32_16x16x32_bf16 v[228:231], a[12:15], a[216:219], v[228:231]
    ds_read_b64_tr_b16 a[254:255], v5 offset:38504
    v_mfma_f32_16x16x32_bf16 v[228:231], a[16:19], a[220:223], v[228:231]
    ds_read_b128 a[160:163], v13 offset:57344
    v_mfma_f32_16x16x32_bf16 v[220:223], a[16:19], a[212:215], v[220:223]
    buffer_load_dwordx4 v3, s[12:15], s32 offen offset:1024 lds
    v_mfma_f32_16x16x32_bf16 v[220:223], a[12:15], a[208:211], v[220:223]
    s_waitcnt lgkmcnt(7)
    v_mfma_f32_16x16x32_bf16 v[16:19], a[240:243], a[32:35], v[16:19]
    ds_read_b64_tr_b16 a[12:13], v6 offset:24640
    v_mfma_f32_16x16x32_bf16 v[16:19], a[244:247], a[36:39], v[16:19]
    ds_read_b64_tr_b16 a[14:15], v6 offset:26176
    v_mfma_f32_16x16x32_bf16 v[24:27], a[244:247], a[64:67], v[24:27]
    s_waitcnt vmcnt(6)
    ds_read_b128 a[164:167], v12 offset:0
    v_mfma_f32_16x16x32_bf16 v[24:27], a[240:243], a[60:63], v[24:27]
    buffer_load_dwordx4 v4, s[12:15], s32 offen offset:2048 lds
    v_mfma_f32_16x16x32_bf16 v[32:35], a[240:243], a[68:71], v[32:35]
    v_mfma_f32_16x16x32_bf16 v[32:35], a[244:247], a[72:75], v[32:35]
    ds_read_b64_tr_b16 a[16:17], v6 offset:36960
    v_mfma_f32_16x16x32_bf16 v[40:43], a[244:247], a[0:3], v[40:43]
    ds_read_b64_tr_b16 a[18:19], v6 offset:38496
    v_mfma_f32_16x16x32_bf16 v[40:43], a[240:243], a[76:79], v[40:43]
    ds_read_b128 a[168:171], v13 offset:0
    v_mfma_f32_16x16x32_bf16 v[48:51], a[240:243], a[4:7], v[48:51]
    buffer_load_dword a239, v14, s[64:67], s89 offen
    v_mfma_f32_16x16x32_bf16 v[48:51], a[244:247], a[8:11], v[48:51]
    s_waitcnt lgkmcnt(7)
    s_add_u32 s89, s89, 1920
    v_mfma_f32_16x16x32_bf16 v[52:55], a[252:255], a[8:11], v[52:55]
    s_add_u32 m0, s31, 12320
    ds_read_b64_tr_b16 a[240:241], v6 offset:24648
    v_mfma_f32_16x16x32_bf16 v[52:55], a[248:251], a[4:7], v[52:55]
    s_mul_i32 s32, s60, 6144
    ds_read_b64_tr_b16 a[242:243], v6 offset:26184
    v_mfma_f32_16x16x32_bf16 v[44:47], a[248:251], a[76:79], v[44:47]
    s_waitcnt vmcnt(6)
    ds_read_b128 a[172:175], v12 offset:8192
    v_mfma_f32_16x16x32_bf16 v[44:47], a[252:255], a[0:3], v[44:47]
    buffer_load_dwordx4 v2, s[12:15], s32 offen lds
    v_mfma_f32_16x16x32_bf16 v[36:39], a[252:255], a[72:75], v[36:39]
    v_mfma_f32_16x16x32_bf16 v[36:39], a[248:251], a[68:71], v[36:39]
    ds_read_b64_tr_b16 a[244:245], v6 offset:36968
    v_mfma_f32_16x16x32_bf16 v[28:31], a[248:251], a[60:63], v[28:31]
    ds_read_b64_tr_b16 a[246:247], v6 offset:38504
    v_mfma_f32_16x16x32_bf16 v[28:31], a[252:255], a[64:67], v[28:31]
    ds_read_b128 a[176:179], v13 offset:8192
    v_mfma_f32_16x16x32_bf16 v[20:23], a[252:255], a[36:39], v[20:23]
    buffer_load_dwordx4 v3, s[12:15], s32 offen offset:1024 lds
    v_mfma_f32_16x16x32_bf16 v[20:23], a[248:251], a[32:35], v[20:23]
    s_waitcnt lgkmcnt(7)
    v_mfma_f32_16x16x32_bf16 v[56:59], a[12:15], a[32:35], v[56:59]
    ds_read_b64_tr_b16 a[248:249], v5 offset:24768
    v_mfma_f32_16x16x32_bf16 v[56:59], a[16:19], a[36:39], v[56:59]
    ds_read_b64_tr_b16 a[250:251], v5 offset:26304
    v_mfma_f32_16x16x32_bf16 v[64:67], a[16:19], a[64:67], v[64:67]
    v_mfma_f32_16x16x32_bf16 v[64:67], a[12:15], a[60:63], v[64:67]
    buffer_load_dwordx4 v4, s[12:15], s32 offen offset:2048 lds
    v_mfma_f32_16x16x32_bf16 v[72:75], a[12:15], a[68:71], v[72:75]
    v_mfma_f32_16x16x32_bf16 v[72:75], a[16:19], a[72:75], v[72:75]
    ds_read_b64_tr_b16 a[252:253], v5 offset:37088
    v_mfma_f32_16x16x32_bf16 v[80:83], a[16:19], a[0:3], v[80:83]
    ds_read_b64_tr_b16 a[254:255], v5 offset:38624
    v_mfma_f32_16x16x32_bf16 v[80:83], a[12:15], a[76:79], v[80:83]
    v_mfma_f32_16x16x32_bf16 v[88:91], a[12:15], a[4:7], v[88:91]
    v_mfma_f32_16x16x32_bf16 v[88:91], a[16:19], a[8:11], v[88:91]
    s_waitcnt lgkmcnt(5)
    v_mfma_f32_16x16x32_bf16 v[92:95], a[244:247], a[8:11], v[92:95]
    ds_read_b64_tr_b16 a[12:13], v5 offset:24776
    v_mfma_f32_16x16x32_bf16 v[92:95], a[240:243], a[4:7], v[92:95]
    ds_read_b64_tr_b16 a[14:15], v5 offset:26312
    v_mfma_f32_16x16x32_bf16 v[84:87], a[240:243], a[76:79], v[84:87]
    v_mfma_f32_16x16x32_bf16 v[84:87], a[244:247], a[0:3], v[84:87]
    buffer_load_dword a239, v14, s[64:67], s89 offen
    v_mfma_f32_16x16x32_bf16 v[76:79], a[244:247], a[72:75], v[76:79]
    s_add_u32 s89, s89, 1920
    v_mfma_f32_16x16x32_bf16 v[76:79], a[240:243], a[68:71], v[76:79]
    ds_read_b64_tr_b16 a[16:17], v5 offset:37096
    v_mfma_f32_16x16x32_bf16 v[68:71], a[240:243], a[60:63], v[68:71]
    ds_read_b64_tr_b16 a[18:19], v5 offset:38632
    v_mfma_f32_16x16x32_bf16 v[68:71], a[244:247], a[64:67], v[68:71]
    v_mfma_f32_16x16x32_bf16 v[60:63], a[244:247], a[36:39], v[60:63]
    v_mfma_f32_16x16x32_bf16 v[60:63], a[240:243], a[32:35], v[60:63]
    s_waitcnt lgkmcnt(4)
    v_mfma_f32_16x16x32_bf16 v[96:99], a[248:251], a[32:35], v[96:99]
    ds_read_b64_tr_b16 a[240:241], v6 offset:24768
    v_mfma_f32_16x16x32_bf16 v[96:99], a[252:255], a[36:39], v[96:99]
    ds_read_b64_tr_b16 a[242:243], v6 offset:26304
    v_mfma_f32_16x16x32_bf16 v[104:107], a[252:255], a[64:67], v[104:107]
    v_mfma_f32_16x16x32_bf16 v[104:107], a[248:251], a[60:63], v[104:107]
    v_mfma_f32_16x16x32_bf16 v[112:115], a[248:251], a[68:71], v[112:115]
    v_mfma_f32_16x16x32_bf16 v[112:115], a[252:255], a[72:75], v[112:115]
    ds_read_b64_tr_b16 a[244:245], v6 offset:37088
    v_mfma_f32_16x16x32_bf16 v[120:123], a[252:255], a[0:3], v[120:123]
    ds_read_b64_tr_b16 a[246:247], v6 offset:38624
    v_mfma_f32_16x16x32_bf16 v[120:123], a[248:251], a[76:79], v[120:123]
    v_mfma_f32_16x16x32_bf16 v[128:131], a[248:251], a[4:7], v[128:131]
    v_mfma_f32_16x16x32_bf16 v[128:131], a[252:255], a[8:11], v[128:131]
    s_waitcnt lgkmcnt(4)
    v_mfma_f32_16x16x32_bf16 v[132:135], a[16:19], a[8:11], v[132:135]
    s_bfe_u32 s100, s2, 131075
    ds_read_b64_tr_b16 a[248:249], v6 offset:24776
    v_mul_u32_u24 v14, 43, v0
    v_mfma_f32_16x16x32_bf16 v[132:135], a[12:15], a[4:7], v[132:135]
    s_and_b32 s101, s2, 1
    ds_read_b64_tr_b16 a[250:251], v6 offset:26312
    v_lshrrev_b32 v14, 11, v14
    v_mfma_f32_16x16x32_bf16 v[124:127], a[12:15], a[76:79], v[124:127]
    s_lshl_b32 s101, s101, 2
    v_mul_u32_u24 v14, 1488, v14
    v_add_lshl_u32 v14, v14, v0, 3
    v_mfma_f32_16x16x32_bf16 v[124:127], a[16:19], a[0:3], v[124:127]
    s_add_u32 s100, s100, s101
    v_min_u32 v14, 49408, v14
    v_mfma_f32_16x16x32_bf16 v[116:119], a[16:19], a[72:75], v[116:119]
    s_lshl_b32 s100, s100, 2
    v_mfma_f32_16x16x32_bf16 v[116:119], a[12:15], a[68:71], v[116:119]
    s_add_u32 s100, s100, s28
    ds_read_b64_tr_b16 a[252:253], v6 offset:37096
    v_mfma_f32_16x16x32_bf16 v[108:111], a[12:15], a[60:63], v[108:111]
    s_mul_i32 s100, s100, 245760
    ds_read_b64_tr_b16 a[254:255], v6 offset:38632
    v_mfma_f32_16x16x32_bf16 v[108:111], a[16:19], a[64:67], v[108:111]
    s_add_u32 s89, s100, 1536
    v_mfma_f32_16x16x32_bf16 v[100:103], a[16:19], a[36:39], v[100:103]
    buffer_load_dword a239, v14, s[12:15], s89 offen
    v_mfma_f32_16x16x32_bf16 v[100:103], a[12:15], a[32:35], v[100:103]
    s_waitcnt lgkmcnt(4)
    s_add_u32 s89, s89, 61440
    v_mfma_f32_16x16x32_bf16 v[136:139], a[240:243], a[32:35], v[136:139]
    ds_read_b64_tr_b16 a[12:13], v5 offset:24896
    v_mfma_f32_16x16x32_bf16 v[136:139], a[244:247], a[36:39], v[136:139]
    ds_read_b64_tr_b16 a[14:15], v5 offset:26432
    v_mfma_f32_16x16x32_bf16 v[144:147], a[244:247], a[64:67], v[144:147]
    v_mfma_f32_16x16x32_bf16 v[144:147], a[240:243], a[60:63], v[144:147]
    v_mfma_f32_16x16x32_bf16 v[152:155], a[240:243], a[68:71], v[152:155]
    v_mfma_f32_16x16x32_bf16 v[152:155], a[244:247], a[72:75], v[152:155]
    ds_read_b64_tr_b16 a[16:17], v5 offset:37216
    v_mfma_f32_16x16x32_bf16 v[160:163], a[244:247], a[0:3], v[160:163]
    ds_read_b64_tr_b16 a[18:19], v5 offset:38752
    v_mfma_f32_16x16x32_bf16 v[160:163], a[240:243], a[76:79], v[160:163]
    v_mfma_f32_16x16x32_bf16 v[168:171], a[240:243], a[4:7], v[168:171]
    v_mfma_f32_16x16x32_bf16 v[168:171], a[244:247], a[8:11], v[168:171]
    s_waitcnt lgkmcnt(4)
    v_mfma_f32_16x16x32_bf16 v[172:175], a[252:255], a[8:11], v[172:175]
    ds_read_b64_tr_b16 a[240:241], v5 offset:24904
    v_mfma_f32_16x16x32_bf16 v[172:175], a[248:251], a[4:7], v[172:175]
    ds_read_b64_tr_b16 a[242:243], v5 offset:26440
    v_mfma_f32_16x16x32_bf16 v[164:167], a[248:251], a[76:79], v[164:167]
    v_mfma_f32_16x16x32_bf16 v[164:167], a[252:255], a[0:3], v[164:167]
    v_mfma_f32_16x16x32_bf16 v[156:159], a[252:255], a[72:75], v[156:159]
    v_mfma_f32_16x16x32_bf16 v[156:159], a[248:251], a[68:71], v[156:159]
    ds_read_b64_tr_b16 a[244:245], v5 offset:37224
    v_mfma_f32_16x16x32_bf16 v[148:151], a[248:251], a[60:63], v[148:151]
    ds_read_b64_tr_b16 a[246:247], v5 offset:38760
    v_mfma_f32_16x16x32_bf16 v[148:151], a[252:255], a[64:67], v[148:151]
    v_mfma_f32_16x16x32_bf16 v[140:143], a[252:255], a[36:39], v[140:143]
    v_mfma_f32_16x16x32_bf16 v[140:143], a[248:251], a[32:35], v[140:143]
    s_waitcnt lgkmcnt(4)
    v_mfma_f32_16x16x32_bf16 v[176:179], a[12:15], a[32:35], v[176:179]
    ds_read_b64_tr_b16 a[248:249], v6 offset:24896
    v_mfma_f32_16x16x32_bf16 v[176:179], a[16:19], a[36:39], v[176:179]
    ds_read_b64_tr_b16 a[250:251], v6 offset:26432
    v_mfma_f32_16x16x32_bf16 v[184:187], a[16:19], a[64:67], v[184:187]
    v_mfma_f32_16x16x32_bf16 v[184:187], a[12:15], a[60:63], v[184:187]
    v_mfma_f32_16x16x32_bf16 v[192:195], a[12:15], a[68:71], v[192:195]
    v_mfma_f32_16x16x32_bf16 v[192:195], a[16:19], a[72:75], v[192:195]
    ds_read_b64_tr_b16 a[252:253], v6 offset:37216
    v_mfma_f32_16x16x32_bf16 v[200:203], a[16:19], a[0:3], v[200:203]
    ds_read_b64_tr_b16 a[254:255], v6 offset:38752
    v_mfma_f32_16x16x32_bf16 v[200:203], a[12:15], a[76:79], v[200:203]
    v_mfma_f32_16x16x32_bf16 v[208:211], a[12:15], a[4:7], v[208:211]
    buffer_load_dword a239, v14, s[12:15], s89 offen
    v_mfma_f32_16x16x32_bf16 v[208:211], a[16:19], a[8:11], v[208:211]
    s_waitcnt lgkmcnt(4)
    s_add_u32 s89, s89, 61440
    v_mfma_f32_16x16x32_bf16 v[212:215], a[244:247], a[8:11], v[212:215]
    ds_read_b64_tr_b16 a[12:13], v6 offset:24904
    v_mfma_f32_16x16x32_bf16 v[212:215], a[240:243], a[4:7], v[212:215]
    ds_read_b64_tr_b16 a[14:15], v6 offset:26440
    v_mfma_f32_16x16x32_bf16 v[204:207], a[240:243], a[76:79], v[204:207]
    v_mfma_f32_16x16x32_bf16 v[204:207], a[244:247], a[0:3], v[204:207]
    v_mfma_f32_16x16x32_bf16 v[196:199], a[244:247], a[72:75], v[196:199]
    v_mfma_f32_16x16x32_bf16 v[196:199], a[240:243], a[68:71], v[196:199]
    ds_read_b64_tr_b16 a[16:17], v6 offset:37224
    v_mfma_f32_16x16x32_bf16 v[188:191], a[240:243], a[60:63], v[188:191]
    ds_read_b64_tr_b16 a[18:19], v6 offset:38760
    v_mfma_f32_16x16x32_bf16 v[188:191], a[244:247], a[64:67], v[188:191]
    v_mfma_f32_16x16x32_bf16 v[180:183], a[244:247], a[36:39], v[180:183]
    v_mfma_f32_16x16x32_bf16 v[180:183], a[240:243], a[32:35], v[180:183]
    s_waitcnt lgkmcnt(4)
    s_waitcnt vmcnt(7)
    s_barrier
    v_mfma_f32_16x16x32_bf16 v[216:219], a[248:251], a[32:35], v[216:219]
    ds_read_b64_tr_b16 a[240:241], v5 offset:49280
    v_mfma_f32_16x16x32_bf16 v[216:219], a[252:255], a[36:39], v[216:219]
    ds_read_b64_tr_b16 a[242:243], v5 offset:50816
    v_mfma_f32_16x16x32_bf16 v[224:227], a[252:255], a[64:67], v[224:227]
    v_mfma_f32_16x16x32_bf16 v[224:227], a[248:251], a[60:63], v[224:227]
    v_mfma_f32_16x16x32_bf16 v[232:235], a[248:251], a[68:71], v[232:235]
    v_mfma_f32_16x16x32_bf16 v[232:235], a[252:255], a[72:75], v[232:235]
    ds_read_b64_tr_b16 a[244:245], v5 offset:0
    v_mfma_f32_16x16x32_bf16 v[240:243], a[252:255], a[0:3], v[240:243]
    ds_read_b64_tr_b16 a[246:247], v5 offset:1536
    v_mfma_f32_16x16x32_bf16 v[240:243], a[248:251], a[76:79], v[240:243]
    v_mfma_f32_16x16x32_bf16 v[248:251], a[248:251], a[4:7], v[248:251]
    v_mfma_f32_16x16x32_bf16 v[248:251], a[252:255], a[8:11], v[248:251]
    s_waitcnt lgkmcnt(4)
    s_barrier
    v_mfma_f32_16x16x32_bf16 v[252:255], a[16:19], a[8:11], v[252:255]
    s_add_u32 m0, s31, 24640
    ds_read_b64_tr_b16 a[248:249], v5 offset:49288
    v_mfma_f32_16x16x32_bf16 v[252:255], a[12:15], a[4:7], v[252:255]
    s_add_u32 s32, s32, 393216
    ds_read_b64_tr_b16 a[250:251], v5 offset:50824
    v_mfma_f32_16x16x32_bf16 v[244:247], a[12:15], a[76:79], v[244:247]
    v_mfma_f32_16x16x32_bf16 v[244:247], a[16:19], a[0:3], v[244:247]
    buffer_load_dwordx4 v2, s[12:15], s32 offen lds
    v_mfma_f32_16x16x32_bf16 v[236:239], a[16:19], a[72:75], v[236:239]
    v_mfma_f32_16x16x32_bf16 v[236:239], a[12:15], a[68:71], v[236:239]
    ds_read_b64_tr_b16 a[252:253], v5 offset:8
    v_mfma_f32_16x16x32_bf16 v[228:231], a[12:15], a[60:63], v[228:231]
    ds_read_b64_tr_b16 a[254:255], v5 offset:1544
    v_mfma_f32_16x16x32_bf16 v[228:231], a[16:19], a[64:67], v[228:231]
    v_mfma_f32_16x16x32_bf16 v[220:223], a[16:19], a[36:39], v[220:223]
    buffer_load_dwordx4 v3, s[12:15], s32 offen offset:1024 lds
    v_mfma_f32_16x16x32_bf16 v[220:223], a[12:15], a[32:35], v[220:223]
    s_waitcnt lgkmcnt(4)
    v_mfma_f32_16x16x32_bf16 v[16:19], a[240:243], a[40:43], v[16:19]
    ds_read_b64_tr_b16 a[12:13], v6 offset:49280
    v_mfma_f32_16x16x32_bf16 v[16:19], a[244:247], a[44:47], v[16:19]
    ds_read_b64_tr_b16 a[14:15], v6 offset:50816
    v_mfma_f32_16x16x32_bf16 v[24:27], a[244:247], a[52:55], v[24:27]
    v_mfma_f32_16x16x32_bf16 v[24:27], a[240:243], a[48:51], v[24:27]
    buffer_load_dwordx4 v4, s[12:15], s32 offen offset:2048 lds
    v_mfma_f32_16x16x32_bf16 v[32:35], a[240:243], a[56:59], v[32:35]
    v_mfma_f32_16x16x32_bf16 v[32:35], a[244:247], a[80:83], v[32:35]
    ds_read_b64_tr_b16 a[16:17], v6 offset:0
    v_mfma_f32_16x16x32_bf16 v[40:43], a[244:247], a[88:91], v[40:43]
    ds_read_b64_tr_b16 a[18:19], v6 offset:1536
    v_mfma_f32_16x16x32_bf16 v[40:43], a[240:243], a[84:87], v[40:43]
    v_mfma_f32_16x16x32_bf16 v[48:51], a[240:243], a[92:95], v[48:51]
    buffer_load_dword a239, v14, s[12:15], s89 offen
    v_mfma_f32_16x16x32_bf16 v[48:51], a[244:247], a[96:99], v[48:51]
    s_waitcnt lgkmcnt(4)
    s_add_u32 s89, s89, 61440
    v_mfma_f32_16x16x32_bf16 v[52:55], a[252:255], a[96:99], v[52:55]
    s_add_u32 m0, s31, 36960
    ds_read_b64_tr_b16 a[240:241], v6 offset:49288
    v_mfma_f32_16x16x32_bf16 v[52:55], a[248:251], a[92:95], v[52:55]
    s_mul_i32 s32, s61, 6144
    ds_read_b64_tr_b16 a[242:243], v6 offset:50824
    v_mfma_f32_16x16x32_bf16 v[44:47], a[248:251], a[84:87], v[44:47]
    v_mfma_f32_16x16x32_bf16 v[44:47], a[252:255], a[88:91], v[44:47]
    buffer_load_dwordx4 v2, s[12:15], s32 offen lds
    v_mfma_f32_16x16x32_bf16 v[36:39], a[252:255], a[80:83], v[36:39]
    v_mfma_f32_16x16x32_bf16 v[36:39], a[248:251], a[56:59], v[36:39]
    ds_read_b64_tr_b16 a[244:245], v6 offset:8
    v_mfma_f32_16x16x32_bf16 v[28:31], a[248:251], a[48:51], v[28:31]
    ds_read_b64_tr_b16 a[246:247], v6 offset:1544
    v_mfma_f32_16x16x32_bf16 v[28:31], a[252:255], a[52:55], v[28:31]
    v_mfma_f32_16x16x32_bf16 v[20:23], a[252:255], a[44:47], v[20:23]
    buffer_load_dwordx4 v3, s[12:15], s32 offen offset:1024 lds
    v_mfma_f32_16x16x32_bf16 v[20:23], a[248:251], a[40:43], v[20:23]
    s_waitcnt lgkmcnt(4)
    v_mfma_f32_16x16x32_bf16 v[56:59], a[12:15], a[40:43], v[56:59]
    ds_read_b64_tr_b16 a[248:249], v5 offset:49408
    v_mfma_f32_16x16x32_bf16 v[56:59], a[16:19], a[44:47], v[56:59]
    ds_read_b64_tr_b16 a[250:251], v5 offset:50944
    v_mfma_f32_16x16x32_bf16 v[64:67], a[16:19], a[52:55], v[64:67]
    v_mfma_f32_16x16x32_bf16 v[64:67], a[12:15], a[48:51], v[64:67]
    buffer_load_dwordx4 v4, s[12:15], s32 offen offset:2048 lds
    v_mfma_f32_16x16x32_bf16 v[72:75], a[12:15], a[56:59], v[72:75]
    v_mfma_f32_16x16x32_bf16 v[72:75], a[16:19], a[80:83], v[72:75]
    ds_read_b64_tr_b16 a[252:253], v5 offset:128
    v_mfma_f32_16x16x32_bf16 v[80:83], a[16:19], a[88:91], v[80:83]
    ds_read_b64_tr_b16 a[254:255], v5 offset:1664
    v_mfma_f32_16x16x32_bf16 v[80:83], a[12:15], a[84:87], v[80:83]
    v_mfma_f32_16x16x32_bf16 v[88:91], a[12:15], a[92:95], v[88:91]
    v_mfma_f32_16x16x32_bf16 v[88:91], a[16:19], a[96:99], v[88:91]
    s_waitcnt lgkmcnt(4)
    v_mfma_f32_16x16x32_bf16 v[92:95], a[244:247], a[96:99], v[92:95]
    ds_read_b64_tr_b16 a[12:13], v5 offset:49416
    v_mfma_f32_16x16x32_bf16 v[92:95], a[240:243], a[92:95], v[92:95]
    ds_read_b64_tr_b16 a[14:15], v5 offset:50952
    v_mfma_f32_16x16x32_bf16 v[84:87], a[240:243], a[84:87], v[84:87]
    v_mfma_f32_16x16x32_bf16 v[84:87], a[244:247], a[88:91], v[84:87]
    buffer_load_dword a239, v14, s[12:15], s89 offen
    v_mfma_f32_16x16x32_bf16 v[76:79], a[244:247], a[80:83], v[76:79]
    s_add_u32 s89, s89, 61440
    v_mfma_f32_16x16x32_bf16 v[76:79], a[240:243], a[56:59], v[76:79]
    ds_read_b64_tr_b16 a[16:17], v5 offset:136
    v_mfma_f32_16x16x32_bf16 v[68:71], a[240:243], a[48:51], v[68:71]
    ds_read_b64_tr_b16 a[18:19], v5 offset:1672
    v_mfma_f32_16x16x32_bf16 v[68:71], a[244:247], a[52:55], v[68:71]
    v_mfma_f32_16x16x32_bf16 v[60:63], a[244:247], a[44:47], v[60:63]
    v_mfma_f32_16x16x32_bf16 v[60:63], a[240:243], a[40:43], v[60:63]
    s_waitcnt lgkmcnt(4)
    v_mfma_f32_16x16x32_bf16 v[96:99], a[248:251], a[40:43], v[96:99]
    ds_read_b64_tr_b16 a[240:241], v6 offset:49408
    v_mfma_f32_16x16x32_bf16 v[96:99], a[252:255], a[44:47], v[96:99]
    ds_read_b64_tr_b16 a[242:243], v6 offset:50944
    v_mfma_f32_16x16x32_bf16 v[104:107], a[252:255], a[52:55], v[104:107]
    v_mfma_f32_16x16x32_bf16 v[104:107], a[248:251], a[48:51], v[104:107]
    v_mfma_f32_16x16x32_bf16 v[112:115], a[248:251], a[56:59], v[112:115]
    v_mfma_f32_16x16x32_bf16 v[112:115], a[252:255], a[80:83], v[112:115]
    ds_read_b64_tr_b16 a[244:245], v6 offset:128
    v_mfma_f32_16x16x32_bf16 v[120:123], a[252:255], a[88:91], v[120:123]
    ds_read_b64_tr_b16 a[246:247], v6 offset:1664
    v_mfma_f32_16x16x32_bf16 v[120:123], a[248:251], a[84:87], v[120:123]
    v_mfma_f32_16x16x32_bf16 v[128:131], a[248:251], a[92:95], v[128:131]
    v_mfma_f32_16x16x32_bf16 v[128:131], a[252:255], a[96:99], v[128:131]
    s_waitcnt lgkmcnt(4)
    v_mfma_f32_16x16x32_bf16 v[132:135], a[16:19], a[96:99], v[132:135]
    ds_read_b64_tr_b16 a[248:249], v6 offset:49416
    v_mfma_f32_16x16x32_bf16 v[132:135], a[12:15], a[92:95], v[132:135]
    ds_read_b64_tr_b16 a[250:251], v6 offset:50952
    v_mfma_f32_16x16x32_bf16 v[124:127], a[12:15], a[84:87], v[124:127]
    v_mfma_f32_16x16x32_bf16 v[124:127], a[16:19], a[88:91], v[124:127]
    v_mfma_f32_16x16x32_bf16 v[116:119], a[16:19], a[80:83], v[116:119]
    v_mfma_f32_16x16x32_bf16 v[116:119], a[12:15], a[56:59], v[116:119]
    s_add_u32 m0, s33, 0
    ds_read_b64_tr_b16 a[252:253], v6 offset:136
    v_mfma_f32_16x16x32_bf16 v[108:111], a[12:15], a[48:51], v[108:111]
    s_mov_b32 s35, 0
    ds_read_b64_tr_b16 a[254:255], v6 offset:1672
    v_mfma_f32_16x16x32_bf16 v[108:111], a[16:19], a[52:55], v[108:111]
    v_mfma_f32_16x16x32_bf16 v[100:103], a[16:19], a[44:47], v[100:103]
    buffer_load_dwordx4 v7, s[16:19], s35 offen nt lds
    v_mfma_f32_16x16x32_bf16 v[100:103], a[12:15], a[40:43], v[100:103]
    s_waitcnt lgkmcnt(4)
    v_mfma_f32_16x16x32_bf16 v[136:139], a[240:243], a[40:43], v[136:139]
    ds_read_b64_tr_b16 a[12:13], v5 offset:49536
    v_mfma_f32_16x16x32_bf16 v[136:139], a[244:247], a[44:47], v[136:139]
    ds_read_b64_tr_b16 a[14:15], v5 offset:51072
    v_mfma_f32_16x16x32_bf16 v[144:147], a[244:247], a[52:55], v[144:147]
    v_mfma_f32_16x16x32_bf16 v[144:147], a[240:243], a[48:51], v[144:147]
    v_mfma_f32_16x16x32_bf16 v[152:155], a[240:243], a[56:59], v[152:155]
    v_mfma_f32_16x16x32_bf16 v[152:155], a[244:247], a[80:83], v[152:155]
    ds_read_b64_tr_b16 a[16:17], v5 offset:256
    v_mfma_f32_16x16x32_bf16 v[160:163], a[244:247], a[88:91], v[160:163]
    ds_read_b64_tr_b16 a[18:19], v5 offset:1792
    v_mfma_f32_16x16x32_bf16 v[160:163], a[240:243], a[84:87], v[160:163]
    v_mfma_f32_16x16x32_bf16 v[168:171], a[240:243], a[92:95], v[168:171]
    v_mfma_f32_16x16x32_bf16 v[168:171], a[244:247], a[96:99], v[168:171]
    s_waitcnt lgkmcnt(4)
    v_mfma_f32_16x16x32_bf16 v[172:175], a[252:255], a[96:99], v[172:175]
    s_add_u32 m0, s33, 0
    ds_read_b64_tr_b16 a[240:241], v5 offset:49544
    v_mfma_f32_16x16x32_bf16 v[172:175], a[248:251], a[92:95], v[172:175]
    s_mov_b32 s35, 0
    ds_read_b64_tr_b16 a[242:243], v5 offset:51080
    v_mfma_f32_16x16x32_bf16 v[164:167], a[248:251], a[84:87], v[164:167]
    v_mfma_f32_16x16x32_bf16 v[164:167], a[252:255], a[88:91], v[164:167]
    buffer_load_dwordx4 v8, s[16:19], s35 offen offset:1024 nt lds
    v_mfma_f32_16x16x32_bf16 v[156:159], a[252:255], a[80:83], v[156:159]
    v_mfma_f32_16x16x32_bf16 v[156:159], a[248:251], a[56:59], v[156:159]
    ds_read_b64_tr_b16 a[244:245], v5 offset:264
    v_mfma_f32_16x16x32_bf16 v[148:151], a[248:251], a[48:51], v[148:151]
    ds_read_b64_tr_b16 a[246:247], v5 offset:1800
    v_mfma_f32_16x16x32_bf16 v[148:151], a[252:255], a[52:55], v[148:151]
    v_mfma_f32_16x16x32_bf16 v[140:143], a[252:255], a[44:47], v[140:143]
    v_mfma_f32_16x16x32_bf16 v[140:143], a[248:251], a[40:43], v[140:143]
    s_waitcnt lgkmcnt(4)
    v_mfma_f32_16x16x32_bf16 v[176:179], a[12:15], a[40:43], v[176:179]
    s_add_u32 m0, s33, 0
    ds_read_b64_tr_b16 a[248:249], v6 offset:49536
    v_mfma_f32_16x16x32_bf16 v[176:179], a[16:19], a[44:47], v[176:179]
    s_mov_b32 s35, 0
    ds_read_b64_tr_b16 a[250:251], v6 offset:51072
    v_mfma_f32_16x16x32_bf16 v[184:187], a[16:19], a[52:55], v[184:187]
    v_mfma_f32_16x16x32_bf16 v[184:187], a[12:15], a[48:51], v[184:187]
    buffer_load_dwordx4 v9, s[16:19], s35 offen offset:2048 nt lds
    v_mfma_f32_16x16x32_bf16 v[192:195], a[12:15], a[56:59], v[192:195]
    v_mfma_f32_16x16x32_bf16 v[192:195], a[16:19], a[80:83], v[192:195]
    ds_read_b64_tr_b16 a[252:253], v6 offset:256
    v_mfma_f32_16x16x32_bf16 v[200:203], a[16:19], a[88:91], v[200:203]
    ds_read_b64_tr_b16 a[254:255], v6 offset:1792
    v_mfma_f32_16x16x32_bf16 v[200:203], a[12:15], a[84:87], v[200:203]
    v_mfma_f32_16x16x32_bf16 v[208:211], a[12:15], a[92:95], v[208:211]
    v_mfma_f32_16x16x32_bf16 v[208:211], a[16:19], a[96:99], v[208:211]
    s_waitcnt lgkmcnt(4)
    v_mfma_f32_16x16x32_bf16 v[212:215], a[244:247], a[96:99], v[212:215]
    ds_read_b64_tr_b16 a[12:13], v6 offset:49544
    v_mfma_f32_16x16x32_bf16 v[212:215], a[240:243], a[92:95], v[212:215]
    ds_read_b64_tr_b16 a[14:15], v6 offset:51080
    v_mfma_f32_16x16x32_bf16 v[204:207], a[240:243], a[84:87], v[204:207]
    v_mfma_f32_16x16x32_bf16 v[204:207], a[244:247], a[88:91], v[204:207]
    v_mfma_f32_16x16x32_bf16 v[196:199], a[244:247], a[80:83], v[196:199]
    v_mfma_f32_16x16x32_bf16 v[196:199], a[240:243], a[56:59], v[196:199]
    s_add_u32 m0, s33, 3072
    ds_read_b64_tr_b16 a[16:17], v6 offset:264
    v_mfma_f32_16x16x32_bf16 v[188:191], a[240:243], a[48:51], v[188:191]
    s_mov_b32 s35, 3072
    ds_read_b64_tr_b16 a[18:19], v6 offset:1800
    v_mfma_f32_16x16x32_bf16 v[188:191], a[244:247], a[52:55], v[188:191]
    v_mfma_f32_16x16x32_bf16 v[180:183], a[244:247], a[44:47], v[180:183]
    buffer_load_dwordx4 v7, s[16:19], s35 offen nt lds
    v_mfma_f32_16x16x32_bf16 v[180:183], a[240:243], a[40:43], v[180:183]
    s_waitcnt lgkmcnt(4)
    s_waitcnt vmcnt(9)
    s_barrier
    v_mfma_f32_16x16x32_bf16 v[216:219], a[248:251], a[40:43], v[216:219]
    ds_read_b64_tr_b16 a[240:241], v5 offset:12320
    v_mfma_f32_16x16x32_bf16 v[216:219], a[252:255], a[44:47], v[216:219]
    ds_read_b64_tr_b16 a[242:243], v5 offset:13856
    v_mfma_f32_16x16x32_bf16 v[224:227], a[252:255], a[52:55], v[224:227]
    v_mfma_f32_16x16x32_bf16 v[224:227], a[248:251], a[48:51], v[224:227]
    v_mfma_f32_16x16x32_bf16 v[232:235], a[248:251], a[56:59], v[232:235]
    v_mfma_f32_16x16x32_bf16 v[232:235], a[252:255], a[80:83], v[232:235]
    s_add_u32 m0, s33, 3072
    ds_read_b64_tr_b16 a[244:245], v5 offset:24640
    v_mfma_f32_16x16x32_bf16 v[240:243], a[252:255], a[88:91], v[240:243]
    s_mov_b32 s35, 3072
    ds_read_b64_tr_b16 a[246:247], v5 offset:26176
    v_mfma_f32_16x16x32_bf16 v[240:243], a[248:251], a[84:87], v[240:243]
    v_mfma_f32_16x16x32_bf16 v[248:251], a[248:251], a[92:95], v[248:251]
    buffer_load_dwordx4 v8, s[16:19], s35 offen offset:1024 nt lds
    v_mfma_f32_16x16x32_bf16 v[248:251], a[252:255], a[96:99], v[248:251]
    s_waitcnt lgkmcnt(4)
    s_barrier
    v_mfma_f32_16x16x32_bf16 v[252:255], a[16:19], a[96:99], v[252:255]
    s_add_u32 m0, s31, 49280
    ds_read_b64_tr_b16 a[248:249], v5 offset:12328
    v_mfma_f32_16x16x32_bf16 v[252:255], a[12:15], a[92:95], v[252:255]
    s_add_u32 s32, s32, 393216
    ds_read_b64_tr_b16 a[250:251], v5 offset:13864
    v_mfma_f32_16x16x32_bf16 v[244:247], a[12:15], a[84:87], v[244:247]
    v_mfma_f32_16x16x32_bf16 v[244:247], a[16:19], a[88:91], v[244:247]
    buffer_load_dwordx4 v2, s[12:15], s32 offen lds
    v_mfma_f32_16x16x32_bf16 v[236:239], a[16:19], a[80:83], v[236:239]
    v_mfma_f32_16x16x32_bf16 v[236:239], a[12:15], a[56:59], v[236:239]
    ds_read_b64_tr_b16 a[252:253], v5 offset:24648
    v_mfma_f32_16x16x32_bf16 v[228:231], a[12:15], a[48:51], v[228:231]
    ds_read_b64_tr_b16 a[254:255], v5 offset:26184
    v_mfma_f32_16x16x32_bf16 v[228:231], a[16:19], a[52:55], v[228:231]
    v_mfma_f32_16x16x32_bf16 v[220:223], a[16:19], a[44:47], v[220:223]
    buffer_load_dwordx4 v3, s[12:15], s32 offen offset:1024 lds
    v_mfma_f32_16x16x32_bf16 v[220:223], a[12:15], a[40:43], v[220:223]
    s_waitcnt lgkmcnt(4)
    v_mfma_f32_16x16x32_bf16 v[16:19], a[240:243], a[100:103], v[16:19]
    ds_read_b64_tr_b16 a[12:13], v6 offset:12320
    v_mfma_f32_16x16x32_bf16 v[16:19], a[244:247], a[104:107], v[16:19]
    ds_read_b64_tr_b16 a[14:15], v6 offset:13856
    v_mfma_f32_16x16x32_bf16 v[24:27], a[244:247], a[112:115], v[24:27]
    v_mfma_f32_16x16x32_bf16 v[24:27], a[240:243], a[108:111], v[24:27]
    buffer_load_dwordx4 v4, s[12:15], s32 offen offset:2048 lds
    v_mfma_f32_16x16x32_bf16 v[32:35], a[240:243], a[116:119], v[32:35]
    v_mfma_f32_16x16x32_bf16 v[32:35], a[244:247], a[120:123], v[32:35]
    s_add_u32 m0, s33, 3072
    ds_read_b64_tr_b16 a[16:17], v6 offset:24640
    v_mfma_f32_16x16x32_bf16 v[40:43], a[244:247], a[128:131], v[40:43]
    s_mov_b32 s35, 3072
    ds_read_b64_tr_b16 a[18:19], v6 offset:26176
    v_mfma_f32_16x16x32_bf16 v[40:43], a[240:243], a[124:127], v[40:43]
    v_mfma_f32_16x16x32_bf16 v[48:51], a[240:243], a[132:135], v[48:51]
    buffer_load_dwordx4 v9, s[16:19], s35 offen offset:2048 nt lds
    v_mfma_f32_16x16x32_bf16 v[48:51], a[244:247], a[136:139], v[48:51]
    s_waitcnt lgkmcnt(4)
    v_mfma_f32_16x16x32_bf16 v[52:55], a[252:255], a[136:139], v[52:55]
    ds_read_b64_tr_b16 a[240:241], v6 offset:12328
    v_mfma_f32_16x16x32_bf16 v[52:55], a[248:251], a[132:135], v[52:55]
    ds_read_b64_tr_b16 a[242:243], v6 offset:13864
    v_mfma_f32_16x16x32_bf16 v[44:47], a[248:251], a[124:127], v[44:47]
    v_mfma_f32_16x16x32_bf16 v[44:47], a[252:255], a[128:131], v[44:47]
    v_mfma_f32_16x16x32_bf16 v[36:39], a[252:255], a[120:123], v[36:39]
    v_mfma_f32_16x16x32_bf16 v[36:39], a[248:251], a[116:119], v[36:39]
    s_add_u32 m0, s33, 24576
    ds_read_b64_tr_b16 a[244:245], v6 offset:24648
    v_mfma_f32_16x16x32_bf16 v[28:31], a[248:251], a[108:111], v[28:31]
    s_mov_b32 s35, 12288
    ds_read_b64_tr_b16 a[246:247], v6 offset:26184
    v_mfma_f32_16x16x32_bf16 v[28:31], a[252:255], a[112:115], v[28:31]
    v_mfma_f32_16x16x32_bf16 v[20:23], a[252:255], a[104:107], v[20:23]
    buffer_load_dwordx4 v7, s[16:19], s35 offen nt lds
    v_mfma_f32_16x16x32_bf16 v[20:23], a[248:251], a[100:103], v[20:23]
    s_waitcnt lgkmcnt(4)
    v_mfma_f32_16x16x32_bf16 v[56:59], a[12:15], a[100:103], v[56:59]
    ds_read_b64_tr_b16 a[248:249], v5 offset:12448
    v_mfma_f32_16x16x32_bf16 v[56:59], a[16:19], a[104:107], v[56:59]
    ds_read_b64_tr_b16 a[250:251], v5 offset:13984
    v_mfma_f32_16x16x32_bf16 v[64:67], a[16:19], a[112:115], v[64:67]
    v_mfma_f32_16x16x32_bf16 v[64:67], a[12:15], a[108:111], v[64:67]
    v_mfma_f32_16x16x32_bf16 v[72:75], a[12:15], a[116:119], v[72:75]
    v_mfma_f32_16x16x32_bf16 v[72:75], a[16:19], a[120:123], v[72:75]
    s_add_u32 m0, s33, 24576
    ds_read_b64_tr_b16 a[252:253], v5 offset:24768
    v_mfma_f32_16x16x32_bf16 v[80:83], a[16:19], a[128:131], v[80:83]
    s_mov_b32 s35, 12288
    ds_read_b64_tr_b16 a[254:255], v5 offset:26304
    v_mfma_f32_16x16x32_bf16 v[80:83], a[12:15], a[124:127], v[80:83]
    v_mfma_f32_16x16x32_bf16 v[88:91], a[12:15], a[132:135], v[88:91]
    buffer_load_dwordx4 v8, s[16:19], s35 offen offset:1024 nt lds
    v_mfma_f32_16x16x32_bf16 v[88:91], a[16:19], a[136:139], v[88:91]
    s_waitcnt lgkmcnt(4)
    v_mfma_f32_16x16x32_bf16 v[92:95], a[244:247], a[136:139], v[92:95]
    ds_read_b64_tr_b16 a[12:13], v5 offset:12456
    v_mfma_f32_16x16x32_bf16 v[92:95], a[240:243], a[132:135], v[92:95]
    ds_read_b64_tr_b16 a[14:15], v5 offset:13992
    v_mfma_f32_16x16x32_bf16 v[84:87], a[240:243], a[124:127], v[84:87]
    v_mfma_f32_16x16x32_bf16 v[84:87], a[244:247], a[128:131], v[84:87]
    v_mfma_f32_16x16x32_bf16 v[76:79], a[244:247], a[120:123], v[76:79]
    v_mfma_f32_16x16x32_bf16 v[76:79], a[240:243], a[116:119], v[76:79]
    ds_read_b64_tr_b16 a[16:17], v5 offset:24776
    v_mfma_f32_16x16x32_bf16 v[68:71], a[240:243], a[108:111], v[68:71]
    ds_read_b64_tr_b16 a[18:19], v5 offset:26312
    v_mfma_f32_16x16x32_bf16 v[68:71], a[244:247], a[112:115], v[68:71]
    v_mfma_f32_16x16x32_bf16 v[60:63], a[244:247], a[104:107], v[60:63]
    v_mfma_f32_16x16x32_bf16 v[60:63], a[240:243], a[100:103], v[60:63]
    s_waitcnt lgkmcnt(4)
    v_mfma_f32_16x16x32_bf16 v[96:99], a[248:251], a[100:103], v[96:99]
    s_add_u32 m0, s33, 24576
    ds_read_b64_tr_b16 a[240:241], v6 offset:12448
    v_mfma_f32_16x16x32_bf16 v[96:99], a[252:255], a[104:107], v[96:99]
    s_mov_b32 s35, 12288
    ds_read_b64_tr_b16 a[242:243], v6 offset:13984
    v_mfma_f32_16x16x32_bf16 v[104:107], a[252:255], a[112:115], v[104:107]
    v_mfma_f32_16x16x32_bf16 v[104:107], a[248:251], a[108:111], v[104:107]
    buffer_load_dwordx4 v9, s[16:19], s35 offen offset:2048 nt lds
    v_mfma_f32_16x16x32_bf16 v[112:115], a[248:251], a[116:119], v[112:115]
    v_mfma_f32_16x16x32_bf16 v[112:115], a[252:255], a[120:123], v[112:115]
    ds_read_b64_tr_b16 a[244:245], v6 offset:24768
    v_mfma_f32_16x16x32_bf16 v[120:123], a[252:255], a[128:131], v[120:123]
    ds_read_b64_tr_b16 a[246:247], v6 offset:26304
    v_mfma_f32_16x16x32_bf16 v[120:123], a[248:251], a[124:127], v[120:123]
    v_mfma_f32_16x16x32_bf16 v[128:131], a[248:251], a[132:135], v[128:131]
    v_mfma_f32_16x16x32_bf16 v[128:131], a[252:255], a[136:139], v[128:131]
    s_waitcnt lgkmcnt(4)
    v_mfma_f32_16x16x32_bf16 v[132:135], a[16:19], a[136:139], v[132:135]
    s_add_u32 m0, s33, 27648
    ds_read_b64_tr_b16 a[248:249], v6 offset:12456
    v_mfma_f32_16x16x32_bf16 v[132:135], a[12:15], a[132:135], v[132:135]
    s_mov_b32 s35, 15360
    ds_read_b64_tr_b16 a[250:251], v6 offset:13992
    v_mfma_f32_16x16x32_bf16 v[124:127], a[12:15], a[124:127], v[124:127]
    v_mfma_f32_16x16x32_bf16 v[124:127], a[16:19], a[128:131], v[124:127]
    buffer_load_dwordx4 v7, s[16:19], s35 offen nt lds
    v_mfma_f32_16x16x32_bf16 v[116:119], a[16:19], a[120:123], v[116:119]
    v_mfma_f32_16x16x32_bf16 v[116:119], a[12:15], a[116:119], v[116:119]
    ds_read_b64_tr_b16 a[252:253], v6 offset:24776
    v_mfma_f32_16x16x32_bf16 v[108:111], a[12:15], a[108:111], v[108:111]
    ds_read_b64_tr_b16 a[254:255], v6 offset:26312
    v_mfma_f32_16x16x32_bf16 v[108:111], a[16:19], a[112:115], v[108:111]
    v_mfma_f32_16x16x32_bf16 v[100:103], a[16:19], a[104:107], v[100:103]
    v_mfma_f32_16x16x32_bf16 v[100:103], a[12:15], a[100:103], v[100:103]
    s_waitcnt lgkmcnt(4)
    v_mfma_f32_16x16x32_bf16 v[136:139], a[240:243], a[100:103], v[136:139]
    ds_read_b64_tr_b16 a[12:13], v5 offset:12576
    v_mfma_f32_16x16x32_bf16 v[136:139], a[244:247], a[104:107], v[136:139]
    ds_read_b64_tr_b16 a[14:15], v5 offset:14112
    v_mfma_f32_16x16x32_bf16 v[144:147], a[244:247], a[112:115], v[144:147]
    v_mfma_f32_16x16x32_bf16 v[144:147], a[240:243], a[108:111], v[144:147]
    v_mfma_f32_16x16x32_bf16 v[152:155], a[240:243], a[116:119], v[152:155]
    v_mfma_f32_16x16x32_bf16 v[152:155], a[244:247], a[120:123], v[152:155]
    s_add_u32 m0, s33, 27648
    ds_read_b64_tr_b16 a[16:17], v5 offset:24896
    v_mfma_f32_16x16x32_bf16 v[160:163], a[244:247], a[128:131], v[160:163]
    s_mov_b32 s35, 15360
    ds_read_b64_tr_b16 a[18:19], v5 offset:26432
    v_mfma_f32_16x16x32_bf16 v[160:163], a[240:243], a[124:127], v[160:163]
    v_mfma_f32_16x16x32_bf16 v[168:171], a[240:243], a[132:135], v[168:171]
    buffer_load_dwordx4 v8, s[16:19], s35 offen offset:1024 nt lds
    v_mfma_f32_16x16x32_bf16 v[168:171], a[244:247], a[136:139], v[168:171]
    s_waitcnt lgkmcnt(4)
    v_mfma_f32_16x16x32_bf16 v[172:175], a[252:255], a[136:139], v[172:175]
    ds_read_b64_tr_b16 a[240:241], v5 offset:12584
    v_mfma_f32_16x16x32_bf16 v[172:175], a[248:251], a[132:135], v[172:175]
    ds_read_b64_tr_b16 a[242:243], v5 offset:14120
    v_mfma_f32_16x16x32_bf16 v[164:167], a[248:251], a[124:127], v[164:167]
    v_mfma_f32_16x16x32_bf16 v[164:167], a[252:255], a[128:131], v[164:167]
    v_mfma_f32_16x16x32_bf16 v[156:159], a[252:255], a[120:123], v[156:159]
    v_mfma_f32_16x16x32_bf16 v[156:159], a[248:251], a[116:119], v[156:159]
    s_add_u32 m0, s33, 27648
    ds_read_b64_tr_b16 a[244:245], v5 offset:24904
    v_mfma_f32_16x16x32_bf16 v[148:151], a[248:251], a[108:111], v[148:151]
    s_mov_b32 s35, 15360
    ds_read_b64_tr_b16 a[246:247], v5 offset:26440
    v_mfma_f32_16x16x32_bf16 v[148:151], a[252:255], a[112:115], v[148:151]
    v_mfma_f32_16x16x32_bf16 v[140:143], a[252:255], a[104:107], v[140:143]
    buffer_load_dwordx4 v9, s[16:19], s35 offen offset:2048 nt lds
    v_mfma_f32_16x16x32_bf16 v[140:143], a[248:251], a[100:103], v[140:143]
    s_waitcnt lgkmcnt(4)
    v_mfma_f32_16x16x32_bf16 v[176:179], a[12:15], a[100:103], v[176:179]
    ds_read_b64_tr_b16 a[248:249], v6 offset:12576
    v_mfma_f32_16x16x32_bf16 v[176:179], a[16:19], a[104:107], v[176:179]
    ds_read_b64_tr_b16 a[250:251], v6 offset:14112
    v_mfma_f32_16x16x32_bf16 v[184:187], a[16:19], a[112:115], v[184:187]
    v_mfma_f32_16x16x32_bf16 v[184:187], a[12:15], a[108:111], v[184:187]
    v_mfma_f32_16x16x32_bf16 v[192:195], a[12:15], a[116:119], v[192:195]
    v_mfma_f32_16x16x32_bf16 v[192:195], a[16:19], a[120:123], v[192:195]
    ds_read_b64_tr_b16 a[252:253], v6 offset:24896
    v_mfma_f32_16x16x32_bf16 v[200:203], a[16:19], a[128:131], v[200:203]
    ds_read_b64_tr_b16 a[254:255], v6 offset:26432
    v_mfma_f32_16x16x32_bf16 v[200:203], a[12:15], a[124:127], v[200:203]
    v_mfma_f32_16x16x32_bf16 v[208:211], a[12:15], a[132:135], v[208:211]
    v_mfma_f32_16x16x32_bf16 v[208:211], a[16:19], a[136:139], v[208:211]
    s_waitcnt lgkmcnt(4)
    v_mfma_f32_16x16x32_bf16 v[212:215], a[244:247], a[136:139], v[212:215]
    s_add_u32 m0, s33, 49152
    ds_read_b64_tr_b16 a[12:13], v6 offset:12584
    v_mfma_f32_16x16x32_bf16 v[212:215], a[240:243], a[132:135], v[212:215]
    s_mov_b32 s35, 24576
    ds_read_b64_tr_b16 a[14:15], v6 offset:14120
    v_mfma_f32_16x16x32_bf16 v[204:207], a[240:243], a[124:127], v[204:207]
    v_mfma_f32_16x16x32_bf16 v[204:207], a[244:247], a[128:131], v[204:207]
    buffer_load_dwordx4 v7, s[16:19], s35 offen nt lds
    v_mfma_f32_16x16x32_bf16 v[196:199], a[244:247], a[120:123], v[196:199]
    v_mfma_f32_16x16x32_bf16 v[196:199], a[240:243], a[116:119], v[196:199]
    ds_read_b64_tr_b16 a[16:17], v6 offset:24904
    v_mfma_f32_16x16x32_bf16 v[188:191], a[240:243], a[108:111], v[188:191]
    ds_read_b64_tr_b16 a[18:19], v6 offset:26440
    v_mfma_f32_16x16x32_bf16 v[188:191], a[244:247], a[112:115], v[188:191]
    v_mfma_f32_16x16x32_bf16 v[180:183], a[244:247], a[104:107], v[180:183]
    v_mfma_f32_16x16x32_bf16 v[180:183], a[240:243], a[100:103], v[180:183]
    s_waitcnt lgkmcnt(4)
    s_waitcnt vmcnt(8)
    s_barrier
    v_mfma_f32_16x16x32_bf16 v[216:219], a[248:251], a[100:103], v[216:219]
    s_add_u32 m0, s33, 49152
    ds_read_b64_tr_b16 a[240:241], v5 offset:36960
    v_mfma_f32_16x16x32_bf16 v[216:219], a[252:255], a[104:107], v[216:219]
    s_mov_b32 s35, 24576
    ds_read_b64_tr_b16 a[242:243], v5 offset:38496
    v_mfma_f32_16x16x32_bf16 v[224:227], a[252:255], a[112:115], v[224:227]
    v_mfma_f32_16x16x32_bf16 v[224:227], a[248:251], a[108:111], v[224:227]
    buffer_load_dwordx4 v8, s[16:19], s35 offen offset:1024 nt lds
    v_mfma_f32_16x16x32_bf16 v[232:235], a[248:251], a[116:119], v[232:235]
    v_mfma_f32_16x16x32_bf16 v[232:235], a[252:255], a[120:123], v[232:235]
    ds_read_b64_tr_b16 a[244:245], v5 offset:49280
    v_mfma_f32_16x16x32_bf16 v[240:243], a[252:255], a[128:131], v[240:243]
    ds_read_b64_tr_b16 a[246:247], v5 offset:50816
    v_mfma_f32_16x16x32_bf16 v[240:243], a[248:251], a[124:127], v[240:243]
    v_mfma_f32_16x16x32_bf16 v[248:251], a[248:251], a[132:135], v[248:251]
    v_mfma_f32_16x16x32_bf16 v[248:251], a[252:255], a[136:139], v[248:251]
    s_waitcnt lgkmcnt(4)
    s_barrier
    v_mfma_f32_16x16x32_bf16 v[252:255], a[16:19], a[136:139], v[252:255]
    ds_read_b64_tr_b16 a[248:249], v5 offset:36968
    v_mfma_f32_16x16x32_bf16 v[252:255], a[12:15], a[132:135], v[252:255]
    ds_read_b64_tr_b16 a[250:251], v5 offset:38504
    v_mfma_f32_16x16x32_bf16 v[244:247], a[12:15], a[124:127], v[244:247]
    v_mfma_f32_16x16x32_bf16 v[244:247], a[16:19], a[128:131], v[244:247]
    v_mfma_f32_16x16x32_bf16 v[236:239], a[16:19], a[120:123], v[236:239]
    v_mfma_f32_16x16x32_bf16 v[236:239], a[12:15], a[116:119], v[236:239]
    s_add_u32 m0, s33, 49152
    ds_read_b64_tr_b16 a[252:253], v5 offset:49288
    v_mfma_f32_16x16x32_bf16 v[228:231], a[12:15], a[108:111], v[228:231]
    s_mov_b32 s35, 24576
    ds_read_b64_tr_b16 a[254:255], v5 offset:50824
    v_mfma_f32_16x16x32_bf16 v[228:231], a[16:19], a[112:115], v[228:231]
    v_mfma_f32_16x16x32_bf16 v[220:223], a[16:19], a[104:107], v[220:223]
    buffer_load_dwordx4 v9, s[16:19], s35 offen offset:2048 nt lds
    v_mfma_f32_16x16x32_bf16 v[220:223], a[12:15], a[100:103], v[220:223]
    s_waitcnt lgkmcnt(4)
    v_mfma_f32_16x16x32_bf16 v[16:19], a[240:243], a[140:143], v[16:19]
    ds_read_b64_tr_b16 a[12:13], v6 offset:36960
    v_mfma_f32_16x16x32_bf16 v[16:19], a[244:247], a[144:147], v[16:19]
    ds_read_b64_tr_b16 a[14:15], v6 offset:38496
    v_mfma_f32_16x16x32_bf16 v[24:27], a[244:247], a[152:155], v[24:27]
    v_mfma_f32_16x16x32_bf16 v[24:27], a[240:243], a[148:151], v[24:27]
    v_mfma_f32_16x16x32_bf16 v[32:35], a[240:243], a[156:159], v[32:35]
    v_mfma_f32_16x16x32_bf16 v[32:35], a[244:247], a[160:163], v[32:35]
    s_add_u32 m0, s33, 52224
    ds_read_b64_tr_b16 a[16:17], v6 offset:49280
    v_mfma_f32_16x16x32_bf16 v[40:43], a[244:247], a[168:171], v[40:43]
    s_mov_b32 s35, 27648
    ds_read_b64_tr_b16 a[18:19], v6 offset:50816
    v_mfma_f32_16x16x32_bf16 v[40:43], a[240:243], a[164:167], v[40:43]
    v_mfma_f32_16x16x32_bf16 v[48:51], a[240:243], a[172:175], v[48:51]
    buffer_load_dwordx4 v7, s[16:19], s35 offen nt lds
    v_mfma_f32_16x16x32_bf16 v[48:51], a[244:247], a[176:179], v[48:51]
    s_waitcnt lgkmcnt(4)
    v_mfma_f32_16x16x32_bf16 v[52:55], a[252:255], a[176:179], v[52:55]
    ds_read_b64_tr_b16 a[240:241], v6 offset:36968
    v_mfma_f32_16x16x32_bf16 v[52:55], a[248:251], a[172:175], v[52:55]
    ds_read_b64_tr_b16 a[242:243], v6 offset:38504
    v_mfma_f32_16x16x32_bf16 v[44:47], a[248:251], a[164:167], v[44:47]
    v_mfma_f32_16x16x32_bf16 v[44:47], a[252:255], a[168:171], v[44:47]
    v_mfma_f32_16x16x32_bf16 v[36:39], a[252:255], a[160:163], v[36:39]
    v_mfma_f32_16x16x32_bf16 v[36:39], a[248:251], a[156:159], v[36:39]
    ds_read_b64_tr_b16 a[244:245], v6 offset:49288
    v_mov_b32 v14, 1
    v_mfma_f32_16x16x32_bf16 v[28:31], a[248:251], a[148:151], v[28:31]
    ds_read_b64_tr_b16 a[246:247], v6 offset:50824
    v_mfma_f32_16x16x32_bf16 v[28:31], a[252:255], a[152:155], v[28:31]
    v_xor_b32 v13, 64, v10
    v_mfma_f32_16x16x32_bf16 v[20:23], a[252:255], a[144:147], v[20:23]
    v_mfma_f32_16x16x32_bf16 v[20:23], a[248:251], a[140:143], v[20:23]
    s_waitcnt lgkmcnt(4)
    v_mfma_f32_16x16x32_bf16 v[56:59], a[12:15], a[140:143], v[56:59]
    s_add_u32 m0, s33, 52224
    ds_read_b64_tr_b16 a[248:249], v5 offset:37088
    v_mfma_f32_16x16x32_bf16 v[56:59], a[16:19], a[144:147], v[56:59]
    s_mov_b32 s35, 27648
    ds_read_b64_tr_b16 a[250:251], v5 offset:38624
    v_mfma_f32_16x16x32_bf16 v[64:67], a[16:19], a[152:155], v[64:67]
    v_mfma_f32_16x16x32_bf16 v[64:67], a[12:15], a[148:151], v[64:67]
    buffer_load_dwordx4 v8, s[16:19], s35 offen offset:1024 nt lds
    v_mul_f32 v16, s42, v16
    v_mfma_f32_16x16x32_bf16 v[72:75], a[12:15], a[156:159], v[72:75]
    v_mul_f32 v17, s42, v17
    v_mul_f32 v18, s42, v18
    v_mfma_f32_16x16x32_bf16 v[72:75], a[16:19], a[160:163], v[72:75]
    ds_read_b64_tr_b16 a[252:253], v5 offset:49408
    v_mul_f32 v19, s42, v19
    v_mfma_f32_16x16x32_bf16 v[80:83], a[16:19], a[168:171], v[80:83]
    ds_read_b64_tr_b16 a[254:255], v5 offset:50944
    v_mul_f32 v20, s42, v20
    v_mfma_f32_16x16x32_bf16 v[80:83], a[12:15], a[164:167], v[80:83]
    v_mul_f32 v21, s42, v21
    v_mul_f32 v22, s42, v22
    v_mfma_f32_16x16x32_bf16 v[88:91], a[12:15], a[172:175], v[88:91]
    v_mul_f32 v23, s42, v23
    v_cvt_pk_bf16_f32 v16, v16, v17
    v_mfma_f32_16x16x32_bf16 v[88:91], a[16:19], a[176:179], v[88:91]
    s_waitcnt lgkmcnt(4)
    v_cvt_pk_bf16_f32 v17, v18, v19
    v_cvt_pk_bf16_f32 v18, v20, v21
    v_mfma_f32_16x16x32_bf16 v[92:95], a[244:247], a[176:179], v[92:95]
    s_add_u32 m0, s33, 52224
    ds_read_b64_tr_b16 a[12:13], v5 offset:37096
    v_cvt_pk_bf16_f32 v19, v22, v23
    v_mfma_f32_16x16x32_bf16 v[92:95], a[240:243], a[172:175], v[92:95]
    s_mov_b32 s35, 27648
    ds_read_b64_tr_b16 a[14:15], v5 offset:38632
    v_mul_f32 v24, s42, v24
    v_mfma_f32_16x16x32_bf16 v[84:87], a[240:243], a[164:167], v[84:87]
    v_mul_f32 v25, s42, v25
    v_mul_f32 v26, s42, v26
    v_mfma_f32_16x16x32_bf16 v[84:87], a[244:247], a[168:171], v[84:87]
    buffer_load_dwordx4 v9, s[16:19], s35 offen offset:2048 nt lds
    v_mul_f32 v27, s42, v27
    v_mfma_f32_16x16x32_bf16 v[76:79], a[244:247], a[160:163], v[76:79]
    v_mul_f32 v28, s42, v28
    v_mul_f32 v29, s42, v29
    v_mfma_f32_16x16x32_bf16 v[76:79], a[240:243], a[156:159], v[76:79]
    ds_read_b64_tr_b16 a[16:17], v5 offset:49416
    v_mul_f32 v30, s42, v30
    v_mfma_f32_16x16x32_bf16 v[68:71], a[240:243], a[148:151], v[68:71]
    ds_read_b64_tr_b16 a[18:19], v5 offset:50952
    v_mul_f32 v31, s42, v31
    v_mfma_f32_16x16x32_bf16 v[68:71], a[244:247], a[152:155], v[68:71]
    v_cvt_pk_bf16_f32 v20, v24, v25
    v_cvt_pk_bf16_f32 v21, v26, v27
    v_mfma_f32_16x16x32_bf16 v[60:63], a[244:247], a[144:147], v[60:63]
    v_cvt_pk_bf16_f32 v22, v28, v29
    v_cvt_pk_bf16_f32 v23, v30, v31
    v_mfma_f32_16x16x32_bf16 v[60:63], a[240:243], a[140:143], v[60:63]
    s_waitcnt lgkmcnt(4)
    v_mul_f32 v32, s42, v32
    v_mul_f32 v33, s42, v33
    v_mfma_f32_16x16x32_bf16 v[96:99], a[248:251], a[140:143], v[96:99]
    ds_read_b64_tr_b16 a[240:241], v6 offset:37088
    v_mul_f32 v34, s42, v34
    v_mfma_f32_16x16x32_bf16 v[96:99], a[252:255], a[144:147], v[96:99]
    ds_read_b64_tr_b16 a[242:243], v6 offset:38624
    v_mul_f32 v35, s42, v35
    v_mfma_f32_16x16x32_bf16 v[104:107], a[252:255], a[152:155], v[104:107]
    v_mul_f32 v36, s42, v36
    v_mul_f32 v37, s42, v37
    v_mfma_f32_16x16x32_bf16 v[104:107], a[248:251], a[148:151], v[104:107]
    v_mul_f32 v38, s42, v38
    v_mul_f32 v39, s42, v39
    v_mfma_f32_16x16x32_bf16 v[112:115], a[248:251], a[156:159], v[112:115]
    v_cvt_pk_bf16_f32 v24, v32, v33
    v_cvt_pk_bf16_f32 v25, v34, v35
    v_mfma_f32_16x16x32_bf16 v[112:115], a[252:255], a[160:163], v[112:115]
    s_add_u32 m0, s34, 24576
    ds_read_b64_tr_b16 a[244:245], v6 offset:49408
    v_cvt_pk_bf16_f32 v26, v36, v37
    v_mfma_f32_16x16x32_bf16 v[120:123], a[252:255], a[168:171], v[120:123]
    s_mov_b32 s36, 12288
    ds_read_b64_tr_b16 a[246:247], v6 offset:50944
    v_cvt_pk_bf16_f32 v27, v38, v39
    v_mfma_f32_16x16x32_bf16 v[120:123], a[248:251], a[164:167], v[120:123]
    v_mul_f32 v40, s42, v40
    v_mul_f32 v41, s42, v41
    v_mfma_f32_16x16x32_bf16 v[128:131], a[248:251], a[172:175], v[128:131]
    buffer_load_dwordx4 v7, s[20:23], s36 offen nt lds
    v_mul_f32 v42, s42, v42
    v_mfma_f32_16x16x32_bf16 v[128:131], a[252:255], a[176:179], v[128:131]
    s_waitcnt lgkmcnt(4)
    v_mul_f32 v43, s42, v43
    v_mul_f32 v44, s42, v44
    v_mfma_f32_16x16x32_bf16 v[132:135], a[16:19], a[176:179], v[132:135]
    ds_read_b64_tr_b16 a[248:249], v6 offset:37096
    v_mul_f32 v45, s42, v45
    v_mfma_f32_16x16x32_bf16 v[132:135], a[12:15], a[172:175], v[132:135]
    ds_read_b64_tr_b16 a[250:251], v6 offset:38632
    v_mul_f32 v46, s42, v46
    v_mfma_f32_16x16x32_bf16 v[124:127], a[12:15], a[164:167], v[124:127]
    v_mul_f32 v47, s42, v47
    v_cvt_pk_bf16_f32 v28, v40, v41
    v_mfma_f32_16x16x32_bf16 v[124:127], a[16:19], a[168:171], v[124:127]
    v_cvt_pk_bf16_f32 v29, v42, v43
    v_cvt_pk_bf16_f32 v30, v44, v45
    v_mfma_f32_16x16x32_bf16 v[116:119], a[16:19], a[160:163], v[116:119]
    v_cvt_pk_bf16_f32 v31, v46, v47
    v_mul_f32 v48, s42, v48
    v_mfma_f32_16x16x32_bf16 v[116:119], a[12:15], a[156:159], v[116:119]
    s_add_u32 m0, s34, 24576
    ds_read_b64_tr_b16 a[252:253], v6 offset:49416
    v_mul_f32 v49, s42, v49
    v_mfma_f32_16x16x32_bf16 v[108:111], a[12:15], a[148:151], v[108:111]
    s_mov_b32 s36, 12288
    ds_read_b64_tr_b16 a[254:255], v6 offset:50952
    v_mul_f32 v50, s42, v50
    v_mfma_f32_16x16x32_bf16 v[108:111], a[16:19], a[152:155], v[108:111]
    v_mul_f32 v51, s42, v51
    v_mul_f32 v52, s42, v52
    v_mfma_f32_16x16x32_bf16 v[100:103], a[16:19], a[144:147], v[100:103]
    buffer_load_dwordx4 v8, s[20:23], s36 offen offset:1024 nt lds
    v_mul_f32 v53, s42, v53
    v_mfma_f32_16x16x32_bf16 v[100:103], a[12:15], a[140:143], v[100:103]
    s_waitcnt lgkmcnt(4)
    v_mul_f32 v54, s42, v54
    v_mul_f32 v55, s42, v55
    v_mfma_f32_16x16x32_bf16 v[136:139], a[240:243], a[140:143], v[136:139]
    ds_read_b64_tr_b16 a[12:13], v5 offset:37216
    v_cvt_pk_bf16_f32 v32, v48, v49
    v_mfma_f32_16x16x32_bf16 v[136:139], a[244:247], a[144:147], v[136:139]
    ds_read_b64_tr_b16 a[14:15], v5 offset:38752
    v_cvt_pk_bf16_f32 v33, v50, v51
    v_mfma_f32_16x16x32_bf16 v[144:147], a[244:247], a[152:155], v[144:147]
    v_cvt_pk_bf16_f32 v34, v52, v53
    v_cvt_pk_bf16_f32 v35, v54, v55
    v_mfma_f32_16x16x32_bf16 v[144:147], a[240:243], a[148:151], v[144:147]
    v_mul_f32 v56, s42, v56
    v_mul_f32 v57, s42, v57
    v_mfma_f32_16x16x32_bf16 v[152:155], a[240:243], a[156:159], v[152:155]
    v_mul_f32 v58, s42, v58
    v_mul_f32 v59, s42, v59
    v_mfma_f32_16x16x32_bf16 v[152:155], a[244:247], a[160:163], v[152:155]
    s_add_u32 m0, s34, 24576
    ds_read_b64_tr_b16 a[16:17], v5 offset:49536
    v_mul_f32 v60, s42, v60
    v_mfma_f32_16x16x32_bf16 v[160:163], a[244:247], a[168:171], v[160:163]
    s_mov_b32 s36, 12288
    ds_read_b64_tr_b16 a[18:19], v5 offset:51072
    v_mul_f32 v61, s42, v61
    v_mfma_f32_16x16x32_bf16 v[160:163], a[240:243], a[164:167], v[160:163]
    v_mul_f32 v62, s42, v62
    v_mul_f32 v63, s42, v63
    v_mfma_f32_16x16x32_bf16 v[168:171], a[240:243], a[172:175], v[168:171]
    buffer_load_dwordx4 v9, s[20:23], s36 offen offset:2048 nt lds
    v_cvt_pk_bf16_f32 v36, v56, v57
    v_mfma_f32_16x16x32_bf16 v[168:171], a[244:247], a[176:179], v[168:171]
    s_waitcnt lgkmcnt(4)
    v_cvt_pk_bf16_f32 v37, v58, v59
    v_cvt_pk_bf16_f32 v38, v60, v61
    v_mfma_f32_16x16x32_bf16 v[172:175], a[252:255], a[176:179], v[172:175]
    ds_read_b64_tr_b16 a[240:241], v5 offset:37224
    v_cvt_pk_bf16_f32 v39, v62, v63
    v_mfma_f32_16x16x32_bf16 v[172:175], a[248:251], a[172:175], v[172:175]
    ds_read_b64_tr_b16 a[242:243], v5 offset:38760
    v_mul_f32 v64, s42, v64
    v_mfma_f32_16x16x32_bf16 v[164:167], a[248:251], a[164:167], v[164:167]
    v_mul_f32 v65, s42, v65
    v_mul_f32 v66, s42, v66
    v_mfma_f32_16x16x32_bf16 v[164:167], a[252:255], a[168:171], v[164:167]
    v_mul_f32 v67, s42, v67
    v_mul_f32 v68, s42, v68
    v_mfma_f32_16x16x32_bf16 v[156:159], a[252:255], a[160:163], v[156:159]
    v_mul_f32 v69, s42, v69
    v_mul_f32 v70, s42, v70
    v_mfma_f32_16x16x32_bf16 v[156:159], a[248:251], a[156:159], v[156:159]
    s_add_u32 m0, s34, 27648
    ds_read_b64_tr_b16 a[244:245], v5 offset:49544
    v_mul_f32 v71, s42, v71
    v_mfma_f32_16x16x32_bf16 v[148:151], a[248:251], a[148:151], v[148:151]
    s_mov_b32 s36, 15360
    ds_read_b64_tr_b16 a[246:247], v5 offset:51080
    v_cvt_pk_bf16_f32 v40, v64, v65
    v_mfma_f32_16x16x32_bf16 v[148:151], a[252:255], a[152:155], v[148:151]
    v_cvt_pk_bf16_f32 v41, v66, v67
    v_cvt_pk_bf16_f32 v42, v68, v69
    v_mfma_f32_16x16x32_bf16 v[140:143], a[252:255], a[144:147], v[140:143]
    buffer_load_dwordx4 v7, s[20:23], s36 offen nt lds
    v_cvt_pk_bf16_f32 v43, v70, v71
    v_mfma_f32_16x16x32_bf16 v[140:143], a[248:251], a[140:143], v[140:143]
    s_waitcnt lgkmcnt(4)
    v_mul_f32 v72, s42, v72
    v_mul_f32 v73, s42, v73
    v_mfma_f32_16x16x32_bf16 v[176:179], a[12:15], a[140:143], v[176:179]
    ds_read_b64_tr_b16 a[248:249], v6 offset:37216
    v_mul_f32 v74, s42, v74
    v_mfma_f32_16x16x32_bf16 v[176:179], a[16:19], a[144:147], v[176:179]
    ds_read_b64_tr_b16 a[250:251], v6 offset:38752
    v_mul_f32 v75, s42, v75
    v_mfma_f32_16x16x32_bf16 v[184:187], a[16:19], a[152:155], v[184:187]
    v_mul_f32 v76, s42, v76
    v_mul_f32 v77, s42, v77
    v_mfma_f32_16x16x32_bf16 v[184:187], a[12:15], a[148:151], v[184:187]
    v_mul_f32 v78, s42, v78
    v_mul_f32 v79, s42, v79
    v_mfma_f32_16x16x32_bf16 v[192:195], a[12:15], a[156:159], v[192:195]
    v_cvt_pk_bf16_f32 v44, v72, v73
    v_cvt_pk_bf16_f32 v45, v74, v75
    v_mfma_f32_16x16x32_bf16 v[192:195], a[16:19], a[160:163], v[192:195]
    s_add_u32 m0, s34, 27648
    ds_read_b64_tr_b16 a[252:253], v6 offset:49536
    v_cvt_pk_bf16_f32 v46, v76, v77
    v_mfma_f32_16x16x32_bf16 v[200:203], a[16:19], a[168:171], v[200:203]
    s_mov_b32 s36, 15360
    ds_read_b64_tr_b16 a[254:255], v6 offset:51072
    v_cvt_pk_bf16_f32 v47, v78, v79
    v_mfma_f32_16x16x32_bf16 v[200:203], a[12:15], a[164:167], v[200:203]
    v_mul_f32 v80, s42, v80
    v_mul_f32 v81, s42, v81
    v_mfma_f32_16x16x32_bf16 v[208:211], a[12:15], a[172:175], v[208:211]
    buffer_load_dwordx4 v8, s[20:23], s36 offen offset:1024 nt lds
    v_mul_f32 v82, s42, v82
    v_mfma_f32_16x16x32_bf16 v[208:211], a[16:19], a[176:179], v[208:211]
    s_waitcnt lgkmcnt(4)
    v_mul_f32 v83, s42, v83
    v_mul_f32 v84, s42, v84
    v_mfma_f32_16x16x32_bf16 v[212:215], a[244:247], a[176:179], v[212:215]
    ds_read_b64_tr_b16 a[12:13], v6 offset:37224
    v_mul_f32 v85, s42, v85
    v_mfma_f32_16x16x32_bf16 v[212:215], a[240:243], a[172:175], v[212:215]
    ds_read_b64_tr_b16 a[14:15], v6 offset:38760
    v_mul_f32 v86, s42, v86
    v_mfma_f32_16x16x32_bf16 v[204:207], a[240:243], a[164:167], v[204:207]
    v_mul_f32 v87, s42, v87
    v_cvt_pk_bf16_f32 v48, v80, v81
    v_mfma_f32_16x16x32_bf16 v[204:207], a[244:247], a[168:171], v[204:207]
    v_cvt_pk_bf16_f32 v49, v82, v83
    v_cvt_pk_bf16_f32 v50, v84, v85
    v_mfma_f32_16x16x32_bf16 v[196:199], a[244:247], a[160:163], v[196:199]
    v_cvt_pk_bf16_f32 v51, v86, v87
    v_mul_f32 v88, s42, v88
    v_mfma_f32_16x16x32_bf16 v[196:199], a[240:243], a[156:159], v[196:199]
    s_add_u32 m0, s34, 27648
    ds_read_b64_tr_b16 a[16:17], v6 offset:49544
    v_mul_f32 v89, s42, v89
    v_mfma_f32_16x16x32_bf16 v[188:191], a[240:243], a[148:151], v[188:191]
    s_mov_b32 s36, 15360
    ds_read_b64_tr_b16 a[18:19], v6 offset:51080
    v_mul_f32 v90, s42, v90
    v_mfma_f32_16x16x32_bf16 v[188:191], a[244:247], a[152:155], v[188:191]
    v_mul_f32 v91, s42, v91
    v_mul_f32 v92, s42, v92
    v_mfma_f32_16x16x32_bf16 v[180:183], a[244:247], a[144:147], v[180:183]
    buffer_load_dwordx4 v9, s[20:23], s36 offen offset:2048 nt lds
    v_mul_f32 v93, s42, v93
    v_mfma_f32_16x16x32_bf16 v[180:183], a[240:243], a[140:143], v[180:183]
    s_waitcnt lgkmcnt(4)
    s_waitcnt vmcnt(18)
    s_barrier
    v_mfma_f32_16x16x32_bf16 v[216:219], a[248:251], a[140:143], v[216:219]
    ds_read_b128 a[240:243], v10 offset:0
    v_mul_f32 v94, s42, v94
    v_mfma_f32_16x16x32_bf16 v[216:219], a[252:255], a[144:147], v[216:219]
    v_mul_f32 v95, s42, v95
    v_cvt_pk_bf16_f32 v52, v88, v89
    v_mfma_f32_16x16x32_bf16 v[224:227], a[252:255], a[152:155], v[224:227]
    v_cvt_pk_bf16_f32 v53, v90, v91
    v_cvt_pk_bf16_f32 v54, v92, v93
    v_mfma_f32_16x16x32_bf16 v[224:227], a[248:251], a[148:151], v[224:227]
    v_cvt_pk_bf16_f32 v55, v94, v95
    v_mul_f32 v96, s42, v96
    v_mfma_f32_16x16x32_bf16 v[232:235], a[248:251], a[156:159], v[232:235]
    v_mul_f32 v97, s42, v97
    v_mul_f32 v98, s42, v98
    v_mfma_f32_16x16x32_bf16 v[232:235], a[252:255], a[160:163], v[232:235]
    ds_read_b128 a[244:247], v13 offset:0
    v_mul_f32 v99, s42, v99
    v_mfma_f32_16x16x32_bf16 v[240:243], a[252:255], a[168:171], v[240:243]
    v_mul_f32 v100, s42, v100
    v_mul_f32 v101, s42, v101
    v_mfma_f32_16x16x32_bf16 v[240:243], a[248:251], a[164:167], v[240:243]
    v_mul_f32 v102, s42, v102
    v_mul_f32 v103, s42, v103
    v_mfma_f32_16x16x32_bf16 v[248:251], a[248:251], a[172:175], v[248:251]
    v_cvt_pk_bf16_f32 v56, v96, v97
    v_cvt_pk_bf16_f32 v57, v98, v99
    v_mfma_f32_16x16x32_bf16 v[248:251], a[252:255], a[176:179], v[248:251]
    s_waitcnt lgkmcnt(2)
    v_cvt_pk_bf16_f32 v58, v100, v101
    v_cvt_pk_bf16_f32 v59, v102, v103
    v_mfma_f32_16x16x32_bf16 v[252:255], a[16:19], a[176:179], v[252:255]
    v_mul_f32 v104, s42, v104
    v_mul_f32 v105, s42, v105
    v_mfma_f32_16x16x32_bf16 v[252:255], a[12:15], a[172:175], v[252:255]
    v_mul_f32 v106, s42, v106
    v_mul_f32 v107, s42, v107
    v_mfma_f32_16x16x32_bf16 v[244:247], a[12:15], a[164:167], v[244:247]
    v_mul_f32 v108, s42, v108
    v_mul_f32 v109, s42, v109
    v_mfma_f32_16x16x32_bf16 v[244:247], a[16:19], a[168:171], v[244:247]
    v_mul_f32 v110, s42, v110
    v_mul_f32 v111, s42, v111
    v_mfma_f32_16x16x32_bf16 v[236:239], a[16:19], a[160:163], v[236:239]
    s_add_u32 s12, s12, 1536
    s_addc_u32 s13, s13, 0
    s_sub_u32 s14, s14, 1536
    v_mfma_f32_16x16x32_bf16 v[236:239], a[12:15], a[156:159], v[236:239]
    v_cvt_pk_bf16_f32 v60, v104, v105
    v_cvt_pk_bf16_f32 v61, v106, v107
    v_mfma_f32_16x16x32_bf16 v[228:231], a[12:15], a[148:151], v[228:231]
    v_cvt_pk_bf16_f32 v62, v108, v109
    v_cvt_pk_bf16_f32 v63, v110, v111
    v_mfma_f32_16x16x32_bf16 v[228:231], a[16:19], a[152:155], v[228:231]
    v_mul_f32 v112, s42, v112
    v_mul_f32 v113, s42, v113
    v_mfma_f32_16x16x32_bf16 v[220:223], a[16:19], a[144:147], v[220:223]
    v_mul_f32 v114, s42, v114
    v_mul_f32 v115, s42, v115
    v_mfma_f32_16x16x32_bf16 v[220:223], a[12:15], a[140:143], v[220:223]
    s_waitcnt lgkmcnt(0)
    s_mov_b32 s35, 36864
    s_mov_b32 s36, 24576
    v_mul_f32 v116, s42, v116
    v_mul_f32 v117, s42, v117
    v_mul_f32 v118, s42, v118
    v_mul_f32 v119, s42, v119
    v_cvt_pk_bf16_f32 v64, v112, v113
    v_cvt_pk_bf16_f32 v65, v114, v115
    v_cvt_pk_bf16_f32 v66, v116, v117
    v_cvt_pk_bf16_f32 v67, v118, v119
    v_pk_mul_f32 v[120:121], v[120:121], s[42:43]
    v_pk_mul_f32 v[122:123], v[122:123], s[42:43]
    v_pk_mul_f32 v[124:125], v[124:125], s[42:43]
    v_pk_mul_f32 v[126:127], v[126:127], s[42:43]
    v_cvt_pk_bf16_f32 v68, v120, v121
    v_cvt_pk_bf16_f32 v69, v122, v123
    v_cvt_pk_bf16_f32 v70, v124, v125
    v_cvt_pk_bf16_f32 v71, v126, v127
    v_pk_mul_f32 v[128:129], v[128:129], s[42:43]
    v_pk_mul_f32 v[130:131], v[130:131], s[42:43]
    v_pk_mul_f32 v[132:133], v[132:133], s[42:43]
    v_pk_mul_f32 v[134:135], v[134:135], s[42:43]
    v_cvt_pk_bf16_f32 v72, v128, v129
    v_cvt_pk_bf16_f32 v73, v130, v131
    v_cvt_pk_bf16_f32 v74, v132, v133
    v_cvt_pk_bf16_f32 v75, v134, v135
    v_pk_mul_f32 v[136:137], v[136:137], s[42:43]
    v_pk_mul_f32 v[138:139], v[138:139], s[42:43]
    v_pk_mul_f32 v[140:141], v[140:141], s[42:43]
    v_pk_mul_f32 v[142:143], v[142:143], s[42:43]
    v_cvt_pk_bf16_f32 v76, v136, v137
    v_cvt_pk_bf16_f32 v77, v138, v139
    v_cvt_pk_bf16_f32 v78, v140, v141
    v_cvt_pk_bf16_f32 v79, v142, v143
    v_pk_mul_f32 v[144:145], v[144:145], s[42:43]
    v_pk_mul_f32 v[146:147], v[146:147], s[42:43]
    v_pk_mul_f32 v[148:149], v[148:149], s[42:43]
    v_pk_mul_f32 v[150:151], v[150:151], s[42:43]
    v_cvt_pk_bf16_f32 v80, v144, v145
    v_cvt_pk_bf16_f32 v81, v146, v147
    v_cvt_pk_bf16_f32 v82, v148, v149
    v_cvt_pk_bf16_f32 v83, v150, v151
    v_pk_mul_f32 v[152:153], v[152:153], s[42:43]
    v_pk_mul_f32 v[154:155], v[154:155], s[42:43]
    v_pk_mul_f32 v[156:157], v[156:157], s[42:43]
    v_pk_mul_f32 v[158:159], v[158:159], s[42:43]
    v_cvt_pk_bf16_f32 v84, v152, v153
    v_cvt_pk_bf16_f32 v85, v154, v155
    v_cvt_pk_bf16_f32 v86, v156, v157
    v_cvt_pk_bf16_f32 v87, v158, v159
    v_pk_mul_f32 v[160:161], v[160:161], s[42:43]
    v_pk_mul_f32 v[162:163], v[162:163], s[42:43]
    v_pk_mul_f32 v[164:165], v[164:165], s[42:43]
    v_pk_mul_f32 v[166:167], v[166:167], s[42:43]
    v_cvt_pk_bf16_f32 v88, v160, v161
    v_cvt_pk_bf16_f32 v89, v162, v163
    v_cvt_pk_bf16_f32 v90, v164, v165
    v_cvt_pk_bf16_f32 v91, v166, v167
    v_pk_mul_f32 v[168:169], v[168:169], s[42:43]
    v_pk_mul_f32 v[170:171], v[170:171], s[42:43]
    v_pk_mul_f32 v[172:173], v[172:173], s[42:43]
    v_pk_mul_f32 v[174:175], v[174:175], s[42:43]
    v_cvt_pk_bf16_f32 v92, v168, v169
    v_cvt_pk_bf16_f32 v93, v170, v171
    v_cvt_pk_bf16_f32 v94, v172, v173
    v_cvt_pk_bf16_f32 v95, v174, v175
    v_pk_mul_f32 v[176:177], v[176:177], s[42:43]
    v_pk_mul_f32 v[178:179], v[178:179], s[42:43]
    v_pk_mul_f32 v[180:181], v[180:181], s[42:43]
    v_pk_mul_f32 v[182:183], v[182:183], s[42:43]
    v_cvt_pk_bf16_f32 v96, v176, v177
    v_cvt_pk_bf16_f32 v97, v178, v179
    v_cvt_pk_bf16_f32 v98, v180, v181
    v_cvt_pk_bf16_f32 v99, v182, v183
    v_pk_mul_f32 v[184:185], v[184:185], s[42:43]
    v_pk_mul_f32 v[186:187], v[186:187], s[42:43]
    v_pk_mul_f32 v[188:189], v[188:189], s[42:43]
    v_pk_mul_f32 v[190:191], v[190:191], s[42:43]
    v_cvt_pk_bf16_f32 v100, v184, v185
    v_cvt_pk_bf16_f32 v101, v186, v187
    v_cvt_pk_bf16_f32 v102, v188, v189
    v_cvt_pk_bf16_f32 v103, v190, v191
    v_pk_mul_f32 v[192:193], v[192:193], s[42:43]
    v_pk_mul_f32 v[194:195], v[194:195], s[42:43]
    v_pk_mul_f32 v[196:197], v[196:197], s[42:43]
    v_pk_mul_f32 v[198:199], v[198:199], s[42:43]
    v_cvt_pk_bf16_f32 v104, v192, v193
    v_cvt_pk_bf16_f32 v105, v194, v195
    v_cvt_pk_bf16_f32 v106, v196, v197
    v_cvt_pk_bf16_f32 v107, v198, v199
    v_pk_mul_f32 v[200:201], v[200:201], s[42:43]
    v_pk_mul_f32 v[202:203], v[202:203], s[42:43]
    v_pk_mul_f32 v[204:205], v[204:205], s[42:43]
    v_pk_mul_f32 v[206:207], v[206:207], s[42:43]
    v_cvt_pk_bf16_f32 v108, v200, v201
    v_cvt_pk_bf16_f32 v109, v202, v203
    v_cvt_pk_bf16_f32 v110, v204, v205
    v_cvt_pk_bf16_f32 v111, v206, v207
    v_pk_mul_f32 v[208:209], v[208:209], s[42:43]
    v_pk_mul_f32 v[210:211], v[210:211], s[42:43]
    v_pk_mul_f32 v[212:213], v[212:213], s[42:43]
    v_pk_mul_f32 v[214:215], v[214:215], s[42:43]
    v_cvt_pk_bf16_f32 v112, v208, v209
    v_cvt_pk_bf16_f32 v113, v210, v211
    v_cvt_pk_bf16_f32 v114, v212, v213
    v_cvt_pk_bf16_f32 v115, v214, v215
    v_pk_mul_f32 v[216:217], v[216:217], s[42:43]
    v_pk_mul_f32 v[218:219], v[218:219], s[42:43]
    v_pk_mul_f32 v[220:221], v[220:221], s[42:43]
    v_pk_mul_f32 v[222:223], v[222:223], s[42:43]
    v_cvt_pk_bf16_f32 v116, v216, v217
    v_cvt_pk_bf16_f32 v117, v218, v219
    v_cvt_pk_bf16_f32 v118, v220, v221
    v_cvt_pk_bf16_f32 v119, v222, v223
    v_pk_mul_f32 v[224:225], v[224:225], s[42:43]
    v_pk_mul_f32 v[226:227], v[226:227], s[42:43]
    v_pk_mul_f32 v[228:229], v[228:229], s[42:43]
    v_pk_mul_f32 v[230:231], v[230:231], s[42:43]
    v_cvt_pk_bf16_f32 v120, v224, v225
    v_cvt_pk_bf16_f32 v121, v226, v227
    v_cvt_pk_bf16_f32 v122, v228, v229
    v_cvt_pk_bf16_f32 v123, v230, v231
.p2align 3
L_sm1:
    v_mfma_f32_16x16x32_bf16 v[156:159], a[240:243], v[16:19], 0
    ds_read_b128 a[248:251], v10 offset:128
    v_mfma_f32_16x16x32_bf16 v[156:159], a[244:247], v[36:39], v[156:159]
    s_mov_b32 s40, 0x33800000
    ds_read_b128 a[252:255], v13 offset:128
    v_mfma_f32_16x16x32_bf16 v[160:163], a[244:247], v[40:43], 0
    s_mov_b32 s41, 0x53800000
    v_mfma_f32_16x16x32_bf16 v[160:163], a[240:243], v[20:23], v[160:163]
    v_mul_f32 v232, s42, v232
    v_mul_f32 v233, s42, v233
    v_mfma_f32_16x16x32_bf16 v[164:167], a[240:243], v[24:27], 0
    s_barrier
    v_mul_f32 v234, s42, v234
    v_mul_f32 v235, s42, v235
    v_mfma_f32_16x16x32_bf16 v[164:167], a[244:247], v[44:47], v[164:167]
    s_add_u32 m0, s34, 49152
    v_mul_f32 v236, s42, v236
    v_mul_f32 v237, s42, v237
    v_mfma_f32_16x16x32_bf16 v[168:171], a[244:247], v[48:51], 0
    v_mul_f32 v238, s42, v238
    v_mul_f32 v239, s42, v239
    v_mfma_f32_16x16x32_bf16 v[168:171], a[240:243], v[28:31], v[168:171]
    v_cvt_pk_bf16_f32 v124, v232, v233
    v_cvt_pk_bf16_f32 v125, v234, v235
    v_mfma_f32_16x16x32_bf16 v[172:175], a[240:243], v[32:35], 0
    s_waitcnt vmcnt(7)
    buffer_load_dwordx4 v7, s[20:23], s36 offen nt lds
    v_cvt_pk_bf16_f32 v126, v236, v237
    v_mfma_f32_16x16x32_bf16 v[172:175], a[244:247], v[52:55], v[172:175]
    s_waitcnt lgkmcnt(0)
    v_cvt_pk_bf16_f32 v127, v238, v239
    v_mul_f32 v240, s42, v240
    v_mfma_f32_16x16x32_bf16 v[156:159], a[248:251], v[56:59], v[156:159]
    ds_read_b128 a[240:243], v10 offset:256
    v_mul_f32 v241, s42, v241
    v_mfma_f32_16x16x32_bf16 v[156:159], a[252:255], v[76:79], v[156:159]
    ds_read_b128 a[244:247], v13 offset:256
    v_mul_f32 v242, s42, v242
    v_mfma_f32_16x16x32_bf16 v[160:163], a[252:255], v[80:83], v[160:163]
    v_mul_f32 v243, s42, v243
    v_mul_f32 v244, s42, v244
    v_mfma_f32_16x16x32_bf16 v[160:163], a[248:251], v[60:63], v[160:163]
    v_mul_f32 v245, s42, v245
    v_mul_f32 v246, s42, v246
    v_mfma_f32_16x16x32_bf16 v[164:167], a[248:251], v[64:67], v[164:167]
    v_mul_f32 v247, s42, v247
    v_cvt_pk_bf16_f32 v128, v240, v241
    v_mfma_f32_16x16x32_bf16 v[164:167], a[252:255], v[84:87], v[164:167]
    v_cvt_pk_bf16_f32 v129, v242, v243
    v_cvt_pk_bf16_f32 v130, v244, v245
    v_mfma_f32_16x16x32_bf16 v[168:171], a[252:255], v[88:91], v[168:171]
    v_cvt_pk_bf16_f32 v131, v246, v247
    v_mul_f32 v248, s42, v248
    v_mfma_f32_16x16x32_bf16 v[168:171], a[248:251], v[68:71], v[168:171]
    v_mul_f32 v249, s42, v249
    v_mul_f32 v250, s42, v250
    v_mfma_f32_16x16x32_bf16 v[172:175], a[248:251], v[72:75], v[172:175]
    s_waitcnt vmcnt(7)
    buffer_load_dwordx4 v8, s[20:23], s36 offen offset:1024 nt lds
    v_mul_f32 v251, s42, v251
    v_mfma_f32_16x16x32_bf16 v[172:175], a[252:255], v[92:95], v[172:175]
    s_waitcnt lgkmcnt(0)
    v_mul_f32 v252, s42, v252
    v_mul_f32 v253, s42, v253
    v_mfma_f32_16x16x32_bf16 v[156:159], a[240:243], v[96:99], v[156:159]
    ds_read_b128 a[248:251], v10 offset:6144
    v_mul_f32 v254, s42, v254
    v_mfma_f32_16x16x32_bf16 v[156:159], a[244:247], v[116:119], v[156:159]
    ds_read_b128 a[252:255], v13 offset:6144
    v_mul_f32 v255, s42, v255
    v_mfma_f32_16x16x32_bf16 v[160:163], a[244:247], v[120:123], v[160:163]
    v_cvt_pk_bf16_f32 v132, v248, v249
    v_cvt_pk_bf16_f32 v133, v250, v251
    v_mfma_f32_16x16x32_bf16 v[160:163], a[240:243], v[100:103], v[160:163]
    v_cvt_pk_bf16_f32 v134, v252, v253
    v_cvt_pk_bf16_f32 v135, v254, v255
    v_mfma_f32_16x16x32_bf16 v[164:167], a[240:243], v[104:107], v[164:167]
    v_mov_b32 v196, 0
    v_mov_b32 v197, 0
    v_mfma_f32_16x16x32_bf16 v[164:167], a[244:247], v[124:127], v[164:167]
    v_mov_b32 v198, 0
    v_mov_b32 v199, 0
    v_mfma_f32_16x16x32_bf16 v[168:171], a[244:247], v[128:131], v[168:171]
    v_mov_b32 v200, 0
    v_mov_b32 v201, 0
    v_mfma_f32_16x16x32_bf16 v[168:171], a[240:243], v[108:111], v[168:171]
    v_mov_b32 v202, 0
    v_mov_b32 v203, 0
    v_mfma_f32_16x16x32_bf16 v[172:175], a[240:243], v[112:115], v[172:175]
    s_waitcnt vmcnt(7)
    buffer_load_dwordx4 v9, s[20:23], s36 offen offset:2048 nt lds
    v_mov_b32 v204, 0
    v_mfma_f32_16x16x32_bf16 v[172:175], a[244:247], v[132:135], v[172:175]
    s_waitcnt lgkmcnt(0)
    s_add_u32 s36, s36, 3072
    v_mov_b32 v205, 0
    v_xor_b32 v206, 32, v11
    v_mfma_f32_16x16x32_bf16 v[136:139], a[248:251], v[16:19], 0
    ds_read_b128 a[240:243], v10 offset:6272
    v_xor_b32 v207, 64, v11
    v_mfma_f32_16x16x32_bf16 v[136:139], a[252:255], v[36:39], v[136:139]
    ds_read_b128 a[244:247], v13 offset:6272
    v_xor_b32 v208, 96, v11
    v_mfma_f32_16x16x32_bf16 v[140:143], a[252:255], v[40:43], 0
    v_exp_f32 v156, v156
    v_mfma_f32_16x16x32_bf16 v[140:143], a[248:251], v[20:23], v[140:143]
    v_add_f32 v196, v196, v156
    v_mfma_f32_16x16x32_bf16 v[144:147], a[248:251], v[24:27], 0
    v_exp_f32 v157, v157
    v_mfma_f32_16x16x32_bf16 v[144:147], a[252:255], v[44:47], v[144:147]
    s_add_u32 m0, s34, 52224
    v_exp_f32 v158, v158
    v_mfma_f32_16x16x32_bf16 v[148:151], a[252:255], v[48:51], 0
    v_add_f32 v197, v197, v157
    v_add_f32 v196, v196, v158
    v_mfma_f32_16x16x32_bf16 v[148:151], a[248:251], v[28:31], v[148:151]
    v_mfma_f32_16x16x32_bf16 v[152:155], a[248:251], v[32:35], 0
    s_waitcnt vmcnt(7)
    buffer_load_dwordx4 v7, s[20:23], s36 offen nt lds
    v_exp_f32 v159, v159
    v_mfma_f32_16x16x32_bf16 v[152:155], a[252:255], v[52:55], v[152:155]
    s_waitcnt lgkmcnt(0)
    v_add_f32 v197, v197, v159
    v_mfma_f32_16x16x32_bf16 v[136:139], a[240:243], v[56:59], v[136:139]
    ds_read_b128 a[248:251], v10 offset:6400
    v_mfma_f32_16x16x32_bf16 v[136:139], a[244:247], v[76:79], v[136:139]
    ds_read_b128 a[252:255], v13 offset:6400
    v_mfma_f32_16x16x32_bf16 v[140:143], a[244:247], v[80:83], v[140:143]
    v_exp_f32 v160, v160
    v_mfma_f32_16x16x32_bf16 v[140:143], a[240:243], v[60:63], v[140:143]
    v_add_f32 v198, v198, v160
    v_mfma_f32_16x16x32_bf16 v[144:147], a[240:243], v[64:67], v[144:147]
    v_exp_f32 v161, v161
    v_mfma_f32_16x16x32_bf16 v[144:147], a[244:247], v[84:87], v[144:147]
    v_exp_f32 v162, v162
    v_mfma_f32_16x16x32_bf16 v[148:151], a[244:247], v[88:91], v[148:151]
    v_add_f32 v199, v199, v161
    v_add_f32 v198, v198, v162
    v_mfma_f32_16x16x32_bf16 v[148:151], a[240:243], v[68:71], v[148:151]
    v_exp_f32 v163, v163
    v_mfma_f32_16x16x32_bf16 v[152:155], a[240:243], v[72:75], v[152:155]
    s_waitcnt vmcnt(7)
    buffer_load_dwordx4 v8, s[20:23], s36 offen offset:1024 nt lds
    v_add_f32 v199, v199, v163
    v_mfma_f32_16x16x32_bf16 v[152:155], a[244:247], v[92:95], v[152:155]
    s_waitcnt lgkmcnt(0)
    v_mfma_f32_16x16x32_bf16 v[136:139], a[248:251], v[96:99], v[136:139]
    v_mfma_f32_16x16x32_bf16 v[136:139], a[252:255], v[116:119], v[136:139]
    v_mfma_f32_16x16x32_bf16 v[140:143], a[252:255], v[120:123], v[140:143]
    v_exp_f32 v164, v164
    v_mfma_f32_16x16x32_bf16 v[140:143], a[248:251], v[100:103], v[140:143]
    v_add_f32 v200, v200, v164
    v_mfma_f32_16x16x32_bf16 v[144:147], a[248:251], v[104:107], v[144:147]
    v_exp_f32 v165, v165
    v_mfma_f32_16x16x32_bf16 v[144:147], a[252:255], v[124:127], v[144:147]
    v_add_f32 v201, v201, v165
    v_mfma_f32_16x16x32_bf16 v[148:151], a[252:255], v[128:131], v[148:151]
    v_mfma_f32_16x16x32_bf16 v[148:151], a[248:251], v[108:111], v[148:151]
    v_exp_f32 v166, v166
    v_mfma_f32_16x16x32_bf16 v[152:155], a[248:251], v[112:115], v[152:155]
    s_waitcnt vmcnt(7)
    buffer_load_dwordx4 v9, s[20:23], s36 offen offset:2048 nt lds
    v_exp_f32 v167, v167
    v_mfma_f32_16x16x32_bf16 v[152:155], a[252:255], v[132:135], v[152:155]
    s_add_u32 s36, s36, 9216
    v_exp_f32 v168, v168
    v_add_f32 v200, v200, v166
    v_add_f32 v201, v201, v167
    v_exp_f32 v169, v169
    v_add_f32 v202, v202, v168
    v_exp_f32 v170, v170
    v_add_f32 v203, v203, v169
    v_add_f32 v202, v202, v170
    v_exp_f32 v171, v171
    s_nop 0
    v_add_f32 v203, v203, v171
    v_exp_f32 v172, v172
    s_nop 0
    v_add_f32 v204, v204, v172
    v_exp_f32 v173, v173
    s_nop 0
    v_add_f32 v205, v205, v173
    v_exp_f32 v174, v174
    s_nop 0
    v_add_f32 v204, v204, v174
    v_exp_f32 v175, v175
    s_nop 0
    v_add_f32 v205, v205, v175
    v_exp_f32 v136, v136
    s_nop 0
    v_add_f32 v196, v196, v136
    v_exp_f32 v137, v137
    s_nop 0
    v_add_f32 v197, v197, v137
    v_exp_f32 v138, v138
    s_nop 0
    v_add_f32 v196, v196, v138
    v_exp_f32 v139, v139
    v_exp_f32 v140, v140
    v_add_f32 v197, v197, v139
    v_cvt_pk_bf16_f32 v139, v138, v139
    v_cvt_pk_bf16_f32 v138, v136, v137
    v_cvt_pk_bf16_f32 v136, v156, v157
    v_exp_f32 v141, v141
    v_cvt_pk_bf16_f32 v137, v158, v159
    v_exp_f32 v142, v142
    v_add_f32 v198, v198, v140
    v_add_f32 v199, v199, v141
    v_exp_f32 v143, v143
    v_exp_f32 v144, v144
    v_add_f32 v198, v198, v142
    v_add_f32 v199, v199, v143
    v_cvt_pk_bf16_f32 v143, v142, v143
    v_cvt_pk_bf16_f32 v142, v140, v141
    v_exp_f32 v145, v145
    v_cvt_pk_bf16_f32 v140, v160, v161
    v_exp_f32 v146, v146
    v_cvt_pk_bf16_f32 v141, v162, v163
    v_add_f32 v200, v200, v144
    v_exp_f32 v147, v147
    v_exp_f32 v148, v148
    s_waitcnt vmcnt(18)
    s_barrier
    v_add_f32 v201, v201, v145
    ds_read_b128 a[240:243], v10 offset:24576
    v_add_f32 v200, v200, v146
    ds_read_b128 a[244:247], v13 offset:24576
    v_add_f32 v201, v201, v147
    v_exp_f32 v149, v149
    v_cvt_pk_bf16_f32 v147, v146, v147
    v_exp_f32 v150, v150
    v_exp_f32 v151, v151
    v_cvt_pk_bf16_f32 v146, v144, v145
    v_cvt_pk_bf16_f32 v144, v164, v165
    v_exp_f32 v152, v152
    v_cvt_pk_bf16_f32 v145, v166, v167
    v_add_f32 v202, v202, v148
    s_waitcnt lgkmcnt(0)
    v_add_f32 v203, v203, v149
L_s0:
    v_mfma_f32_16x16x32_bf16 v[176:179], a[240:243], v[16:19], 0
    s_add_u32 m0, s33, 0
    ds_read_b128 a[248:251], v10 offset:24704
    v_add_f32 v202, v202, v150
    v_mfma_f32_16x16x32_bf16 v[176:179], a[244:247], v[36:39], v[176:179]
    ds_read_b128 a[252:255], v13 offset:24704
    v_add_f32 v203, v203, v151
    v_mfma_f32_16x16x32_bf16 v[180:183], a[244:247], v[40:43], 0
    s_mul_i32 s100, s28, 5120
    s_lshl_b32 s101, s81, 2
    v_exp_f32 v153, v153
    v_lshrrev_b32 v230, 4, v0
    v_mfma_f32_16x16x32_bf16 v[180:183], a[240:243], v[20:23], v[180:183]
    s_waitcnt vmcnt(7)
    buffer_load_dwordx4 v7, s[16:19], s35 offen nt lds
    v_cvt_pk_bf16_f32 v151, v150, v151
    v_lshrrev_b32 v231, 4, v230
    v_mfma_f32_16x16x32_bf16 v[184:187], a[240:243], v[24:27], 0
    v_exp_f32 v154, v154
    v_bfe_u32 v232, v230, 2, 2
    v_mfma_f32_16x16x32_bf16 v[184:187], a[244:247], v[44:47], v[184:187]
    v_exp_f32 v155, v155
    v_and_b32 v233, 3, v230
    v_mfma_f32_16x16x32_bf16 v[188:191], a[244:247], v[48:51], 0
    v_cvt_pk_bf16_f32 v150, v148, v149
    v_cvt_pk_bf16_f32 v148, v168, v169
    v_add_u32 v235, 0, v230
    v_mfma_f32_16x16x32_bf16 v[188:191], a[240:243], v[28:31], v[188:191]
    v_cvt_pk_bf16_f32 v149, v170, v171
    v_add_f32 v204, v204, v152
    v_mul_u32_u24 v234, 2731, v235
    v_mfma_f32_16x16x32_bf16 v[192:195], a[240:243], v[32:35], 0
    v_add_f32 v205, v205, v153
    v_add_f32 v204, v204, v154
    v_lshrrev_b32 v234, 16, v234
    v_mfma_f32_16x16x32_bf16 v[192:195], a[244:247], v[52:55], v[192:195]
    s_waitcnt lgkmcnt(0)
    v_add_f32 v205, v205, v155
    v_cvt_pk_bf16_f32 v155, v154, v155
    v_mul_u32_u24 v238, 24, v234
    v_mfma_f32_16x16x32_bf16 v[176:179], a[248:251], v[56:59], v[176:179]
    ds_read_b128 a[240:243], v10 offset:24832
    v_cvt_pk_bf16_f32 v154, v152, v153
    v_sub_u32 v235, v235, v238
    v_mfma_f32_16x16x32_bf16 v[176:179], a[252:255], v[76:79], v[176:179]
    ds_read_b128 a[244:247], v13 offset:24832
    v_cvt_pk_bf16_f32 v152, v172, v173
    v_bfe_u32 v236, v234, 1, 1
    v_mfma_f32_16x16x32_bf16 v[180:183], a[252:255], v[80:83], v[180:183]
    v_cvt_pk_bf16_f32 v153, v174, v175
    v_lshlrev_b32 v236, 2, v236
    v_xor_b32 v236, v236, v235
    v_mfma_f32_16x16x32_bf16 v[180:183], a[248:251], v[60:63], v[180:183]
    s_waitcnt vmcnt(7)
    buffer_load_dwordx4 v8, s[16:19], s35 offen offset:1024 nt lds
    v_lshrrev_b32 v237, 2, v234
    v_mul_u32_u24 v237, 12, v237
    v_mfma_f32_16x16x32_bf16 v[184:187], a[248:251], v[64:67], v[184:187]
    v_add_u32 v237, v237, v234
    v_mul_u32_u24 v237, 1280, v237
    v_lshl_add_u32 v237, v236, 4, v237
    v_mfma_f32_16x16x32_bf16 v[184:187], a[252:255], v[84:87], v[184:187]
    v_add_u32 v237, s100, v237
    v_subrev_u32 v242, 0, v237
    v_add_u32 v235, 64, v230
    v_mfma_f32_16x16x32_bf16 v[188:191], a[252:255], v[88:91], v[188:191]
    v_mul_u32_u24 v234, 2731, v235
    v_lshrrev_b32 v234, 16, v234
    v_mul_u32_u24 v238, 24, v234
    v_mfma_f32_16x16x32_bf16 v[188:191], a[248:251], v[68:71], v[188:191]
    v_sub_u32 v235, v235, v238
    v_bfe_u32 v236, v234, 1, 1
    v_lshlrev_b32 v236, 2, v236
    v_mfma_f32_16x16x32_bf16 v[192:195], a[248:251], v[72:75], v[192:195]
    v_xor_b32 v236, v236, v235
    v_lshrrev_b32 v237, 2, v234
    v_mul_u32_u24 v237, 12, v237
    v_mfma_f32_16x16x32_bf16 v[192:195], a[252:255], v[92:95], v[192:195]
    s_waitcnt lgkmcnt(0)
    v_add_u32 v237, v237, v234
    v_mul_u32_u24 v237, 1280, v237
    v_lshl_add_u32 v237, v236, 4, v237
    v_mfma_f32_16x16x32_bf16 v[176:179], a[240:243], v[96:99], v[176:179]
    ds_read_b128 a[248:251], v10 offset:30720
    v_add_u32 v237, s100, v237
    v_subrev_u32 v243, 1024, v237
    v_mfma_f32_16x16x32_bf16 v[176:179], a[244:247], v[116:119], v[176:179]
    ds_read_b128 a[252:255], v13 offset:30720
    v_add_u32 v235, 128, v230
    v_mul_u32_u24 v234, 2731, v235
    v_mfma_f32_16x16x32_bf16 v[180:183], a[244:247], v[120:123], v[180:183]
    v_lshrrev_b32 v234, 16, v234
    v_mul_u32_u24 v238, 24, v234
    v_sub_u32 v235, v235, v238
    v_mfma_f32_16x16x32_bf16 v[180:183], a[240:243], v[100:103], v[180:183]
    s_waitcnt vmcnt(7)
    buffer_load_dwordx4 v9, s[16:19], s35 offen offset:2048 nt lds
    v_bfe_u32 v236, v234, 1, 1
    v_lshlrev_b32 v236, 2, v236
    v_mfma_f32_16x16x32_bf16 v[184:187], a[240:243], v[104:107], v[184:187]
    s_add_u32 s35, s35, 3072
    v_xor_b32 v236, v236, v235
    v_lshrrev_b32 v237, 2, v234
    v_mul_u32_u24 v237, 12, v237
    v_mfma_f32_16x16x32_bf16 v[184:187], a[244:247], v[124:127], v[184:187]
    v_add_u32 v237, v237, v234
    v_mul_u32_u24 v237, 1280, v237
    v_lshl_add_u32 v237, v236, 4, v237
    v_mfma_f32_16x16x32_bf16 v[188:191], a[244:247], v[128:131], v[188:191]
    v_add_u32 v237, s100, v237
    v_subrev_u32 v244, 2048, v237
    v_mul_u32_u24 v234, 3080, v231
    v_mfma_f32_16x16x32_bf16 v[188:191], a[240:243], v[108:111], v[188:191]
    v_mul_u32_u24 v235, 384, v232
    v_add_u32 v237, v234, v235
    v_lshrrev_b32 v235, 1, v232
    v_mfma_f32_16x16x32_bf16 v[192:195], a[240:243], v[112:115], v[192:195]
    v_lshlrev_b32 v235, 2, v235
    v_xor_b32 v236, v233, v235
    v_lshl_add_u32 v234, v236, 4, v237
    v_mfma_f32_16x16x32_bf16 v[192:195], a[244:247], v[132:135], v[192:195]
    s_waitcnt lgkmcnt(0)
    v_xor_b32 v236, 4, v236
    v_lshl_add_u32 v235, v236, 4, v237
    v_sub_u32 v235, v235, v234
    v_mfma_f32_16x16x32_bf16 v[156:159], a[248:251], v[16:19], 0
    s_add_u32 m0, s33, 3072
    s_mov_b32 s100, s81
    s_and_b32 s101, s100, 1
    s_lshr_b32 s100, s100, 1
    s_lshl_b32 s100, s100, 7
    ds_read_b128 a[240:243], v10 offset:30848
    v_mad_i32_i24 v236, v235, s101, v234
    v_add_u32 v245, s100, v236
    v_mfma_f32_16x16x32_bf16 v[156:159], a[252:255], v[36:39], v[156:159]
    s_add_u32 s100, s80, 1
    s_and_b32 s100, s100, 3
    s_add_u32 s100, s100, s81
    s_add_u32 s100, s100, 1
    s_and_b32 s101, s100, 1
    s_lshr_b32 s100, s100, 1
    s_lshl_b32 s100, s100, 7
    ds_read_b128 a[244:247], v13 offset:30848
    v_mad_i32_i24 v236, v235, s101, v234
    v_add_u32 v246, s100, v236
    v_mfma_f32_16x16x32_bf16 v[160:163], a[252:255], v[40:43], 0
    s_add_u32 s100, s80, 2
    s_and_b32 s100, s100, 3
    s_add_u32 s100, s100, s81
    s_add_u32 s100, s100, 1
    s_and_b32 s101, s100, 1
    s_lshr_b32 s100, s100, 1
    s_lshl_b32 s100, s100, 7
    v_exp_f32 v176, v176
    v_mad_i32_i24 v236, v235, s101, v234
    v_mfma_f32_16x16x32_bf16 v[160:163], a[248:251], v[20:23], v[160:163]
    s_waitcnt vmcnt(7)
    buffer_load_dwordx4 v7, s[16:19], s35 offen nt lds
    v_add_f32 v196, v196, v176
    v_add_u32 v247, s100, v236
    v_mfma_f32_16x16x32_bf16 v[164:167], a[248:251], v[24:27], 0
    s_add_u32 s100, s80, 3
    s_and_b32 s100, s100, 3
    s_add_u32 s100, s100, s81
    s_add_u32 s100, s100, 1
    s_and_b32 s101, s100, 1
    s_lshr_b32 s100, s100, 1
    s_lshl_b32 s100, s100, 7
    v_exp_f32 v177, v177
    v_mad_i32_i24 v236, v235, s101, v234
    v_mfma_f32_16x16x32_bf16 v[164:167], a[252:255], v[44:47], v[164:167]
    v_exp_f32 v178, v178
    v_add_u32 v248, s100, v236
    v_mfma_f32_16x16x32_bf16 v[168:171], a[252:255], v[48:51], 0
    s_add_u32 s100, s80, 4
    s_and_b32 s100, s100, 3
    s_add_u32 s100, s100, s81
    s_add_u32 s100, s100, 1
    s_and_b32 s101, s100, 1
    s_lshr_b32 s100, s100, 1
    s_lshl_b32 s100, s100, 7
    v_add_f32 v197, v197, v177
    v_add_f32 v196, v196, v178
    v_mad_i32_i24 v236, v235, s101, v234
    v_mfma_f32_16x16x32_bf16 v[168:171], a[248:251], v[28:31], v[168:171]
    v_add_u32 v249, s100, v236
    v_add_u32 v250, 61600, v245
    v_add_u32 v251, 61600, v246
    v_mfma_f32_16x16x32_bf16 v[172:175], a[248:251], v[32:35], 0
    v_exp_f32 v179, v179
    v_add_u32 v252, 61600, v247
    v_mfma_f32_16x16x32_bf16 v[172:175], a[252:255], v[52:55], v[172:175]
    s_waitcnt lgkmcnt(0)
    v_add_f32 v197, v197, v179
    v_add_u32 v253, 61600, v248
    v_add_u32 v254, 61600, v249
    v_mfma_f32_16x16x32_bf16 v[156:159], a[240:243], v[56:59], v[156:159]
    ds_read_b128 a[248:251], v10 offset:30976
    v_lshrrev_b32 v234, 2, v230
    v_mul_u32_u24 v234, 2560, v234
    v_mfma_f32_16x16x32_bf16 v[156:159], a[244:247], v[76:79], v[156:159]
    ds_read_b128 a[252:255], v13 offset:30976
    v_lshl_add_u32 v255, v233, 4, v234
    v_mfma_f32_16x16x32_bf16 v[160:163], a[244:247], v[80:83], v[160:163]
    v_exp_f32 v180, v180
    v_mfma_f32_16x16x32_bf16 v[160:163], a[240:243], v[60:63], v[160:163]
    s_waitcnt vmcnt(7)
    buffer_load_dwordx4 v8, s[16:19], s35 offen offset:1024 nt lds
    v_add_f32 v198, v198, v180
    v_mfma_f32_16x16x32_bf16 v[164:167], a[240:243], v[64:67], v[164:167]
    v_exp_f32 v181, v181
    v_mfma_f32_16x16x32_bf16 v[164:167], a[244:247], v[84:87], v[164:167]
    v_exp_f32 v182, v182
    v_mfma_f32_16x16x32_bf16 v[168:171], a[244:247], v[88:91], v[168:171]
    v_add_f32 v199, v199, v181
    v_add_f32 v198, v198, v182
    v_mfma_f32_16x16x32_bf16 v[168:171], a[240:243], v[68:71], v[168:171]
    v_exp_f32 v183, v183
    v_mfma_f32_16x16x32_bf16 v[172:175], a[240:243], v[72:75], v[172:175]
    v_add_f32 v199, v199, v183
    v_mfma_f32_16x16x32_bf16 v[172:175], a[244:247], v[92:95], v[172:175]
    s_waitcnt lgkmcnt(0)
    s_waitcnt vmcnt(54)
    s_barrier
    v_mfma_f32_16x16x32_bf16 v[156:159], a[248:251], v[96:99], v[156:159]
    ds_read_b64_tr_b16 a[240:241], v11 offset:0
    v_mfma_f32_16x16x32_bf16 v[156:159], a[252:255], v[116:119], v[156:159]
    ds_read_b64_tr_b16 a[242:243], v11 offset:6144
    v_mfma_f32_16x16x32_bf16 v[160:163], a[252:255], v[120:123], v[160:163]
    v_exp_f32 v184, v184
    v_mfma_f32_16x16x32_bf16 v[160:163], a[248:251], v[100:103], v[160:163]
    s_waitcnt vmcnt(7)
    buffer_load_dwordx4 v9, s[16:19], s35 offen offset:2048 nt lds
    v_add_f32 v200, v200, v184
    v_mfma_f32_16x16x32_bf16 v[164:167], a[248:251], v[104:107], v[164:167]
    s_add_u32 s35, s35, 9216
    v_exp_f32 v185, v185
    v_mfma_f32_16x16x32_bf16 v[164:167], a[252:255], v[124:127], v[164:167]
    ds_read_b64_tr_b16 a[244:245], v206 offset:0
    v_add_f32 v201, v201, v185
    v_mfma_f32_16x16x32_bf16 v[168:171], a[252:255], v[128:131], v[168:171]
    ds_read_b64_tr_b16 a[246:247], v206 offset:6144
    v_mfma_f32_16x16x32_bf16 v[168:171], a[248:251], v[108:111], v[168:171]
    v_exp_f32 v186, v186
    v_mfma_f32_16x16x32_bf16 v[172:175], a[248:251], v[112:115], v[172:175]
    v_exp_f32 v187, v187
    v_mfma_f32_16x16x32_bf16 v[172:175], a[252:255], v[132:135], v[172:175]
    s_waitcnt lgkmcnt(2)
    v_exp_f32 v188, v188
    v_mfma_f32_16x16x32_bf16 a[0:3], a[240:243], v[136:139], 0
    s_add_u32 m0, s33, 24576
    ds_read_b64_tr_b16 a[248:249], v207 offset:0
    v_add_f32 v200, v200, v186
    v_mfma_f32_16x16x32_bf16 a[4:7], a[240:243], v[140:143], 0
    ds_read_b64_tr_b16 a[250:251], v207 offset:6144
    v_add_f32 v201, v201, v187
    v_mfma_f32_16x16x32_bf16 a[8:11], a[240:243], v[144:147], 0
    v_exp_f32 v189, v189
    v_mfma_f32_16x16x32_bf16 a[12:15], a[240:243], v[148:151], 0
    s_waitcnt vmcnt(7)
    buffer_load_dwordx4 v7, s[16:19], s35 offen nt lds
    v_add_f32 v202, v202, v188
    v_mfma_f32_16x16x32_bf16 a[16:19], a[240:243], v[152:155], 0
    s_waitcnt lgkmcnt(2)
    v_exp_f32 v190, v190
    v_mfma_f32_16x16x32_bf16 a[36:39], a[244:247], v[152:155], 0
    ds_read_b64_tr_b16 a[252:253], v208 offset:0
    v_add_f32 v203, v203, v189
    v_mfma_f32_16x16x32_bf16 a[32:35], a[244:247], v[148:151], 0
    ds_read_b64_tr_b16 a[254:255], v208 offset:6144
    v_add_f32 v202, v202, v190
    v_mfma_f32_16x16x32_bf16 a[28:31], a[244:247], v[144:147], 0
    v_exp_f32 v191, v191
    v_mfma_f32_16x16x32_bf16 a[24:27], a[244:247], v[140:143], 0
    v_add_f32 v203, v203, v191
    v_mfma_f32_16x16x32_bf16 a[20:23], a[244:247], v[136:139], 0
    s_waitcnt lgkmcnt(2)
    v_exp_f32 v192, v192
    v_mfma_f32_16x16x32_bf16 a[40:43], a[248:251], v[136:139], 0
    ds_read_b64_tr_b16 a[240:241], v11 offset:128
    v_add_f32 v204, v204, v192
    v_mfma_f32_16x16x32_bf16 a[44:47], a[248:251], v[140:143], 0
    ds_read_b64_tr_b16 a[242:243], v11 offset:6272
    v_mfma_f32_16x16x32_bf16 a[48:51], a[248:251], v[144:147], 0
    v_exp_f32 v193, v193
    v_mfma_f32_16x16x32_bf16 a[52:55], a[248:251], v[148:151], 0
    s_waitcnt vmcnt(7)
    buffer_load_dwordx4 v8, s[16:19], s35 offen offset:1024 nt lds
    v_add_f32 v205, v205, v193
    v_mfma_f32_16x16x32_bf16 a[56:59], a[248:251], v[152:155], 0
    s_waitcnt lgkmcnt(2)
    v_exp_f32 v194, v194
    v_mfma_f32_16x16x32_bf16 a[76:79], a[252:255], v[152:155], 0
    ds_read_b64_tr_b16 a[244:245], v206 offset:128
    v_add_f32 v204, v204, v194
    v_mfma_f32_16x16x32_bf16 a[72:75], a[252:255], v[148:151], 0
    ds_read_b64_tr_b16 a[246:247], v206 offset:6272
    v_mfma_f32_16x16x32_bf16 a[68:71], a[252:255], v[144:147], 0
    v_exp_f32 v195, v195
    v_mfma_f32_16x16x32_bf16 a[64:67], a[252:255], v[140:143], 0
    v_add_f32 v205, v205, v195
    v_mfma_f32_16x16x32_bf16 a[60:63], a[252:255], v[136:139], 0
    s_waitcnt lgkmcnt(2)
    v_exp_f32 v156, v156
    v_mfma_f32_16x16x32_bf16 a[80:83], a[240:243], v[136:139], 0
    ds_read_b64_tr_b16 a[248:249], v207 offset:128
    v_add_f32 v196, v196, v156
    v_mfma_f32_16x16x32_bf16 a[84:87], a[240:243], v[140:143], 0
    ds_read_b64_tr_b16 a[250:251], v207 offset:6272
    v_mfma_f32_16x16x32_bf16 a[88:91], a[240:243], v[144:147], 0
    v_exp_f32 v157, v157
    v_mfma_f32_16x16x32_bf16 a[92:95], a[240:243], v[148:151], 0
    s_waitcnt vmcnt(7)
    buffer_load_dwordx4 v9, s[16:19], s35 offen offset:2048 nt lds
    v_add_f32 v197, v197, v157
    v_mfma_f32_16x16x32_bf16 a[96:99], a[240:243], v[152:155], 0
    s_waitcnt lgkmcnt(2)
    s_add_u32 s35, s35, 3072
    v_exp_f32 v158, v158
    v_mfma_f32_16x16x32_bf16 a[116:119], a[244:247], v[152:155], 0
    ds_read_b64_tr_b16 a[252:253], v208 offset:128
    v_add_f32 v196, v196, v158
    v_mfma_f32_16x16x32_bf16 a[112:115], a[244:247], v[148:151], 0
    ds_read_b64_tr_b16 a[254:255], v208 offset:6272
    v_mfma_f32_16x16x32_bf16 a[108:111], a[244:247], v[144:147], 0
    v_exp_f32 v159, v159
    v_mfma_f32_16x16x32_bf16 a[104:107], a[244:247], v[140:143], 0
    v_exp_f32 v160, v160
    v_mfma_f32_16x16x32_bf16 a[100:103], a[244:247], v[136:139], 0
    s_waitcnt lgkmcnt(2)
    v_add_f32 v197, v197, v159
    v_cvt_pk_bf16_f32 v159, v158, v159
    v_mfma_f32_16x16x32_bf16 a[120:123], a[248:251], v[136:139], 0
    s_add_u32 m0, s33, 27648
    ds_read_b64_tr_b16 a[240:241], v11 offset:256
    v_cvt_pk_bf16_f32 v158, v156, v157
    v_mfma_f32_16x16x32_bf16 a[124:127], a[248:251], v[140:143], 0
    ds_read_b64_tr_b16 a[242:243], v11 offset:6400
    v_cvt_pk_bf16_f32 v156, v176, v177
    v_mfma_f32_16x16x32_bf16 a[128:131], a[248:251], v[144:147], 0
    v_exp_f32 v161, v161
    v_mfma_f32_16x16x32_bf16 a[132:135], a[248:251], v[148:151], 0
    s_waitcnt vmcnt(7)
    buffer_load_dwordx4 v7, s[16:19], s35 offen nt lds
    v_cvt_pk_bf16_f32 v157, v178, v179
    v_mfma_f32_16x16x32_bf16 a[136:139], a[248:251], v[152:155], 0
    s_waitcnt lgkmcnt(2)
    v_exp_f32 v162, v162
    v_mfma_f32_16x16x32_bf16 a[156:159], a[252:255], v[152:155], 0
    ds_read_b64_tr_b16 a[244:245], v206 offset:256
    v_add_f32 v198, v198, v160
    v_mfma_f32_16x16x32_bf16 a[152:155], a[252:255], v[148:151], 0
    ds_read_b64_tr_b16 a[246:247], v206 offset:6400
    v_add_f32 v199, v199, v161
    v_mfma_f32_16x16x32_bf16 a[148:151], a[252:255], v[144:147], 0
    v_exp_f32 v163, v163
    v_mfma_f32_16x16x32_bf16 a[144:147], a[252:255], v[140:143], 0
    v_exp_f32 v164, v164
    v_mfma_f32_16x16x32_bf16 a[140:143], a[252:255], v[136:139], 0
    s_waitcnt lgkmcnt(2)
    v_add_f32 v198, v198, v162
    v_add_f32 v199, v199, v163
    v_mfma_f32_16x16x32_bf16 a[160:163], a[240:243], v[136:139], 0
    ds_read_b64_tr_b16 a[248:249], v207 offset:256
    v_cvt_pk_bf16_f32 v163, v162, v163
    v_mfma_f32_16x16x32_bf16 a[164:167], a[240:243], v[140:143], 0
    ds_read_b64_tr_b16 a[250:251], v207 offset:6400
    v_cvt_pk_bf16_f32 v162, v160, v161
    v_mfma_f32_16x16x32_bf16 a[168:171], a[240:243], v[144:147], 0
    v_exp_f32 v165, v165
    v_mfma_f32_16x16x32_bf16 a[172:175], a[240:243], v[148:151], 0
    s_waitcnt vmcnt(7)
    buffer_load_dwordx4 v8, s[16:19], s35 offen offset:1024 nt lds
    v_cvt_pk_bf16_f32 v160, v180, v181
    v_mfma_f32_16x16x32_bf16 a[176:179], a[240:243], v[152:155], 0
    s_waitcnt lgkmcnt(2)
    v_exp_f32 v166, v166
    v_mfma_f32_16x16x32_bf16 a[196:199], a[244:247], v[152:155], 0
    ds_read_b64_tr_b16 a[252:253], v208 offset:256
    v_cvt_pk_bf16_f32 v161, v182, v183
    v_mfma_f32_16x16x32_bf16 a[192:195], a[244:247], v[148:151], 0
    ds_read_b64_tr_b16 a[254:255], v208 offset:6400
    v_add_f32 v200, v200, v164
    v_mfma_f32_16x16x32_bf16 a[188:191], a[244:247], v[144:147], 0
    v_exp_f32 v167, v167
    v_mfma_f32_16x16x32_bf16 a[184:187], a[244:247], v[140:143], 0
    v_exp_f32 v168, v168
    v_mfma_f32_16x16x32_bf16 a[180:183], a[244:247], v[136:139], 0
    s_waitcnt lgkmcnt(2)
    s_waitcnt vmcnt(23)
    s_barrier
    v_add_f32 v201, v201, v165
    v_mfma_f32_16x16x32_bf16 a[200:203], a[248:251], v[136:139], 0
    ds_read_b128 a[240:243], v10 offset:49152
    v_add_f32 v200, v200, v166
    v_mfma_f32_16x16x32_bf16 a[204:207], a[248:251], v[140:143], 0
    ds_read_b128 a[244:247], v13 offset:49152
    v_add_f32 v201, v201, v167
    v_mfma_f32_16x16x32_bf16 a[208:211], a[248:251], v[144:147], 0
    v_exp_f32 v169, v169
    v_mfma_f32_16x16x32_bf16 a[212:215], a[248:251], v[148:151], 0
    s_waitcnt vmcnt(7)
    buffer_load_dwordx4 v9, s[16:19], s35 offen offset:2048 nt lds
    v_cvt_pk_bf16_f32 v167, v166, v167
    v_mfma_f32_16x16x32_bf16 a[216:219], a[248:251], v[152:155], 0
    s_waitcnt lgkmcnt(2)
    s_add_u32 s35, s35, 9216
    v_exp_f32 v170, v170
    v_mfma_f32_16x16x32_bf16 a[236:239], a[252:255], v[152:155], 0
    s_mov_b32 s6, 4
    v_exp_f32 v171, v171
    v_mfma_f32_16x16x32_bf16 a[232:235], a[252:255], v[148:151], 0
    v_cvt_pk_bf16_f32 v166, v164, v165
    v_cvt_pk_bf16_f32 v164, v184, v185
    v_mfma_f32_16x16x32_bf16 a[228:231], a[252:255], v[144:147], 0
    v_exp_f32 v172, v172
    v_mfma_f32_16x16x32_bf16 a[224:227], a[252:255], v[140:143], 0
    buffer_load_dword v209, v0, s[4:7], 0 offen sc1
    v_cvt_pk_bf16_f32 v165, v186, v187
    v_add_f32 v202, v202, v168
    v_mfma_f32_16x16x32_bf16 a[220:223], a[252:255], v[136:139], 0
    s_waitcnt lgkmcnt(0)
    s_barrier
    v_add_f32 v203, v203, v169
    s_mov_b32 s29, 5
    s_mov_b32 s86, 1
    s_mov_b32 s32, 49152
    s_mov_b32 s39, 0
.p2align 6
L_s1:
    v_mfma_f32_16x16x32_bf16 v[136:139], a[240:243], v[16:19], 0
    s_cmp_lg_u32 s86, s99
    ds_read_b128 a[248:251], v10 offset:49280
    v_add_f32 v202, v202, v170
    v_mfma_f32_16x16x32_bf16 v[136:139], a[244:247], v[36:39], v[136:139]
    s_cselect_b32 s22, 196608, 0
    ds_read_b128 a[252:255], v13 offset:49280
    v_add_f32 v203, v203, v171
    v_mfma_f32_16x16x32_bf16 v[140:143], a[244:247], v[40:43], 0
    s_add_u32 m0, s34, s39
    v_exp_f32 v173, v173
    v_mfma_f32_16x16x32_bf16 v[140:143], a[240:243], v[20:23], v[140:143]
    s_waitcnt vmcnt(5)
    buffer_load_dwordx4 v7, s[20:23], s36 offen nt lds
    v_cvt_pk_bf16_f32 v171, v170, v171
    v_mfma_f32_16x16x32_bf16 v[144:147], a[240:243], v[24:27], 0
    v_exp_f32 v174, v174
    v_mfma_f32_16x16x32_bf16 v[144:147], a[244:247], v[44:47], v[144:147]
    v_exp_f32 v175, v175
    v_mfma_f32_16x16x32_bf16 v[148:151], a[244:247], v[48:51], 0
    v_cvt_pk_bf16_f32 v170, v168, v169
    v_cvt_pk_bf16_f32 v168, v188, v189
    v_mfma_f32_16x16x32_bf16 v[148:151], a[240:243], v[28:31], v[148:151]
    v_cvt_pk_bf16_f32 v169, v190, v191
    v_add_f32 v204, v204, v172
    v_mfma_f32_16x16x32_bf16 v[152:155], a[240:243], v[32:35], 0
    v_add_f32 v205, v205, v173
    v_add_f32 v204, v204, v174
    v_mfma_f32_16x16x32_bf16 v[152:155], a[244:247], v[52:55], v[152:155]
    s_waitcnt lgkmcnt(0)
    v_add_f32 v205, v205, v175
    v_cvt_pk_bf16_f32 v175, v174, v175
    v_mfma_f32_16x16x32_bf16 v[136:139], a[248:251], v[56:59], v[136:139]
    ds_read_b128 a[240:243], v10 offset:49408
    v_cvt_pk_bf16_f32 v174, v172, v173
    v_mfma_f32_16x16x32_bf16 v[136:139], a[252:255], v[76:79], v[136:139]
    ds_read_b128 a[244:247], v13 offset:49408
    v_cvt_pk_bf16_f32 v172, v192, v193
    v_mfma_f32_16x16x32_bf16 v[140:143], a[252:255], v[80:83], v[140:143]
    v_cvt_pk_bf16_f32 v173, v194, v195
    v_mfma_f32_16x16x32_bf16 v[140:143], a[248:251], v[60:63], v[140:143]
    s_waitcnt vmcnt(5)
    buffer_load_dwordx4 v8, s[20:23], s36 offen offset:1024 nt lds
    v_mfma_f32_16x16x32_bf16 v[144:147], a[248:251], v[64:67], v[144:147]
    v_mfma_f32_16x16x32_bf16 v[144:147], a[252:255], v[84:87], v[144:147]
    v_mfma_f32_16x16x32_bf16 v[148:151], a[252:255], v[88:91], v[148:151]
    v_mfma_f32_16x16x32_bf16 v[148:151], a[248:251], v[68:71], v[148:151]
    v_mfma_f32_16x16x32_bf16 v[152:155], a[248:251], v[72:75], v[152:155]
    v_mfma_f32_16x16x32_bf16 v[152:155], a[252:255], v[92:95], v[152:155]
    s_waitcnt lgkmcnt(0)
    v_mfma_f32_16x16x32_bf16 v[136:139], a[240:243], v[96:99], v[136:139]
    ds_read_b128 a[248:251], v10 offset:55296
    v_mfma_f32_16x16x32_bf16 v[136:139], a[244:247], v[116:119], v[136:139]
    ds_read_b128 a[252:255], v13 offset:55296
    v_mfma_f32_16x16x32_bf16 v[140:143], a[244:247], v[120:123], v[140:143]
    v_mfma_f32_16x16x32_bf16 v[140:143], a[240:243], v[100:103], v[140:143]
    s_waitcnt vmcnt(5)
    buffer_load_dwordx4 v9, s[20:23], s36 offen offset:2048 nt lds
    v_mfma_f32_16x16x32_bf16 v[144:147], a[240:243], v[104:107], v[144:147]
    v_mfma_f32_16x16x32_bf16 v[144:147], a[244:247], v[124:127], v[144:147]
    s_add_u32 s89, s36, 3072
    v_mfma_f32_16x16x32_bf16 v[148:151], a[244:247], v[128:131], v[148:151]
    s_add_u32 m0, m0, 3072
    v_mfma_f32_16x16x32_bf16 v[148:151], a[240:243], v[108:111], v[148:151]
    v_mfma_f32_16x16x32_bf16 v[152:155], a[240:243], v[112:115], v[152:155]
    v_mfma_f32_16x16x32_bf16 v[152:155], a[244:247], v[132:135], v[152:155]
    s_waitcnt lgkmcnt(0)
    v_mfma_f32_16x16x32_bf16 v[176:179], a[248:251], v[16:19], 0
    ds_read_b128 a[240:243], v10 offset:55424
    v_mfma_f32_16x16x32_bf16 v[176:179], a[252:255], v[36:39], v[176:179]
    ds_read_b128 a[244:247], v13 offset:55424
    v_mfma_f32_16x16x32_bf16 v[180:183], a[252:255], v[40:43], 0
    v_exp_f32 v136, v136
    v_mfma_f32_16x16x32_bf16 v[180:183], a[248:251], v[20:23], v[180:183]
    s_waitcnt vmcnt(5)
    buffer_load_dwordx4 v7, s[20:23], s89 offen nt lds
    v_add_f32 v196, v196, v136
    v_mfma_f32_16x16x32_bf16 v[184:187], a[248:251], v[24:27], 0
    v_exp_f32 v137, v137
    v_mfma_f32_16x16x32_bf16 v[184:187], a[252:255], v[44:47], v[184:187]
    s_cmp_lg_u32 s22, 0
    v_exp_f32 v138, v138
    v_mfma_f32_16x16x32_bf16 v[188:191], a[252:255], v[48:51], 0
    s_cselect_b32 s3, 24576, 0
    v_add_f32 v197, v197, v137
    v_add_f32 v196, v196, v138
    v_mfma_f32_16x16x32_bf16 v[188:191], a[248:251], v[28:31], v[188:191]
    s_add_u32 s39, s39, s3
    v_mfma_f32_16x16x32_bf16 v[192:195], a[248:251], v[32:35], 0
    s_lshr_b32 s3, s3, 1
    v_exp_f32 v139, v139
    v_mfma_f32_16x16x32_bf16 v[192:195], a[252:255], v[52:55], v[192:195]
    s_waitcnt lgkmcnt(0)
    v_add_f32 v197, v197, v139
    v_mfma_f32_16x16x32_bf16 v[176:179], a[240:243], v[56:59], v[176:179]
    s_cmp_eq_u32 s39, 73728
    ds_read_b128 a[248:251], v10 offset:55552
    v_mfma_f32_16x16x32_bf16 v[176:179], a[244:247], v[76:79], v[176:179]
    s_cselect_b32 s39, 0, s39
    ds_read_b128 a[252:255], v13 offset:55552
    v_mfma_f32_16x16x32_bf16 v[180:183], a[244:247], v[80:83], v[180:183]
    s_add_u32 s36, s36, s3
    v_exp_f32 v140, v140
    v_mfma_f32_16x16x32_bf16 v[180:183], a[240:243], v[60:63], v[180:183]
    s_waitcnt vmcnt(5)
    buffer_load_dwordx4 v8, s[20:23], s89 offen offset:1024 nt lds
    v_add_f32 v198, v198, v140
    v_mfma_f32_16x16x32_bf16 v[184:187], a[240:243], v[64:67], v[184:187]
    v_exp_f32 v141, v141
    v_mfma_f32_16x16x32_bf16 v[184:187], a[244:247], v[84:87], v[184:187]
    v_exp_f32 v142, v142
    v_mfma_f32_16x16x32_bf16 v[188:191], a[244:247], v[88:91], v[188:191]
    v_add_f32 v199, v199, v141
    v_add_f32 v198, v198, v142
    v_mfma_f32_16x16x32_bf16 v[188:191], a[240:243], v[68:71], v[188:191]
    v_exp_f32 v143, v143
    v_mfma_f32_16x16x32_bf16 v[192:195], a[240:243], v[72:75], v[192:195]
    v_add_f32 v199, v199, v143
    v_mfma_f32_16x16x32_bf16 v[192:195], a[244:247], v[92:95], v[192:195]
    s_waitcnt lgkmcnt(0)
    s_waitcnt vmcnt(11)
    s_barrier
    v_mfma_f32_16x16x32_bf16 v[176:179], a[248:251], v[96:99], v[176:179]
    ds_read_b64_tr_b16 a[240:241], v11 offset:24576
    v_mfma_f32_16x16x32_bf16 v[176:179], a[252:255], v[116:119], v[176:179]
    ds_read_b64_tr_b16 a[242:243], v11 offset:30720
    v_mfma_f32_16x16x32_bf16 v[180:183], a[252:255], v[120:123], v[180:183]
    v_exp_f32 v144, v144
    v_mfma_f32_16x16x32_bf16 v[180:183], a[248:251], v[100:103], v[180:183]
    s_waitcnt vmcnt(5)
    buffer_load_dwordx4 v9, s[20:23], s89 offen offset:2048 nt lds
    v_add_f32 v200, v200, v144
    v_mfma_f32_16x16x32_bf16 v[184:187], a[248:251], v[104:107], v[184:187]
    v_exp_f32 v145, v145
    v_mfma_f32_16x16x32_bf16 v[184:187], a[252:255], v[124:127], v[184:187]
    ds_read_b64_tr_b16 a[244:245], v206 offset:24576
    v_add_f32 v201, v201, v145
    v_mfma_f32_16x16x32_bf16 v[188:191], a[252:255], v[128:131], v[188:191]
    ds_read_b64_tr_b16 a[246:247], v206 offset:30720
    v_mfma_f32_16x16x32_bf16 v[188:191], a[248:251], v[108:111], v[188:191]
    v_exp_f32 v146, v146
    v_mfma_f32_16x16x32_bf16 v[192:195], a[248:251], v[112:115], v[192:195]
    v_exp_f32 v147, v147
    v_mfma_f32_16x16x32_bf16 v[192:195], a[252:255], v[132:135], v[192:195]
    s_waitcnt lgkmcnt(2)
    v_exp_f32 v148, v148
    v_mfma_f32_16x16x32_bf16 a[0:3], a[240:243], v[156:159], a[0:3]
    s_cmp_lg_u32 s86, s98
    ds_read_b64_tr_b16 a[248:249], v207 offset:24576
    v_add_f32 v200, v200, v146
    v_mfma_f32_16x16x32_bf16 a[4:7], a[240:243], v[160:163], a[4:7]
    s_cselect_b32 s18, 196608, 0
    ds_read_b64_tr_b16 a[250:251], v207 offset:30720
    v_add_f32 v201, v201, v147
    v_mfma_f32_16x16x32_bf16 a[8:11], a[240:243], v[164:167], a[8:11]
    s_add_u32 m0, s33, s32
    v_exp_f32 v149, v149
    v_mfma_f32_16x16x32_bf16 a[12:15], a[240:243], v[168:171], a[12:15]
    s_waitcnt vmcnt(5)
    buffer_load_dwordx4 v7, s[16:19], s35 offen nt lds
    v_add_f32 v202, v202, v148
    v_mfma_f32_16x16x32_bf16 a[16:19], a[240:243], v[172:175], a[16:19]
    s_waitcnt lgkmcnt(2)
    v_exp_f32 v150, v150
    v_mfma_f32_16x16x32_bf16 a[36:39], a[244:247], v[172:175], a[36:39]
    ds_read_b64_tr_b16 a[252:253], v208 offset:24576
    v_add_f32 v203, v203, v149
    v_mfma_f32_16x16x32_bf16 a[32:35], a[244:247], v[168:171], a[32:35]
    ds_read_b64_tr_b16 a[254:255], v208 offset:30720
    v_add_f32 v202, v202, v150
    v_mfma_f32_16x16x32_bf16 a[28:31], a[244:247], v[164:167], a[28:31]
    v_exp_f32 v151, v151
    v_mfma_f32_16x16x32_bf16 a[24:27], a[244:247], v[160:163], a[24:27]
    v_add_f32 v203, v203, v151
    v_mfma_f32_16x16x32_bf16 a[20:23], a[244:247], v[156:159], a[20:23]
    s_waitcnt lgkmcnt(2)
    v_exp_f32 v152, v152
    v_mfma_f32_16x16x32_bf16 a[40:43], a[248:251], v[156:159], a[40:43]
    ds_read_b64_tr_b16 a[240:241], v11 offset:24704
    v_add_f32 v204, v204, v152
    v_mfma_f32_16x16x32_bf16 a[44:47], a[248:251], v[160:163], a[44:47]
    ds_read_b64_tr_b16 a[242:243], v11 offset:30848
    v_mfma_f32_16x16x32_bf16 a[48:51], a[248:251], v[164:167], a[48:51]
    v_exp_f32 v153, v153
    v_mfma_f32_16x16x32_bf16 a[52:55], a[248:251], v[168:171], a[52:55]
    s_waitcnt vmcnt(5)
    buffer_load_dwordx4 v8, s[16:19], s35 offen offset:1024 nt lds
    v_add_f32 v205, v205, v153
    v_mfma_f32_16x16x32_bf16 a[56:59], a[248:251], v[172:175], a[56:59]
    s_waitcnt lgkmcnt(2)
    v_exp_f32 v154, v154
    v_mfma_f32_16x16x32_bf16 a[76:79], a[252:255], v[172:175], a[76:79]
    ds_read_b64_tr_b16 a[244:245], v206 offset:24704
    v_add_f32 v204, v204, v154
    v_mfma_f32_16x16x32_bf16 a[72:75], a[252:255], v[168:171], a[72:75]
    ds_read_b64_tr_b16 a[246:247], v206 offset:30848
    v_mfma_f32_16x16x32_bf16 a[68:71], a[252:255], v[164:167], a[68:71]
    v_exp_f32 v155, v155
    v_mfma_f32_16x16x32_bf16 a[64:67], a[252:255], v[160:163], a[64:67]
    v_add_f32 v205, v205, v155
    v_mfma_f32_16x16x32_bf16 a[60:63], a[252:255], v[156:159], a[60:63]
    s_waitcnt lgkmcnt(2)
    v_exp_f32 v176, v176
    v_mfma_f32_16x16x32_bf16 a[80:83], a[240:243], v[156:159], a[80:83]
    ds_read_b64_tr_b16 a[248:249], v207 offset:24704
    v_add_f32 v196, v196, v176
    v_mfma_f32_16x16x32_bf16 a[84:87], a[240:243], v[160:163], a[84:87]
    ds_read_b64_tr_b16 a[250:251], v207 offset:30848
    v_mfma_f32_16x16x32_bf16 a[88:91], a[240:243], v[164:167], a[88:91]
    v_exp_f32 v177, v177
    v_mfma_f32_16x16x32_bf16 a[92:95], a[240:243], v[168:171], a[92:95]
    s_waitcnt vmcnt(5)
    buffer_load_dwordx4 v9, s[16:19], s35 offen offset:2048 nt lds
    v_add_f32 v197, v197, v177
    v_mfma_f32_16x16x32_bf16 a[96:99], a[240:243], v[172:175], a[96:99]
    s_waitcnt lgkmcnt(2)
    v_exp_f32 v178, v178
    v_mfma_f32_16x16x32_bf16 a[116:119], a[244:247], v[172:175], a[116:119]
    s_add_u32 s89, s35, 3072
    ds_read_b64_tr_b16 a[252:253], v208 offset:24704
    v_add_f32 v196, v196, v178
    v_mfma_f32_16x16x32_bf16 a[112:115], a[244:247], v[168:171], a[112:115]
    s_add_u32 m0, m0, 3072
    ds_read_b64_tr_b16 a[254:255], v208 offset:30848
    v_mfma_f32_16x16x32_bf16 a[108:111], a[244:247], v[164:167], a[108:111]
    v_exp_f32 v179, v179
    v_mfma_f32_16x16x32_bf16 a[104:107], a[244:247], v[160:163], a[104:107]
    v_exp_f32 v180, v180
    v_mfma_f32_16x16x32_bf16 a[100:103], a[244:247], v[156:159], a[100:103]
    s_waitcnt lgkmcnt(2)
    v_add_f32 v197, v197, v179
    v_cvt_pk_bf16_f32 v179, v178, v179
    v_mfma_f32_16x16x32_bf16 a[120:123], a[248:251], v[156:159], a[120:123]
    ds_read_b64_tr_b16 a[240:241], v11 offset:24832
    v_cvt_pk_bf16_f32 v178, v176, v177
    v_mfma_f32_16x16x32_bf16 a[124:127], a[248:251], v[160:163], a[124:127]
    ds_read_b64_tr_b16 a[242:243], v11 offset:30976
    v_cvt_pk_bf16_f32 v176, v136, v137
    v_mfma_f32_16x16x32_bf16 a[128:131], a[248:251], v[164:167], a[128:131]
    v_exp_f32 v181, v181
    v_mfma_f32_16x16x32_bf16 a[132:135], a[248:251], v[168:171], a[132:135]
    s_waitcnt vmcnt(5)
    buffer_load_dwordx4 v7, s[16:19], s89 offen nt lds
    v_cvt_pk_bf16_f32 v177, v138, v139
    v_mfma_f32_16x16x32_bf16 a[136:139], a[248:251], v[172:175], a[136:139]
    s_waitcnt lgkmcnt(2)
    v_exp_f32 v182, v182
    v_mfma_f32_16x16x32_bf16 a[156:159], a[252:255], v[172:175], a[156:159]
    s_cmp_lg_u32 s18, 0
    ds_read_b64_tr_b16 a[244:245], v206 offset:24832
    v_add_f32 v198, v198, v180
    v_mfma_f32_16x16x32_bf16 a[152:155], a[252:255], v[168:171], a[152:155]
    s_cselect_b32 s3, 24576, 0
    ds_read_b64_tr_b16 a[246:247], v206 offset:30976
    v_add_f32 v199, v199, v181
    v_mfma_f32_16x16x32_bf16 a[148:151], a[252:255], v[164:167], a[148:151]
    s_add_u32 s32, s32, s3
    v_exp_f32 v183, v183
    v_mfma_f32_16x16x32_bf16 a[144:147], a[252:255], v[160:163], a[144:147]
    s_lshr_b32 s3, s3, 1
    v_exp_f32 v184, v184
    v_mfma_f32_16x16x32_bf16 a[140:143], a[252:255], v[156:159], a[140:143]
    s_waitcnt lgkmcnt(2)
    v_add_f32 v198, v198, v182
    v_add_f32 v199, v199, v183
    v_mfma_f32_16x16x32_bf16 a[160:163], a[240:243], v[156:159], a[160:163]
    s_cmp_eq_u32 s32, 73728
    ds_read_b64_tr_b16 a[248:249], v207 offset:24832
    v_cvt_pk_bf16_f32 v183, v182, v183
    v_mfma_f32_16x16x32_bf16 a[164:167], a[240:243], v[160:163], a[164:167]
    s_cselect_b32 s32, 0, s32
    ds_read_b64_tr_b16 a[250:251], v207 offset:30976
    v_cvt_pk_bf16_f32 v182, v180, v181
    v_mfma_f32_16x16x32_bf16 a[168:171], a[240:243], v[164:167], a[168:171]
    s_add_u32 s35, s35, s3
    v_exp_f32 v185, v185
    v_mfma_f32_16x16x32_bf16 a[172:175], a[240:243], v[168:171], a[172:175]
    s_waitcnt vmcnt(5)
    buffer_load_dwordx4 v8, s[16:19], s89 offen offset:1024 nt lds
    v_cvt_pk_bf16_f32 v180, v140, v141
    v_mfma_f32_16x16x32_bf16 a[176:179], a[240:243], v[172:175], a[176:179]
    s_waitcnt lgkmcnt(2)
    v_exp_f32 v186, v186
    v_mfma_f32_16x16x32_bf16 a[196:199], a[244:247], v[172:175], a[196:199]
    ds_read_b64_tr_b16 a[252:253], v208 offset:24832
    v_cvt_pk_bf16_f32 v181, v142, v143
    v_mfma_f32_16x16x32_bf16 a[192:195], a[244:247], v[168:171], a[192:195]
    ds_read_b64_tr_b16 a[254:255], v208 offset:30976
    v_add_f32 v200, v200, v184
    v_mfma_f32_16x16x32_bf16 a[188:191], a[244:247], v[164:167], a[188:191]
    v_exp_f32 v187, v187
    v_mfma_f32_16x16x32_bf16 a[184:187], a[244:247], v[160:163], a[184:187]
    v_exp_f32 v188, v188
    v_mfma_f32_16x16x32_bf16 a[180:183], a[244:247], v[156:159], a[180:183]
    s_waitcnt lgkmcnt(2)
    s_waitcnt vmcnt(11)
    s_barrier
    v_add_f32 v201, v201, v185
    v_mfma_f32_16x16x32_bf16 a[200:203], a[248:251], v[156:159], a[200:203]
    ds_read_b128 a[240:243], v10 offset:0
    v_add_f32 v200, v200, v186
    v_mfma_f32_16x16x32_bf16 a[204:207], a[248:251], v[160:163], a[204:207]
    ds_read_b128 a[244:247], v13 offset:0
    v_add_f32 v201, v201, v187
    v_mfma_f32_16x16x32_bf16 a[208:211], a[248:251], v[164:167], a[208:211]
    v_exp_f32 v189, v189
    v_mfma_f32_16x16x32_bf16 a[212:215], a[248:251], v[168:171], a[212:215]
    s_waitcnt vmcnt(5)
    buffer_load_dwordx4 v9, s[16:19], s89 offen offset:2048 nt lds
    v_cvt_pk_bf16_f32 v187, v186, v187
    v_mfma_f32_16x16x32_bf16 a[216:219], a[248:251], v[172:175], a[216:219]
    s_waitcnt lgkmcnt(2)
    v_exp_f32 v190, v190
    v_mfma_f32_16x16x32_bf16 a[236:239], a[252:255], v[172:175], a[236:239]
    v_exp_f32 v191, v191
    v_mfma_f32_16x16x32_bf16 a[232:235], a[252:255], v[168:171], a[232:235]
    s_add_u32 s86, s86, 1
    v_cvt_pk_bf16_f32 v186, v184, v185
    v_cvt_pk_bf16_f32 v184, v144, v145
    v_mfma_f32_16x16x32_bf16 a[228:231], a[252:255], v[164:167], a[228:231]
    v_exp_f32 v192, v192
    v_mfma_f32_16x16x32_bf16 a[224:227], a[252:255], v[160:163], a[224:227]
    v_cvt_pk_bf16_f32 v185, v146, v147
    v_add_f32 v202, v202, v188
    v_mfma_f32_16x16x32_bf16 a[220:223], a[252:255], v[156:159], a[220:223]
    s_waitcnt lgkmcnt(0)
    s_barrier
    v_add_f32 v203, v203, v189
L_s2:
    v_mfma_f32_16x16x32_bf16 v[156:159], a[240:243], v[16:19], 0
    s_cmp_lg_u32 s86, s99
    ds_read_b128 a[248:251], v10 offset:128
    v_add_f32 v202, v202, v190
    v_mfma_f32_16x16x32_bf16 v[156:159], a[244:247], v[36:39], v[156:159]
    s_cselect_b32 s22, 196608, 0
    ds_read_b128 a[252:255], v13 offset:128
    v_add_f32 v203, v203, v191
    v_mfma_f32_16x16x32_bf16 v[160:163], a[244:247], v[40:43], 0
    s_add_u32 m0, s34, s39
    v_exp_f32 v193, v193
    v_mfma_f32_16x16x32_bf16 v[160:163], a[240:243], v[20:23], v[160:163]
    s_waitcnt vmcnt(5)
    buffer_load_dwordx4 v7, s[20:23], s36 offen nt lds
    v_cvt_pk_bf16_f32 v191, v190, v191
    v_mfma_f32_16x16x32_bf16 v[164:167], a[240:243], v[24:27], 0
    v_exp_f32 v194, v194
    v_mfma_f32_16x16x32_bf16 v[164:167], a[244:247], v[44:47], v[164:167]
    v_exp_f32 v195, v195
    v_mfma_f32_16x16x32_bf16 v[168:171], a[244:247], v[48:51], 0
    v_cvt_pk_bf16_f32 v190, v188, v189
    v_cvt_pk_bf16_f32 v188, v148, v149
    v_mfma_f32_16x16x32_bf16 v[168:171], a[240:243], v[28:31], v[168:171]
    v_cvt_pk_bf16_f32 v189, v150, v151
    v_add_f32 v204, v204, v192
    v_mfma_f32_16x16x32_bf16 v[172:175], a[240:243], v[32:35], 0
    v_add_f32 v205, v205, v193
    v_add_f32 v204, v204, v194
    v_mfma_f32_16x16x32_bf16 v[172:175], a[244:247], v[52:55], v[172:175]
    s_waitcnt lgkmcnt(0)
    v_add_f32 v205, v205, v195
    v_cvt_pk_bf16_f32 v195, v194, v195
    v_mfma_f32_16x16x32_bf16 v[156:159], a[248:251], v[56:59], v[156:159]
    ds_read_b128 a[240:243], v10 offset:256
    v_cvt_pk_bf16_f32 v194, v192, v193
    v_mfma_f32_16x16x32_bf16 v[156:159], a[252:255], v[76:79], v[156:159]
    ds_read_b128 a[244:247], v13 offset:256
    v_cvt_pk_bf16_f32 v192, v152, v153
    v_mfma_f32_16x16x32_bf16 v[160:163], a[252:255], v[80:83], v[160:163]
    v_cvt_pk_bf16_f32 v193, v154, v155
    v_mfma_f32_16x16x32_bf16 v[160:163], a[248:251], v[60:63], v[160:163]
    s_waitcnt vmcnt(5)
    buffer_load_dwordx4 v8, s[20:23], s36 offen offset:1024 nt lds
    v_mfma_f32_16x16x32_bf16 v[164:167], a[248:251], v[64:67], v[164:167]
    v_mfma_f32_16x16x32_bf16 v[164:167], a[252:255], v[84:87], v[164:167]
    v_mfma_f32_16x16x32_bf16 v[168:171], a[252:255], v[88:91], v[168:171]
    v_mfma_f32_16x16x32_bf16 v[168:171], a[248:251], v[68:71], v[168:171]
    v_mfma_f32_16x16x32_bf16 v[172:175], a[248:251], v[72:75], v[172:175]
    v_mfma_f32_16x16x32_bf16 v[172:175], a[252:255], v[92:95], v[172:175]
    s_waitcnt lgkmcnt(0)
    v_mfma_f32_16x16x32_bf16 v[156:159], a[240:243], v[96:99], v[156:159]
    ds_read_b128 a[248:251], v10 offset:6144
    v_mfma_f32_16x16x32_bf16 v[156:159], a[244:247], v[116:119], v[156:159]
    ds_read_b128 a[252:255], v13 offset:6144
    v_mfma_f32_16x16x32_bf16 v[160:163], a[244:247], v[120:123], v[160:163]
    v_mfma_f32_16x16x32_bf16 v[160:163], a[240:243], v[100:103], v[160:163]
    s_waitcnt vmcnt(5)
    buffer_load_dwordx4 v9, s[20:23], s36 offen offset:2048 nt lds
    v_mfma_f32_16x16x32_bf16 v[164:167], a[240:243], v[104:107], v[164:167]
    v_mfma_f32_16x16x32_bf16 v[164:167], a[244:247], v[124:127], v[164:167]
    s_add_u32 s89, s36, 3072
    v_mfma_f32_16x16x32_bf16 v[168:171], a[244:247], v[128:131], v[168:171]
    s_add_u32 m0, m0, 3072
    v_mfma_f32_16x16x32_bf16 v[168:171], a[240:243], v[108:111], v[168:171]
    v_mfma_f32_16x16x32_bf16 v[172:175], a[240:243], v[112:115], v[172:175]
    v_mfma_f32_16x16x32_bf16 v[172:175], a[244:247], v[132:135], v[172:175]
    s_waitcnt lgkmcnt(0)
    v_mfma_f32_16x16x32_bf16 v[136:139], a[248:251], v[16:19], 0
    ds_read_b128 a[240:243], v10 offset:6272
    v_mfma_f32_16x16x32_bf16 v[136:139], a[252:255], v[36:39], v[136:139]
    ds_read_b128 a[244:247], v13 offset:6272
    v_mfma_f32_16x16x32_bf16 v[140:143], a[252:255], v[40:43], 0
    v_exp_f32 v156, v156
    v_mfma_f32_16x16x32_bf16 v[140:143], a[248:251], v[20:23], v[140:143]
    s_waitcnt vmcnt(5)
    buffer_load_dwordx4 v7, s[20:23], s89 offen nt lds
    v_add_f32 v196, v196, v156
    v_mfma_f32_16x16x32_bf16 v[144:147], a[248:251], v[24:27], 0
    v_exp_f32 v157, v157
    v_mfma_f32_16x16x32_bf16 v[144:147], a[252:255], v[44:47], v[144:147]
    s_cmp_lg_u32 s22, 0
    v_exp_f32 v158, v158
    v_mfma_f32_16x16x32_bf16 v[148:151], a[252:255], v[48:51], 0
    s_cselect_b32 s3, 24576, 0
    v_add_f32 v197, v197, v157
    v_add_f32 v196, v196, v158
    v_mfma_f32_16x16x32_bf16 v[148:151], a[248:251], v[28:31], v[148:151]
    s_add_u32 s39, s39, s3
    v_mfma_f32_16x16x32_bf16 v[152:155], a[248:251], v[32:35], 0
    s_lshr_b32 s3, s3, 1
    v_exp_f32 v159, v159
    v_mfma_f32_16x16x32_bf16 v[152:155], a[252:255], v[52:55], v[152:155]
    s_waitcnt lgkmcnt(0)
    v_add_f32 v197, v197, v159
    v_mfma_f32_16x16x32_bf16 v[136:139], a[240:243], v[56:59], v[136:139]
    s_cmp_eq_u32 s39, 73728
    ds_read_b128 a[248:251], v10 offset:6400
    v_mfma_f32_16x16x32_bf16 v[136:139], a[244:247], v[76:79], v[136:139]
    s_cselect_b32 s39, 0, s39
    ds_read_b128 a[252:255], v13 offset:6400
    v_mfma_f32_16x16x32_bf16 v[140:143], a[244:247], v[80:83], v[140:143]
    s_add_u32 s36, s36, s3
    v_exp_f32 v160, v160
    v_mfma_f32_16x16x32_bf16 v[140:143], a[240:243], v[60:63], v[140:143]
    s_waitcnt vmcnt(5)
    buffer_load_dwordx4 v8, s[20:23], s89 offen offset:1024 nt lds
    v_add_f32 v198, v198, v160
    v_mfma_f32_16x16x32_bf16 v[144:147], a[240:243], v[64:67], v[144:147]
    v_exp_f32 v161, v161
    v_mfma_f32_16x16x32_bf16 v[144:147], a[244:247], v[84:87], v[144:147]
    v_exp_f32 v162, v162
    v_mfma_f32_16x16x32_bf16 v[148:151], a[244:247], v[88:91], v[148:151]
    v_add_f32 v199, v199, v161
    v_add_f32 v198, v198, v162
    v_mfma_f32_16x16x32_bf16 v[148:151], a[240:243], v[68:71], v[148:151]
    v_exp_f32 v163, v163
    v_mfma_f32_16x16x32_bf16 v[152:155], a[240:243], v[72:75], v[152:155]
    v_add_f32 v199, v199, v163
    v_mfma_f32_16x16x32_bf16 v[152:155], a[244:247], v[92:95], v[152:155]
    s_waitcnt lgkmcnt(0)
    s_waitcnt vmcnt(11)
    s_barrier
    v_mfma_f32_16x16x32_bf16 v[136:139], a[248:251], v[96:99], v[136:139]
    ds_read_b64_tr_b16 a[240:241], v11 offset:49152
    v_mfma_f32_16x16x32_bf16 v[136:139], a[252:255], v[116:119], v[136:139]
    ds_read_b64_tr_b16 a[242:243], v11 offset:55296
    v_mfma_f32_16x16x32_bf16 v[140:143], a[252:255], v[120:123], v[140:143]
    v_exp_f32 v164, v164
    v_mfma_f32_16x16x32_bf16 v[140:143], a[248:251], v[100:103], v[140:143]
    s_waitcnt vmcnt(5)
    buffer_load_dwordx4 v9, s[20:23], s89 offen offset:2048 nt lds
    v_add_f32 v200, v200, v164
    v_mfma_f32_16x16x32_bf16 v[144:147], a[248:251], v[104:107], v[144:147]
    v_exp_f32 v165, v165
    v_mfma_f32_16x16x32_bf16 v[144:147], a[252:255], v[124:127], v[144:147]
    ds_read_b64_tr_b16 a[244:245], v206 offset:49152
    v_add_f32 v201, v201, v165
    v_mfma_f32_16x16x32_bf16 v[148:151], a[252:255], v[128:131], v[148:151]
    ds_read_b64_tr_b16 a[246:247], v206 offset:55296
    v_mfma_f32_16x16x32_bf16 v[148:151], a[248:251], v[108:111], v[148:151]
    v_exp_f32 v166, v166
    v_mfma_f32_16x16x32_bf16 v[152:155], a[248:251], v[112:115], v[152:155]
    v_exp_f32 v167, v167
    v_mfma_f32_16x16x32_bf16 v[152:155], a[252:255], v[132:135], v[152:155]
    s_waitcnt lgkmcnt(2)
    v_exp_f32 v168, v168
    v_mfma_f32_16x16x32_bf16 a[0:3], a[240:243], v[176:179], a[0:3]
    s_cmp_lg_u32 s86, s98
    ds_read_b64_tr_b16 a[248:249], v207 offset:49152
    v_add_f32 v200, v200, v166
    v_mfma_f32_16x16x32_bf16 a[4:7], a[240:243], v[180:183], a[4:7]
    s_cselect_b32 s18, 196608, 0
    ds_read_b64_tr_b16 a[250:251], v207 offset:55296
    v_add_f32 v201, v201, v167
    v_mfma_f32_16x16x32_bf16 a[8:11], a[240:243], v[184:187], a[8:11]
    s_add_u32 m0, s33, s32
    v_exp_f32 v169, v169
    v_mfma_f32_16x16x32_bf16 a[12:15], a[240:243], v[188:191], a[12:15]
    s_waitcnt vmcnt(5)
    buffer_load_dwordx4 v7, s[16:19], s35 offen nt lds
    v_add_f32 v202, v202, v168
    v_mfma_f32_16x16x32_bf16 a[16:19], a[240:243], v[192:195], a[16:19]
    s_waitcnt lgkmcnt(2)
    v_exp_f32 v170, v170
    v_mfma_f32_16x16x32_bf16 a[36:39], a[244:247], v[192:195], a[36:39]
    ds_read_b64_tr_b16 a[252:253], v208 offset:49152
    v_add_f32 v203, v203, v169
    v_mfma_f32_16x16x32_bf16 a[32:35], a[244:247], v[188:191], a[32:35]
    ds_read_b64_tr_b16 a[254:255], v208 offset:55296
    v_add_f32 v202, v202, v170
    v_mfma_f32_16x16x32_bf16 a[28:31], a[244:247], v[184:187], a[28:31]
    v_exp_f32 v171, v171
    v_mfma_f32_16x16x32_bf16 a[24:27], a[244:247], v[180:183], a[24:27]
    v_add_f32 v203, v203, v171
    v_mfma_f32_16x16x32_bf16 a[20:23], a[244:247], v[176:179], a[20:23]
    s_waitcnt lgkmcnt(2)
    v_exp_f32 v172, v172
    v_mfma_f32_16x16x32_bf16 a[40:43], a[248:251], v[176:179], a[40:43]
    ds_read_b64_tr_b16 a[240:241], v11 offset:49280
    v_add_f32 v204, v204, v172
    v_mfma_f32_16x16x32_bf16 a[44:47], a[248:251], v[180:183], a[44:47]
    ds_read_b64_tr_b16 a[242:243], v11 offset:55424
    v_mfma_f32_16x16x32_bf16 a[48:51], a[248:251], v[184:187], a[48:51]
    v_exp_f32 v173, v173
    v_mfma_f32_16x16x32_bf16 a[52:55], a[248:251], v[188:191], a[52:55]
    s_waitcnt vmcnt(5)
    buffer_load_dwordx4 v8, s[16:19], s35 offen offset:1024 nt lds
    v_add_f32 v205, v205, v173
    v_mfma_f32_16x16x32_bf16 a[56:59], a[248:251], v[192:195], a[56:59]
    s_waitcnt lgkmcnt(2)
    v_exp_f32 v174, v174
    v_mfma_f32_16x16x32_bf16 a[76:79], a[252:255], v[192:195], a[76:79]
    ds_read_b64_tr_b16 a[244:245], v206 offset:49280
    v_add_f32 v204, v204, v174
    v_mfma_f32_16x16x32_bf16 a[72:75], a[252:255], v[188:191], a[72:75]
    ds_read_b64_tr_b16 a[246:247], v206 offset:55424
    v_mfma_f32_16x16x32_bf16 a[68:71], a[252:255], v[184:187], a[68:71]
    v_exp_f32 v175, v175
    v_mfma_f32_16x16x32_bf16 a[64:67], a[252:255], v[180:183], a[64:67]
    v_add_f32 v205, v205, v175
    v_mfma_f32_16x16x32_bf16 a[60:63], a[252:255], v[176:179], a[60:63]
    s_waitcnt lgkmcnt(2)
    v_exp_f32 v136, v136
    v_mfma_f32_16x16x32_bf16 a[80:83], a[240:243], v[176:179], a[80:83]
    ds_read_b64_tr_b16 a[248:249], v207 offset:49280
    v_add_f32 v196, v196, v136
    v_mfma_f32_16x16x32_bf16 a[84:87], a[240:243], v[180:183], a[84:87]
    ds_read_b64_tr_b16 a[250:251], v207 offset:55424
    v_mfma_f32_16x16x32_bf16 a[88:91], a[240:243], v[184:187], a[88:91]
    v_exp_f32 v137, v137
    v_mfma_f32_16x16x32_bf16 a[92:95], a[240:243], v[188:191], a[92:95]
    s_waitcnt vmcnt(5)
    buffer_load_dwordx4 v9, s[16:19], s35 offen offset:2048 nt lds
    v_add_f32 v197, v197, v137
    v_mfma_f32_16x16x32_bf16 a[96:99], a[240:243], v[192:195], a[96:99]
    s_waitcnt lgkmcnt(2)
    v_exp_f32 v138, v138
    v_mfma_f32_16x16x32_bf16 a[116:119], a[244:247], v[192:195], a[116:119]
    s_add_u32 s89, s35, 3072
    ds_read_b64_tr_b16 a[252:253], v208 offset:49280
    v_add_f32 v196, v196, v138
    v_mfma_f32_16x16x32_bf16 a[112:115], a[244:247], v[188:191], a[112:115]
    s_add_u32 m0, m0, 3072
    ds_read_b64_tr_b16 a[254:255], v208 offset:55424
    v_mfma_f32_16x16x32_bf16 a[108:111], a[244:247], v[184:187], a[108:111]
    v_exp_f32 v139, v139
    v_mfma_f32_16x16x32_bf16 a[104:107], a[244:247], v[180:183], a[104:107]
    v_exp_f32 v140, v140
    v_mfma_f32_16x16x32_bf16 a[100:103], a[244:247], v[176:179], a[100:103]
    s_waitcnt lgkmcnt(2)
    v_add_f32 v197, v197, v139
    v_cvt_pk_bf16_f32 v139, v138, v139
    v_mfma_f32_16x16x32_bf16 a[120:123], a[248:251], v[176:179], a[120:123]
    ds_read_b64_tr_b16 a[240:241], v11 offset:49408
    v_cvt_pk_bf16_f32 v138, v136, v137
    v_mfma_f32_16x16x32_bf16 a[124:127], a[248:251], v[180:183], a[124:127]
    ds_read_b64_tr_b16 a[242:243], v11 offset:55552
    v_cvt_pk_bf16_f32 v136, v156, v157
    v_mfma_f32_16x16x32_bf16 a[128:131], a[248:251], v[184:187], a[128:131]
    v_exp_f32 v141, v141
    v_mfma_f32_16x16x32_bf16 a[132:135], a[248:251], v[188:191], a[132:135]
    s_waitcnt vmcnt(5)
    buffer_load_dwordx4 v7, s[16:19], s89 offen nt lds
    v_cvt_pk_bf16_f32 v137, v158, v159
    v_mfma_f32_16x16x32_bf16 a[136:139], a[248:251], v[192:195], a[136:139]
    s_waitcnt lgkmcnt(2)
    v_exp_f32 v142, v142
    v_mfma_f32_16x16x32_bf16 a[156:159], a[252:255], v[192:195], a[156:159]
    s_cmp_lg_u32 s18, 0
    ds_read_b64_tr_b16 a[244:245], v206 offset:49408
    v_add_f32 v198, v198, v140
    v_mfma_f32_16x16x32_bf16 a[152:155], a[252:255], v[188:191], a[152:155]
    s_cselect_b32 s3, 24576, 0
    ds_read_b64_tr_b16 a[246:247], v206 offset:55552
    v_add_f32 v199, v199, v141
    v_mfma_f32_16x16x32_bf16 a[148:151], a[252:255], v[184:187], a[148:151]
    s_add_u32 s32, s32, s3
    v_exp_f32 v143, v143
    v_mfma_f32_16x16x32_bf16 a[144:147], a[252:255], v[180:183], a[144:147]
    s_lshr_b32 s3, s3, 1
    v_exp_f32 v144, v144
    v_mfma_f32_16x16x32_bf16 a[140:143], a[252:255], v[176:179], a[140:143]
    s_waitcnt lgkmcnt(2)
    v_add_f32 v198, v198, v142
    v_add_f32 v199, v199, v143
    v_mfma_f32_16x16x32_bf16 a[160:163], a[240:243], v[176:179], a[160:163]
    s_cmp_eq_u32 s32, 73728
    ds_read_b64_tr_b16 a[248:249], v207 offset:49408
    v_cvt_pk_bf16_f32 v143, v142, v143
    v_mfma_f32_16x16x32_bf16 a[164:167], a[240:243], v[180:183], a[164:167]
    s_cselect_b32 s32, 0, s32
    ds_read_b64_tr_b16 a[250:251], v207 offset:55552
    v_cvt_pk_bf16_f32 v142, v140, v141
    v_mfma_f32_16x16x32_bf16 a[168:171], a[240:243], v[184:187], a[168:171]
    s_add_u32 s35, s35, s3
    v_exp_f32 v145, v145
    v_mfma_f32_16x16x32_bf16 a[172:175], a[240:243], v[188:191], a[172:175]
    s_waitcnt vmcnt(5)
    buffer_load_dwordx4 v8, s[16:19], s89 offen offset:1024 nt lds
    v_cvt_pk_bf16_f32 v140, v160, v161
    v_mfma_f32_16x16x32_bf16 a[176:179], a[240:243], v[192:195], a[176:179]
    s_waitcnt lgkmcnt(2)
    v_exp_f32 v146, v146
    v_mfma_f32_16x16x32_bf16 a[196:199], a[244:247], v[192:195], a[196:199]
    ds_read_b64_tr_b16 a[252:253], v208 offset:49408
    v_cvt_pk_bf16_f32 v141, v162, v163
    v_mfma_f32_16x16x32_bf16 a[192:195], a[244:247], v[188:191], a[192:195]
    ds_read_b64_tr_b16 a[254:255], v208 offset:55552
    v_add_f32 v200, v200, v144
    v_mfma_f32_16x16x32_bf16 a[188:191], a[244:247], v[184:187], a[188:191]
    v_exp_f32 v147, v147
    v_mfma_f32_16x16x32_bf16 a[184:187], a[244:247], v[180:183], a[184:187]
    v_exp_f32 v148, v148
    v_mfma_f32_16x16x32_bf16 a[180:183], a[244:247], v[176:179], a[180:183]
    s_waitcnt lgkmcnt(2)
    s_waitcnt vmcnt(11)
    s_barrier
    v_add_f32 v201, v201, v145
    v_mfma_f32_16x16x32_bf16 a[200:203], a[248:251], v[176:179], a[200:203]
    ds_read_b128 a[240:243], v10 offset:24576
    v_add_f32 v200, v200, v146
    v_mfma_f32_16x16x32_bf16 a[204:207], a[248:251], v[180:183], a[204:207]
    ds_read_b128 a[244:247], v13 offset:24576
    v_add_f32 v201, v201, v147
    v_mfma_f32_16x16x32_bf16 a[208:211], a[248:251], v[184:187], a[208:211]
    v_exp_f32 v149, v149
    v_mfma_f32_16x16x32_bf16 a[212:215], a[248:251], v[188:191], a[212:215]
    s_waitcnt vmcnt(5)
    buffer_load_dwordx4 v9, s[16:19], s89 offen offset:2048 nt lds
    v_cvt_pk_bf16_f32 v147, v146, v147
    v_mfma_f32_16x16x32_bf16 a[216:219], a[248:251], v[192:195], a[216:219]
    s_waitcnt lgkmcnt(2)
    v_exp_f32 v150, v150
    v_mfma_f32_16x16x32_bf16 a[236:239], a[252:255], v[192:195], a[236:239]
    v_exp_f32 v151, v151
    v_mfma_f32_16x16x32_bf16 a[232:235], a[252:255], v[188:191], a[232:235]
    s_add_u32 s86, s86, 1
    v_cvt_pk_bf16_f32 v146, v144, v145
    v_cvt_pk_bf16_f32 v144, v164, v165
    v_mfma_f32_16x16x32_bf16 a[228:231], a[252:255], v[184:187], a[228:231]
    v_exp_f32 v152, v152
    v_mfma_f32_16x16x32_bf16 a[224:227], a[252:255], v[180:183], a[224:227]
    v_cvt_pk_bf16_f32 v145, v166, v167
    v_add_f32 v202, v202, v148
    v_mfma_f32_16x16x32_bf16 a[220:223], a[252:255], v[176:179], a[220:223]
    s_waitcnt lgkmcnt(0)
    s_barrier
    v_add_f32 v203, v203, v149
    s_sub_u32 s29, s29, 1
    s_cmp_eq_u32 s29, 0
    s_cbranch_scc1 L_t
L_s3:
    v_mfma_f32_16x16x32_bf16 v[176:179], a[240:243], v[16:19], 0
    s_cmp_lg_u32 s86, s99
    ds_read_b128 a[248:251], v10 offset:24704
    v_add_f32 v202, v202, v150
    v_mfma_f32_16x16x32_bf16 v[176:179], a[244:247], v[36:39], v[176:179]
    s_cselect_b32 s22, 196608, 0
    ds_read_b128 a[252:255], v13 offset:24704
    v_add_f32 v203, v203, v151
    v_mfma_f32_16x16x32_bf16 v[180:183], a[244:247], v[40:43], 0
    s_add_u32 m0, s34, s39
    v_exp_f32 v153, v153
    v_mfma_f32_16x16x32_bf16 v[180:183], a[240:243], v[20:23], v[180:183]
    s_waitcnt vmcnt(5)
    buffer_load_dwordx4 v7, s[20:23], s36 offen nt lds
    v_cvt_pk_bf16_f32 v151, v150, v151
    v_mfma_f32_16x16x32_bf16 v[184:187], a[240:243], v[24:27], 0
    v_exp_f32 v154, v154
    v_mfma_f32_16x16x32_bf16 v[184:187], a[244:247], v[44:47], v[184:187]
    v_exp_f32 v155, v155
    v_mfma_f32_16x16x32_bf16 v[188:191], a[244:247], v[48:51], 0
    v_cvt_pk_bf16_f32 v150, v148, v149
    v_cvt_pk_bf16_f32 v148, v168, v169
    v_mfma_f32_16x16x32_bf16 v[188:191], a[240:243], v[28:31], v[188:191]
    v_cvt_pk_bf16_f32 v149, v170, v171
    v_add_f32 v204, v204, v152
    v_mfma_f32_16x16x32_bf16 v[192:195], a[240:243], v[32:35], 0
    v_add_f32 v205, v205, v153
    v_add_f32 v204, v204, v154
    v_mfma_f32_16x16x32_bf16 v[192:195], a[244:247], v[52:55], v[192:195]
    s_waitcnt lgkmcnt(0)
    v_add_f32 v205, v205, v155
    v_cvt_pk_bf16_f32 v155, v154, v155
    v_mfma_f32_16x16x32_bf16 v[176:179], a[248:251], v[56:59], v[176:179]
    ds_read_b128 a[240:243], v10 offset:24832
    v_cvt_pk_bf16_f32 v154, v152, v153
    v_mfma_f32_16x16x32_bf16 v[176:179], a[252:255], v[76:79], v[176:179]
    ds_read_b128 a[244:247], v13 offset:24832
    v_cvt_pk_bf16_f32 v152, v172, v173
    v_mfma_f32_16x16x32_bf16 v[180:183], a[252:255], v[80:83], v[180:183]
    v_cvt_pk_bf16_f32 v153, v174, v175
    v_mfma_f32_16x16x32_bf16 v[180:183], a[248:251], v[60:63], v[180:183]
    s_waitcnt vmcnt(5)
    buffer_load_dwordx4 v8, s[20:23], s36 offen offset:1024 nt lds
    v_mfma_f32_16x16x32_bf16 v[184:187], a[248:251], v[64:67], v[184:187]
    v_mfma_f32_16x16x32_bf16 v[184:187], a[252:255], v[84:87], v[184:187]
    v_mfma_f32_16x16x32_bf16 v[188:191], a[252:255], v[88:91], v[188:191]
    v_mfma_f32_16x16x32_bf16 v[188:191], a[248:251], v[68:71], v[188:191]
    v_mfma_f32_16x16x32_bf16 v[192:195], a[248:251], v[72:75], v[192:195]
    v_mfma_f32_16x16x32_bf16 v[192:195], a[252:255], v[92:95], v[192:195]
    s_waitcnt lgkmcnt(0)
    v_mfma_f32_16x16x32_bf16 v[176:179], a[240:243], v[96:99], v[176:179]
    ds_read_b128 a[248:251], v10 offset:30720
    v_mfma_f32_16x16x32_bf16 v[176:179], a[244:247], v[116:119], v[176:179]
    ds_read_b128 a[252:255], v13 offset:30720
    v_mfma_f32_16x16x32_bf16 v[180:183], a[244:247], v[120:123], v[180:183]
    v_mfma_f32_16x16x32_bf16 v[180:183], a[240:243], v[100:103], v[180:183]
    s_waitcnt vmcnt(5)
    buffer_load_dwordx4 v9, s[20:23], s36 offen offset:2048 nt lds
    v_mfma_f32_16x16x32_bf16 v[184:187], a[240:243], v[104:107], v[184:187]
    v_mfma_f32_16x16x32_bf16 v[184:187], a[244:247], v[124:127], v[184:187]
    s_add_u32 s89, s36, 3072
    v_mfma_f32_16x16x32_bf16 v[188:191], a[244:247], v[128:131], v[188:191]
    s_add_u32 m0, m0, 3072
    v_mfma_f32_16x16x32_bf16 v[188:191], a[240:243], v[108:111], v[188:191]
    v_mfma_f32_16x16x32_bf16 v[192:195], a[240:243], v[112:115], v[192:195]
    v_mfma_f32_16x16x32_bf16 v[192:195], a[244:247], v[132:135], v[192:195]
    s_waitcnt lgkmcnt(0)
    v_mfma_f32_16x16x32_bf16 v[156:159], a[248:251], v[16:19], 0
    ds_read_b128 a[240:243], v10 offset:30848
    v_mfma_f32_16x16x32_bf16 v[156:159], a[252:255], v[36:39], v[156:159]
    ds_read_b128 a[244:247], v13 offset:30848
    v_mfma_f32_16x16x32_bf16 v[160:163], a[252:255], v[40:43], 0
    v_exp_f32 v176, v176
    v_mfma_f32_16x16x32_bf16 v[160:163], a[248:251], v[20:23], v[160:163]
    s_waitcnt vmcnt(5)
    buffer_load_dwordx4 v7, s[20:23], s89 offen nt lds
    v_add_f32 v196, v196, v176
    v_mfma_f32_16x16x32_bf16 v[164:167], a[248:251], v[24:27], 0
    v_exp_f32 v177, v177
    v_mfma_f32_16x16x32_bf16 v[164:167], a[252:255], v[44:47], v[164:167]
    s_cmp_lg_u32 s22, 0
    v_exp_f32 v178, v178
    v_mfma_f32_16x16x32_bf16 v[168:171], a[252:255], v[48:51], 0
    s_cselect_b32 s3, 24576, 0
    v_add_f32 v197, v197, v177
    v_add_f32 v196, v196, v178
    v_mfma_f32_16x16x32_bf16 v[168:171], a[248:251], v[28:31], v[168:171]
    s_add_u32 s39, s39, s3
    v_mfma_f32_16x16x32_bf16 v[172:175], a[248:251], v[32:35], 0
    s_lshr_b32 s3, s3, 1
    v_exp_f32 v179, v179
    v_mfma_f32_16x16x32_bf16 v[172:175], a[252:255], v[52:55], v[172:175]
    s_waitcnt lgkmcnt(0)
    v_add_f32 v197, v197, v179
    v_mfma_f32_16x16x32_bf16 v[156:159], a[240:243], v[56:59], v[156:159]
    s_cmp_eq_u32 s39, 73728
    ds_read_b128 a[248:251], v10 offset:30976
    v_mfma_f32_16x16x32_bf16 v[156:159], a[244:247], v[76:79], v[156:159]
    s_cselect_b32 s39, 0, s39
    ds_read_b128 a[252:255], v13 offset:30976
    v_mfma_f32_16x16x32_bf16 v[160:163], a[244:247], v[80:83], v[160:163]
    s_add_u32 s36, s36, s3
    v_exp_f32 v180, v180
    v_mfma_f32_16x16x32_bf16 v[160:163], a[240:243], v[60:63], v[160:163]
    s_waitcnt vmcnt(5)
    buffer_load_dwordx4 v8, s[20:23], s89 offen offset:1024 nt lds
    v_add_f32 v198, v198, v180
    v_mfma_f32_16x16x32_bf16 v[164:167], a[240:243], v[64:67], v[164:167]
    v_exp_f32 v181, v181
    v_mfma_f32_16x16x32_bf16 v[164:167], a[244:247], v[84:87], v[164:167]
    v_exp_f32 v182, v182
    v_mfma_f32_16x16x32_bf16 v[168:171], a[244:247], v[88:91], v[168:171]
    v_add_f32 v199, v199, v181
    v_add_f32 v198, v198, v182
    v_mfma_f32_16x16x32_bf16 v[168:171], a[240:243], v[68:71], v[168:171]
    v_exp_f32 v183, v183
    v_mfma_f32_16x16x32_bf16 v[172:175], a[240:243], v[72:75], v[172:175]
    v_add_f32 v199, v199, v183
    v_mfma_f32_16x16x32_bf16 v[172:175], a[244:247], v[92:95], v[172:175]
    s_waitcnt lgkmcnt(0)
    s_waitcnt vmcnt(11)
    s_barrier
    v_mfma_f32_16x16x32_bf16 v[156:159], a[248:251], v[96:99], v[156:159]
    ds_read_b64_tr_b16 a[240:241], v11 offset:0
    v_mfma_f32_16x16x32_bf16 v[156:159], a[252:255], v[116:119], v[156:159]
    ds_read_b64_tr_b16 a[242:243], v11 offset:6144
    v_mfma_f32_16x16x32_bf16 v[160:163], a[252:255], v[120:123], v[160:163]
    v_exp_f32 v184, v184
    v_mfma_f32_16x16x32_bf16 v[160:163], a[248:251], v[100:103], v[160:163]
    s_waitcnt vmcnt(5)
    buffer_load_dwordx4 v9, s[20:23], s89 offen offset:2048 nt lds
    v_add_f32 v200, v200, v184
    v_mfma_f32_16x16x32_bf16 v[164:167], a[248:251], v[104:107], v[164:167]
    v_exp_f32 v185, v185
    v_mfma_f32_16x16x32_bf16 v[164:167], a[252:255], v[124:127], v[164:167]
    ds_read_b64_tr_b16 a[244:245], v206 offset:0
    v_add_f32 v201, v201, v185
    v_mfma_f32_16x16x32_bf16 v[168:171], a[252:255], v[128:131], v[168:171]
    ds_read_b64_tr_b16 a[246:247], v206 offset:6144
    v_mfma_f32_16x16x32_bf16 v[168:171], a[248:251], v[108:111], v[168:171]
    v_exp_f32 v186, v186
    v_mfma_f32_16x16x32_bf16 v[172:175], a[248:251], v[112:115], v[172:175]
    v_exp_f32 v187, v187
    v_mfma_f32_16x16x32_bf16 v[172:175], a[252:255], v[132:135], v[172:175]
    s_waitcnt lgkmcnt(2)
    v_exp_f32 v188, v188
    v_mfma_f32_16x16x32_bf16 a[0:3], a[240:243], v[136:139], a[0:3]
    s_cmp_lg_u32 s86, s98
    ds_read_b64_tr_b16 a[248:249], v207 offset:0
    v_add_f32 v200, v200, v186
    v_mfma_f32_16x16x32_bf16 a[4:7], a[240:243], v[140:143], a[4:7]
    s_cselect_b32 s18, 196608, 0
    ds_read_b64_tr_b16 a[250:251], v207 offset:6144
    v_add_f32 v201, v201, v187
    v_mfma_f32_16x16x32_bf16 a[8:11], a[240:243], v[144:147], a[8:11]
    s_add_u32 m0, s33, s32
    v_exp_f32 v189, v189
    v_mfma_f32_16x16x32_bf16 a[12:15], a[240:243], v[148:151], a[12:15]
    s_waitcnt vmcnt(5)
    buffer_load_dwordx4 v7, s[16:19], s35 offen nt lds
    v_add_f32 v202, v202, v188
    v_mfma_f32_16x16x32_bf16 a[16:19], a[240:243], v[152:155], a[16:19]
    s_waitcnt lgkmcnt(2)
    v_exp_f32 v190, v190
    v_mfma_f32_16x16x32_bf16 a[36:39], a[244:247], v[152:155], a[36:39]
    ds_read_b64_tr_b16 a[252:253], v208 offset:0
    v_add_f32 v203, v203, v189
    v_mfma_f32_16x16x32_bf16 a[32:35], a[244:247], v[148:151], a[32:35]
    ds_read_b64_tr_b16 a[254:255], v208 offset:6144
    v_add_f32 v202, v202, v190
    v_mfma_f32_16x16x32_bf16 a[28:31], a[244:247], v[144:147], a[28:31]
    v_exp_f32 v191, v191
    v_mfma_f32_16x16x32_bf16 a[24:27], a[244:247], v[140:143], a[24:27]
    v_add_f32 v203, v203, v191
    v_mfma_f32_16x16x32_bf16 a[20:23], a[244:247], v[136:139], a[20:23]
    s_waitcnt lgkmcnt(2)
    v_exp_f32 v192, v192
    v_mfma_f32_16x16x32_bf16 a[40:43], a[248:251], v[136:139], a[40:43]
    ds_read_b64_tr_b16 a[240:241], v11 offset:128
    v_add_f32 v204, v204, v192
    v_mfma_f32_16x16x32_bf16 a[44:47], a[248:251], v[140:143], a[44:47]
    ds_read_b64_tr_b16 a[242:243], v11 offset:6272
    v_mfma_f32_16x16x32_bf16 a[48:51], a[248:251], v[144:147], a[48:51]
    v_exp_f32 v193, v193
    v_mfma_f32_16x16x32_bf16 a[52:55], a[248:251], v[148:151], a[52:55]
    s_waitcnt vmcnt(5)
    buffer_load_dwordx4 v8, s[16:19], s35 offen offset:1024 nt lds
    v_add_f32 v205, v205, v193
    v_mfma_f32_16x16x32_bf16 a[56:59], a[248:251], v[152:155], a[56:59]
    s_waitcnt lgkmcnt(2)
    v_exp_f32 v194, v194
    v_mfma_f32_16x16x32_bf16 a[76:79], a[252:255], v[152:155], a[76:79]
    ds_read_b64_tr_b16 a[244:245], v206 offset:128
    v_add_f32 v204, v204, v194
    v_mfma_f32_16x16x32_bf16 a[72:75], a[252:255], v[148:151], a[72:75]
    ds_read_b64_tr_b16 a[246:247], v206 offset:6272
    v_mfma_f32_16x16x32_bf16 a[68:71], a[252:255], v[144:147], a[68:71]
    v_exp_f32 v195, v195
    v_mfma_f32_16x16x32_bf16 a[64:67], a[252:255], v[140:143], a[64:67]
    v_add_f32 v205, v205, v195
    v_mfma_f32_16x16x32_bf16 a[60:63], a[252:255], v[136:139], a[60:63]
    s_waitcnt lgkmcnt(2)
    v_exp_f32 v156, v156
    v_mfma_f32_16x16x32_bf16 a[80:83], a[240:243], v[136:139], a[80:83]
    ds_read_b64_tr_b16 a[248:249], v207 offset:128
    v_add_f32 v196, v196, v156
    v_mfma_f32_16x16x32_bf16 a[84:87], a[240:243], v[140:143], a[84:87]
    ds_read_b64_tr_b16 a[250:251], v207 offset:6272
    v_mfma_f32_16x16x32_bf16 a[88:91], a[240:243], v[144:147], a[88:91]
    v_exp_f32 v157, v157
    v_mfma_f32_16x16x32_bf16 a[92:95], a[240:243], v[148:151], a[92:95]
    s_waitcnt vmcnt(5)
    buffer_load_dwordx4 v9, s[16:19], s35 offen offset:2048 nt lds
    v_add_f32 v197, v197, v157
    v_mfma_f32_16x16x32_bf16 a[96:99], a[240:243], v[152:155], a[96:99]
    s_waitcnt lgkmcnt(2)
    v_exp_f32 v158, v158
    v_mfma_f32_16x16x32_bf16 a[116:119], a[244:247], v[152:155], a[116:119]
    s_add_u32 s89, s35, 3072
    ds_read_b64_tr_b16 a[252:253], v208 offset:128
    v_add_f32 v196, v196, v158
    v_mfma_f32_16x16x32_bf16 a[112:115], a[244:247], v[148:151], a[112:115]
    s_add_u32 m0, m0, 3072
    ds_read_b64_tr_b16 a[254:255], v208 offset:6272
    v_mfma_f32_16x16x32_bf16 a[108:111], a[244:247], v[144:147], a[108:111]
    v_exp_f32 v159, v159
    v_mfma_f32_16x16x32_bf16 a[104:107], a[244:247], v[140:143], a[104:107]
    v_exp_f32 v160, v160
    v_mfma_f32_16x16x32_bf16 a[100:103], a[244:247], v[136:139], a[100:103]
    s_waitcnt lgkmcnt(2)
    v_add_f32 v197, v197, v159
    v_cvt_pk_bf16_f32 v159, v158, v159
    v_mfma_f32_16x16x32_bf16 a[120:123], a[248:251], v[136:139], a[120:123]
    ds_read_b64_tr_b16 a[240:241], v11 offset:256
    v_cvt_pk_bf16_f32 v158, v156, v157
    v_mfma_f32_16x16x32_bf16 a[124:127], a[248:251], v[140:143], a[124:127]
    ds_read_b64_tr_b16 a[242:243], v11 offset:6400
    v_cvt_pk_bf16_f32 v156, v176, v177
    v_mfma_f32_16x16x32_bf16 a[128:131], a[248:251], v[144:147], a[128:131]
    v_exp_f32 v161, v161
    v_mfma_f32_16x16x32_bf16 a[132:135], a[248:251], v[148:151], a[132:135]
    s_waitcnt vmcnt(5)
    buffer_load_dwordx4 v7, s[16:19], s89 offen nt lds
    v_cvt_pk_bf16_f32 v157, v178, v179
    v_mfma_f32_16x16x32_bf16 a[136:139], a[248:251], v[152:155], a[136:139]
    s_waitcnt lgkmcnt(2)
    v_exp_f32 v162, v162
    v_mfma_f32_16x16x32_bf16 a[156:159], a[252:255], v[152:155], a[156:159]
    s_cmp_lg_u32 s18, 0
    ds_read_b64_tr_b16 a[244:245], v206 offset:256
    v_add_f32 v198, v198, v160
    v_mfma_f32_16x16x32_bf16 a[152:155], a[252:255], v[148:151], a[152:155]
    s_cselect_b32 s3, 24576, 0
    ds_read_b64_tr_b16 a[246:247], v206 offset:6400
    v_add_f32 v199, v199, v161
    v_mfma_f32_16x16x32_bf16 a[148:151], a[252:255], v[144:147], a[148:151]
    s_add_u32 s32, s32, s3
    v_exp_f32 v163, v163
    v_mfma_f32_16x16x32_bf16 a[144:147], a[252:255], v[140:143], a[144:147]
    s_lshr_b32 s3, s3, 1
    v_exp_f32 v164, v164
    v_mfma_f32_16x16x32_bf16 a[140:143], a[252:255], v[136:139], a[140:143]
    s_waitcnt lgkmcnt(2)
    v_add_f32 v198, v198, v162
    v_add_f32 v199, v199, v163
    v_mfma_f32_16x16x32_bf16 a[160:163], a[240:243], v[136:139], a[160:163]
    s_cmp_eq_u32 s32, 73728
    ds_read_b64_tr_b16 a[248:249], v207 offset:256
    v_cvt_pk_bf16_f32 v163, v162, v163
    v_mfma_f32_16x16x32_bf16 a[164:167], a[240:243], v[140:143], a[164:167]
    s_cselect_b32 s32, 0, s32
    ds_read_b64_tr_b16 a[250:251], v207 offset:6400
    v_cvt_pk_bf16_f32 v162, v160, v161
    v_mfma_f32_16x16x32_bf16 a[168:171], a[240:243], v[144:147], a[168:171]
    s_add_u32 s35, s35, s3
    v_exp_f32 v165, v165
    v_mfma_f32_16x16x32_bf16 a[172:175], a[240:243], v[148:151], a[172:175]
    s_waitcnt vmcnt(5)
    buffer_load_dwordx4 v8, s[16:19], s89 offen offset:1024 nt lds
    v_cvt_pk_bf16_f32 v160, v180, v181
    v_mfma_f32_16x16x32_bf16 a[176:179], a[240:243], v[152:155], a[176:179]
    s_waitcnt lgkmcnt(2)
    v_exp_f32 v166, v166
    v_mfma_f32_16x16x32_bf16 a[196:199], a[244:247], v[152:155], a[196:199]
    ds_read_b64_tr_b16 a[252:253], v208 offset:256
    v_cvt_pk_bf16_f32 v161, v182, v183
    v_mfma_f32_16x16x32_bf16 a[192:195], a[244:247], v[148:151], a[192:195]
    ds_read_b64_tr_b16 a[254:255], v208 offset:6400
    v_add_f32 v200, v200, v164
    v_mfma_f32_16x16x32_bf16 a[188:191], a[244:247], v[144:147], a[188:191]
    v_exp_f32 v167, v167
    v_mfma_f32_16x16x32_bf16 a[184:187], a[244:247], v[140:143], a[184:187]
    v_exp_f32 v168, v168
    v_mfma_f32_16x16x32_bf16 a[180:183], a[244:247], v[136:139], a[180:183]
    s_waitcnt lgkmcnt(2)
    s_waitcnt vmcnt(11)
    s_barrier
    v_add_f32 v201, v201, v165
    v_mfma_f32_16x16x32_bf16 a[200:203], a[248:251], v[136:139], a[200:203]
    ds_read_b128 a[240:243], v10 offset:49152
    v_add_f32 v200, v200, v166
    v_mfma_f32_16x16x32_bf16 a[204:207], a[248:251], v[140:143], a[204:207]
    ds_read_b128 a[244:247], v13 offset:49152
    v_add_f32 v201, v201, v167
    v_mfma_f32_16x16x32_bf16 a[208:211], a[248:251], v[144:147], a[208:211]
    v_exp_f32 v169, v169
    v_mfma_f32_16x16x32_bf16 a[212:215], a[248:251], v[148:151], a[212:215]
    s_waitcnt vmcnt(5)
    buffer_load_dwordx4 v9, s[16:19], s89 offen offset:2048 nt lds
    v_cvt_pk_bf16_f32 v167, v166, v167
    v_mfma_f32_16x16x32_bf16 a[216:219], a[248:251], v[152:155], a[216:219]
    s_waitcnt lgkmcnt(2)
    v_exp_f32 v170, v170
    v_mfma_f32_16x16x32_bf16 a[236:239], a[252:255], v[152:155], a[236:239]
    v_exp_f32 v171, v171
    v_mfma_f32_16x16x32_bf16 a[232:235], a[252:255], v[148:151], a[232:235]
    s_add_u32 s86, s86, 1
    v_cvt_pk_bf16_f32 v166, v164, v165
    v_cvt_pk_bf16_f32 v164, v184, v185
    v_mfma_f32_16x16x32_bf16 a[228:231], a[252:255], v[144:147], a[228:231]
    v_exp_f32 v172, v172
    v_mfma_f32_16x16x32_bf16 a[224:227], a[252:255], v[140:143], a[224:227]
    v_cvt_pk_bf16_f32 v165, v186, v187
    v_add_f32 v202, v202, v168
    v_mfma_f32_16x16x32_bf16 a[220:223], a[252:255], v[136:139], a[220:223]
    s_waitcnt lgkmcnt(0)
    s_barrier
    v_add_f32 v203, v203, v169
    s_branch L_s1
.p2align 6
L_t:
    v_add_f32 v202, v202, v150
    v_add_f32 v203, v203, v151
    v_exp_f32 v153, v153
    v_cvt_pk_bf16_f32 v151, v150, v151
    v_exp_f32 v154, v154
    v_exp_f32 v155, v155
    v_cvt_pk_bf16_f32 v150, v148, v149
    v_cvt_pk_bf16_f32 v148, v168, v169
    v_cvt_pk_bf16_f32 v149, v170, v171
    v_add_f32 v204, v204, v152
    v_add_f32 v205, v205, v153
    v_add_f32 v204, v204, v154
    v_add_f32 v205, v205, v155
    v_cvt_pk_bf16_f32 v155, v154, v155
    v_cvt_pk_bf16_f32 v154, v152, v153
    v_cvt_pk_bf16_f32 v152, v172, v173
    v_cvt_pk_bf16_f32 v153, v174, v175
L_tr:
    s_cmp_eq_u32 s30, 0
    s_cbranch_scc0 L_t1
L_t0:
    s_waitcnt lgkmcnt(0)
    s_waitcnt vmcnt(0)
    s_barrier
    ds_read_b64_tr_b16 a[240:241], v11 offset:0
    ds_read_b64_tr_b16 a[242:243], v11 offset:6144
    ds_read_b64_tr_b16 a[244:245], v206 offset:0
    ds_read_b64_tr_b16 a[246:247], v206 offset:6144
    ds_read_b64_tr_b16 a[248:249], v207 offset:0
    ds_read_b64_tr_b16 a[250:251], v207 offset:6144
    s_add_u32 m0, s31, 0
    s_mul_i32 s32, s52, 6144
    v_add_f32 v196, v196, v197
    v_add_f32 v198, v198, v199
    v_add_f32 v200, v200, v201
    v_add_f32 v202, v202, v203
    v_add_f32 v204, v204, v205
    v_mov_b32 v210, v196
    v_mov_b32 v211, v198
    v_mov_b32 v212, v200
    v_mov_b32 v213, v202
    v_mov_b32 v214, v204
    buffer_load_dwordx4 v2, s[12:15], s32 offen lds
    v_permlane32_swap_b32 v210, v196
    v_permlane32_swap_b32 v211, v198
    v_permlane32_swap_b32 v212, v200
    v_permlane32_swap_b32 v213, v202
    v_permlane32_swap_b32 v214, v204
    v_add_f32 v196, v196, v210
    v_add_f32 v198, v198, v211
    v_add_f32 v200, v200, v212
    v_add_f32 v202, v202, v213
    v_add_f32 v204, v204, v214
    s_lshl_b32 s29, s28, 2
    s_add_u32 s29, s29, 160000
    s_waitcnt lgkmcnt(4)
    v_mfma_f32_16x16x32_bf16 a[0:3], a[240:243], v[136:139], a[0:3]
    ds_read_b64_tr_b16 a[252:253], v208 offset:0
    v_mov_b32 v210, v196
    v_mfma_f32_16x16x32_bf16 a[4:7], a[240:243], v[140:143], a[4:7]
    ds_read_b64_tr_b16 a[254:255], v208 offset:6144
    v_mov_b32 v211, v198
    v_mfma_f32_16x16x32_bf16 a[8:11], a[240:243], v[144:147], a[8:11]
    v_mov_b32 v212, v200
    v_mov_b32 v213, v202
    v_mfma_f32_16x16x32_bf16 a[12:15], a[240:243], v[148:151], a[12:15]
    buffer_load_dwordx4 v3, s[12:15], s32 offen offset:1024 lds
    v_mov_b32 v214, v204
    v_mfma_f32_16x16x32_bf16 a[16:19], a[240:243], v[152:155], a[16:19]
    s_waitcnt lgkmcnt(4)
    v_permlane16_swap_b32 v210, v196
    v_permlane16_swap_b32 v211, v198
    v_mfma_f32_16x16x32_bf16 a[36:39], a[244:247], v[152:155], a[36:39]
    ds_read_b64_tr_b16 a[240:241], v11 offset:128
    v_permlane16_swap_b32 v212, v200
    v_mfma_f32_16x16x32_bf16 a[32:35], a[244:247], v[148:151], a[32:35]
    ds_read_b64_tr_b16 a[242:243], v11 offset:6272
    v_permlane16_swap_b32 v213, v202
    v_mfma_f32_16x16x32_bf16 a[28:31], a[244:247], v[144:147], a[28:31]
    v_permlane16_swap_b32 v214, v204
    v_add_f32 v196, v196, v210
    v_mfma_f32_16x16x32_bf16 a[24:27], a[244:247], v[140:143], a[24:27]
    buffer_load_dwordx4 v4, s[12:15], s32 offen offset:2048 lds
    v_add_f32 v198, v198, v211
    v_mfma_f32_16x16x32_bf16 a[20:23], a[244:247], v[136:139], a[20:23]
    s_waitcnt lgkmcnt(4)
    v_add_f32 v200, v200, v212
    v_add_f32 v202, v202, v213
    v_mfma_f32_16x16x32_bf16 a[40:43], a[248:251], v[136:139], a[40:43]
    s_add_u32 m0, s38, 0
    ds_read_b64_tr_b16 a[244:245], v206 offset:128
    v_add_f32 v204, v204, v214
    v_mfma_f32_16x16x32_bf16 a[44:47], a[248:251], v[140:143], a[44:47]
    s_add_u32 s39, s52, s0
    ds_read_b64_tr_b16 a[246:247], v206 offset:6272
    v_max3_f32 v176, v196, v198, v200
    v_mfma_f32_16x16x32_bf16 a[48:51], a[248:251], v[144:147], a[48:51]
    v_min3_f32 v177, v196, v198, v200
    v_max3_f32 v176, v176, v202, v204
    v_mfma_f32_16x16x32_bf16 a[52:55], a[248:251], v[148:151], a[52:55]
    buffer_load_dwordx4 v1, s[8:11], s39 offen lds
    v_min3_f32 v177, v177, v202, v204
    v_mfma_f32_16x16x32_bf16 a[56:59], a[248:251], v[152:155], a[56:59]
    s_waitcnt lgkmcnt(4)
    v_cmp_lt_f32 vcc, s41, v176
    v_cmp_gt_f32 s[100:101], s40, v177
    v_mfma_f32_16x16x32_bf16 a[76:79], a[252:255], v[152:155], a[76:79]
    s_add_u32 s39, s39, 9216
    ds_read_b64_tr_b16 a[248:249], v207 offset:128
    v_accvgpr_read_b32 v156, a0
    v_mfma_f32_16x16x32_bf16 a[72:75], a[252:255], v[148:151], a[72:75]
    ds_read_b64_tr_b16 a[250:251], v207 offset:6272
    v_accvgpr_read_b32 v157, a1
    v_mfma_f32_16x16x32_bf16 a[68:71], a[252:255], v[144:147], a[68:71]
    v_rcp_f32 v236, v196
    v_mfma_f32_16x16x32_bf16 a[64:67], a[252:255], v[140:143], a[64:67]
    buffer_load_dwordx4 v1, s[8:11], s39 offen offset:1024 lds
    v_accvgpr_read_b32 v158, a2
    v_mfma_f32_16x16x32_bf16 a[60:63], a[252:255], v[136:139], a[60:63]
    s_waitcnt lgkmcnt(4)
    s_or_b64 vcc, vcc, s[100:101]
    s_cselect_b32 s86, 1, 0
    v_rcp_f32 v237, v198
    v_mfma_f32_16x16x32_bf16 a[80:83], a[240:243], v[136:139], a[80:83]
    s_add_u32 m0, s38, 8192
    ds_read_b64_tr_b16 a[252:253], v208 offset:128
    v_mov_b32 v176, s86
    v_mfma_f32_16x16x32_bf16 a[84:87], a[240:243], v[140:143], a[84:87]
    s_add_u32 s39, s52, s1
    ds_read_b64_tr_b16 a[254:255], v208 offset:6272
    v_mov_b32 v177, s29
    v_mfma_f32_16x16x32_bf16 a[88:91], a[240:243], v[144:147], a[88:91]
    ds_write_b32 v177, v176 offset:0
    v_mov_b32 v178, 160000
    v_mfma_f32_16x16x32_bf16 a[92:95], a[240:243], v[148:151], a[92:95]
    buffer_load_dwordx4 v1, s[8:11], s39 offen lds
    v_accvgpr_read_b32 v159, a3
    v_mfma_f32_16x16x32_bf16 a[96:99], a[240:243], v[152:155], a[96:99]
    s_waitcnt lgkmcnt(5)
    v_rcp_f32 v238, v200
    v_mfma_f32_16x16x32_bf16 a[116:119], a[244:247], v[152:155], a[116:119]
    s_add_u32 s39, s39, 9216
    ds_read_b64_tr_b16 a[240:241], v11 offset:256
    v_accvgpr_read_b32 v160, a20
    v_mfma_f32_16x16x32_bf16 a[112:115], a[244:247], v[148:151], a[112:115]
    ds_read_b64_tr_b16 a[242:243], v11 offset:6400
    v_accvgpr_read_b32 v161, a21
    v_mfma_f32_16x16x32_bf16 a[108:111], a[244:247], v[144:147], a[108:111]
    v_rcp_f32 v239, v202
    v_mfma_f32_16x16x32_bf16 a[104:107], a[244:247], v[140:143], a[104:107]
    buffer_load_dwordx4 v1, s[8:11], s39 offen offset:1024 lds
    v_accvgpr_read_b32 v162, a22
    v_mfma_f32_16x16x32_bf16 a[100:103], a[244:247], v[136:139], a[100:103]
    s_waitcnt lgkmcnt(5)
    s_waitcnt lgkmcnt(2)
    s_barrier
    v_rcp_f32 v240, v204
    v_mfma_f32_16x16x32_bf16 a[120:123], a[248:251], v[136:139], a[120:123]
    s_add_u32 m0, s38, 16384
    ds_read_b64_tr_b16 a[244:245], v206 offset:256
    v_accvgpr_read_b32 v163, a23
    v_mfma_f32_16x16x32_bf16 a[124:127], a[248:251], v[140:143], a[124:127]
    s_add_u32 s39, s52, s63
    ds_read_b64_tr_b16 a[246:247], v206 offset:6400
    v_mul_f32 v156, v156, v236
    v_mfma_f32_16x16x32_bf16 a[128:131], a[248:251], v[144:147], a[128:131]
    ds_read_b128 v[180:183], v178 offset:0
    v_mul_f32 v157, v157, v236
    v_mfma_f32_16x16x32_bf16 a[132:135], a[248:251], v[148:151], a[132:135]
    buffer_load_dwordx4 v1, s[8:11], s39 offen lds
    v_mul_f32 v158, v158, v236
    v_mfma_f32_16x16x32_bf16 a[136:139], a[248:251], v[152:155], a[136:139]
    s_waitcnt lgkmcnt(6)
    v_mul_f32 v159, v159, v236
    v_mul_f32 v160, v160, v236
    v_mfma_f32_16x16x32_bf16 a[156:159], a[252:255], v[152:155], a[156:159]
    s_add_u32 s39, s39, 9216
    ds_read_b64_tr_b16 a[248:249], v207 offset:256
    v_mul_f32 v161, v161, v236
    v_mfma_f32_16x16x32_bf16 a[152:155], a[252:255], v[148:151], a[152:155]
    ds_read_b64_tr_b16 a[250:251], v207 offset:6400
    v_mul_f32 v162, v162, v236
    v_mfma_f32_16x16x32_bf16 a[148:151], a[252:255], v[144:147], a[148:151]
    v_mul_f32 v163, v163, v236
    v_cvt_pk_bf16_f32 v184, v156, v157
    v_mfma_f32_16x16x32_bf16 a[144:147], a[252:255], v[140:143], a[144:147]
    buffer_load_dwordx4 v1, s[8:11], s39 offen offset:1024 lds
    v_cvt_pk_bf16_f32 v185, v158, v159
    v_mfma_f32_16x16x32_bf16 a[140:143], a[252:255], v[136:139], a[140:143]
    s_waitcnt lgkmcnt(5)
    s_waitcnt lgkmcnt(2)
    v_or3_b32 v178, v180, v181, v182
    v_or_b32 v178, v178, v183
    v_mfma_f32_16x16x32_bf16 a[160:163], a[240:243], v[136:139], a[160:163]
    s_add_u32 m0, s38, 24576
    ds_read_b64_tr_b16 a[252:253], v208 offset:256
    v_readfirstlane_b32 s86, v178
    v_mfma_f32_16x16x32_bf16 a[164:167], a[240:243], v[140:143], a[164:167]
    s_add_u32 s39, s52, s87
    ds_read_b64_tr_b16 a[254:255], v208 offset:6400
    v_cvt_pk_bf16_f32 v186, v160, v161
    v_mfma_f32_16x16x32_bf16 a[168:171], a[240:243], v[144:147], a[168:171]
    v_cvt_pk_bf16_f32 v187, v162, v163
    v_accvgpr_read_b32 v164, a4
    v_mfma_f32_16x16x32_bf16 a[172:175], a[240:243], v[148:151], a[172:175]
    buffer_load_dwordx4 v1, s[8:11], s39 offen lds
    v_accvgpr_read_b32 v165, a5
    v_mfma_f32_16x16x32_bf16 a[176:179], a[240:243], v[152:155], a[176:179]
    s_waitcnt lgkmcnt(5)
    v_accvgpr_read_b32 v166, a6
    v_accvgpr_read_b32 v167, a7
    v_mfma_f32_16x16x32_bf16 a[196:199], a[244:247], v[152:155], a[196:199]
    s_add_u32 s39, s39, 9216
    v_accvgpr_read_b32 v168, a24
    v_accvgpr_read_b32 v169, a25
    v_mfma_f32_16x16x32_bf16 a[192:195], a[244:247], v[148:151], a[192:195]
    v_accvgpr_read_b32 v170, a26
    v_accvgpr_read_b32 v171, a27
    v_mfma_f32_16x16x32_bf16 a[188:191], a[244:247], v[144:147], a[188:191]
    v_mul_f32 v164, v164, v237
    v_mul_f32 v165, v165, v237
    v_mfma_f32_16x16x32_bf16 a[184:187], a[244:247], v[140:143], a[184:187]
    buffer_load_dwordx4 v1, s[8:11], s39 offen offset:1024 lds
    v_mul_f32 v166, v166, v237
    v_mfma_f32_16x16x32_bf16 a[180:183], a[244:247], v[136:139], a[180:183]
    s_waitcnt lgkmcnt(2)
    v_mul_f32 v167, v167, v237
    v_mul_f32 v168, v168, v237
    v_mfma_f32_16x16x32_bf16 a[200:203], a[248:251], v[136:139], a[200:203]
    s_add_u32 m0, s38, 32768
    v_mul_f32 v169, v169, v237
    v_mul_f32 v170, v170, v237
    v_mfma_f32_16x16x32_bf16 a[204:207], a[248:251], v[140:143], a[204:207]
    s_add_u32 s39, s52, 81920
    v_mul_f32 v171, v171, v237
    v_cvt_pk_bf16_f32 v188, v164, v165
    v_mfma_f32_16x16x32_bf16 a[208:211], a[248:251], v[144:147], a[208:211]
    v_cvt_pk_bf16_f32 v189, v166, v167
    v_cvt_pk_bf16_f32 v190, v168, v169
    v_mfma_f32_16x16x32_bf16 a[212:215], a[248:251], v[148:151], a[212:215]
    buffer_load_dwordx4 v1, s[8:11], s39 offen lds
    v_cvt_pk_bf16_f32 v191, v170, v171
    v_mfma_f32_16x16x32_bf16 a[216:219], a[248:251], v[152:155], a[216:219]
    s_waitcnt lgkmcnt(0)
    v_accvgpr_read_b32 v156, a8
    v_accvgpr_read_b32 v157, a9
    v_mfma_f32_16x16x32_bf16 a[236:239], a[252:255], v[152:155], a[236:239]
    s_add_u32 s39, s39, 9216
    v_accvgpr_read_b32 v158, a10
    v_accvgpr_read_b32 v159, a11
    v_mfma_f32_16x16x32_bf16 a[232:235], a[252:255], v[148:151], a[232:235]
    v_accvgpr_read_b32 v160, a28
    v_accvgpr_read_b32 v161, a29
    v_mfma_f32_16x16x32_bf16 a[228:231], a[252:255], v[144:147], a[228:231]
    v_accvgpr_read_b32 v162, a30
    v_accvgpr_read_b32 v163, a31
    v_mfma_f32_16x16x32_bf16 a[224:227], a[252:255], v[140:143], a[224:227]
    buffer_load_dwordx4 v1, s[8:11], s39 offen offset:1024 lds
    v_mul_f32 v156, v156, v238
    v_mfma_f32_16x16x32_bf16 a[220:223], a[252:255], v[136:139], a[220:223]
    v_mul_f32 v157, v157, v238
    v_mul_f32 v158, v158, v238
    s_cmp_lg_u32 s86, 0
    s_cbranch_scc1 L_slow
    v_mul_f32 v159, v159, v238
    v_mul_f32 v160, v160, v238
    v_mul_f32 v161, v161, v238
    v_mul_f32 v162, v162, v238
    v_mul_f32 v163, v163, v238
    v_cvt_pk_bf16_f32 v192, v156, v157
    v_cvt_pk_bf16_f32 v193, v158, v159
    v_cvt_pk_bf16_f32 v194, v160, v161
    v_cvt_pk_bf16_f32 v195, v162, v163
    s_add_u32 s16, s16, 786432
    s_addc_u32 s17, s17, 0
    s_add_u32 s20, s20, 786432
    s_addc_u32 s21, s21, 0
    s_mov_b32 s30, 1
    v_accvgpr_read_b32 v164, a12
    v_accvgpr_read_b32 v165, a13
    v_accvgpr_read_b32 v166, a14
    v_accvgpr_read_b32 v167, a15
    v_accvgpr_read_b32 v168, a32
    v_accvgpr_read_b32 v169, a33
    v_accvgpr_read_b32 v170, a34
    v_accvgpr_read_b32 v171, a35
    s_add_u32 m0, s31, 12320
    s_add_u32 s32, s32, 393216
    buffer_load_dwordx4 v2, s[12:15], s32 offen lds
    v_pk_mul_f32 v[164:165], v[164:165], v[238:239] op_sel:[0,1]
    v_pk_mul_f32 v[166:167], v[166:167], v[238:239] op_sel:[0,1]
    v_pk_mul_f32 v[168:169], v[168:169], v[238:239] op_sel:[0,1]
    v_pk_mul_f32 v[170:171], v[170:171], v[238:239] op_sel:[0,1]
    v_cvt_pk_bf16_f32 v28, v164, v165
    v_cvt_pk_bf16_f32 v29, v166, v167
    v_cvt_pk_bf16_f32 v30, v168, v169
    v_cvt_pk_bf16_f32 v31, v170, v171
    buffer_load_dwordx4 v3, s[12:15], s32 offen offset:1024 lds
    v_accvgpr_read_b32 v156, a16
    v_accvgpr_read_b32 v157, a17
    v_accvgpr_read_b32 v158, a18
    v_accvgpr_read_b32 v159, a19
    v_accvgpr_read_b32 v160, a36
    v_accvgpr_read_b32 v161, a37
    v_accvgpr_read_b32 v162, a38
    v_accvgpr_read_b32 v163, a39
    buffer_load_dwordx4 v4, s[12:15], s32 offen offset:2048 lds
    v_lshrrev_b32 v140, 4, v0
    s_getpc_b64 s[100:101]
    s_add_u32 s100, s100, L_q1-.
    s_addc_u32 s101, s101, 0
    s_lshr_b32 s29, s2, 3
    s_lshl_b32 s29, s29, 2
    s_add_u32 s29, s29, s28
    s_mul_i32 s29, s29, 2
    s_mov_b32 s86, L_t1-L_q1
    v_min_u32 v138, 1, v140
    v_add_u32 v138, s29, v138
    v_lshlrev_b32 v138, 7, v138
    v_min_u32 v138, s86, v138
    v_mov_b32 v139, s101
    v_add_co_u32 v138, vcc, s100, v138
    s_nop 1
    v_addc_co_u32 v139, vcc, 0, v139, vcc
    global_load_dword v241, v[138:139], off
    v_pk_mul_f32 v[156:157], v[156:157], v[240:241] op_sel_hi:[1,0]
    v_pk_mul_f32 v[158:159], v[158:159], v[240:241] op_sel_hi:[1,0]
    v_pk_mul_f32 v[160:161], v[160:161], v[240:241] op_sel_hi:[1,0]
    v_pk_mul_f32 v[162:163], v[162:163], v[240:241] op_sel_hi:[1,0]
    v_cvt_pk_bf16_f32 v32, v156, v157
    v_cvt_pk_bf16_f32 v33, v158, v159
    v_cvt_pk_bf16_f32 v34, v160, v161
    v_cvt_pk_bf16_f32 v35, v162, v163
    s_add_u32 m0, s38, 40960
    s_add_u32 s39, s53, s0
    buffer_load_dwordx4 v1, s[8:11], s39 offen lds
    s_mov_b32 s88, 0
    buffer_store_dwordx4 v[184:187], v0, s[24:27], s88 offen sc1
    v_accvgpr_read_b32 v164, a40
    v_accvgpr_read_b32 v165, a41
    v_accvgpr_read_b32 v166, a42
    v_accvgpr_read_b32 v167, a43
    v_accvgpr_read_b32 v168, a60
    v_accvgpr_read_b32 v169, a61
    v_accvgpr_read_b32 v170, a62
    v_accvgpr_read_b32 v171, a63
    s_add_u32 s39, s39, 9216
    buffer_load_dwordx4 v1, s[8:11], s39 offen offset:1024 lds
    v_pk_mul_f32 v[164:165], v[164:165], v[236:237] op_sel_hi:[1,0]
    v_pk_mul_f32 v[166:167], v[166:167], v[236:237] op_sel_hi:[1,0]
    v_pk_mul_f32 v[168:169], v[168:169], v[236:237] op_sel_hi:[1,0]
    v_pk_mul_f32 v[170:171], v[170:171], v[236:237] op_sel_hi:[1,0]
    v_cvt_pk_bf16_f32 v36, v164, v165
    v_cvt_pk_bf16_f32 v37, v166, v167
    v_cvt_pk_bf16_f32 v38, v168, v169
    v_cvt_pk_bf16_f32 v39, v170, v171
    s_add_u32 m0, s38, 49152
    s_add_u32 s39, s53, s1
    buffer_load_dwordx4 v1, s[8:11], s39 offen lds
    v_accvgpr_write_b32 a40, v36
    v_accvgpr_write_b32 a41, v37
    v_accvgpr_write_b32 a42, v38
    v_accvgpr_write_b32 a43, v39
    s_mov_b32 s88, 1024
    buffer_store_dwordx4 v[188:191], v0, s[24:27], s88 offen sc1
    v_accvgpr_read_b32 v156, a44
    v_accvgpr_read_b32 v157, a45
    v_accvgpr_read_b32 v158, a46
    v_accvgpr_read_b32 v159, a47
    v_accvgpr_read_b32 v160, a64
    v_accvgpr_read_b32 v161, a65
    v_accvgpr_read_b32 v162, a66
    v_accvgpr_read_b32 v163, a67
    s_add_u32 s39, s39, 9216
    buffer_load_dwordx4 v1, s[8:11], s39 offen offset:1024 lds
    v_pk_mul_f32 v[156:157], v[156:157], v[236:237] op_sel:[0,1]
    v_pk_mul_f32 v[158:159], v[158:159], v[236:237] op_sel:[0,1]
    v_pk_mul_f32 v[160:161], v[160:161], v[236:237] op_sel:[0,1]
    v_pk_mul_f32 v[162:163], v[162:163], v[236:237] op_sel:[0,1]
    v_cvt_pk_bf16_f32 v40, v156, v157
    v_cvt_pk_bf16_f32 v41, v158, v159
    v_cvt_pk_bf16_f32 v42, v160, v161
    v_cvt_pk_bf16_f32 v43, v162, v163
    s_add_u32 m0, s38, 57344
    s_add_u32 s39, s53, s63
    buffer_load_dwordx4 v1, s[8:11], s39 offen lds
    v_accvgpr_write_b32 a44, v40
    v_accvgpr_write_b32 a45, v41
    v_accvgpr_write_b32 a46, v42
    v_accvgpr_write_b32 a47, v43
    s_mov_b32 s88, 2048
    buffer_store_dwordx4 v[192:195], v0, s[24:27], s88 offen sc1
    v_accvgpr_read_b32 v164, a48
    v_accvgpr_read_b32 v165, a49
    v_accvgpr_read_b32 v166, a50
    v_accvgpr_read_b32 v167, a51
    v_accvgpr_read_b32 v168, a68
    v_accvgpr_read_b32 v169, a69
    v_accvgpr_read_b32 v170, a70
    v_accvgpr_read_b32 v171, a71
    s_add_u32 s39, s39, 9216
    buffer_load_dwordx4 v1, s[8:11], s39 offen offset:1024 lds
    v_pk_mul_f32 v[164:165], v[164:165], v[238:239] op_sel_hi:[1,0]
    v_pk_mul_f32 v[166:167], v[166:167], v[238:239] op_sel_hi:[1,0]
    v_pk_mul_f32 v[168:169], v[168:169], v[238:239] op_sel_hi:[1,0]
    v_pk_mul_f32 v[170:171], v[170:171], v[238:239] op_sel_hi:[1,0]
    v_cvt_pk_bf16_f32 v44, v164, v165
    v_cvt_pk_bf16_f32 v45, v166, v167
    v_cvt_pk_bf16_f32 v46, v168, v169
    v_cvt_pk_bf16_f32 v47, v170, v171
    v_accvgpr_write_b32 a48, v44
    v_accvgpr_write_b32 a49, v45
    v_accvgpr_write_b32 a50, v46
    v_accvgpr_write_b32 a51, v47
    v_accvgpr_read_b32 v156, a52
    v_accvgpr_read_b32 v157, a53
    v_accvgpr_read_b32 v158, a54
    v_accvgpr_read_b32 v159, a55
    v_accvgpr_read_b32 v160, a72
    v_accvgpr_read_b32 v161, a73
    v_accvgpr_read_b32 v162, a74
    v_accvgpr_read_b32 v163, a75
    v_xor_b32 v13, 64, v12
    s_waitcnt vmcnt(13)
    s_barrier
    ds_read_b64_tr_b16 a[240:241], v5 offset:0
    ds_read_b64_tr_b16 a[242:243], v5 offset:1536
    ds_read_b64_tr_b16 a[244:245], v5 offset:8
    ds_read_b64_tr_b16 a[246:247], v5 offset:1544
    ds_read_b64_tr_b16 a[248:249], v6 offset:0
    ds_read_b64_tr_b16 a[250:251], v6 offset:1536
    ds_read_b64_tr_b16 a[252:253], v6 offset:8
    ds_read_b64_tr_b16 a[254:255], v6 offset:1544
    ds_read_b128 a[20:23], v12 offset:0
    ds_read_b128 a[24:27], v12 offset:8192
    ds_read_b128 a[28:31], v12 offset:16384
    ds_read_b128 a[32:35], v12 offset:24576
    ds_read_b128 a[36:39], v12 offset:32768
    v_pk_mul_f32 v[156:157], v[156:157], v[238:239] op_sel:[0,1]
    v_pk_mul_f32 v[158:159], v[158:159], v[238:239] op_sel:[0,1]
    v_pk_mul_f32 v[160:161], v[160:161], v[238:239] op_sel:[0,1]
    v_pk_mul_f32 v[162:163], v[162:163], v[238:239] op_sel:[0,1]
    v_cvt_pk_bf16_f32 v48, v156, v157
    v_cvt_pk_bf16_f32 v49, v158, v159
    v_cvt_pk_bf16_f32 v50, v160, v161
    v_cvt_pk_bf16_f32 v51, v162, v163
    v_accvgpr_write_b32 a52, v48
    v_accvgpr_write_b32 a53, v49
    v_accvgpr_write_b32 a54, v50
    v_accvgpr_write_b32 a55, v51
    s_mov_b32 s88, 3072
    buffer_store_dwordx4 v[28:31], v0, s[24:27], s88 offen sc1
    v_accvgpr_write_b32 a0, v7
    v_accvgpr_write_b32 a1, v8
    v_accvgpr_write_b32 a2, v9
    v_accvgpr_write_b32 a3, v10
    v_accvgpr_write_b32 a4, v11
    v_accvgpr_write_b32 a5, v236
    v_accvgpr_write_b32 a6, v237
    v_accvgpr_write_b32 a7, v238
    v_accvgpr_write_b32 a8, v239
    v_accvgpr_write_b32 a9, v240
    v_accvgpr_read_b32 v164, a56
    v_accvgpr_read_b32 v165, a57
    v_accvgpr_read_b32 v166, a58
    v_accvgpr_read_b32 v167, a59
    v_accvgpr_read_b32 v168, a76
    v_accvgpr_read_b32 v169, a77
    v_accvgpr_read_b32 v170, a78
    v_accvgpr_read_b32 v171, a79
    v_pk_mul_f32 v[164:165], v[164:165], v[240:241] op_sel_hi:[1,0]
    v_pk_mul_f32 v[166:167], v[166:167], v[240:241] op_sel_hi:[1,0]
    v_pk_mul_f32 v[168:169], v[168:169], v[240:241] op_sel_hi:[1,0]
    v_pk_mul_f32 v[170:171], v[170:171], v[240:241] op_sel_hi:[1,0]
    v_cvt_pk_bf16_f32 v52, v164, v165
    v_cvt_pk_bf16_f32 v53, v166, v167
    v_cvt_pk_bf16_f32 v54, v168, v169
    v_cvt_pk_bf16_f32 v55, v170, v171
    v_accvgpr_write_b32 a56, v52
    v_accvgpr_write_b32 a57, v53
    v_accvgpr_write_b32 a58, v54
    v_accvgpr_write_b32 a59, v55
    s_mov_b32 s88, 4096
    buffer_store_dwordx4 v[32:35], v0, s[24:27], s88 offen sc1
L_q1:
    s_waitcnt lgkmcnt(0)
    v_mfma_f32_16x16x32_bf16 v[16:19], a[240:243], a[20:23], 0
    s_add_u32 m0, s31, 24640
    ds_read_b64_tr_b16 a[12:13], v5 offset:128
    v_accvgpr_read_b32 v14, a5
    v_mfma_f32_16x16x32_bf16 v[24:27], a[240:243], a[24:27], 0
    s_mul_i32 s32, s53, 6144
    ds_read_b64_tr_b16 a[14:15], v5 offset:1664
    v_accvgpr_read_b32 v8, a80
    v_mfma_f32_16x16x32_bf16 v[32:35], a[240:243], a[28:31], 0
    s_waitcnt vmcnt(23)
    ds_read_b128 a[60:63], v13 offset:0
    v_accvgpr_read_b32 v9, a81
    v_mfma_f32_16x16x32_bf16 v[40:43], a[240:243], a[32:35], 0
    buffer_load_dwordx4 v2, s[12:15], s32 offen lds
    v_mul_f32 v8, v8, v14
    v_mfma_f32_16x16x32_bf16 v[48:51], a[240:243], a[36:39], 0
    v_mul_f32 v9, v9, v14
    v_cvt_pk_bf16_f32 v8, v8, v9
    v_mfma_f32_16x16x32_bf16 v[52:55], a[244:247], a[36:39], 0
    ds_read_b64_tr_b16 a[16:17], v5 offset:136
    v_accvgpr_read_b32 v9, a82
    v_mfma_f32_16x16x32_bf16 v[44:47], a[244:247], a[32:35], 0
    ds_read_b64_tr_b16 a[18:19], v5 offset:1672
    v_accvgpr_read_b32 v10, a83
    v_mfma_f32_16x16x32_bf16 v[36:39], a[244:247], a[28:31], 0
    s_waitcnt vmcnt(22)
    ds_read_b128 a[64:67], v13 offset:8192
    v_mul_f32 v9, v9, v14
    v_mfma_f32_16x16x32_bf16 v[28:31], a[244:247], a[24:27], 0
    buffer_load_dwordx4 v3, s[12:15], s32 offen offset:1024 lds
    v_mul_f32 v10, v10, v14
    v_mfma_f32_16x16x32_bf16 v[20:23], a[244:247], a[20:23], 0
    v_cvt_pk_bf16_f32 v9, v9, v10
    v_accvgpr_read_b32 v10, a100
    v_mfma_f32_16x16x32_bf16 v[56:59], a[248:251], a[20:23], 0
    ds_read_b64_tr_b16 a[240:241], v6 offset:128
    v_accvgpr_read_b32 v11, a101
    v_mfma_f32_16x16x32_bf16 v[64:67], a[248:251], a[24:27], 0
    ds_read_b64_tr_b16 a[242:243], v6 offset:1664
    v_mul_f32 v10, v10, v14
    v_mfma_f32_16x16x32_bf16 v[72:75], a[248:251], a[28:31], 0
    s_waitcnt vmcnt(21)
    ds_read_b128 a[68:71], v13 offset:16384
    v_mul_f32 v11, v11, v14
    v_mfma_f32_16x16x32_bf16 v[80:83], a[248:251], a[32:35], 0
    buffer_load_dwordx4 v4, s[12:15], s32 offen offset:2048 lds
    v_cvt_pk_bf16_f32 v10, v10, v11
    v_mfma_f32_16x16x32_bf16 v[88:91], a[248:251], a[36:39], 0
    v_accvgpr_read_b32 v11, a102
    v_accvgpr_read_b32 v7, a103
    v_mfma_f32_16x16x32_bf16 v[92:95], a[252:255], a[36:39], 0
    s_add_u32 m0, s31, 36960
    ds_read_b64_tr_b16 a[244:245], v6 offset:136
    v_mul_f32 v11, v11, v14
    v_mfma_f32_16x16x32_bf16 v[84:87], a[252:255], a[32:35], 0
    s_add_u32 s32, s32, 393216
    ds_read_b64_tr_b16 a[246:247], v6 offset:1672
    v_mul_f32 v7, v7, v14
    v_mfma_f32_16x16x32_bf16 v[76:79], a[252:255], a[28:31], 0
    s_waitcnt vmcnt(20)
    ds_read_b128 a[72:75], v13 offset:24576
    v_cvt_pk_bf16_f32 v11, v11, v7
    v_mfma_f32_16x16x32_bf16 v[68:71], a[252:255], a[24:27], 0
    buffer_load_dwordx4 v2, s[12:15], s32 offen lds
    v_accvgpr_write_b32 a80, v8
    v_mfma_f32_16x16x32_bf16 v[60:63], a[252:255], a[20:23], 0
    s_waitcnt lgkmcnt(10)
    v_accvgpr_write_b32 a81, v9
    v_accvgpr_write_b32 a82, v10
    v_mfma_f32_16x16x32_bf16 v[96:99], a[12:15], a[20:23], 0
    ds_read_b64_tr_b16 a[248:249], v5 offset:256
    v_accvgpr_write_b32 a83, v11
    v_mfma_f32_16x16x32_bf16 v[104:107], a[12:15], a[24:27], 0
    ds_read_b64_tr_b16 a[250:251], v5 offset:1792
    v_accvgpr_read_b32 v14, a6
    v_mfma_f32_16x16x32_bf16 v[112:115], a[12:15], a[28:31], 0
    s_waitcnt vmcnt(19)
    ds_read_b128 a[76:79], v13 offset:32768
    v_accvgpr_read_b32 v8, a84
    v_mfma_f32_16x16x32_bf16 v[120:123], a[12:15], a[32:35], 0
    buffer_load_dwordx4 v3, s[12:15], s32 offen offset:1024 lds
    v_accvgpr_read_b32 v9, a85
    v_mfma_f32_16x16x32_bf16 v[128:131], a[12:15], a[36:39], 0
    s_waitcnt lgkmcnt(10)
    v_mul_f32 v8, v8, v14
    v_mul_f32 v9, v9, v14
    v_mfma_f32_16x16x32_bf16 v[132:135], a[16:19], a[36:39], 0
    ds_read_b64_tr_b16 a[252:253], v5 offset:264
    v_cvt_pk_bf16_f32 v8, v8, v9
    v_mfma_f32_16x16x32_bf16 v[124:127], a[16:19], a[32:35], 0
    ds_read_b64_tr_b16 a[254:255], v5 offset:1800
    v_accvgpr_read_b32 v9, a86
    v_mfma_f32_16x16x32_bf16 v[116:119], a[16:19], a[28:31], 0
    v_accvgpr_read_b32 v10, a87
    v_mfma_f32_16x16x32_bf16 v[108:111], a[16:19], a[24:27], 0
    buffer_load_dwordx4 v4, s[12:15], s32 offen offset:2048 lds
    v_mul_f32 v9, v9, v14
    v_mfma_f32_16x16x32_bf16 v[100:103], a[16:19], a[20:23], 0
    s_waitcnt lgkmcnt(9)
    v_mul_f32 v10, v10, v14
    v_cvt_pk_bf16_f32 v9, v9, v10
    v_mfma_f32_16x16x32_bf16 v[136:139], a[240:243], a[20:23], 0
    s_add_u32 m0, s38, 0
    ds_read_b64_tr_b16 a[12:13], v6 offset:256
    v_accvgpr_read_b32 v10, a104
    v_mfma_f32_16x16x32_bf16 v[144:147], a[240:243], a[24:27], 0
    s_add_u32 s39, s53, s87
    ds_read_b64_tr_b16 a[14:15], v6 offset:1792
    v_accvgpr_read_b32 v11, a105
    v_mfma_f32_16x16x32_bf16 v[152:155], a[240:243], a[28:31], 0
    s_waitcnt vmcnt(14)
    ds_read_b128 a[100:103], v12 offset:40960
    v_mul_f32 v10, v10, v14
    v_mfma_f32_16x16x32_bf16 v[160:163], a[240:243], a[32:35], 0
    buffer_load_dwordx4 v1, s[8:11], s39 offen lds
    v_mul_f32 v11, v11, v14
    v_mfma_f32_16x16x32_bf16 v[168:171], a[240:243], a[36:39], 0
    s_waitcnt lgkmcnt(9)
    v_cvt_pk_bf16_f32 v10, v10, v11
    v_accvgpr_read_b32 v11, a106
    v_mfma_f32_16x16x32_bf16 v[172:175], a[244:247], a[36:39], 0
    s_add_u32 s39, s39, 9216
    ds_read_b64_tr_b16 a[16:17], v6 offset:264
    v_accvgpr_read_b32 v7, a107
    v_mfma_f32_16x16x32_bf16 v[164:167], a[244:247], a[32:35], 0
    ds_read_b64_tr_b16 a[18:19], v6 offset:1800
    v_mul_f32 v11, v11, v14
    v_mfma_f32_16x16x32_bf16 v[156:159], a[244:247], a[28:31], 0
    ds_read_b128 a[104:107], v13 offset:40960
    v_mul_f32 v7, v7, v14
    v_mfma_f32_16x16x32_bf16 v[148:151], a[244:247], a[24:27], 0
    buffer_load_dwordx4 v1, s[8:11], s39 offen offset:1024 lds
    v_cvt_pk_bf16_f32 v11, v11, v7
    v_mfma_f32_16x16x32_bf16 v[140:143], a[244:247], a[20:23], 0
    s_waitcnt lgkmcnt(9)
    s_waitcnt vmcnt(20)
    s_barrier
    v_accvgpr_write_b32 a84, v8
    v_mfma_f32_16x16x32_bf16 v[176:179], a[248:251], a[20:23], 0
    s_add_u32 m0, s38, 8192
    ds_read_b64_tr_b16 a[240:241], v5 offset:12320
    v_accvgpr_write_b32 a85, v9
    v_mfma_f32_16x16x32_bf16 v[184:187], a[248:251], a[24:27], 0
    s_add_u32 s39, s53, 81920
    ds_read_b64_tr_b16 a[242:243], v5 offset:13856
    v_accvgpr_write_b32 a86, v10
    v_mfma_f32_16x16x32_bf16 v[192:195], a[248:251], a[28:31], 0
    v_accvgpr_write_b32 a87, v11
    v_mfma_f32_16x16x32_bf16 v[200:203], a[248:251], a[32:35], 0
    buffer_load_dwordx4 v1, s[8:11], s39 offen lds
    v_accvgpr_read_b32 v14, a7
    v_mfma_f32_16x16x32_bf16 v[208:211], a[248:251], a[36:39], 0
    s_waitcnt lgkmcnt(8)
    v_accvgpr_read_b32 v8, a88
    v_accvgpr_read_b32 v9, a89
    v_mfma_f32_16x16x32_bf16 v[212:215], a[252:255], a[36:39], 0
    s_add_u32 s39, s39, 9216
    ds_read_b64_tr_b16 a[244:245], v5 offset:12328
    v_mul_f32 v8, v8, v14
    v_mfma_f32_16x16x32_bf16 v[204:207], a[252:255], a[32:35], 0
    ds_read_b64_tr_b16 a[246:247], v5 offset:13864
    v_mul_f32 v9, v9, v14
    v_mfma_f32_16x16x32_bf16 v[196:199], a[252:255], a[28:31], 0
    v_cvt_pk_bf16_f32 v8, v8, v9
    v_mfma_f32_16x16x32_bf16 v[188:191], a[252:255], a[24:27], 0
    buffer_load_dwordx4 v1, s[8:11], s39 offen offset:1024 lds
    v_accvgpr_read_b32 v9, a90
    v_mfma_f32_16x16x32_bf16 v[180:183], a[252:255], a[20:23], 0
    s_waitcnt lgkmcnt(8)
    v_accvgpr_read_b32 v10, a91
    v_mul_f32 v9, v9, v14
    v_mfma_f32_16x16x32_bf16 v[216:219], a[12:15], a[20:23], 0
    s_mov_b32 s88, 10240
    ds_read_b64_tr_b16 a[248:249], v6 offset:12320
    v_mul_f32 v10, v10, v14
    v_mfma_f32_16x16x32_bf16 v[224:227], a[12:15], a[24:27], 0
    ds_read_b64_tr_b16 a[250:251], v6 offset:13856
    v_cvt_pk_bf16_f32 v9, v9, v10
    v_mfma_f32_16x16x32_bf16 v[232:235], a[12:15], a[28:31], 0
    v_accvgpr_read_b32 v10, a108
    v_mfma_f32_16x16x32_bf16 v[240:243], a[12:15], a[32:35], 0
    buffer_store_dwordx4 a[40:43], v0, s[24:27], s88 offen sc1
    v_accvgpr_read_b32 v11, a109
    v_mfma_f32_16x16x32_bf16 v[248:251], a[12:15], a[36:39], 0
    s_waitcnt lgkmcnt(7)
    v_mul_f32 v10, v10, v14
    v_mul_f32 v11, v11, v14
    v_mfma_f32_16x16x32_bf16 v[252:255], a[16:19], a[36:39], 0
    s_mov_b32 s88, 11264
    ds_read_b64_tr_b16 a[252:253], v6 offset:12328
    v_cvt_pk_bf16_f32 v10, v10, v11
    v_mfma_f32_16x16x32_bf16 v[244:247], a[16:19], a[32:35], 0
    ds_read_b64_tr_b16 a[254:255], v6 offset:13864
    v_accvgpr_read_b32 v11, a110
    v_mfma_f32_16x16x32_bf16 v[236:239], a[16:19], a[28:31], 0
    v_accvgpr_read_b32 v7, a111
    v_mfma_f32_16x16x32_bf16 v[228:231], a[16:19], a[24:27], 0
    buffer_store_dwordx4 a[44:47], v0, s[24:27], s88 offen sc1
    v_mul_f32 v11, v11, v14
    v_mfma_f32_16x16x32_bf16 v[220:223], a[16:19], a[20:23], 0
    s_waitcnt lgkmcnt(6)
    v_mul_f32 v7, v7, v14
    v_cvt_pk_bf16_f32 v11, v11, v7
    v_mfma_f32_16x16x32_bf16 v[16:19], a[240:243], a[60:63], v[16:19]
    s_add_u32 m0, s31, 49280
    ds_read_b64_tr_b16 a[12:13], v5 offset:12448
    v_accvgpr_write_b32 a88, v8
    v_mfma_f32_16x16x32_bf16 v[24:27], a[240:243], a[64:67], v[24:27]
    s_mul_i32 s32, s54, 6144
    ds_read_b64_tr_b16 a[14:15], v5 offset:13984
    v_accvgpr_write_b32 a89, v9
    v_mfma_f32_16x16x32_bf16 v[32:35], a[240:243], a[68:71], v[32:35]
    s_waitcnt vmcnt(17)
    ds_read_b128 a[108:111], v12 offset:49152
    v_accvgpr_write_b32 a90, v10
    v_mfma_f32_16x16x32_bf16 v[40:43], a[240:243], a[72:75], v[40:43]
    buffer_load_dwordx4 v2, s[12:15], s32 offen lds
    v_accvgpr_write_b32 a91, v11
    v_mfma_f32_16x16x32_bf16 v[48:51], a[240:243], a[76:79], v[48:51]
    s_waitcnt lgkmcnt(7)
    v_accvgpr_read_b32 v14, a8
    v_accvgpr_read_b32 v8, a92
    v_mfma_f32_16x16x32_bf16 v[52:55], a[244:247], a[76:79], v[52:55]
    ds_read_b64_tr_b16 a[16:17], v5 offset:12456
    v_accvgpr_read_b32 v9, a93
    v_mfma_f32_16x16x32_bf16 v[44:47], a[244:247], a[72:75], v[44:47]
    ds_read_b64_tr_b16 a[18:19], v5 offset:13992
    v_mul_f32 v8, v8, v14
    v_mfma_f32_16x16x32_bf16 v[36:39], a[244:247], a[68:71], v[36:39]
    ds_read_b128 a[20:23], v13 offset:49152
    v_mul_f32 v9, v9, v14
    v_mfma_f32_16x16x32_bf16 v[28:31], a[244:247], a[64:67], v[28:31]
    buffer_load_dwordx4 v3, s[12:15], s32 offen offset:1024 lds
    v_cvt_pk_bf16_f32 v8, v8, v9
    v_mfma_f32_16x16x32_bf16 v[20:23], a[244:247], a[60:63], v[20:23]
    s_waitcnt lgkmcnt(8)
    v_accvgpr_read_b32 v9, a94
    v_accvgpr_read_b32 v10, a95
    v_mfma_f32_16x16x32_bf16 v[56:59], a[248:251], a[60:63], v[56:59]
    ds_read_b64_tr_b16 a[240:241], v6 offset:12448
    v_mul_f32 v9, v9, v14
    v_mfma_f32_16x16x32_bf16 v[64:67], a[248:251], a[64:67], v[64:67]
    ds_read_b64_tr_b16 a[242:243], v6 offset:13984
    v_mul_f32 v10, v10, v14
    v_mfma_f32_16x16x32_bf16 v[72:75], a[248:251], a[68:71], v[72:75]
    s_waitcnt vmcnt(16)
    ds_read_b128 a[24:27], v12 offset:57344
    v_cvt_pk_bf16_f32 v9, v9, v10
    v_mfma_f32_16x16x32_bf16 v[80:83], a[248:251], a[72:75], v[80:83]
    buffer_load_dwordx4 v4, s[12:15], s32 offen offset:2048 lds
    v_accvgpr_read_b32 v10, a112
    v_mfma_f32_16x16x32_bf16 v[88:91], a[248:251], a[76:79], v[88:91]
    s_waitcnt lgkmcnt(9)
    v_accvgpr_read_b32 v11, a113
    v_mul_f32 v10, v10, v14
    v_mfma_f32_16x16x32_bf16 v[92:95], a[252:255], a[76:79], v[92:95]
    s_mov_b32 s88, 12288
    ds_read_b64_tr_b16 a[244:245], v6 offset:12456
    v_mul_f32 v11, v11, v14
    v_mfma_f32_16x16x32_bf16 v[84:87], a[252:255], a[72:75], v[84:87]
    ds_read_b64_tr_b16 a[246:247], v6 offset:13992
    v_cvt_pk_bf16_f32 v10, v10, v11
    v_mfma_f32_16x16x32_bf16 v[76:79], a[252:255], a[68:71], v[76:79]
    ds_read_b128 a[28:31], v13 offset:57344
    v_accvgpr_read_b32 v11, a114
    v_mfma_f32_16x16x32_bf16 v[68:71], a[252:255], a[64:67], v[68:71]
    buffer_store_dwordx4 a[48:51], v0, s[24:27], s88 offen sc1
    v_accvgpr_read_b32 v7, a115
    v_mfma_f32_16x16x32_bf16 v[60:63], a[252:255], a[60:63], v[60:63]
    s_waitcnt lgkmcnt(10)
    v_mul_f32 v11, v11, v14
    v_mul_f32 v7, v7, v14
    v_mfma_f32_16x16x32_bf16 v[96:99], a[12:15], a[60:63], v[96:99]
    s_add_u32 m0, s38, 16384
    ds_read_b64_tr_b16 a[248:249], v5 offset:12576
    v_cvt_pk_bf16_f32 v11, v11, v7
    v_mfma_f32_16x16x32_bf16 v[104:107], a[12:15], a[64:67], v[104:107]
    s_add_u32 s39, s54, s0
    ds_read_b64_tr_b16 a[250:251], v5 offset:14112
    v_accvgpr_write_b32 a92, v8
    v_mfma_f32_16x16x32_bf16 v[112:115], a[12:15], a[68:71], v[112:115]
    s_waitcnt vmcnt(8)
    ds_read_b128 a[32:35], v12 offset:0
    v_accvgpr_write_b32 a93, v9
    v_mfma_f32_16x16x32_bf16 v[120:123], a[12:15], a[72:75], v[120:123]
    buffer_load_dwordx4 v1, s[8:11], s39 offen lds
    v_accvgpr_write_b32 a94, v10
    v_mfma_f32_16x16x32_bf16 v[128:131], a[12:15], a[76:79], v[128:131]
    s_waitcnt lgkmcnt(10)
    v_accvgpr_write_b32 a95, v11
    v_accvgpr_read_b32 v14, a9
    v_mfma_f32_16x16x32_bf16 v[132:135], a[16:19], a[76:79], v[132:135]
    s_add_u32 s39, s39, 9216
    ds_read_b64_tr_b16 a[252:253], v5 offset:12584
    v_accvgpr_read_b32 v8, a96
    v_mfma_f32_16x16x32_bf16 v[124:127], a[16:19], a[72:75], v[124:127]
    ds_read_b64_tr_b16 a[254:255], v5 offset:14120
    v_accvgpr_read_b32 v9, a97
    v_mfma_f32_16x16x32_bf16 v[116:119], a[16:19], a[68:71], v[116:119]
    ds_read_b128 a[36:39], v13 offset:0
    v_mul_f32 v8, v8, v14
    v_mfma_f32_16x16x32_bf16 v[108:111], a[16:19], a[64:67], v[108:111]
    buffer_load_dwordx4 v1, s[8:11], s39 offen offset:1024 lds
    v_mul_f32 v9, v9, v14
    v_mfma_f32_16x16x32_bf16 v[100:103], a[16:19], a[60:63], v[100:103]
    s_waitcnt lgkmcnt(10)
    v_cvt_pk_bf16_f32 v8, v8, v9
    v_accvgpr_read_b32 v9, a98
    v_mfma_f32_16x16x32_bf16 v[136:139], a[240:243], a[60:63], v[136:139]
    s_add_u32 m0, s38, 24576
    ds_read_b64_tr_b16 a[12:13], v6 offset:12576
    v_accvgpr_read_b32 v10, a99
    v_mfma_f32_16x16x32_bf16 v[144:147], a[240:243], a[64:67], v[144:147]
    s_add_u32 s39, s54, s1
    ds_read_b64_tr_b16 a[14:15], v6 offset:14112
    v_mul_f32 v9, v9, v14
    v_mfma_f32_16x16x32_bf16 v[152:155], a[240:243], a[68:71], v[152:155]
    s_waitcnt vmcnt(8)
    ds_read_b128 a[112:115], v12 offset:8192
    v_mul_f32 v10, v10, v14
    v_mfma_f32_16x16x32_bf16 v[160:163], a[240:243], a[72:75], v[160:163]
    buffer_load_dwordx4 v1, s[8:11], s39 offen lds
    v_cvt_pk_bf16_f32 v9, v9, v10
    v_mfma_f32_16x16x32_bf16 v[168:171], a[240:243], a[76:79], v[168:171]
    s_waitcnt lgkmcnt(10)
    v_accvgpr_read_b32 v10, a116
    v_accvgpr_read_b32 v11, a117
    v_mfma_f32_16x16x32_bf16 v[172:175], a[244:247], a[76:79], v[172:175]
    s_add_u32 s39, s39, 9216
    ds_read_b64_tr_b16 a[16:17], v6 offset:12584
    v_mul_f32 v10, v10, v14
    v_mfma_f32_16x16x32_bf16 v[164:167], a[244:247], a[72:75], v[164:167]
    ds_read_b64_tr_b16 a[18:19], v6 offset:14120
    v_mul_f32 v11, v11, v14
    v_mfma_f32_16x16x32_bf16 v[156:159], a[244:247], a[68:71], v[156:159]
    v_cvt_pk_bf16_f32 v10, v10, v11
    v_mfma_f32_16x16x32_bf16 v[148:151], a[244:247], a[64:67], v[148:151]
    buffer_load_dwordx4 v1, s[8:11], s39 offen offset:1024 lds
    v_accvgpr_read_b32 v11, a118
    v_mfma_f32_16x16x32_bf16 v[140:143], a[244:247], a[60:63], v[140:143]
    s_waitcnt lgkmcnt(9)
    s_waitcnt vmcnt(14)
    s_barrier
    v_accvgpr_read_b32 v7, a119
    v_mfma_f32_16x16x32_bf16 v[176:179], a[248:251], a[60:63], v[176:179]
    s_add_u32 m0, s31, 0
    ds_read_b64_tr_b16 a[240:241], v5 offset:24640
    v_mul_f32 v11, v11, v14
    v_mfma_f32_16x16x32_bf16 v[184:187], a[248:251], a[64:67], v[184:187]
    s_add_u32 s32, s32, 393216
    ds_read_b64_tr_b16 a[242:243], v5 offset:26176
    v_mul_f32 v7, v7, v14
    v_mfma_f32_16x16x32_bf16 v[192:195], a[248:251], a[68:71], v[192:195]
    ds_read_b128 a[116:119], v13 offset:8192
    v_cvt_pk_bf16_f32 v11, v11, v7
    v_mfma_f32_16x16x32_bf16 v[200:203], a[248:251], a[72:75], v[200:203]
    buffer_load_dwordx4 v2, s[12:15], s32 offen lds
    v_accvgpr_write_b32 a96, v8
    v_mfma_f32_16x16x32_bf16 v[208:211], a[248:251], a[76:79], v[208:211]
    s_waitcnt lgkmcnt(9)
    v_accvgpr_write_b32 a97, v9
    v_accvgpr_write_b32 a98, v10
    v_mfma_f32_16x16x32_bf16 v[212:215], a[252:255], a[76:79], v[212:215]
    ds_read_b64_tr_b16 a[244:245], v5 offset:36960
    v_accvgpr_write_b32 a99, v11
    v_mfma_f32_16x16x32_bf16 v[204:207], a[252:255], a[72:75], v[204:207]
    ds_read_b64_tr_b16 a[246:247], v5 offset:38496
    v_accvgpr_read_b32 v14, a5
    v_mfma_f32_16x16x32_bf16 v[196:199], a[252:255], a[68:71], v[196:199]
    v_accvgpr_read_b32 v8, a120
    v_mfma_f32_16x16x32_bf16 v[188:191], a[252:255], a[64:67], v[188:191]
    buffer_load_dwordx4 v3, s[12:15], s32 offen offset:1024 lds
    v_accvgpr_read_b32 v9, a121
    v_mfma_f32_16x16x32_bf16 v[180:183], a[252:255], a[60:63], v[180:183]
    s_waitcnt lgkmcnt(8)
    v_mul_f32 v8, v8, v14
    v_mul_f32 v9, v9, v14
    v_mfma_f32_16x16x32_bf16 v[216:219], a[12:15], a[60:63], v[216:219]
    ds_read_b64_tr_b16 a[248:249], v5 offset:24648
    v_cvt_pk_bf16_f32 v8, v8, v9
    v_mfma_f32_16x16x32_bf16 v[224:227], a[12:15], a[64:67], v[224:227]
    ds_read_b64_tr_b16 a[250:251], v5 offset:26184
    v_accvgpr_read_b32 v9, a122
    v_mfma_f32_16x16x32_bf16 v[232:235], a[12:15], a[68:71], v[232:235]
    v_accvgpr_read_b32 v10, a123
    v_mfma_f32_16x16x32_bf16 v[240:243], a[12:15], a[72:75], v[240:243]
    buffer_load_dwordx4 v4, s[12:15], s32 offen offset:2048 lds
    v_mul_f32 v9, v9, v14
    v_mfma_f32_16x16x32_bf16 v[248:251], a[12:15], a[76:79], v[248:251]
    s_waitcnt lgkmcnt(7)
    v_mul_f32 v10, v10, v14
    v_cvt_pk_bf16_f32 v9, v9, v10
    v_mfma_f32_16x16x32_bf16 v[252:255], a[16:19], a[76:79], v[252:255]
    s_mov_b32 s88, 13312
    ds_read_b64_tr_b16 a[252:253], v5 offset:36968
    v_accvgpr_read_b32 v10, a140
    v_mfma_f32_16x16x32_bf16 v[244:247], a[16:19], a[72:75], v[244:247]
    ds_read_b64_tr_b16 a[254:255], v5 offset:38504
    v_accvgpr_read_b32 v11, a141
    v_mfma_f32_16x16x32_bf16 v[236:239], a[16:19], a[68:71], v[236:239]
    v_mul_f32 v10, v10, v14
    v_mfma_f32_16x16x32_bf16 v[228:231], a[16:19], a[64:67], v[228:231]
    buffer_store_dwordx4 a[52:55], v0, s[24:27], s88 offen sc1
    v_mul_f32 v11, v11, v14
    v_mfma_f32_16x16x32_bf16 v[220:223], a[16:19], a[60:63], v[220:223]
    s_waitcnt lgkmcnt(4)
    v_cvt_pk_bf16_f32 v10, v10, v11
    v_accvgpr_read_b32 v11, a142
    v_mfma_f32_16x16x32_bf16 v[16:19], a[240:243], a[100:103], v[16:19]
    s_add_u32 m0, s38, 32768
    ds_read_b64_tr_b16 a[12:13], v6 offset:24640
    v_accvgpr_read_b32 v7, a143
    v_mfma_f32_16x16x32_bf16 v[16:19], a[244:247], a[104:107], v[16:19]
    s_add_u32 s39, s54, s63
    ds_read_b64_tr_b16 a[14:15], v6 offset:26176
    v_mul_f32 v11, v11, v14
    v_mfma_f32_16x16x32_bf16 v[24:27], a[244:247], a[20:23], v[24:27]
    v_mul_f32 v7, v7, v14
    v_mfma_f32_16x16x32_bf16 v[24:27], a[240:243], a[108:111], v[24:27]
    buffer_load_dwordx4 v1, s[8:11], s39 offen lds
    v_cvt_pk_bf16_f32 v11, v11, v7
    v_mfma_f32_16x16x32_bf16 v[32:35], a[240:243], a[24:27], v[32:35]
    v_accvgpr_write_b32 a120, v8
    v_accvgpr_write_b32 a121, v9
    v_mfma_f32_16x16x32_bf16 v[32:35], a[244:247], a[28:31], v[32:35]
    s_add_u32 s39, s39, 9216
    ds_read_b64_tr_b16 a[16:17], v6 offset:36960
    v_accvgpr_write_b32 a122, v10
    v_mfma_f32_16x16x32_bf16 v[40:43], a[244:247], a[36:39], v[40:43]
    ds_read_b64_tr_b16 a[18:19], v6 offset:38496
    v_accvgpr_write_b32 a123, v11
    v_mfma_f32_16x16x32_bf16 v[40:43], a[240:243], a[32:35], v[40:43]
    v_accvgpr_read_b32 v14, a6
    v_mfma_f32_16x16x32_bf16 v[48:51], a[240:243], a[112:115], v[48:51]
    buffer_load_dwordx4 v1, s[8:11], s39 offen offset:1024 lds
    v_accvgpr_read_b32 v8, a124
    v_mfma_f32_16x16x32_bf16 v[48:51], a[244:247], a[116:119], v[48:51]
    s_waitcnt lgkmcnt(4)
    v_accvgpr_read_b32 v9, a125
    v_mul_f32 v8, v8, v14
    v_mfma_f32_16x16x32_bf16 v[52:55], a[252:255], a[116:119], v[52:55]
    s_add_u32 m0, s38, 40960
    ds_read_b64_tr_b16 a[240:241], v6 offset:24648
    v_mul_f32 v9, v9, v14
    v_mfma_f32_16x16x32_bf16 v[52:55], a[248:251], a[112:115], v[52:55]
    s_add_u32 s39, s54, s87
    ds_read_b64_tr_b16 a[242:243], v6 offset:26184
    v_cvt_pk_bf16_f32 v8, v8, v9
    v_mfma_f32_16x16x32_bf16 v[44:47], a[248:251], a[32:35], v[44:47]
    v_accvgpr_read_b32 v9, a126
    v_mfma_f32_16x16x32_bf16 v[44:47], a[252:255], a[36:39], v[44:47]
    buffer_load_dwordx4 v1, s[8:11], s39 offen lds
    v_accvgpr_read_b32 v10, a127
    v_mfma_f32_16x16x32_bf16 v[36:39], a[252:255], a[28:31], v[36:39]
    v_mul_f32 v9, v9, v14
    v_mul_f32 v10, v10, v14
    v_mfma_f32_16x16x32_bf16 v[36:39], a[248:251], a[24:27], v[36:39]
    s_add_u32 s39, s39, 9216
    ds_read_b64_tr_b16 a[244:245], v6 offset:36968
    v_cvt_pk_bf16_f32 v9, v9, v10
    v_mfma_f32_16x16x32_bf16 v[28:31], a[248:251], a[108:111], v[28:31]
    ds_read_b64_tr_b16 a[246:247], v6 offset:38504
    v_accvgpr_read_b32 v10, a144
    v_mfma_f32_16x16x32_bf16 v[28:31], a[252:255], a[20:23], v[28:31]
    v_accvgpr_read_b32 v11, a145
    v_mfma_f32_16x16x32_bf16 v[20:23], a[252:255], a[104:107], v[20:23]
    buffer_load_dwordx4 v1, s[8:11], s39 offen offset:1024 lds
    v_mul_f32 v10, v10, v14
    v_mfma_f32_16x16x32_bf16 v[20:23], a[248:251], a[100:103], v[20:23]
    s_waitcnt lgkmcnt(4)
    v_mul_f32 v11, v11, v14
    v_cvt_pk_bf16_f32 v10, v10, v11
    v_mfma_f32_16x16x32_bf16 v[56:59], a[12:15], a[100:103], v[56:59]
    s_mov_b32 s88, 14336
    ds_read_b64_tr_b16 a[248:249], v5 offset:24768
    v_accvgpr_read_b32 v11, a146
    v_mfma_f32_16x16x32_bf16 v[56:59], a[16:19], a[104:107], v[56:59]
    ds_read_b64_tr_b16 a[250:251], v5 offset:26304
    v_accvgpr_read_b32 v7, a147
    v_mfma_f32_16x16x32_bf16 v[64:67], a[16:19], a[20:23], v[64:67]
    v_mul_f32 v11, v11, v14
    v_mfma_f32_16x16x32_bf16 v[64:67], a[12:15], a[108:111], v[64:67]
    buffer_store_dwordx4 a[56:59], v0, s[24:27], s88 offen sc1
    v_mul_f32 v7, v7, v14
    v_mfma_f32_16x16x32_bf16 v[72:75], a[12:15], a[24:27], v[72:75]
    v_cvt_pk_bf16_f32 v11, v11, v7
    v_accvgpr_write_b32 a124, v8
    v_mfma_f32_16x16x32_bf16 v[72:75], a[16:19], a[28:31], v[72:75]
    s_add_u32 m0, s38, 49152
    ds_read_b64_tr_b16 a[252:253], v5 offset:37088
    v_accvgpr_write_b32 a125, v9
    v_mfma_f32_16x16x32_bf16 v[80:83], a[16:19], a[36:39], v[80:83]
    s_add_u32 s39, s54, 81920
    ds_read_b64_tr_b16 a[254:255], v5 offset:38624
    v_accvgpr_write_b32 a126, v10
    v_mfma_f32_16x16x32_bf16 v[80:83], a[12:15], a[32:35], v[80:83]
    v_accvgpr_write_b32 a127, v11
    v_mfma_f32_16x16x32_bf16 v[88:91], a[12:15], a[112:115], v[88:91]
    buffer_load_dwordx4 v1, s[8:11], s39 offen lds
    v_accvgpr_read_b32 v14, a7
    v_mfma_f32_16x16x32_bf16 v[88:91], a[16:19], a[116:119], v[88:91]
    s_waitcnt lgkmcnt(4)
    v_accvgpr_read_b32 v8, a128
    v_accvgpr_read_b32 v9, a129
    v_mfma_f32_16x16x32_bf16 v[92:95], a[244:247], a[116:119], v[92:95]
    s_add_u32 s39, s39, 9216
    ds_read_b64_tr_b16 a[12:13], v5 offset:24776
    v_mul_f32 v8, v8, v14
    v_mfma_f32_16x16x32_bf16 v[92:95], a[240:243], a[112:115], v[92:95]
    ds_read_b64_tr_b16 a[14:15], v5 offset:26312
    v_mul_f32 v9, v9, v14
    v_mfma_f32_16x16x32_bf16 v[84:87], a[240:243], a[32:35], v[84:87]
    v_cvt_pk_bf16_f32 v8, v8, v9
    v_mfma_f32_16x16x32_bf16 v[84:87], a[244:247], a[36:39], v[84:87]
    buffer_load_dwordx4 v1, s[8:11], s39 offen offset:1024 lds
    v_accvgpr_read_b32 v9, a130
    v_mfma_f32_16x16x32_bf16 v[76:79], a[244:247], a[28:31], v[76:79]
    v_accvgpr_read_b32 v10, a131
    v_mul_f32 v9, v9, v14
    v_mfma_f32_16x16x32_bf16 v[76:79], a[240:243], a[24:27], v[76:79]
    s_mov_b32 s88, 20480
    ds_read_b64_tr_b16 a[16:17], v5 offset:37096
    v_mul_f32 v10, v10, v14
    v_mfma_f32_16x16x32_bf16 v[68:71], a[240:243], a[108:111], v[68:71]
    ds_read_b64_tr_b16 a[18:19], v5 offset:38632
    v_cvt_pk_bf16_f32 v9, v9, v10
    v_mfma_f32_16x16x32_bf16 v[68:71], a[244:247], a[20:23], v[68:71]
    v_accvgpr_read_b32 v10, a148
    v_mfma_f32_16x16x32_bf16 v[60:63], a[244:247], a[104:107], v[60:63]
    buffer_store_dwordx4 a[80:83], v0, s[24:27], s88 offen sc1
    v_accvgpr_read_b32 v11, a149
    v_mfma_f32_16x16x32_bf16 v[60:63], a[240:243], a[100:103], v[60:63]
    s_waitcnt lgkmcnt(4)
    v_mul_f32 v10, v10, v14
    v_mul_f32 v11, v11, v14
    v_mfma_f32_16x16x32_bf16 v[96:99], a[248:251], a[100:103], v[96:99]
    s_mov_b32 s88, 21504
    ds_read_b64_tr_b16 a[240:241], v6 offset:24768
    v_cvt_pk_bf16_f32 v10, v10, v11
    v_mfma_f32_16x16x32_bf16 v[96:99], a[252:255], a[104:107], v[96:99]
    ds_read_b64_tr_b16 a[242:243], v6 offset:26304
    v_accvgpr_read_b32 v11, a150
    v_mfma_f32_16x16x32_bf16 v[104:107], a[252:255], a[20:23], v[104:107]
    s_waitcnt vmcnt(14)
    ds_read_b128 a[40:43], v12 offset:16384
    v_accvgpr_read_b32 v7, a151
    v_mfma_f32_16x16x32_bf16 v[104:107], a[248:251], a[108:111], v[104:107]
    buffer_store_dwordx4 a[84:87], v0, s[24:27], s88 offen sc1
    v_mul_f32 v11, v11, v14
    v_mfma_f32_16x16x32_bf16 v[112:115], a[248:251], a[24:27], v[112:115]
    v_mul_f32 v7, v7, v14
    v_cvt_pk_bf16_f32 v11, v11, v7
    v_mfma_f32_16x16x32_bf16 v[112:115], a[252:255], a[28:31], v[112:115]
    s_add_u32 m0, s38, 57344
    ds_read_b64_tr_b16 a[244:245], v6 offset:37088
    v_accvgpr_write_b32 a128, v8
    v_mfma_f32_16x16x32_bf16 v[120:123], a[252:255], a[36:39], v[120:123]
    s_add_u32 s39, s55, s0
    ds_read_b64_tr_b16 a[246:247], v6 offset:38624
    v_accvgpr_write_b32 a129, v9
    v_mfma_f32_16x16x32_bf16 v[120:123], a[248:251], a[32:35], v[120:123]
    ds_read_b128 a[44:47], v13 offset:16384
    v_accvgpr_write_b32 a130, v10
    v_mfma_f32_16x16x32_bf16 v[128:131], a[248:251], a[112:115], v[128:131]
    buffer_load_dwordx4 v1, s[8:11], s39 offen lds
    v_accvgpr_write_b32 a131, v11
    v_mfma_f32_16x16x32_bf16 v[128:131], a[252:255], a[116:119], v[128:131]
    s_waitcnt lgkmcnt(6)
    v_accvgpr_read_b32 v14, a8
    v_accvgpr_read_b32 v8, a132
    v_mfma_f32_16x16x32_bf16 v[132:135], a[16:19], a[116:119], v[132:135]
    s_add_u32 s39, s39, 9216
    ds_read_b64_tr_b16 a[248:249], v6 offset:24776
    v_accvgpr_read_b32 v9, a133
    v_mfma_f32_16x16x32_bf16 v[132:135], a[12:15], a[112:115], v[132:135]
    ds_read_b64_tr_b16 a[250:251], v6 offset:26312
    v_mul_f32 v8, v8, v14
    v_mfma_f32_16x16x32_bf16 v[124:127], a[12:15], a[32:35], v[124:127]
    s_waitcnt vmcnt(14)
    ds_read_b128 a[48:51], v12 offset:24576
    v_mul_f32 v9, v9, v14
    v_mfma_f32_16x16x32_bf16 v[124:127], a[16:19], a[36:39], v[124:127]
    buffer_load_dwordx4 v1, s[8:11], s39 offen offset:1024 lds
    v_cvt_pk_bf16_f32 v8, v8, v9
    v_mfma_f32_16x16x32_bf16 v[116:119], a[16:19], a[28:31], v[116:119]
    v_accvgpr_read_b32 v9, a134
    v_accvgpr_read_b32 v10, a135
    v_mfma_f32_16x16x32_bf16 v[116:119], a[12:15], a[24:27], v[116:119]
    s_mov_b32 s88, 22528
    ds_read_b64_tr_b16 a[252:253], v6 offset:37096
    v_mul_f32 v9, v9, v14
    v_mfma_f32_16x16x32_bf16 v[108:111], a[12:15], a[108:111], v[108:111]
    ds_read_b64_tr_b16 a[254:255], v6 offset:38632
    v_mul_f32 v10, v10, v14
    v_mfma_f32_16x16x32_bf16 v[108:111], a[16:19], a[20:23], v[108:111]
    ds_read_b128 a[60:63], v13 offset:24576
    v_cvt_pk_bf16_f32 v9, v9, v10
    v_mfma_f32_16x16x32_bf16 v[100:103], a[16:19], a[104:107], v[100:103]
    buffer_store_dwordx4 a[88:91], v0, s[24:27], s88 offen sc1
    v_accvgpr_read_b32 v10, a152
    v_mfma_f32_16x16x32_bf16 v[100:103], a[12:15], a[100:103], v[100:103]
    s_waitcnt lgkmcnt(7)
    v_accvgpr_read_b32 v11, a153
    v_mul_f32 v10, v10, v14
    v_mfma_f32_16x16x32_bf16 v[136:139], a[240:243], a[100:103], v[136:139]
    s_add_u32 m0, s38, 0
    ds_read_b64_tr_b16 a[12:13], v5 offset:24896
    v_mul_f32 v11, v11, v14
    v_mfma_f32_16x16x32_bf16 v[136:139], a[244:247], a[104:107], v[136:139]
    s_add_u32 s39, s55, s1
    ds_read_b64_tr_b16 a[14:15], v5 offset:26432
    v_cvt_pk_bf16_f32 v10, v10, v11
    v_mfma_f32_16x16x32_bf16 v[144:147], a[244:247], a[20:23], v[144:147]
    v_accvgpr_read_b32 v11, a154
    v_mfma_f32_16x16x32_bf16 v[144:147], a[240:243], a[108:111], v[144:147]
    buffer_load_dwordx4 v1, s[8:11], s39 offen lds
    v_accvgpr_read_b32 v7, a155
    v_mfma_f32_16x16x32_bf16 v[152:155], a[240:243], a[24:27], v[152:155]
    v_mul_f32 v11, v11, v14
    v_mul_f32 v7, v7, v14
    v_mfma_f32_16x16x32_bf16 v[152:155], a[244:247], a[28:31], v[152:155]
    s_add_u32 s39, s39, 9216
    ds_read_b64_tr_b16 a[16:17], v5 offset:37216
    v_cvt_pk_bf16_f32 v11, v11, v7
    v_mfma_f32_16x16x32_bf16 v[160:163], a[244:247], a[36:39], v[160:163]
    ds_read_b64_tr_b16 a[18:19], v5 offset:38752
    v_accvgpr_write_b32 a132, v8
    v_mfma_f32_16x16x32_bf16 v[160:163], a[240:243], a[32:35], v[160:163]
    v_accvgpr_write_b32 a133, v9
    v_mfma_f32_16x16x32_bf16 v[168:171], a[240:243], a[112:115], v[168:171]
    buffer_load_dwordx4 v1, s[8:11], s39 offen offset:1024 lds
    v_accvgpr_write_b32 a134, v10
    v_mfma_f32_16x16x32_bf16 v[168:171], a[244:247], a[116:119], v[168:171]
    s_waitcnt lgkmcnt(5)
    v_accvgpr_write_b32 a135, v11
    v_accvgpr_read_b32 v14, a9
    v_mfma_f32_16x16x32_bf16 v[172:175], a[252:255], a[116:119], v[172:175]
    s_add_u32 m0, s38, 8192
    ds_read_b64_tr_b16 a[240:241], v5 offset:24904
    v_accvgpr_read_b32 v8, a136
    v_mfma_f32_16x16x32_bf16 v[172:175], a[248:251], a[112:115], v[172:175]
    s_add_u32 s39, s55, s63
    ds_read_b64_tr_b16 a[242:243], v5 offset:26440
    v_accvgpr_read_b32 v9, a137
    v_mfma_f32_16x16x32_bf16 v[164:167], a[248:251], a[32:35], v[164:167]
    s_waitcnt vmcnt(12)
    ds_read_b128 a[64:67], v12 offset:32768
    v_mul_f32 v8, v8, v14
    v_mfma_f32_16x16x32_bf16 v[164:167], a[252:255], a[36:39], v[164:167]
    buffer_load_dwordx4 v1, s[8:11], s39 offen lds
    v_mul_f32 v9, v9, v14
    v_mfma_f32_16x16x32_bf16 v[156:159], a[252:255], a[28:31], v[156:159]
    v_cvt_pk_bf16_f32 v8, v8, v9
    v_accvgpr_read_b32 v9, a138
    v_mfma_f32_16x16x32_bf16 v[156:159], a[248:251], a[24:27], v[156:159]
    s_add_u32 s39, s39, 9216
    ds_read_b64_tr_b16 a[244:245], v5 offset:37224
    v_accvgpr_read_b32 v10, a139
    v_mfma_f32_16x16x32_bf16 v[148:151], a[248:251], a[108:111], v[148:151]
    ds_read_b64_tr_b16 a[246:247], v5 offset:38760
    v_mul_f32 v9, v9, v14
    v_mfma_f32_16x16x32_bf16 v[148:151], a[252:255], a[20:23], v[148:151]
    ds_read_b128 a[68:71], v13 offset:32768
    v_mul_f32 v10, v10, v14
    v_mfma_f32_16x16x32_bf16 v[140:143], a[252:255], a[104:107], v[140:143]
    buffer_load_dwordx4 v1, s[8:11], s39 offen offset:1024 lds
    v_cvt_pk_bf16_f32 v9, v9, v10
    v_mfma_f32_16x16x32_bf16 v[140:143], a[248:251], a[100:103], v[140:143]
    s_waitcnt lgkmcnt(6)
    v_accvgpr_read_b32 v10, a156
    v_accvgpr_read_b32 v11, a157
    v_mfma_f32_16x16x32_bf16 v[176:179], a[12:15], a[100:103], v[176:179]
    s_mov_b32 s88, 23552
    ds_read_b64_tr_b16 a[248:249], v6 offset:24896
    v_mul_f32 v10, v10, v14
    v_mfma_f32_16x16x32_bf16 v[176:179], a[16:19], a[104:107], v[176:179]
    ds_read_b64_tr_b16 a[250:251], v6 offset:26432
    v_mul_f32 v11, v11, v14
    v_mfma_f32_16x16x32_bf16 v[184:187], a[16:19], a[20:23], v[184:187]
    s_waitcnt vmcnt(12)
    ds_read_b128 a[72:75], v12 offset:40960
    v_cvt_pk_bf16_f32 v10, v10, v11
    v_mfma_f32_16x16x32_bf16 v[184:187], a[12:15], a[108:111], v[184:187]
    buffer_store_dwordx4 a[92:95], v0, s[24:27], s88 offen sc1
    v_accvgpr_read_b32 v11, a158
    v_mfma_f32_16x16x32_bf16 v[192:195], a[12:15], a[24:27], v[192:195]
    v_accvgpr_read_b32 v7, a159
    v_mul_f32 v11, v11, v14
    v_mfma_f32_16x16x32_bf16 v[192:195], a[16:19], a[28:31], v[192:195]
    s_add_u32 m0, s38, 16384
    ds_read_b64_tr_b16 a[252:253], v6 offset:37216
    v_mul_f32 v7, v7, v14
    v_mfma_f32_16x16x32_bf16 v[200:203], a[16:19], a[36:39], v[200:203]
    s_add_u32 s39, s55, s87
    ds_read_b64_tr_b16 a[254:255], v6 offset:38752
    v_cvt_pk_bf16_f32 v11, v11, v7
    v_mfma_f32_16x16x32_bf16 v[200:203], a[12:15], a[32:35], v[200:203]
    ds_read_b128 a[76:79], v13 offset:40960
    v_accvgpr_write_b32 a136, v8
    v_mfma_f32_16x16x32_bf16 v[208:211], a[12:15], a[112:115], v[208:211]
    buffer_load_dwordx4 v1, s[8:11], s39 offen lds
    v_accvgpr_write_b32 a137, v9
    v_mfma_f32_16x16x32_bf16 v[208:211], a[16:19], a[116:119], v[208:211]
    s_waitcnt lgkmcnt(7)
    v_accvgpr_write_b32 a138, v10
    v_accvgpr_write_b32 a139, v11
    v_mfma_f32_16x16x32_bf16 v[212:215], a[244:247], a[116:119], v[212:215]
    s_add_u32 s39, s39, 9216
    ds_read_b64_tr_b16 a[12:13], v6 offset:24904
    v_accvgpr_read_b32 v14, a5
    v_mfma_f32_16x16x32_bf16 v[212:215], a[240:243], a[112:115], v[212:215]
    ds_read_b64_tr_b16 a[14:15], v6 offset:26440
    v_accvgpr_read_b32 v8, a160
    v_mfma_f32_16x16x32_bf16 v[204:207], a[240:243], a[32:35], v[204:207]
    s_waitcnt vmcnt(11)
    ds_read_b128 a[140:143], v12 offset:49152
    v_accvgpr_read_b32 v9, a161
    v_mfma_f32_16x16x32_bf16 v[204:207], a[244:247], a[36:39], v[204:207]
    buffer_load_dwordx4 v1, s[8:11], s39 offen offset:1024 lds
    v_mul_f32 v8, v8, v14
    v_mfma_f32_16x16x32_bf16 v[196:199], a[244:247], a[28:31], v[196:199]
    v_mul_f32 v9, v9, v14
    v_cvt_pk_bf16_f32 v8, v8, v9
    v_mfma_f32_16x16x32_bf16 v[196:199], a[240:243], a[24:27], v[196:199]
    s_add_u32 m0, s38, 24576
    ds_read_b64_tr_b16 a[16:17], v6 offset:37224
    v_accvgpr_read_b32 v9, a162
    v_mfma_f32_16x16x32_bf16 v[188:191], a[240:243], a[108:111], v[188:191]
    s_add_u32 s39, s55, 81920
    ds_read_b64_tr_b16 a[18:19], v6 offset:38760
    v_accvgpr_read_b32 v10, a163
    v_mfma_f32_16x16x32_bf16 v[188:191], a[244:247], a[20:23], v[188:191]
    ds_read_b128 a[52:55], v13 offset:49152
    v_mul_f32 v9, v9, v14
    v_mfma_f32_16x16x32_bf16 v[180:183], a[244:247], a[104:107], v[180:183]
    buffer_load_dwordx4 v1, s[8:11], s39 offen lds
    v_mul_f32 v10, v10, v14
    v_mfma_f32_16x16x32_bf16 v[180:183], a[240:243], a[100:103], v[180:183]
    s_waitcnt lgkmcnt(7)
    s_waitcnt vmcnt(21)
    s_barrier
    v_cvt_pk_bf16_f32 v9, v9, v10
    v_mfma_f32_16x16x32_bf16 v[216:219], a[248:251], a[100:103], v[216:219]
    s_add_u32 s39, s39, 9216
    ds_read_b64_tr_b16 a[240:241], v5 offset:49280
    v_accvgpr_read_b32 v10, a180
    v_mfma_f32_16x16x32_bf16 v[216:219], a[252:255], a[104:107], v[216:219]
    ds_read_b64_tr_b16 a[242:243], v5 offset:50816
    v_accvgpr_read_b32 v11, a181
    v_mfma_f32_16x16x32_bf16 v[224:227], a[252:255], a[20:23], v[224:227]
    v_mul_f32 v10, v10, v14
    v_mfma_f32_16x16x32_bf16 v[224:227], a[248:251], a[108:111], v[224:227]
    buffer_load_dwordx4 v1, s[8:11], s39 offen offset:1024 lds
    v_mul_f32 v11, v11, v14
    v_mfma_f32_16x16x32_bf16 v[232:235], a[248:251], a[24:27], v[232:235]
    v_cvt_pk_bf16_f32 v10, v10, v11
    v_accvgpr_read_b32 v11, a182
    v_mfma_f32_16x16x32_bf16 v[232:235], a[252:255], a[28:31], v[232:235]
    s_add_u32 m0, s31, 12320
    ds_read_b64_tr_b16 a[244:245], v5 offset:0
    v_accvgpr_read_b32 v7, a183
    v_mfma_f32_16x16x32_bf16 v[240:243], a[252:255], a[36:39], v[240:243]
    s_mul_i32 s32, s55, 6144
    ds_read_b64_tr_b16 a[246:247], v5 offset:1536
    v_mul_f32 v11, v11, v14
    v_mfma_f32_16x16x32_bf16 v[240:243], a[248:251], a[32:35], v[240:243]
    v_mul_f32 v7, v7, v14
    v_mfma_f32_16x16x32_bf16 v[248:251], a[248:251], a[112:115], v[248:251]
    buffer_load_dwordx4 v2, s[12:15], s32 offen lds
    v_cvt_pk_bf16_f32 v11, v11, v7
    v_mfma_f32_16x16x32_bf16 v[248:251], a[252:255], a[116:119], v[248:251]
    s_waitcnt lgkmcnt(5)
    s_barrier
    v_accvgpr_write_b32 a160, v8
    v_mfma_f32_16x16x32_bf16 v[252:255], a[16:19], a[116:119], v[252:255]
    ds_read_b64_tr_b16 a[248:249], v5 offset:49288
    v_accvgpr_write_b32 a161, v9
    v_mfma_f32_16x16x32_bf16 v[252:255], a[12:15], a[112:115], v[252:255]
    ds_read_b64_tr_b16 a[250:251], v5 offset:50824
    v_accvgpr_write_b32 a162, v10
    v_mfma_f32_16x16x32_bf16 v[244:247], a[12:15], a[32:35], v[244:247]
    v_accvgpr_write_b32 a163, v11
    v_mfma_f32_16x16x32_bf16 v[244:247], a[16:19], a[36:39], v[244:247]
    buffer_load_dwordx4 v3, s[12:15], s32 offen offset:1024 lds
    v_accvgpr_read_b32 v14, a6
    v_mfma_f32_16x16x32_bf16 v[236:239], a[16:19], a[28:31], v[236:239]
    v_accvgpr_read_b32 v8, a164
    v_accvgpr_read_b32 v9, a165
    v_mfma_f32_16x16x32_bf16 v[236:239], a[12:15], a[24:27], v[236:239]
    ds_read_b64_tr_b16 a[252:253], v5 offset:8
    v_mul_f32 v8, v8, v14
    v_mfma_f32_16x16x32_bf16 v[228:231], a[12:15], a[108:111], v[228:231]
    ds_read_b64_tr_b16 a[254:255], v5 offset:1544
    v_mul_f32 v9, v9, v14
    v_mfma_f32_16x16x32_bf16 v[228:231], a[16:19], a[20:23], v[228:231]
    v_cvt_pk_bf16_f32 v8, v8, v9
    v_mfma_f32_16x16x32_bf16 v[220:223], a[16:19], a[104:107], v[220:223]
    buffer_load_dwordx4 v4, s[12:15], s32 offen offset:2048 lds
    v_accvgpr_read_b32 v9, a166
    v_mfma_f32_16x16x32_bf16 v[220:223], a[12:15], a[100:103], v[220:223]
    s_waitcnt lgkmcnt(4)
    v_accvgpr_read_b32 v10, a167
    v_mul_f32 v9, v9, v14
    v_mfma_f32_16x16x32_bf16 v[16:19], a[240:243], a[40:43], v[16:19]
    s_add_u32 m0, s31, 24640
    ds_read_b64_tr_b16 a[12:13], v6 offset:49280
    v_mul_f32 v10, v10, v14
    v_mfma_f32_16x16x32_bf16 v[16:19], a[244:247], a[44:47], v[16:19]
    s_add_u32 s32, s32, 393216
    ds_read_b64_tr_b16 a[14:15], v6 offset:50816
    v_cvt_pk_bf16_f32 v9, v9, v10
    v_mfma_f32_16x16x32_bf16 v[24:27], a[244:247], a[60:63], v[24:27]
    v_accvgpr_read_b32 v10, a184
    v_mfma_f32_16x16x32_bf16 v[24:27], a[240:243], a[48:51], v[24:27]
    buffer_load_dwordx4 v2, s[12:15], s32 offen lds
    v_accvgpr_read_b32 v11, a185
    v_mfma_f32_16x16x32_bf16 v[32:35], a[240:243], a[64:67], v[32:35]
    v_mul_f32 v10, v10, v14
    v_mul_f32 v11, v11, v14
    v_mfma_f32_16x16x32_bf16 v[32:35], a[244:247], a[68:71], v[32:35]
    ds_read_b64_tr_b16 a[16:17], v6 offset:0
    v_cvt_pk_bf16_f32 v10, v10, v11
    v_mfma_f32_16x16x32_bf16 v[40:43], a[244:247], a[76:79], v[40:43]
    ds_read_b64_tr_b16 a[18:19], v6 offset:1536
    v_accvgpr_read_b32 v11, a186
    v_mfma_f32_16x16x32_bf16 v[40:43], a[240:243], a[72:75], v[40:43]
    s_waitcnt vmcnt(14)
    ds_read_b128 a[144:147], v12 offset:57344
    v_accvgpr_read_b32 v7, a187
    v_mfma_f32_16x16x32_bf16 v[48:51], a[240:243], a[140:143], v[48:51]
    buffer_load_dwordx4 v3, s[12:15], s32 offen offset:1024 lds
    v_mul_f32 v11, v11, v14
    v_mfma_f32_16x16x32_bf16 v[48:51], a[244:247], a[52:55], v[48:51]
    s_waitcnt lgkmcnt(5)
    v_mul_f32 v7, v7, v14
    v_cvt_pk_bf16_f32 v11, v11, v7
    v_mfma_f32_16x16x32_bf16 v[52:55], a[252:255], a[52:55], v[52:55]
    ds_read_b64_tr_b16 a[240:241], v6 offset:49288
    v_accvgpr_write_b32 a164, v8
    v_mfma_f32_16x16x32_bf16 v[52:55], a[248:251], a[140:143], v[52:55]
    ds_read_b64_tr_b16 a[242:243], v6 offset:50824
    v_accvgpr_write_b32 a165, v9
    v_mfma_f32_16x16x32_bf16 v[44:47], a[248:251], a[72:75], v[44:47]
    ds_read_b128 a[56:59], v13 offset:57344
    v_accvgpr_write_b32 a166, v10
    v_mfma_f32_16x16x32_bf16 v[44:47], a[252:255], a[76:79], v[44:47]
    buffer_load_dwordx4 v4, s[12:15], s32 offen offset:2048 lds
    v_accvgpr_write_b32 a167, v11
    v_mfma_f32_16x16x32_bf16 v[36:39], a[252:255], a[68:71], v[36:39]
    v_accvgpr_read_b32 v14, a7
    v_accvgpr_read_b32 v8, a168
    v_mfma_f32_16x16x32_bf16 v[36:39], a[248:251], a[64:67], v[36:39]
    s_mov_b32 s88, 24576
    ds_read_b64_tr_b16 a[244:245], v6 offset:8
    v_accvgpr_read_b32 v9, a169
    v_mfma_f32_16x16x32_bf16 v[28:31], a[248:251], a[48:51], v[28:31]
    ds_read_b64_tr_b16 a[246:247], v6 offset:1544
    v_mul_f32 v8, v8, v14
    v_mfma_f32_16x16x32_bf16 v[28:31], a[252:255], a[60:63], v[28:31]
    v_mul_f32 v9, v9, v14
    v_mfma_f32_16x16x32_bf16 v[20:23], a[252:255], a[44:47], v[20:23]
    buffer_store_dwordx4 a[96:99], v0, s[24:27], s88 offen sc1
    v_cvt_pk_bf16_f32 v8, v8, v9
    v_mfma_f32_16x16x32_bf16 v[20:23], a[248:251], a[40:43], v[20:23]
    s_waitcnt lgkmcnt(6)
    v_accvgpr_read_b32 v9, a170
    v_accvgpr_read_b32 v10, a171
    v_mfma_f32_16x16x32_bf16 v[56:59], a[12:15], a[40:43], v[56:59]
    s_mov_b32 s88, 30720
    ds_read_b64_tr_b16 a[248:249], v5 offset:49408
    v_mul_f32 v9, v9, v14
    v_mfma_f32_16x16x32_bf16 v[56:59], a[16:19], a[44:47], v[56:59]
    ds_read_b64_tr_b16 a[250:251], v5 offset:50944
    v_mul_f32 v10, v10, v14
    v_mfma_f32_16x16x32_bf16 v[64:67], a[16:19], a[60:63], v[64:67]
    s_waitcnt vmcnt(14)
    ds_read_b128 a[80:83], v12 offset:0
    v_cvt_pk_bf16_f32 v9, v9, v10
    v_mfma_f32_16x16x32_bf16 v[64:67], a[12:15], a[48:51], v[64:67]
    buffer_store_dwordx4 a[120:123], v0, s[24:27], s88 offen sc1
    v_accvgpr_read_b32 v10, a188
    v_mfma_f32_16x16x32_bf16 v[72:75], a[12:15], a[64:67], v[72:75]
    v_accvgpr_read_b32 v11, a189
    v_mul_f32 v10, v10, v14
    v_mfma_f32_16x16x32_bf16 v[72:75], a[16:19], a[68:71], v[72:75]
    s_add_u32 m0, s31, 36960
    ds_read_b64_tr_b16 a[252:253], v5 offset:128
    v_mul_f32 v11, v11, v14
    v_mfma_f32_16x16x32_bf16 v[80:83], a[16:19], a[76:79], v[80:83]
    s_mul_i32 s32, s56, 6144
    ds_read_b64_tr_b16 a[254:255], v5 offset:1664
    v_cvt_pk_bf16_f32 v10, v10, v11
    v_mfma_f32_16x16x32_bf16 v[80:83], a[12:15], a[72:75], v[80:83]
    ds_read_b128 a[148:151], v13 offset:0
    v_accvgpr_read_b32 v11, a190
    v_mfma_f32_16x16x32_bf16 v[88:91], a[12:15], a[140:143], v[88:91]
    buffer_load_dwordx4 v2, s[12:15], s32 offen lds
    v_accvgpr_read_b32 v7, a191
    v_mfma_f32_16x16x32_bf16 v[88:91], a[16:19], a[52:55], v[88:91]
    s_waitcnt lgkmcnt(6)
    v_mul_f32 v11, v11, v14
    v_mul_f32 v7, v7, v14
    v_mfma_f32_16x16x32_bf16 v[92:95], a[244:247], a[52:55], v[92:95]
    ds_read_b64_tr_b16 a[12:13], v5 offset:49416
    v_cvt_pk_bf16_f32 v11, v11, v7
    v_mfma_f32_16x16x32_bf16 v[92:95], a[240:243], a[140:143], v[92:95]
    ds_read_b64_tr_b16 a[14:15], v5 offset:50952
    v_accvgpr_write_b32 a168, v8
    v_mfma_f32_16x16x32_bf16 v[84:87], a[240:243], a[72:75], v[84:87]
    s_waitcnt vmcnt(14)
    ds_read_b128 a[84:87], v12 offset:8192
    v_accvgpr_write_b32 a169, v9
    v_mfma_f32_16x16x32_bf16 v[84:87], a[244:247], a[76:79], v[84:87]
    buffer_load_dwordx4 v3, s[12:15], s32 offen offset:1024 lds
    v_accvgpr_write_b32 a170, v10
    v_mfma_f32_16x16x32_bf16 v[76:79], a[244:247], a[68:71], v[76:79]
    v_accvgpr_write_b32 a171, v11
    v_accvgpr_read_b32 v14, a8
    v_mfma_f32_16x16x32_bf16 v[76:79], a[240:243], a[64:67], v[76:79]
    ds_read_b64_tr_b16 a[16:17], v5 offset:136
    v_accvgpr_read_b32 v8, a172
    v_mfma_f32_16x16x32_bf16 v[68:71], a[240:243], a[48:51], v[68:71]
    ds_read_b64_tr_b16 a[18:19], v5 offset:1672
    v_accvgpr_read_b32 v9, a173
    v_mfma_f32_16x16x32_bf16 v[68:71], a[244:247], a[60:63], v[68:71]
    ds_read_b128 a[88:91], v13 offset:8192
    v_mul_f32 v8, v8, v14
    v_mfma_f32_16x16x32_bf16 v[60:63], a[244:247], a[44:47], v[60:63]
    buffer_load_dwordx4 v4, s[12:15], s32 offen offset:2048 lds
    v_mul_f32 v9, v9, v14
    v_mfma_f32_16x16x32_bf16 v[60:63], a[240:243], a[40:43], v[60:63]
    s_waitcnt lgkmcnt(7)
    v_cvt_pk_bf16_f32 v8, v8, v9
    v_accvgpr_read_b32 v9, a174
    v_mfma_f32_16x16x32_bf16 v[96:99], a[248:251], a[40:43], v[96:99]
    s_mov_b32 s88, 31744
    ds_read_b64_tr_b16 a[240:241], v6 offset:49408
    v_accvgpr_read_b32 v10, a175
    v_mfma_f32_16x16x32_bf16 v[96:99], a[252:255], a[44:47], v[96:99]
    ds_read_b64_tr_b16 a[242:243], v6 offset:50944
    v_mul_f32 v9, v9, v14
    v_mfma_f32_16x16x32_bf16 v[104:107], a[252:255], a[60:63], v[104:107]
    v_mul_f32 v10, v10, v14
    v_mfma_f32_16x16x32_bf16 v[104:107], a[248:251], a[48:51], v[104:107]
    buffer_store_dwordx4 a[124:127], v0, s[24:27], s88 offen sc1
    v_cvt_pk_bf16_f32 v9, v9, v10
    v_mfma_f32_16x16x32_bf16 v[112:115], a[248:251], a[64:67], v[112:115]
    v_accvgpr_read_b32 v10, a192
    v_accvgpr_read_b32 v11, a193
    v_mfma_f32_16x16x32_bf16 v[112:115], a[252:255], a[68:71], v[112:115]
    s_add_u32 m0, s38, 32768
    ds_read_b64_tr_b16 a[244:245], v6 offset:128
    v_mul_f32 v10, v10, v14
    v_mfma_f32_16x16x32_bf16 v[120:123], a[252:255], a[76:79], v[120:123]
    s_add_u32 s39, s56, s0
    ds_read_b64_tr_b16 a[246:247], v6 offset:1664
    v_mul_f32 v11, v11, v14
    v_mfma_f32_16x16x32_bf16 v[120:123], a[248:251], a[72:75], v[120:123]
    s_waitcnt vmcnt(14)
    ds_read_b128 a[152:155], v12 offset:16384
    v_cvt_pk_bf16_f32 v10, v10, v11
    v_mfma_f32_16x16x32_bf16 v[128:131], a[248:251], a[140:143], v[128:131]
    buffer_load_dwordx4 v1, s[8:11], s39 offen lds
    v_accvgpr_read_b32 v11, a194
    v_mfma_f32_16x16x32_bf16 v[128:131], a[252:255], a[52:55], v[128:131]
    s_waitcnt lgkmcnt(6)
    v_accvgpr_read_b32 v7, a195
    v_mul_f32 v11, v11, v14
    v_mfma_f32_16x16x32_bf16 v[132:135], a[16:19], a[52:55], v[132:135]
    s_add_u32 s39, s39, 9216
    ds_read_b64_tr_b16 a[248:249], v6 offset:49416
    v_mul_f32 v7, v7, v14
    v_mfma_f32_16x16x32_bf16 v[132:135], a[12:15], a[140:143], v[132:135]
    ds_read_b64_tr_b16 a[250:251], v6 offset:50952
    v_cvt_pk_bf16_f32 v11, v11, v7
    v_mfma_f32_16x16x32_bf16 v[124:127], a[12:15], a[72:75], v[124:127]
    ds_read_b128 a[156:159], v13 offset:16384
    v_accvgpr_write_b32 a172, v8
    v_mfma_f32_16x16x32_bf16 v[124:127], a[16:19], a[76:79], v[124:127]
    buffer_load_dwordx4 v1, s[8:11], s39 offen offset:1024 lds
    v_accvgpr_write_b32 a173, v9
    v_mfma_f32_16x16x32_bf16 v[116:119], a[16:19], a[68:71], v[116:119]
    v_accvgpr_write_b32 a174, v10
    v_accvgpr_write_b32 a175, v11
    v_mfma_f32_16x16x32_bf16 v[116:119], a[12:15], a[64:67], v[116:119]
    s_add_u32 m0, s38, 40960
    ds_read_b64_tr_b16 a[252:253], v6 offset:136
    v_accvgpr_read_b32 v14, a9
    v_mfma_f32_16x16x32_bf16 v[108:111], a[12:15], a[48:51], v[108:111]
    s_add_u32 s39, s56, s1
    ds_read_b64_tr_b16 a[254:255], v6 offset:1672
    v_accvgpr_read_b32 v8, a176
    v_mfma_f32_16x16x32_bf16 v[108:111], a[16:19], a[60:63], v[108:111]
    s_waitcnt vmcnt(14)
    ds_read_b128 a[92:95], v12 offset:24576
    v_accvgpr_read_b32 v9, a177
    v_mfma_f32_16x16x32_bf16 v[100:103], a[16:19], a[44:47], v[100:103]
    buffer_load_dwordx4 v1, s[8:11], s39 offen lds
    v_mul_f32 v8, v8, v14
    v_mfma_f32_16x16x32_bf16 v[100:103], a[12:15], a[40:43], v[100:103]
    s_waitcnt lgkmcnt(7)
    v_mul_f32 v9, v9, v14
    v_cvt_pk_bf16_f32 v8, v8, v9
    v_mfma_f32_16x16x32_bf16 v[136:139], a[240:243], a[40:43], v[136:139]
    s_add_u32 s39, s39, 9216
    ds_read_b64_tr_b16 a[12:13], v5 offset:49536
    v_accvgpr_read_b32 v9, a178
    v_mfma_f32_16x16x32_bf16 v[136:139], a[244:247], a[44:47], v[136:139]
    ds_read_b64_tr_b16 a[14:15], v5 offset:51072
    v_accvgpr_read_b32 v10, a179
    v_mfma_f32_16x16x32_bf16 v[144:147], a[244:247], a[60:63], v[144:147]
    ds_read_b128 a[180:183], v13 offset:24576
    v_mul_f32 v9, v9, v14
    v_mfma_f32_16x16x32_bf16 v[144:147], a[240:243], a[48:51], v[144:147]
    buffer_load_dwordx4 v1, s[8:11], s39 offen offset:1024 lds
    v_mul_f32 v10, v10, v14
    v_mfma_f32_16x16x32_bf16 v[152:155], a[240:243], a[64:67], v[152:155]
    v_cvt_pk_bf16_f32 v9, v9, v10
    v_accvgpr_read_b32 v10, a196
    v_mfma_f32_16x16x32_bf16 v[152:155], a[244:247], a[68:71], v[152:155]
    s_mov_b32 s88, 32768
    ds_read_b64_tr_b16 a[16:17], v5 offset:256
    v_accvgpr_read_b32 v11, a197
    v_mfma_f32_16x16x32_bf16 v[160:163], a[244:247], a[76:79], v[160:163]
    ds_read_b64_tr_b16 a[18:19], v5 offset:1792
    v_mul_f32 v10, v10, v14
    v_mfma_f32_16x16x32_bf16 v[160:163], a[240:243], a[72:75], v[160:163]
    v_mul_f32 v11, v11, v14
    v_mfma_f32_16x16x32_bf16 v[168:171], a[240:243], a[140:143], v[168:171]
    buffer_store_dwordx4 a[128:131], v0, s[24:27], s88 offen sc1
    v_cvt_pk_bf16_f32 v10, v10, v11
    v_mfma_f32_16x16x32_bf16 v[168:171], a[244:247], a[52:55], v[168:171]
    s_waitcnt lgkmcnt(6)
    v_accvgpr_read_b32 v11, a198
    v_accvgpr_read_b32 v7, a199
    v_mfma_f32_16x16x32_bf16 v[172:175], a[252:255], a[52:55], v[172:175]
    s_add_u32 m0, s38, 49152
    ds_read_b64_tr_b16 a[240:241], v5 offset:49544
    v_mul_f32 v11, v11, v14
    v_mfma_f32_16x16x32_bf16 v[172:175], a[248:251], a[140:143], v[172:175]
    s_add_u32 s39, s56, s63
    ds_read_b64_tr_b16 a[242:243], v5 offset:51080
    v_mul_f32 v7, v7, v14
    v_mfma_f32_16x16x32_bf16 v[164:167], a[248:251], a[72:75], v[164:167]
    v_cvt_pk_bf16_f32 v11, v11, v7
    v_mfma_f32_16x16x32_bf16 v[164:167], a[252:255], a[76:79], v[164:167]
    buffer_load_dwordx4 v1, s[8:11], s39 offen lds
    v_accvgpr_write_b32 a176, v8
    v_mfma_f32_16x16x32_bf16 v[156:159], a[252:255], a[68:71], v[156:159]
    v_accvgpr_write_b32 a177, v9
    v_accvgpr_write_b32 a178, v10
    v_mfma_f32_16x16x32_bf16 v[156:159], a[248:251], a[64:67], v[156:159]
    s_add_u32 s39, s39, 9216
    ds_read_b64_tr_b16 a[244:245], v5 offset:264
    v_accvgpr_write_b32 a179, v11
    v_mfma_f32_16x16x32_bf16 v[148:151], a[248:251], a[48:51], v[148:151]
    ds_read_b64_tr_b16 a[246:247], v5 offset:1800
    v_accvgpr_read_b32 v14, a5
    v_mfma_f32_16x16x32_bf16 v[148:151], a[252:255], a[60:63], v[148:151]
    v_accvgpr_read_b32 v8, a200
    v_mfma_f32_16x16x32_bf16 v[140:143], a[252:255], a[44:47], v[140:143]
    buffer_load_dwordx4 v1, s[8:11], s39 offen offset:1024 lds
    v_accvgpr_read_b32 v9, a201
    v_mfma_f32_16x16x32_bf16 v[140:143], a[248:251], a[40:43], v[140:143]
    s_waitcnt lgkmcnt(4)
    v_mul_f32 v8, v8, v14
    v_mul_f32 v9, v9, v14
    v_mfma_f32_16x16x32_bf16 v[176:179], a[12:15], a[40:43], v[176:179]
    s_add_u32 m0, s38, 57344
    ds_read_b64_tr_b16 a[248:249], v6 offset:49536
    v_cvt_pk_bf16_f32 v8, v8, v9
    v_mfma_f32_16x16x32_bf16 v[176:179], a[16:19], a[44:47], v[176:179]
    s_add_u32 s39, s56, s87
    ds_read_b64_tr_b16 a[250:251], v6 offset:51072
    v_accvgpr_read_b32 v9, a202
    v_mfma_f32_16x16x32_bf16 v[184:187], a[16:19], a[60:63], v[184:187]
    v_accvgpr_read_b32 v10, a203
    v_mfma_f32_16x16x32_bf16 v[184:187], a[12:15], a[48:51], v[184:187]
    buffer_load_dwordx4 v1, s[8:11], s39 offen lds
    v_mul_f32 v9, v9, v14
    v_mfma_f32_16x16x32_bf16 v[192:195], a[12:15], a[64:67], v[192:195]
    v_mul_f32 v10, v10, v14
    v_cvt_pk_bf16_f32 v9, v9, v10
    v_mfma_f32_16x16x32_bf16 v[192:195], a[16:19], a[68:71], v[192:195]
    s_add_u32 s39, s39, 9216
    ds_read_b64_tr_b16 a[252:253], v6 offset:256
    v_accvgpr_read_b32 v10, a220
    v_mfma_f32_16x16x32_bf16 v[200:203], a[16:19], a[76:79], v[200:203]
    ds_read_b64_tr_b16 a[254:255], v6 offset:1792
    v_accvgpr_read_b32 v11, a221
    v_mfma_f32_16x16x32_bf16 v[200:203], a[12:15], a[72:75], v[200:203]
    v_mul_f32 v10, v10, v14
    v_mfma_f32_16x16x32_bf16 v[208:211], a[12:15], a[140:143], v[208:211]
    buffer_load_dwordx4 v1, s[8:11], s39 offen offset:1024 lds
    v_mul_f32 v11, v11, v14
    v_mfma_f32_16x16x32_bf16 v[208:211], a[16:19], a[52:55], v[208:211]
    s_waitcnt lgkmcnt(4)
    v_cvt_pk_bf16_f32 v10, v10, v11
    v_accvgpr_read_b32 v11, a222
    v_mfma_f32_16x16x32_bf16 v[212:215], a[244:247], a[52:55], v[212:215]
    s_mov_b32 s88, 33792
    ds_read_b64_tr_b16 a[12:13], v6 offset:49544
    v_accvgpr_read_b32 v7, a223
    v_mfma_f32_16x16x32_bf16 v[212:215], a[240:243], a[140:143], v[212:215]
    ds_read_b64_tr_b16 a[14:15], v6 offset:51080
    v_mul_f32 v11, v11, v14
    v_mfma_f32_16x16x32_bf16 v[204:207], a[240:243], a[72:75], v[204:207]
    v_mul_f32 v7, v7, v14
    v_mfma_f32_16x16x32_bf16 v[204:207], a[244:247], a[76:79], v[204:207]
    buffer_store_dwordx4 a[132:135], v0, s[24:27], s88 offen sc1
    v_cvt_pk_bf16_f32 v11, v11, v7
    v_mfma_f32_16x16x32_bf16 v[196:199], a[244:247], a[68:71], v[196:199]
    v_accvgpr_write_b32 a200, v8
    v_accvgpr_write_b32 a201, v9
    v_mfma_f32_16x16x32_bf16 v[196:199], a[240:243], a[64:67], v[196:199]
    s_add_u32 m0, s38, 0
    ds_read_b64_tr_b16 a[16:17], v6 offset:264
    v_accvgpr_write_b32 a202, v10
    v_mfma_f32_16x16x32_bf16 v[188:191], a[240:243], a[48:51], v[188:191]
    s_add_u32 s39, s56, 81920
    ds_read_b64_tr_b16 a[18:19], v6 offset:1800
    v_accvgpr_write_b32 a203, v11
    v_mfma_f32_16x16x32_bf16 v[188:191], a[244:247], a[60:63], v[188:191]
    v_accvgpr_read_b32 v14, a6
    v_mfma_f32_16x16x32_bf16 v[180:183], a[244:247], a[44:47], v[180:183]
    buffer_load_dwordx4 v1, s[8:11], s39 offen lds
    v_accvgpr_read_b32 v8, a204
    v_mfma_f32_16x16x32_bf16 v[180:183], a[240:243], a[40:43], v[180:183]
    s_waitcnt lgkmcnt(4)
    s_waitcnt vmcnt(17)
    s_barrier
    v_accvgpr_read_b32 v9, a205
    v_mfma_f32_16x16x32_bf16 v[216:219], a[248:251], a[40:43], v[216:219]
    s_add_u32 s39, s39, 9216
    ds_read_b64_tr_b16 a[240:241], v5 offset:12320
    v_mul_f32 v8, v8, v14
    v_mfma_f32_16x16x32_bf16 v[216:219], a[252:255], a[44:47], v[216:219]
    ds_read_b64_tr_b16 a[242:243], v5 offset:13856
    v_mul_f32 v9, v9, v14
    v_mfma_f32_16x16x32_bf16 v[224:227], a[252:255], a[60:63], v[224:227]
    v_cvt_pk_bf16_f32 v8, v8, v9
    v_mfma_f32_16x16x32_bf16 v[224:227], a[248:251], a[48:51], v[224:227]
    buffer_load_dwordx4 v1, s[8:11], s39 offen offset:1024 lds
    v_accvgpr_read_b32 v9, a206
    v_mfma_f32_16x16x32_bf16 v[232:235], a[248:251], a[64:67], v[232:235]
    v_accvgpr_read_b32 v10, a207
    v_mul_f32 v9, v9, v14
    v_mfma_f32_16x16x32_bf16 v[232:235], a[252:255], a[68:71], v[232:235]
    s_add_u32 m0, s38, 8192
    ds_read_b64_tr_b16 a[244:245], v5 offset:24640
    v_mul_f32 v10, v10, v14
    v_mfma_f32_16x16x32_bf16 v[240:243], a[252:255], a[76:79], v[240:243]
    s_add_u32 s39, s57, s0
    ds_read_b64_tr_b16 a[246:247], v5 offset:26176
    v_cvt_pk_bf16_f32 v9, v9, v10
    v_mfma_f32_16x16x32_bf16 v[240:243], a[248:251], a[72:75], v[240:243]
    v_accvgpr_read_b32 v10, a224
    v_mfma_f32_16x16x32_bf16 v[248:251], a[248:251], a[140:143], v[248:251]
    buffer_load_dwordx4 v1, s[8:11], s39 offen lds
    v_accvgpr_read_b32 v11, a225
    v_mfma_f32_16x16x32_bf16 v[248:251], a[252:255], a[52:55], v[248:251]
    s_waitcnt lgkmcnt(4)
    s_barrier
    v_mul_f32 v10, v10, v14
    v_mfma_f32_16x16x32_bf16 v[252:255], a[16:19], a[52:55], v[252:255]
    s_add_u32 s39, s39, 9216
    ds_read_b64_tr_b16 a[248:249], v5 offset:12328
    v_mul_f32 v11, v11, v14
    v_mfma_f32_16x16x32_bf16 v[252:255], a[12:15], a[140:143], v[252:255]
    ds_read_b64_tr_b16 a[250:251], v5 offset:13864
    v_cvt_pk_bf16_f32 v10, v10, v11
    v_mfma_f32_16x16x32_bf16 v[244:247], a[12:15], a[72:75], v[244:247]
    v_accvgpr_read_b32 v11, a226
    v_mfma_f32_16x16x32_bf16 v[244:247], a[16:19], a[76:79], v[244:247]
    buffer_load_dwordx4 v1, s[8:11], s39 offen offset:1024 lds
    v_accvgpr_read_b32 v7, a227
    v_mfma_f32_16x16x32_bf16 v[236:239], a[16:19], a[68:71], v[236:239]
    v_mul_f32 v11, v11, v14
    v_mul_f32 v7, v7, v14
    v_mfma_f32_16x16x32_bf16 v[236:239], a[12:15], a[64:67], v[236:239]
    s_add_u32 m0, s31, 49280
    ds_read_b64_tr_b16 a[252:253], v5 offset:24648
    v_cvt_pk_bf16_f32 v11, v11, v7
    v_mfma_f32_16x16x32_bf16 v[228:231], a[12:15], a[48:51], v[228:231]
    s_add_u32 s32, s32, 393216
    ds_read_b64_tr_b16 a[254:255], v5 offset:26184
    v_accvgpr_write_b32 a204, v8
    v_mfma_f32_16x16x32_bf16 v[228:231], a[16:19], a[60:63], v[228:231]
    v_accvgpr_write_b32 a205, v9
    v_mfma_f32_16x16x32_bf16 v[220:223], a[16:19], a[44:47], v[220:223]
    buffer_load_dwordx4 v2, s[12:15], s32 offen lds
    v_accvgpr_write_b32 a206, v10
    v_mfma_f32_16x16x32_bf16 v[220:223], a[12:15], a[40:43], v[220:223]
    s_waitcnt lgkmcnt(4)
    v_accvgpr_write_b32 a207, v11
    v_accvgpr_read_b32 v14, a7
    v_mfma_f32_16x16x32_bf16 v[16:19], a[240:243], a[144:147], v[16:19]
    ds_read_b64_tr_b16 a[12:13], v6 offset:12320
    v_accvgpr_read_b32 v8, a208
    v_mfma_f32_16x16x32_bf16 v[16:19], a[244:247], a[56:59], v[16:19]
    ds_read_b64_tr_b16 a[14:15], v6 offset:13856
    v_accvgpr_read_b32 v9, a209
    v_mfma_f32_16x16x32_bf16 v[24:27], a[244:247], a[148:151], v[24:27]
    v_mul_f32 v8, v8, v14
    v_mfma_f32_16x16x32_bf16 v[24:27], a[240:243], a[80:83], v[24:27]
    buffer_load_dwordx4 v3, s[12:15], s32 offen offset:1024 lds
    v_mul_f32 v9, v9, v14
    v_mfma_f32_16x16x32_bf16 v[32:35], a[240:243], a[84:87], v[32:35]
    v_cvt_pk_bf16_f32 v8, v8, v9
    v_accvgpr_read_b32 v9, a210
    v_mfma_f32_16x16x32_bf16 v[32:35], a[244:247], a[88:91], v[32:35]
    ds_read_b64_tr_b16 a[16:17], v6 offset:24640
    v_accvgpr_read_b32 v10, a211
    v_mfma_f32_16x16x32_bf16 v[40:43], a[244:247], a[156:159], v[40:43]
    ds_read_b64_tr_b16 a[18:19], v6 offset:26176
    v_mul_f32 v9, v9, v14
    v_mfma_f32_16x16x32_bf16 v[40:43], a[240:243], a[152:155], v[40:43]
    s_waitcnt vmcnt(14)
    ds_read_b128 a[20:23], v12 offset:32768
    v_mul_f32 v10, v10, v14
    v_mfma_f32_16x16x32_bf16 v[48:51], a[240:243], a[92:95], v[48:51]
    buffer_load_dwordx4 v4, s[12:15], s32 offen offset:2048 lds
    v_cvt_pk_bf16_f32 v9, v9, v10
    v_mfma_f32_16x16x32_bf16 v[48:51], a[244:247], a[180:183], v[48:51]
    s_waitcnt lgkmcnt(5)
    v_accvgpr_read_b32 v10, a228
    v_accvgpr_read_b32 v11, a229
    v_mfma_f32_16x16x32_bf16 v[52:55], a[252:255], a[180:183], v[52:55]
    s_mov_b32 s88, 34816
    ds_read_b64_tr_b16 a[240:241], v6 offset:12328
    v_mul_f32 v10, v10, v14
    v_mfma_f32_16x16x32_bf16 v[52:55], a[248:251], a[92:95], v[52:55]
    ds_read_b64_tr_b16 a[242:243], v6 offset:13864
    v_mul_f32 v11, v11, v14
    v_mfma_f32_16x16x32_bf16 v[44:47], a[248:251], a[152:155], v[44:47]
    ds_read_b128 a[24:27], v13 offset:32768
    v_cvt_pk_bf16_f32 v10, v10, v11
    v_mfma_f32_16x16x32_bf16 v[44:47], a[252:255], a[156:159], v[44:47]
    buffer_store_dwordx4 a[136:139], v0, s[24:27], s88 offen sc1
    v_accvgpr_read_b32 v11, a230
    v_mfma_f32_16x16x32_bf16 v[36:39], a[252:255], a[88:91], v[36:39]
    v_accvgpr_read_b32 v7, a231
    v_mul_f32 v11, v11, v14
    v_mfma_f32_16x16x32_bf16 v[36:39], a[248:251], a[84:87], v[36:39]
    s_mov_b32 s88, 40960
    ds_read_b64_tr_b16 a[244:245], v6 offset:24648
    v_mul_f32 v7, v7, v14
    v_mfma_f32_16x16x32_bf16 v[28:31], a[248:251], a[80:83], v[28:31]
    ds_read_b64_tr_b16 a[246:247], v6 offset:26184
    v_cvt_pk_bf16_f32 v11, v11, v7
    v_mfma_f32_16x16x32_bf16 v[28:31], a[252:255], a[148:151], v[28:31]
    s_waitcnt vmcnt(14)
    ds_read_b128 a[28:31], v12 offset:40960
    v_accvgpr_write_b32 a208, v8
    v_mfma_f32_16x16x32_bf16 v[20:23], a[252:255], a[56:59], v[20:23]
    buffer_store_dwordx4 a[160:163], v0, s[24:27], s88 offen sc1
    v_accvgpr_write_b32 a209, v9
    v_mfma_f32_16x16x32_bf16 v[20:23], a[248:251], a[144:147], v[20:23]
    s_waitcnt lgkmcnt(7)
    v_accvgpr_write_b32 a210, v10
    v_accvgpr_write_b32 a211, v11
    v_mfma_f32_16x16x32_bf16 v[56:59], a[12:15], a[144:147], v[56:59]
    s_add_u32 m0, s31, 0
    ds_read_b64_tr_b16 a[248:249], v5 offset:12448
    v_accvgpr_read_b32 v14, a8
    v_mfma_f32_16x16x32_bf16 v[56:59], a[16:19], a[56:59], v[56:59]
    s_mul_i32 s32, s57, 6144
    ds_read_b64_tr_b16 a[250:251], v5 offset:13984
    v_accvgpr_read_b32 v8, a212
    v_mfma_f32_16x16x32_bf16 v[64:67], a[16:19], a[148:151], v[64:67]
    ds_read_b128 a[32:35], v13 offset:40960
    v_accvgpr_read_b32 v9, a213
    v_mfma_f32_16x16x32_bf16 v[64:67], a[12:15], a[80:83], v[64:67]
    buffer_load_dwordx4 v2, s[12:15], s32 offen lds
    v_mul_f32 v8, v8, v14
    v_mfma_f32_16x16x32_bf16 v[72:75], a[12:15], a[84:87], v[72:75]
    v_mul_f32 v9, v9, v14
    v_cvt_pk_bf16_f32 v8, v8, v9
    v_mfma_f32_16x16x32_bf16 v[72:75], a[16:19], a[88:91], v[72:75]
    ds_read_b64_tr_b16 a[252:253], v5 offset:24768
    v_accvgpr_read_b32 v9, a214
    v_mfma_f32_16x16x32_bf16 v[80:83], a[16:19], a[156:159], v[80:83]
    ds_read_b64_tr_b16 a[254:255], v5 offset:26304
    v_accvgpr_read_b32 v10, a215
    v_mfma_f32_16x16x32_bf16 v[80:83], a[12:15], a[152:155], v[80:83]
    v_mul_f32 v9, v9, v14
    v_mfma_f32_16x16x32_bf16 v[88:91], a[12:15], a[92:95], v[88:91]
    buffer_load_dwordx4 v3, s[12:15], s32 offen offset:1024 lds
    v_mul_f32 v10, v10, v14
    v_mfma_f32_16x16x32_bf16 v[88:91], a[16:19], a[180:183], v[88:91]
    s_waitcnt lgkmcnt(6)
    v_cvt_pk_bf16_f32 v9, v9, v10
    v_accvgpr_read_b32 v10, a232
    v_mfma_f32_16x16x32_bf16 v[92:95], a[244:247], a[180:183], v[92:95]
    ds_read_b64_tr_b16 a[12:13], v5 offset:12456
    v_accvgpr_read_b32 v11, a233
    v_mfma_f32_16x16x32_bf16 v[92:95], a[240:243], a[92:95], v[92:95]
    ds_read_b64_tr_b16 a[14:15], v5 offset:13992
    v_mul_f32 v10, v10, v14
    v_mfma_f32_16x16x32_bf16 v[84:87], a[240:243], a[152:155], v[84:87]
    s_waitcnt vmcnt(14)
    ds_read_b128 a[36:39], v12 offset:49152
    v_mul_f32 v11, v11, v14
    v_mfma_f32_16x16x32_bf16 v[84:87], a[244:247], a[156:159], v[84:87]
    buffer_load_dwordx4 v4, s[12:15], s32 offen offset:2048 lds
    v_cvt_pk_bf16_f32 v10, v10, v11
    v_mfma_f32_16x16x32_bf16 v[76:79], a[244:247], a[88:91], v[76:79]
    v_accvgpr_read_b32 v11, a234
    v_accvgpr_read_b32 v7, a235
    v_mfma_f32_16x16x32_bf16 v[76:79], a[240:243], a[84:87], v[76:79]
    s_add_u32 m0, s38, 16384
    ds_read_b64_tr_b16 a[16:17], v5 offset:24776
    v_mul_f32 v11, v11, v14
    v_mfma_f32_16x16x32_bf16 v[68:71], a[240:243], a[80:83], v[68:71]
    s_add_u32 s39, s57, s1
    ds_read_b64_tr_b16 a[18:19], v5 offset:26312
    v_mul_f32 v7, v7, v14
    v_mfma_f32_16x16x32_bf16 v[68:71], a[244:247], a[148:151], v[68:71]
    ds_read_b128 a[100:103], v13 offset:49152
    v_cvt_pk_bf16_f32 v11, v11, v7
    v_mfma_f32_16x16x32_bf16 v[60:63], a[244:247], a[56:59], v[60:63]
    buffer_load_dwordx4 v1, s[8:11], s39 offen lds
    v_accvgpr_write_b32 a212, v8
    v_mfma_f32_16x16x32_bf16 v[60:63], a[240:243], a[144:147], v[60:63]
    s_waitcnt lgkmcnt(6)
    v_accvgpr_write_b32 a213, v9
    v_accvgpr_write_b32 a214, v10
    v_mfma_f32_16x16x32_bf16 v[96:99], a[248:251], a[144:147], v[96:99]
    s_add_u32 s39, s39, 9216
    ds_read_b64_tr_b16 a[240:241], v6 offset:12448
    v_accvgpr_write_b32 a215, v11
    v_mfma_f32_16x16x32_bf16 v[96:99], a[252:255], a[56:59], v[96:99]
    ds_read_b64_tr_b16 a[242:243], v6 offset:13984
    v_accvgpr_read_b32 v14, a9
    v_mfma_f32_16x16x32_bf16 v[104:107], a[252:255], a[148:151], v[104:107]
    s_waitcnt vmcnt(14)
    ds_read_b128 a[104:107], v12 offset:57344
    v_accvgpr_read_b32 v8, a216
    v_mfma_f32_16x16x32_bf16 v[104:107], a[248:251], a[80:83], v[104:107]
    buffer_load_dwordx4 v1, s[8:11], s39 offen offset:1024 lds
    v_accvgpr_read_b32 v9, a217
    v_mfma_f32_16x16x32_bf16 v[112:115], a[248:251], a[84:87], v[112:115]
    v_mul_f32 v8, v8, v14
    v_mul_f32 v9, v9, v14
    v_mfma_f32_16x16x32_bf16 v[112:115], a[252:255], a[88:91], v[112:115]
    s_mov_b32 s88, 41984
    ds_read_b64_tr_b16 a[244:245], v6 offset:24768
    v_cvt_pk_bf16_f32 v8, v8, v9
    v_mfma_f32_16x16x32_bf16 v[120:123], a[252:255], a[156:159], v[120:123]
    ds_read_b64_tr_b16 a[246:247], v6 offset:26304
    v_accvgpr_read_b32 v9, a218
    v_mfma_f32_16x16x32_bf16 v[120:123], a[248:251], a[152:155], v[120:123]
    ds_read_b128 a[108:111], v13 offset:57344
    v_accvgpr_read_b32 v10, a219
    v_mfma_f32_16x16x32_bf16 v[128:131], a[248:251], a[92:95], v[128:131]
    buffer_store_dwordx4 a[164:167], v0, s[24:27], s88 offen sc1
    v_mul_f32 v9, v9, v14
    v_mfma_f32_16x16x32_bf16 v[128:131], a[252:255], a[180:183], v[128:131]
    s_waitcnt lgkmcnt(7)
    v_mul_f32 v10, v10, v14
    v_cvt_pk_bf16_f32 v9, v9, v10
    v_mfma_f32_16x16x32_bf16 v[132:135], a[16:19], a[180:183], v[132:135]
    s_add_u32 m0, s38, 24576
    ds_read_b64_tr_b16 a[248:249], v6 offset:12456
    v_accvgpr_read_b32 v10, a236
    v_mfma_f32_16x16x32_bf16 v[132:135], a[12:15], a[92:95], v[132:135]
    s_add_u32 s39, s57, s63
    ds_read_b64_tr_b16 a[250:251], v6 offset:13992
    v_accvgpr_read_b32 v11, a237
    v_mfma_f32_16x16x32_bf16 v[124:127], a[12:15], a[152:155], v[124:127]
    v_mul_f32 v10, v10, v14
    v_mfma_f32_16x16x32_bf16 v[124:127], a[16:19], a[156:159], v[124:127]
    buffer_load_dwordx4 v1, s[8:11], s39 offen lds
    v_mul_f32 v11, v11, v14
    v_mfma_f32_16x16x32_bf16 v[116:119], a[16:19], a[88:91], v[116:119]
    v_cvt_pk_bf16_f32 v10, v10, v11
    v_accvgpr_read_b32 v11, a238
    v_mfma_f32_16x16x32_bf16 v[116:119], a[12:15], a[84:87], v[116:119]
    s_add_u32 s39, s39, 9216
    ds_read_b64_tr_b16 a[252:253], v6 offset:24776
    v_accvgpr_read_b32 v7, a239
    v_mfma_f32_16x16x32_bf16 v[108:111], a[12:15], a[80:83], v[108:111]
    ds_read_b64_tr_b16 a[254:255], v6 offset:26312
    v_mul_f32 v11, v11, v14
    v_mfma_f32_16x16x32_bf16 v[108:111], a[16:19], a[148:151], v[108:111]
    s_waitcnt vmcnt(14)
    ds_read_b128 a[112:115], v12 offset:0
    v_mul_f32 v7, v7, v14
    v_mfma_f32_16x16x32_bf16 v[100:103], a[16:19], a[56:59], v[100:103]
    buffer_load_dwordx4 v1, s[8:11], s39 offen offset:1024 lds
    v_cvt_pk_bf16_f32 v11, v11, v7
    v_mfma_f32_16x16x32_bf16 v[100:103], a[12:15], a[144:147], v[100:103]
    s_waitcnt lgkmcnt(6)
    v_accvgpr_write_b32 a216, v8
    v_accvgpr_write_b32 a217, v9
    v_mfma_f32_16x16x32_bf16 v[136:139], a[240:243], a[144:147], v[136:139]
    s_add_u32 m0, s38, 32768
    ds_read_b64_tr_b16 a[12:13], v5 offset:12576
    v_accvgpr_write_b32 a218, v10
    v_mfma_f32_16x16x32_bf16 v[136:139], a[244:247], a[56:59], v[136:139]
    s_add_u32 s39, s57, s87
    ds_read_b64_tr_b16 a[14:15], v5 offset:14112
    v_accvgpr_write_b32 a219, v11
    v_mfma_f32_16x16x32_bf16 v[144:147], a[244:247], a[148:151], v[144:147]
    ds_read_b128 a[116:119], v13 offset:0
    v_accvgpr_read_b32 v7, a0
    v_mfma_f32_16x16x32_bf16 v[144:147], a[240:243], a[80:83], v[144:147]
    buffer_load_dwordx4 v1, s[8:11], s39 offen lds
    v_accvgpr_read_b32 v8, a1
    v_mfma_f32_16x16x32_bf16 v[152:155], a[240:243], a[84:87], v[152:155]
    v_accvgpr_read_b32 v9, a2
    v_accvgpr_read_b32 v10, a3
    v_mfma_f32_16x16x32_bf16 v[152:155], a[244:247], a[88:91], v[152:155]
    s_add_u32 s39, s39, 9216
    ds_read_b64_tr_b16 a[16:17], v5 offset:24896
    v_accvgpr_read_b32 v11, a4
    v_mfma_f32_16x16x32_bf16 v[160:163], a[244:247], a[156:159], v[160:163]
    ds_read_b64_tr_b16 a[18:19], v5 offset:26432
    v_mov_b32 v14, 1
    v_mfma_f32_16x16x32_bf16 v[160:163], a[240:243], a[152:155], v[160:163]
    s_waitcnt vmcnt(14)
    ds_read_b128 a[184:187], v12 offset:8192
    v_mfma_f32_16x16x32_bf16 v[168:171], a[240:243], a[92:95], v[168:171]
    buffer_load_dwordx4 v1, s[8:11], s39 offen offset:1024 lds
    v_mfma_f32_16x16x32_bf16 v[168:171], a[244:247], a[180:183], v[168:171]
    s_waitcnt lgkmcnt(7)
    v_mfma_f32_16x16x32_bf16 v[172:175], a[252:255], a[180:183], v[172:175]
    s_mov_b32 s88, 43008
    ds_read_b64_tr_b16 a[240:241], v5 offset:12584
    v_mfma_f32_16x16x32_bf16 v[172:175], a[248:251], a[92:95], v[172:175]
    ds_read_b64_tr_b16 a[242:243], v5 offset:14120
    v_mfma_f32_16x16x32_bf16 v[164:167], a[248:251], a[152:155], v[164:167]
    ds_read_b128 a[96:99], v13 offset:8192
    v_mfma_f32_16x16x32_bf16 v[164:167], a[252:255], a[156:159], v[164:167]
    buffer_store_dwordx4 a[168:171], v0, s[24:27], s88 offen sc1
    v_mfma_f32_16x16x32_bf16 v[156:159], a[252:255], a[88:91], v[156:159]
    v_mfma_f32_16x16x32_bf16 v[156:159], a[248:251], a[84:87], v[156:159]
    s_add_u32 m0, s38, 40960
    ds_read_b64_tr_b16 a[244:245], v5 offset:24904
    v_mfma_f32_16x16x32_bf16 v[148:151], a[248:251], a[80:83], v[148:151]
    s_add_u32 s39, s57, 81920
    ds_read_b64_tr_b16 a[246:247], v5 offset:26440
    v_mfma_f32_16x16x32_bf16 v[148:151], a[252:255], a[148:151], v[148:151]
    v_mfma_f32_16x16x32_bf16 v[140:143], a[252:255], a[56:59], v[140:143]
    buffer_load_dwordx4 v1, s[8:11], s39 offen lds
    v_mfma_f32_16x16x32_bf16 v[140:143], a[248:251], a[144:147], v[140:143]
    s_waitcnt lgkmcnt(6)
    v_mfma_f32_16x16x32_bf16 v[176:179], a[12:15], a[144:147], v[176:179]
    s_add_u32 s39, s39, 9216
    ds_read_b64_tr_b16 a[248:249], v6 offset:12576
    v_mfma_f32_16x16x32_bf16 v[176:179], a[16:19], a[56:59], v[176:179]
    ds_read_b64_tr_b16 a[250:251], v6 offset:14112
    v_mfma_f32_16x16x32_bf16 v[184:187], a[16:19], a[148:151], v[184:187]
    v_mfma_f32_16x16x32_bf16 v[184:187], a[12:15], a[80:83], v[184:187]
    buffer_load_dwordx4 v1, s[8:11], s39 offen offset:1024 lds
    v_mfma_f32_16x16x32_bf16 v[192:195], a[12:15], a[84:87], v[192:195]
    v_mfma_f32_16x16x32_bf16 v[192:195], a[16:19], a[88:91], v[192:195]
    s_add_u32 m0, s38, 49152
    ds_read_b64_tr_b16 a[252:253], v6 offset:24896
    v_mfma_f32_16x16x32_bf16 v[200:203], a[16:19], a[156:159], v[200:203]
    s_add_u32 s39, s58, s0
    ds_read_b64_tr_b16 a[254:255], v6 offset:26432
    v_mfma_f32_16x16x32_bf16 v[200:203], a[12:15], a[152:155], v[200:203]
    v_mfma_f32_16x16x32_bf16 v[208:211], a[12:15], a[92:95], v[208:211]
    buffer_load_dwordx4 v1, s[8:11], s39 offen lds
    v_mfma_f32_16x16x32_bf16 v[208:211], a[16:19], a[180:183], v[208:211]
    s_waitcnt lgkmcnt(4)
    v_mfma_f32_16x16x32_bf16 v[212:215], a[244:247], a[180:183], v[212:215]
    s_add_u32 s39, s39, 9216
    ds_read_b64_tr_b16 a[12:13], v6 offset:12584
    v_mfma_f32_16x16x32_bf16 v[212:215], a[240:243], a[92:95], v[212:215]
    ds_read_b64_tr_b16 a[14:15], v6 offset:14120
    v_mfma_f32_16x16x32_bf16 v[204:207], a[240:243], a[152:155], v[204:207]
    v_mfma_f32_16x16x32_bf16 v[204:207], a[244:247], a[156:159], v[204:207]
    buffer_load_dwordx4 v1, s[8:11], s39 offen offset:1024 lds
    v_mfma_f32_16x16x32_bf16 v[196:199], a[244:247], a[88:91], v[196:199]
    v_mfma_f32_16x16x32_bf16 v[196:199], a[240:243], a[84:87], v[196:199]
    s_mov_b32 s88, 44032
    ds_read_b64_tr_b16 a[16:17], v6 offset:24904
    v_mfma_f32_16x16x32_bf16 v[188:191], a[240:243], a[80:83], v[188:191]
    ds_read_b64_tr_b16 a[18:19], v6 offset:26440
    v_mfma_f32_16x16x32_bf16 v[188:191], a[244:247], a[148:151], v[188:191]
    v_mfma_f32_16x16x32_bf16 v[180:183], a[244:247], a[56:59], v[180:183]
    buffer_store_dwordx4 a[172:175], v0, s[24:27], s88 offen sc1
    v_mfma_f32_16x16x32_bf16 v[180:183], a[240:243], a[144:147], v[180:183]
    s_waitcnt lgkmcnt(4)
    s_waitcnt vmcnt(18)
    s_barrier
    v_mfma_f32_16x16x32_bf16 v[216:219], a[248:251], a[144:147], v[216:219]
    s_add_u32 m0, s38, 57344
    ds_read_b64_tr_b16 a[240:241], v5 offset:36960
    v_mfma_f32_16x16x32_bf16 v[216:219], a[252:255], a[56:59], v[216:219]
    s_add_u32 s39, s58, s1
    ds_read_b64_tr_b16 a[242:243], v5 offset:38496
    v_mfma_f32_16x16x32_bf16 v[224:227], a[252:255], a[148:151], v[224:227]
    v_mfma_f32_16x16x32_bf16 v[224:227], a[248:251], a[80:83], v[224:227]
    buffer_load_dwordx4 v1, s[8:11], s39 offen lds
    v_mfma_f32_16x16x32_bf16 v[232:235], a[248:251], a[84:87], v[232:235]
    v_mfma_f32_16x16x32_bf16 v[232:235], a[252:255], a[88:91], v[232:235]
    s_add_u32 s39, s39, 9216
    ds_read_b64_tr_b16 a[244:245], v5 offset:49280
    v_mfma_f32_16x16x32_bf16 v[240:243], a[252:255], a[156:159], v[240:243]
    ds_read_b64_tr_b16 a[246:247], v5 offset:50816
    v_mfma_f32_16x16x32_bf16 v[240:243], a[248:251], a[152:155], v[240:243]
    v_mfma_f32_16x16x32_bf16 v[248:251], a[248:251], a[92:95], v[248:251]
    buffer_load_dwordx4 v1, s[8:11], s39 offen offset:1024 lds
    v_mfma_f32_16x16x32_bf16 v[248:251], a[252:255], a[180:183], v[248:251]
    s_waitcnt lgkmcnt(4)
    s_barrier
    v_mfma_f32_16x16x32_bf16 v[252:255], a[16:19], a[180:183], v[252:255]
    s_add_u32 m0, s31, 12320
    ds_read_b64_tr_b16 a[248:249], v5 offset:36968
    v_mfma_f32_16x16x32_bf16 v[252:255], a[12:15], a[92:95], v[252:255]
    s_add_u32 s32, s32, 393216
    ds_read_b64_tr_b16 a[250:251], v5 offset:38504
    v_mfma_f32_16x16x32_bf16 v[244:247], a[12:15], a[152:155], v[244:247]
    v_mfma_f32_16x16x32_bf16 v[244:247], a[16:19], a[156:159], v[244:247]
    buffer_load_dwordx4 v2, s[12:15], s32 offen lds
    v_mfma_f32_16x16x32_bf16 v[236:239], a[16:19], a[88:91], v[236:239]
    v_mfma_f32_16x16x32_bf16 v[236:239], a[12:15], a[84:87], v[236:239]
    ds_read_b64_tr_b16 a[252:253], v5 offset:49288
    v_mfma_f32_16x16x32_bf16 v[228:231], a[12:15], a[80:83], v[228:231]
    ds_read_b64_tr_b16 a[254:255], v5 offset:50824
    v_mfma_f32_16x16x32_bf16 v[228:231], a[16:19], a[148:151], v[228:231]
    s_waitcnt vmcnt(14)
    ds_read_b128 a[120:123], v12 offset:16384
    v_mfma_f32_16x16x32_bf16 v[220:223], a[16:19], a[56:59], v[220:223]
    buffer_load_dwordx4 v3, s[12:15], s32 offen offset:1024 lds
    v_mfma_f32_16x16x32_bf16 v[220:223], a[12:15], a[144:147], v[220:223]
    s_waitcnt lgkmcnt(5)
    v_mfma_f32_16x16x32_bf16 v[16:19], a[240:243], a[20:23], v[16:19]
    ds_read_b64_tr_b16 a[12:13], v6 offset:36960
    v_mfma_f32_16x16x32_bf16 v[16:19], a[244:247], a[24:27], v[16:19]
    ds_read_b64_tr_b16 a[14:15], v6 offset:38496
    v_mfma_f32_16x16x32_bf16 v[24:27], a[244:247], a[32:35], v[24:27]
    ds_read_b128 a[188:191], v13 offset:16384
    v_mfma_f32_16x16x32_bf16 v[24:27], a[240:243], a[28:31], v[24:27]
    buffer_load_dwordx4 v4, s[12:15], s32 offen offset:2048 lds
    v_mfma_f32_16x16x32_bf16 v[32:35], a[240:243], a[36:39], v[32:35]
    v_mfma_f32_16x16x32_bf16 v[32:35], a[244:247], a[100:103], v[32:35]
    s_mov_b32 s88, 45056
    ds_read_b64_tr_b16 a[16:17], v6 offset:49280
    v_mfma_f32_16x16x32_bf16 v[40:43], a[244:247], a[108:111], v[40:43]
    ds_read_b64_tr_b16 a[18:19], v6 offset:50816
    v_mfma_f32_16x16x32_bf16 v[40:43], a[240:243], a[104:107], v[40:43]
    v_mfma_f32_16x16x32_bf16 v[48:51], a[240:243], a[112:115], v[48:51]
    buffer_store_dwordx4 a[176:179], v0, s[24:27], s88 offen sc1
    v_mfma_f32_16x16x32_bf16 v[48:51], a[244:247], a[116:119], v[48:51]
    s_waitcnt lgkmcnt(6)
    v_mfma_f32_16x16x32_bf16 v[52:55], a[252:255], a[116:119], v[52:55]
    s_add_u32 m0, s31, 24640
    ds_read_b64_tr_b16 a[240:241], v6 offset:36968
    v_mfma_f32_16x16x32_bf16 v[52:55], a[248:251], a[112:115], v[52:55]
    s_mul_i32 s32, s58, 6144
    ds_read_b64_tr_b16 a[242:243], v6 offset:38504
    v_mfma_f32_16x16x32_bf16 v[44:47], a[248:251], a[104:107], v[44:47]
    s_waitcnt vmcnt(14)
    ds_read_b128 a[124:127], v12 offset:24576
    v_mfma_f32_16x16x32_bf16 v[44:47], a[252:255], a[108:111], v[44:47]
    buffer_load_dwordx4 v2, s[12:15], s32 offen lds
    v_mfma_f32_16x16x32_bf16 v[36:39], a[252:255], a[100:103], v[36:39]
    v_mfma_f32_16x16x32_bf16 v[36:39], a[248:251], a[36:39], v[36:39]
    ds_read_b64_tr_b16 a[244:245], v6 offset:49288
    v_mfma_f32_16x16x32_bf16 v[28:31], a[248:251], a[28:31], v[28:31]
    ds_read_b64_tr_b16 a[246:247], v6 offset:50824
    v_mfma_f32_16x16x32_bf16 v[28:31], a[252:255], a[32:35], v[28:31]
    ds_read_b128 a[192:195], v13 offset:24576
    v_mfma_f32_16x16x32_bf16 v[20:23], a[252:255], a[24:27], v[20:23]
    buffer_load_dwordx4 v3, s[12:15], s32 offen offset:1024 lds
    v_mfma_f32_16x16x32_bf16 v[20:23], a[248:251], a[20:23], v[20:23]
    s_waitcnt lgkmcnt(6)
    v_mfma_f32_16x16x32_bf16 v[56:59], a[12:15], a[20:23], v[56:59]
    ds_read_b64_tr_b16 a[248:249], v5 offset:37088
    v_mfma_f32_16x16x32_bf16 v[56:59], a[16:19], a[24:27], v[56:59]
    ds_read_b64_tr_b16 a[250:251], v5 offset:38624
    v_mfma_f32_16x16x32_bf16 v[64:67], a[16:19], a[32:35], v[64:67]
    s_waitcnt vmcnt(14)
    ds_read_b128 a[196:199], v12 offset:32768
    v_mfma_f32_16x16x32_bf16 v[64:67], a[12:15], a[28:31], v[64:67]
    buffer_load_dwordx4 v4, s[12:15], s32 offen offset:2048 lds
    v_mfma_f32_16x16x32_bf16 v[72:75], a[12:15], a[36:39], v[72:75]
    v_mfma_f32_16x16x32_bf16 v[72:75], a[16:19], a[100:103], v[72:75]
    s_mov_b32 s88, 51200
    ds_read_b64_tr_b16 a[252:253], v5 offset:49408
    v_mfma_f32_16x16x32_bf16 v[80:83], a[16:19], a[108:111], v[80:83]
    ds_read_b64_tr_b16 a[254:255], v5 offset:50944
    v_mfma_f32_16x16x32_bf16 v[80:83], a[12:15], a[104:107], v[80:83]
    ds_read_b128 a[128:131], v13 offset:32768
    v_mfma_f32_16x16x32_bf16 v[88:91], a[12:15], a[112:115], v[88:91]
    buffer_store_dwordx4 a[200:203], v0, s[24:27], s88 offen sc1
    v_mfma_f32_16x16x32_bf16 v[88:91], a[16:19], a[116:119], v[88:91]
    s_waitcnt lgkmcnt(7)
    v_mfma_f32_16x16x32_bf16 v[92:95], a[244:247], a[116:119], v[92:95]
    s_add_u32 m0, s38, 0
    ds_read_b64_tr_b16 a[12:13], v5 offset:37096
    v_mfma_f32_16x16x32_bf16 v[92:95], a[240:243], a[112:115], v[92:95]
    s_add_u32 s39, s58, s63
    ds_read_b64_tr_b16 a[14:15], v5 offset:38632
    v_mfma_f32_16x16x32_bf16 v[84:87], a[240:243], a[104:107], v[84:87]
    v_mfma_f32_16x16x32_bf16 v[84:87], a[244:247], a[108:111], v[84:87]
    buffer_load_dwordx4 v1, s[8:11], s39 offen lds
    v_mfma_f32_16x16x32_bf16 v[76:79], a[244:247], a[100:103], v[76:79]
    v_mfma_f32_16x16x32_bf16 v[76:79], a[240:243], a[36:39], v[76:79]
    s_add_u32 s39, s39, 9216
    ds_read_b64_tr_b16 a[16:17], v5 offset:49416
    v_mfma_f32_16x16x32_bf16 v[68:71], a[240:243], a[28:31], v[68:71]
    ds_read_b64_tr_b16 a[18:19], v5 offset:50952
    v_mfma_f32_16x16x32_bf16 v[68:71], a[244:247], a[32:35], v[68:71]
    s_waitcnt vmcnt(14)
    ds_read_b128 a[220:223], v12 offset:40960
    v_mfma_f32_16x16x32_bf16 v[60:63], a[244:247], a[24:27], v[60:63]
    buffer_load_dwordx4 v1, s[8:11], s39 offen offset:1024 lds
    v_mfma_f32_16x16x32_bf16 v[60:63], a[240:243], a[20:23], v[60:63]
    s_waitcnt lgkmcnt(6)
    v_mfma_f32_16x16x32_bf16 v[96:99], a[248:251], a[20:23], v[96:99]
    s_add_u32 m0, s38, 8192
    ds_read_b64_tr_b16 a[240:241], v6 offset:37088
    v_mfma_f32_16x16x32_bf16 v[96:99], a[252:255], a[24:27], v[96:99]
    s_add_u32 s39, s58, s87
    ds_read_b64_tr_b16 a[242:243], v6 offset:38624
    v_mfma_f32_16x16x32_bf16 v[104:107], a[252:255], a[32:35], v[104:107]
    ds_read_b128 a[132:135], v13 offset:40960
    v_mfma_f32_16x16x32_bf16 v[104:107], a[248:251], a[28:31], v[104:107]
    buffer_load_dwordx4 v1, s[8:11], s39 offen lds
    v_mfma_f32_16x16x32_bf16 v[112:115], a[248:251], a[36:39], v[112:115]
    v_mfma_f32_16x16x32_bf16 v[112:115], a[252:255], a[100:103], v[112:115]
    s_add_u32 s39, s39, 9216
    ds_read_b64_tr_b16 a[244:245], v6 offset:49408
    v_mfma_f32_16x16x32_bf16 v[120:123], a[252:255], a[108:111], v[120:123]
    ds_read_b64_tr_b16 a[246:247], v6 offset:50944
    v_mfma_f32_16x16x32_bf16 v[120:123], a[248:251], a[104:107], v[120:123]
    s_waitcnt vmcnt(14)
    ds_read_b128 a[224:227], v12 offset:49152
    v_mfma_f32_16x16x32_bf16 v[128:131], a[248:251], a[112:115], v[128:131]
    buffer_load_dwordx4 v1, s[8:11], s39 offen offset:1024 lds
    v_mfma_f32_16x16x32_bf16 v[128:131], a[252:255], a[116:119], v[128:131]
    s_waitcnt lgkmcnt(7)
    v_mfma_f32_16x16x32_bf16 v[132:135], a[16:19], a[116:119], v[132:135]
    s_mov_b32 s88, 52224
    ds_read_b64_tr_b16 a[248:249], v6 offset:37096
    v_mfma_f32_16x16x32_bf16 v[132:135], a[12:15], a[112:115], v[132:135]
    ds_read_b64_tr_b16 a[250:251], v6 offset:38632
    v_mfma_f32_16x16x32_bf16 v[124:127], a[12:15], a[104:107], v[124:127]
    ds_read_b128 a[40:43], v13 offset:49152
    v_mfma_f32_16x16x32_bf16 v[124:127], a[16:19], a[108:111], v[124:127]
    buffer_store_dwordx4 a[204:207], v0, s[24:27], s88 offen sc1
    v_mfma_f32_16x16x32_bf16 v[116:119], a[16:19], a[100:103], v[116:119]
    v_mfma_f32_16x16x32_bf16 v[116:119], a[12:15], a[36:39], v[116:119]
    s_add_u32 m0, s38, 16384
    ds_read_b64_tr_b16 a[252:253], v6 offset:49416
    v_mfma_f32_16x16x32_bf16 v[108:111], a[12:15], a[28:31], v[108:111]
    s_add_u32 s39, s58, 81920
    ds_read_b64_tr_b16 a[254:255], v6 offset:50952
    v_mfma_f32_16x16x32_bf16 v[108:111], a[16:19], a[32:35], v[108:111]
    v_mfma_f32_16x16x32_bf16 v[100:103], a[16:19], a[24:27], v[100:103]
    buffer_load_dwordx4 v1, s[8:11], s39 offen lds
    v_mfma_f32_16x16x32_bf16 v[100:103], a[12:15], a[20:23], v[100:103]
    s_waitcnt lgkmcnt(6)
    v_mfma_f32_16x16x32_bf16 v[136:139], a[240:243], a[20:23], v[136:139]
    s_add_u32 s39, s39, 9216
    ds_read_b64_tr_b16 a[12:13], v5 offset:37216
    v_mfma_f32_16x16x32_bf16 v[136:139], a[244:247], a[24:27], v[136:139]
    ds_read_b64_tr_b16 a[14:15], v5 offset:38752
    v_mfma_f32_16x16x32_bf16 v[144:147], a[244:247], a[32:35], v[144:147]
    s_waitcnt vmcnt(14)
    ds_read_b128 a[44:47], v12 offset:57344
    v_mfma_f32_16x16x32_bf16 v[144:147], a[240:243], a[28:31], v[144:147]
    buffer_load_dwordx4 v1, s[8:11], s39 offen offset:1024 lds
    v_mfma_f32_16x16x32_bf16 v[152:155], a[240:243], a[36:39], v[152:155]
    v_mfma_f32_16x16x32_bf16 v[152:155], a[244:247], a[100:103], v[152:155]
    s_add_u32 m0, s38, 24576
    ds_read_b64_tr_b16 a[16:17], v5 offset:49536
    v_mfma_f32_16x16x32_bf16 v[160:163], a[244:247], a[108:111], v[160:163]
    s_add_u32 s39, s59, s0
    ds_read_b64_tr_b16 a[18:19], v5 offset:51072
    v_mfma_f32_16x16x32_bf16 v[160:163], a[240:243], a[104:107], v[160:163]
    ds_read_b128 a[48:51], v13 offset:57344
    v_mfma_f32_16x16x32_bf16 v[168:171], a[240:243], a[112:115], v[168:171]
    buffer_load_dwordx4 v1, s[8:11], s39 offen lds
    v_mfma_f32_16x16x32_bf16 v[168:171], a[244:247], a[116:119], v[168:171]
    s_waitcnt lgkmcnt(6)
    v_mfma_f32_16x16x32_bf16 v[172:175], a[252:255], a[116:119], v[172:175]
    s_add_u32 s39, s39, 9216
    ds_read_b64_tr_b16 a[240:241], v5 offset:37224
    v_mfma_f32_16x16x32_bf16 v[172:175], a[248:251], a[112:115], v[172:175]
    ds_read_b64_tr_b16 a[242:243], v5 offset:38760
    v_mfma_f32_16x16x32_bf16 v[164:167], a[248:251], a[104:107], v[164:167]
    v_mfma_f32_16x16x32_bf16 v[164:167], a[252:255], a[108:111], v[164:167]
    buffer_load_dwordx4 v1, s[8:11], s39 offen offset:1024 lds
    v_mfma_f32_16x16x32_bf16 v[156:159], a[252:255], a[100:103], v[156:159]
    v_mfma_f32_16x16x32_bf16 v[156:159], a[248:251], a[36:39], v[156:159]
    s_mov_b32 s88, 53248
    ds_read_b64_tr_b16 a[244:245], v5 offset:49544
    v_mfma_f32_16x16x32_bf16 v[148:151], a[248:251], a[28:31], v[148:151]
    ds_read_b64_tr_b16 a[246:247], v5 offset:51080
    v_mfma_f32_16x16x32_bf16 v[148:151], a[252:255], a[32:35], v[148:151]
    v_mfma_f32_16x16x32_bf16 v[140:143], a[252:255], a[24:27], v[140:143]
    buffer_store_dwordx4 a[208:211], v0, s[24:27], s88 offen sc1
    v_mfma_f32_16x16x32_bf16 v[140:143], a[248:251], a[20:23], v[140:143]
    s_waitcnt lgkmcnt(5)
    v_mfma_f32_16x16x32_bf16 v[176:179], a[12:15], a[20:23], v[176:179]
    s_add_u32 m0, s38, 32768
    ds_read_b64_tr_b16 a[248:249], v6 offset:37216
    v_mfma_f32_16x16x32_bf16 v[176:179], a[16:19], a[24:27], v[176:179]
    s_add_u32 s39, s59, s1
    ds_read_b64_tr_b16 a[250:251], v6 offset:38752
    v_mfma_f32_16x16x32_bf16 v[184:187], a[16:19], a[32:35], v[184:187]
    v_mfma_f32_16x16x32_bf16 v[184:187], a[12:15], a[28:31], v[184:187]
    buffer_load_dwordx4 v1, s[8:11], s39 offen lds
    v_mfma_f32_16x16x32_bf16 v[192:195], a[12:15], a[36:39], v[192:195]
    v_mfma_f32_16x16x32_bf16 v[192:195], a[16:19], a[100:103], v[192:195]
    s_add_u32 s39, s39, 9216
    ds_read_b64_tr_b16 a[252:253], v6 offset:49536
    v_mfma_f32_16x16x32_bf16 v[200:203], a[16:19], a[108:111], v[200:203]
    ds_read_b64_tr_b16 a[254:255], v6 offset:51072
    v_mfma_f32_16x16x32_bf16 v[200:203], a[12:15], a[104:107], v[200:203]
    v_mfma_f32_16x16x32_bf16 v[208:211], a[12:15], a[112:115], v[208:211]
    buffer_load_dwordx4 v1, s[8:11], s39 offen offset:1024 lds
    v_mfma_f32_16x16x32_bf16 v[208:211], a[16:19], a[116:119], v[208:211]
    s_waitcnt lgkmcnt(4)
    v_mfma_f32_16x16x32_bf16 v[212:215], a[244:247], a[116:119], v[212:215]
    s_add_u32 m0, s38, 40960
    ds_read_b64_tr_b16 a[12:13], v6 offset:37224
    v_mfma_f32_16x16x32_bf16 v[212:215], a[240:243], a[112:115], v[212:215]
    s_add_u32 s39, s59, s63
    ds_read_b64_tr_b16 a[14:15], v6 offset:38760
    v_mfma_f32_16x16x32_bf16 v[204:207], a[240:243], a[104:107], v[204:207]
    v_mfma_f32_16x16x32_bf16 v[204:207], a[244:247], a[108:111], v[204:207]
    buffer_load_dwordx4 v1, s[8:11], s39 offen lds
    v_mfma_f32_16x16x32_bf16 v[196:199], a[244:247], a[100:103], v[196:199]
    v_mfma_f32_16x16x32_bf16 v[196:199], a[240:243], a[36:39], v[196:199]
    s_add_u32 s39, s39, 9216
    ds_read_b64_tr_b16 a[16:17], v6 offset:49544
    v_mfma_f32_16x16x32_bf16 v[188:191], a[240:243], a[28:31], v[188:191]
    ds_read_b64_tr_b16 a[18:19], v6 offset:51080
    v_mfma_f32_16x16x32_bf16 v[188:191], a[244:247], a[32:35], v[188:191]
    v_mfma_f32_16x16x32_bf16 v[180:183], a[244:247], a[24:27], v[180:183]
    buffer_load_dwordx4 v1, s[8:11], s39 offen offset:1024 lds
    v_mfma_f32_16x16x32_bf16 v[180:183], a[240:243], a[20:23], v[180:183]
    s_waitcnt lgkmcnt(4)
    s_waitcnt vmcnt(19)
    s_barrier
    v_mfma_f32_16x16x32_bf16 v[216:219], a[248:251], a[20:23], v[216:219]
    s_mov_b32 s88, 54272
    ds_read_b64_tr_b16 a[240:241], v5 offset:0
    v_mfma_f32_16x16x32_bf16 v[216:219], a[252:255], a[24:27], v[216:219]
    ds_read_b64_tr_b16 a[242:243], v5 offset:1536
    v_mfma_f32_16x16x32_bf16 v[224:227], a[252:255], a[32:35], v[224:227]
    v_mfma_f32_16x16x32_bf16 v[224:227], a[248:251], a[28:31], v[224:227]
    buffer_store_dwordx4 a[212:215], v0, s[24:27], s88 offen sc1
    v_mfma_f32_16x16x32_bf16 v[232:235], a[248:251], a[36:39], v[232:235]
    v_mfma_f32_16x16x32_bf16 v[232:235], a[252:255], a[100:103], v[232:235]
    s_add_u32 m0, s38, 49152
    ds_read_b64_tr_b16 a[244:245], v5 offset:12320
    v_mfma_f32_16x16x32_bf16 v[240:243], a[252:255], a[108:111], v[240:243]
    s_add_u32 s39, s59, s87
    ds_read_b64_tr_b16 a[246:247], v5 offset:13856
    v_mfma_f32_16x16x32_bf16 v[240:243], a[248:251], a[104:107], v[240:243]
    v_mfma_f32_16x16x32_bf16 v[248:251], a[248:251], a[112:115], v[248:251]
    buffer_load_dwordx4 v1, s[8:11], s39 offen lds
    v_mfma_f32_16x16x32_bf16 v[248:251], a[252:255], a[116:119], v[248:251]
    s_waitcnt lgkmcnt(4)
    s_barrier
    v_mfma_f32_16x16x32_bf16 v[252:255], a[16:19], a[116:119], v[252:255]
    s_add_u32 s39, s39, 9216
    ds_read_b64_tr_b16 a[248:249], v5 offset:8
    v_mfma_f32_16x16x32_bf16 v[252:255], a[12:15], a[112:115], v[252:255]
    ds_read_b64_tr_b16 a[250:251], v5 offset:1544
    v_mfma_f32_16x16x32_bf16 v[244:247], a[12:15], a[104:107], v[244:247]
    s_waitcnt vmcnt(14)
    ds_read_b128 a[52:55], v12 offset:0
    v_mfma_f32_16x16x32_bf16 v[244:247], a[16:19], a[108:111], v[244:247]
    buffer_load_dwordx4 v1, s[8:11], s39 offen offset:1024 lds
    v_mfma_f32_16x16x32_bf16 v[236:239], a[16:19], a[100:103], v[236:239]
    v_mfma_f32_16x16x32_bf16 v[236:239], a[12:15], a[36:39], v[236:239]
    s_add_u32 m0, s31, 36960
    ds_read_b64_tr_b16 a[252:253], v5 offset:12328
    v_mfma_f32_16x16x32_bf16 v[228:231], a[12:15], a[28:31], v[228:231]
    s_add_u32 s32, s32, 393216
    ds_read_b64_tr_b16 a[254:255], v5 offset:13864
    v_mfma_f32_16x16x32_bf16 v[228:231], a[16:19], a[32:35], v[228:231]
    ds_read_b128 a[60:63], v13 offset:0
    v_mfma_f32_16x16x32_bf16 v[220:223], a[16:19], a[24:27], v[220:223]
    buffer_load_dwordx4 v2, s[12:15], s32 offen lds
    v_mfma_f32_16x16x32_bf16 v[220:223], a[12:15], a[20:23], v[220:223]
    s_waitcnt lgkmcnt(6)
    v_mfma_f32_16x16x32_bf16 v[16:19], a[240:243], a[184:187], v[16:19]
    ds_read_b64_tr_b16 a[12:13], v6 offset:0
    v_mfma_f32_16x16x32_bf16 v[16:19], a[244:247], a[96:99], v[16:19]
    ds_read_b64_tr_b16 a[14:15], v6 offset:1536
    v_mfma_f32_16x16x32_bf16 v[24:27], a[244:247], a[188:191], v[24:27]
    s_waitcnt vmcnt(14)
    ds_read_b128 a[64:67], v12 offset:8192
    v_mfma_f32_16x16x32_bf16 v[24:27], a[240:243], a[120:123], v[24:27]
    buffer_load_dwordx4 v3, s[12:15], s32 offen offset:1024 lds
    v_mfma_f32_16x16x32_bf16 v[32:35], a[240:243], a[124:127], v[32:35]
    v_mfma_f32_16x16x32_bf16 v[32:35], a[244:247], a[192:195], v[32:35]
    ds_read_b64_tr_b16 a[16:17], v6 offset:12320
    v_mfma_f32_16x16x32_bf16 v[40:43], a[244:247], a[128:131], v[40:43]
    ds_read_b64_tr_b16 a[18:19], v6 offset:13856
    v_mfma_f32_16x16x32_bf16 v[40:43], a[240:243], a[196:199], v[40:43]
    ds_read_b128 a[68:71], v13 offset:8192
    v_mfma_f32_16x16x32_bf16 v[48:51], a[240:243], a[220:223], v[48:51]
    buffer_load_dwordx4 v4, s[12:15], s32 offen offset:2048 lds
    v_mfma_f32_16x16x32_bf16 v[48:51], a[244:247], a[132:135], v[48:51]
    s_waitcnt lgkmcnt(7)
    v_mfma_f32_16x16x32_bf16 v[52:55], a[252:255], a[132:135], v[52:55]
    s_mov_b32 s88, 55296
    ds_read_b64_tr_b16 a[240:241], v6 offset:8
    v_mfma_f32_16x16x32_bf16 v[52:55], a[248:251], a[220:223], v[52:55]
    ds_read_b64_tr_b16 a[242:243], v6 offset:1544
    v_mfma_f32_16x16x32_bf16 v[44:47], a[248:251], a[196:199], v[44:47]
    v_mfma_f32_16x16x32_bf16 v[44:47], a[252:255], a[128:131], v[44:47]
    buffer_store_dwordx4 a[216:219], v0, s[24:27], s88 offen sc1
    v_mfma_f32_16x16x32_bf16 v[36:39], a[252:255], a[192:195], v[36:39]
    v_mfma_f32_16x16x32_bf16 v[36:39], a[248:251], a[124:127], v[36:39]
    s_add_u32 m0, s31, 49280
    ds_read_b64_tr_b16 a[244:245], v6 offset:12328
    v_mfma_f32_16x16x32_bf16 v[28:31], a[248:251], a[120:123], v[28:31]
    s_mul_i32 s32, s59, 6144
    ds_read_b64_tr_b16 a[246:247], v6 offset:13864
    v_mfma_f32_16x16x32_bf16 v[28:31], a[252:255], a[188:191], v[28:31]
    s_waitcnt vmcnt(14)
    ds_read_b128 a[72:75], v12 offset:16384
    v_mfma_f32_16x16x32_bf16 v[20:23], a[252:255], a[96:99], v[20:23]
    buffer_load_dwordx4 v2, s[12:15], s32 offen lds
    v_mfma_f32_16x16x32_bf16 v[20:23], a[248:251], a[184:187], v[20:23]
    s_waitcnt lgkmcnt(6)
    v_mfma_f32_16x16x32_bf16 v[56:59], a[12:15], a[184:187], v[56:59]
    ds_read_b64_tr_b16 a[248:249], v5 offset:128
    v_mfma_f32_16x16x32_bf16 v[56:59], a[16:19], a[96:99], v[56:59]
    ds_read_b64_tr_b16 a[250:251], v5 offset:1664
    v_mfma_f32_16x16x32_bf16 v[64:67], a[16:19], a[188:191], v[64:67]
    ds_read_b128 a[76:79], v13 offset:16384
    v_mfma_f32_16x16x32_bf16 v[64:67], a[12:15], a[120:123], v[64:67]
    buffer_load_dwordx4 v3, s[12:15], s32 offen offset:1024 lds
    v_mfma_f32_16x16x32_bf16 v[72:75], a[12:15], a[124:127], v[72:75]
    v_mfma_f32_16x16x32_bf16 v[72:75], a[16:19], a[192:195], v[72:75]
    ds_read_b64_tr_b16 a[252:253], v5 offset:12448
    v_mfma_f32_16x16x32_bf16 v[80:83], a[16:19], a[128:131], v[80:83]
    ds_read_b64_tr_b16 a[254:255], v5 offset:13984
    v_mfma_f32_16x16x32_bf16 v[80:83], a[12:15], a[196:199], v[80:83]
    s_waitcnt vmcnt(14)
    ds_read_b128 a[140:143], v12 offset:24576
    v_mfma_f32_16x16x32_bf16 v[88:91], a[12:15], a[220:223], v[88:91]
    buffer_load_dwordx4 v4, s[12:15], s32 offen offset:2048 lds
    v_mfma_f32_16x16x32_bf16 v[88:91], a[16:19], a[132:135], v[88:91]
    s_waitcnt lgkmcnt(7)
    v_mfma_f32_16x16x32_bf16 v[92:95], a[244:247], a[132:135], v[92:95]
    s_add_u32 m0, s38, 57344
    ds_read_b64_tr_b16 a[12:13], v5 offset:136
    v_mfma_f32_16x16x32_bf16 v[92:95], a[240:243], a[220:223], v[92:95]
    s_add_u32 s39, s59, 81920
    ds_read_b64_tr_b16 a[14:15], v5 offset:1672
    v_mfma_f32_16x16x32_bf16 v[84:87], a[240:243], a[196:199], v[84:87]
    ds_read_b128 a[228:231], v13 offset:24576
    v_mfma_f32_16x16x32_bf16 v[84:87], a[244:247], a[128:131], v[84:87]
    buffer_load_dwordx4 v1, s[8:11], s39 offen lds
    v_mfma_f32_16x16x32_bf16 v[76:79], a[244:247], a[192:195], v[76:79]
    v_mfma_f32_16x16x32_bf16 v[76:79], a[240:243], a[124:127], v[76:79]
    s_add_u32 s39, s39, 9216
    ds_read_b64_tr_b16 a[16:17], v5 offset:12456
    v_mfma_f32_16x16x32_bf16 v[68:71], a[240:243], a[120:123], v[68:71]
    ds_read_b64_tr_b16 a[18:19], v5 offset:13992
    v_mfma_f32_16x16x32_bf16 v[68:71], a[244:247], a[188:191], v[68:71]
    v_mfma_f32_16x16x32_bf16 v[60:63], a[244:247], a[96:99], v[60:63]
    buffer_load_dwordx4 v1, s[8:11], s39 offen offset:1024 lds
    v_mfma_f32_16x16x32_bf16 v[60:63], a[240:243], a[184:187], v[60:63]
    s_waitcnt lgkmcnt(6)
    v_mfma_f32_16x16x32_bf16 v[96:99], a[248:251], a[184:187], v[96:99]
    s_add_u32 m0, s38, 0
    ds_read_b64_tr_b16 a[240:241], v6 offset:128
    v_mfma_f32_16x16x32_bf16 v[96:99], a[252:255], a[96:99], v[96:99]
    s_add_u32 s39, s60, s0
    ds_read_b64_tr_b16 a[242:243], v6 offset:1664
    v_mfma_f32_16x16x32_bf16 v[104:107], a[252:255], a[188:191], v[104:107]
    s_waitcnt vmcnt(14)
    ds_read_b128 a[136:139], v12 offset:32768
    v_mfma_f32_16x16x32_bf16 v[104:107], a[248:251], a[120:123], v[104:107]
    buffer_load_dwordx4 v1, s[8:11], s39 offen lds
    v_mfma_f32_16x16x32_bf16 v[112:115], a[248:251], a[124:127], v[112:115]
    v_mfma_f32_16x16x32_bf16 v[112:115], a[252:255], a[192:195], v[112:115]
    s_add_u32 s39, s39, 9216
    ds_read_b64_tr_b16 a[244:245], v6 offset:12448
    v_mfma_f32_16x16x32_bf16 v[120:123], a[252:255], a[128:131], v[120:123]
    ds_read_b64_tr_b16 a[246:247], v6 offset:13984
    v_mfma_f32_16x16x32_bf16 v[120:123], a[248:251], a[196:199], v[120:123]
    ds_read_b128 a[160:163], v13 offset:32768
    v_mfma_f32_16x16x32_bf16 v[128:131], a[248:251], a[220:223], v[128:131]
    buffer_load_dwordx4 v1, s[8:11], s39 offen offset:1024 lds
    v_mfma_f32_16x16x32_bf16 v[128:131], a[252:255], a[132:135], v[128:131]
    s_waitcnt lgkmcnt(6)
    v_mfma_f32_16x16x32_bf16 v[132:135], a[16:19], a[132:135], v[132:135]
    s_add_u32 m0, s38, 8192
    ds_read_b64_tr_b16 a[248:249], v6 offset:136
    v_mfma_f32_16x16x32_bf16 v[132:135], a[12:15], a[220:223], v[132:135]
    s_add_u32 s39, s60, s1
    ds_read_b64_tr_b16 a[250:251], v6 offset:1672
    v_mfma_f32_16x16x32_bf16 v[124:127], a[12:15], a[196:199], v[124:127]
    s_waitcnt vmcnt(14)
    ds_read_b128 a[232:235], v12 offset:40960
    v_mfma_f32_16x16x32_bf16 v[124:127], a[16:19], a[128:131], v[124:127]
    buffer_load_dwordx4 v1, s[8:11], s39 offen lds
    v_mfma_f32_16x16x32_bf16 v[116:119], a[16:19], a[192:195], v[116:119]
    v_mfma_f32_16x16x32_bf16 v[116:119], a[12:15], a[124:127], v[116:119]
    s_add_u32 s39, s39, 9216
    ds_read_b64_tr_b16 a[252:253], v6 offset:12456
    v_mfma_f32_16x16x32_bf16 v[108:111], a[12:15], a[120:123], v[108:111]
    ds_read_b64_tr_b16 a[254:255], v6 offset:13992
    v_mfma_f32_16x16x32_bf16 v[108:111], a[16:19], a[188:191], v[108:111]
    ds_read_b128 a[164:167], v13 offset:40960
    v_mfma_f32_16x16x32_bf16 v[100:103], a[16:19], a[96:99], v[100:103]
    buffer_load_dwordx4 v1, s[8:11], s39 offen offset:1024 lds
    v_mfma_f32_16x16x32_bf16 v[100:103], a[12:15], a[184:187], v[100:103]
    s_waitcnt lgkmcnt(7)
    v_mfma_f32_16x16x32_bf16 v[136:139], a[240:243], a[184:187], v[136:139]
    s_add_u32 m0, s38, 16384
    ds_read_b64_tr_b16 a[12:13], v5 offset:256
    v_mfma_f32_16x16x32_bf16 v[136:139], a[244:247], a[96:99], v[136:139]
    s_add_u32 s39, s60, s63
    ds_read_b64_tr_b16 a[14:15], v5 offset:1792
    v_mfma_f32_16x16x32_bf16 v[144:147], a[244:247], a[188:191], v[144:147]
    v_mfma_f32_16x16x32_bf16 v[144:147], a[240:243], a[120:123], v[144:147]
    buffer_load_dwordx4 v1, s[8:11], s39 offen lds
    v_mfma_f32_16x16x32_bf16 v[152:155], a[240:243], a[124:127], v[152:155]
    v_mfma_f32_16x16x32_bf16 v[152:155], a[244:247], a[192:195], v[152:155]
    s_add_u32 s39, s39, 9216
    ds_read_b64_tr_b16 a[16:17], v5 offset:12576
    v_mfma_f32_16x16x32_bf16 v[160:163], a[244:247], a[128:131], v[160:163]
    ds_read_b64_tr_b16 a[18:19], v5 offset:14112
    v_mfma_f32_16x16x32_bf16 v[160:163], a[240:243], a[196:199], v[160:163]
    s_waitcnt vmcnt(14)
    ds_read_b128 a[236:239], v12 offset:49152
    v_mfma_f32_16x16x32_bf16 v[168:171], a[240:243], a[220:223], v[168:171]
    buffer_load_dwordx4 v1, s[8:11], s39 offen offset:1024 lds
    v_mfma_f32_16x16x32_bf16 v[168:171], a[244:247], a[132:135], v[168:171]
    s_waitcnt lgkmcnt(6)
    v_mfma_f32_16x16x32_bf16 v[172:175], a[252:255], a[132:135], v[172:175]
    s_add_u32 m0, s38, 24576
    ds_read_b64_tr_b16 a[240:241], v5 offset:264
    v_mfma_f32_16x16x32_bf16 v[172:175], a[248:251], a[220:223], v[172:175]
    s_add_u32 s39, s60, s87
    ds_read_b64_tr_b16 a[242:243], v5 offset:1800
    v_mfma_f32_16x16x32_bf16 v[164:167], a[248:251], a[196:199], v[164:167]
    ds_read_b128 a[0:3], v13 offset:49152
    v_mfma_f32_16x16x32_bf16 v[164:167], a[252:255], a[128:131], v[164:167]
    buffer_load_dwordx4 v1, s[8:11], s39 offen lds
    v_mfma_f32_16x16x32_bf16 v[156:159], a[252:255], a[192:195], v[156:159]
    v_mfma_f32_16x16x32_bf16 v[156:159], a[248:251], a[124:127], v[156:159]
    s_add_u32 s39, s39, 9216
    ds_read_b64_tr_b16 a[244:245], v5 offset:12584
    v_mfma_f32_16x16x32_bf16 v[148:151], a[248:251], a[120:123], v[148:151]
    ds_read_b64_tr_b16 a[246:247], v5 offset:14120
    v_mfma_f32_16x16x32_bf16 v[148:151], a[252:255], a[188:191], v[148:151]
    v_mfma_f32_16x16x32_bf16 v[140:143], a[252:255], a[96:99], v[140:143]
    buffer_load_dwordx4 v1, s[8:11], s39 offen offset:1024 lds
    v_mfma_f32_16x16x32_bf16 v[140:143], a[248:251], a[184:187], v[140:143]
    s_waitcnt lgkmcnt(6)
    v_mfma_f32_16x16x32_bf16 v[176:179], a[12:15], a[184:187], v[176:179]
    s_add_u32 m0, s38, 32768
    ds_read_b64_tr_b16 a[248:249], v6 offset:256
    v_mfma_f32_16x16x32_bf16 v[176:179], a[16:19], a[96:99], v[176:179]
    s_add_u32 s39, s60, 81920
    ds_read_b64_tr_b16 a[250:251], v6 offset:1792
    v_mfma_f32_16x16x32_bf16 v[184:187], a[16:19], a[188:191], v[184:187]
    v_mfma_f32_16x16x32_bf16 v[184:187], a[12:15], a[120:123], v[184:187]
    buffer_load_dwordx4 v1, s[8:11], s39 offen lds
    v_mfma_f32_16x16x32_bf16 v[192:195], a[12:15], a[124:127], v[192:195]
    v_mfma_f32_16x16x32_bf16 v[192:195], a[16:19], a[192:195], v[192:195]
    s_add_u32 s39, s39, 9216
    ds_read_b64_tr_b16 a[252:253], v6 offset:12576
    v_mfma_f32_16x16x32_bf16 v[200:203], a[16:19], a[128:131], v[200:203]
    ds_read_b64_tr_b16 a[254:255], v6 offset:14112
    v_mfma_f32_16x16x32_bf16 v[200:203], a[12:15], a[196:199], v[200:203]
    v_mfma_f32_16x16x32_bf16 v[208:211], a[12:15], a[220:223], v[208:211]
    buffer_load_dwordx4 v1, s[8:11], s39 offen offset:1024 lds
    v_mfma_f32_16x16x32_bf16 v[208:211], a[16:19], a[132:135], v[208:211]
    s_waitcnt lgkmcnt(4)
    v_mfma_f32_16x16x32_bf16 v[212:215], a[244:247], a[132:135], v[212:215]
    s_add_u32 m0, s38, 40960
    ds_read_b64_tr_b16 a[12:13], v6 offset:264
    v_mfma_f32_16x16x32_bf16 v[212:215], a[240:243], a[220:223], v[212:215]
    s_add_u32 s39, s61, s0
    ds_read_b64_tr_b16 a[14:15], v6 offset:1800
    v_mfma_f32_16x16x32_bf16 v[204:207], a[240:243], a[196:199], v[204:207]
    v_mfma_f32_16x16x32_bf16 v[204:207], a[244:247], a[128:131], v[204:207]
    buffer_load_dwordx4 v1, s[8:11], s39 offen lds
    v_mfma_f32_16x16x32_bf16 v[196:199], a[244:247], a[192:195], v[196:199]
    v_mfma_f32_16x16x32_bf16 v[196:199], a[240:243], a[124:127], v[196:199]
    s_add_u32 s39, s39, 9216
    ds_read_b64_tr_b16 a[16:17], v6 offset:12584
    v_mfma_f32_16x16x32_bf16 v[188:191], a[240:243], a[120:123], v[188:191]
    ds_read_b64_tr_b16 a[18:19], v6 offset:14120
    v_mfma_f32_16x16x32_bf16 v[188:191], a[244:247], a[188:191], v[188:191]
    v_mfma_f32_16x16x32_bf16 v[180:183], a[244:247], a[96:99], v[180:183]
    buffer_load_dwordx4 v1, s[8:11], s39 offen offset:1024 lds
    v_mfma_f32_16x16x32_bf16 v[180:183], a[240:243], a[184:187], v[180:183]
    s_waitcnt lgkmcnt(4)
    s_waitcnt vmcnt(18)
    s_barrier
    v_mfma_f32_16x16x32_bf16 v[216:219], a[248:251], a[184:187], v[216:219]
    s_add_u32 m0, s38, 49152
    ds_read_b64_tr_b16 a[240:241], v5 offset:24640
    v_mfma_f32_16x16x32_bf16 v[216:219], a[252:255], a[96:99], v[216:219]
    s_add_u32 s39, s61, s1
    ds_read_b64_tr_b16 a[242:243], v5 offset:26176
    v_mfma_f32_16x16x32_bf16 v[224:227], a[252:255], a[188:191], v[224:227]
    v_mfma_f32_16x16x32_bf16 v[224:227], a[248:251], a[120:123], v[224:227]
    buffer_load_dwordx4 v1, s[8:11], s39 offen lds
    v_mfma_f32_16x16x32_bf16 v[232:235], a[248:251], a[124:127], v[232:235]
    v_mfma_f32_16x16x32_bf16 v[232:235], a[252:255], a[192:195], v[232:235]
    s_add_u32 s39, s39, 9216
    ds_read_b64_tr_b16 a[244:245], v5 offset:36960
    v_mfma_f32_16x16x32_bf16 v[240:243], a[252:255], a[128:131], v[240:243]
    ds_read_b64_tr_b16 a[246:247], v5 offset:38496
    v_mfma_f32_16x16x32_bf16 v[240:243], a[248:251], a[196:199], v[240:243]
    v_mfma_f32_16x16x32_bf16 v[248:251], a[248:251], a[220:223], v[248:251]
    buffer_load_dwordx4 v1, s[8:11], s39 offen offset:1024 lds
    v_mfma_f32_16x16x32_bf16 v[248:251], a[252:255], a[132:135], v[248:251]
    s_waitcnt lgkmcnt(4)
    s_barrier
    v_mfma_f32_16x16x32_bf16 v[252:255], a[16:19], a[132:135], v[252:255]
    s_add_u32 m0, s31, 0
    ds_read_b64_tr_b16 a[248:249], v5 offset:24648
    v_mfma_f32_16x16x32_bf16 v[252:255], a[12:15], a[220:223], v[252:255]
    s_add_u32 s32, s32, 393216
    ds_read_b64_tr_b16 a[250:251], v5 offset:26184
    v_mfma_f32_16x16x32_bf16 v[244:247], a[12:15], a[196:199], v[244:247]
    s_waitcnt vmcnt(14)
    ds_read_b128 a[4:7], v12 offset:57344
    v_mfma_f32_16x16x32_bf16 v[244:247], a[16:19], a[128:131], v[244:247]
    buffer_load_dwordx4 v2, s[12:15], s32 offen lds
    v_mfma_f32_16x16x32_bf16 v[236:239], a[16:19], a[192:195], v[236:239]
    v_mfma_f32_16x16x32_bf16 v[236:239], a[12:15], a[124:127], v[236:239]
    ds_read_b64_tr_b16 a[252:253], v5 offset:36968
    v_mfma_f32_16x16x32_bf16 v[228:231], a[12:15], a[120:123], v[228:231]
    ds_read_b64_tr_b16 a[254:255], v5 offset:38504
    v_mfma_f32_16x16x32_bf16 v[228:231], a[16:19], a[188:191], v[228:231]
    ds_read_b128 a[8:11], v13 offset:57344
    v_mfma_f32_16x16x32_bf16 v[220:223], a[16:19], a[96:99], v[220:223]
    buffer_load_dwordx4 v3, s[12:15], s32 offen offset:1024 lds
    v_mfma_f32_16x16x32_bf16 v[220:223], a[12:15], a[184:187], v[220:223]
    s_waitcnt lgkmcnt(6)
    v_mfma_f32_16x16x32_bf16 v[16:19], a[240:243], a[224:227], v[16:19]
    ds_read_b64_tr_b16 a[12:13], v6 offset:24640
    v_mfma_f32_16x16x32_bf16 v[16:19], a[244:247], a[40:43], v[16:19]
    ds_read_b64_tr_b16 a[14:15], v6 offset:26176
    v_mfma_f32_16x16x32_bf16 v[24:27], a[244:247], a[48:51], v[24:27]
    s_waitcnt vmcnt(14)
    ds_read_b128 a[168:171], v12 offset:0
    v_mfma_f32_16x16x32_bf16 v[24:27], a[240:243], a[44:47], v[24:27]
    buffer_load_dwordx4 v4, s[12:15], s32 offen offset:2048 lds
    v_mfma_f32_16x16x32_bf16 v[32:35], a[240:243], a[52:55], v[32:35]
    v_mfma_f32_16x16x32_bf16 v[32:35], a[244:247], a[60:63], v[32:35]
    s_add_u32 m0, s34, 0
    ds_read_b64_tr_b16 a[16:17], v6 offset:36960
    v_mfma_f32_16x16x32_bf16 v[40:43], a[244:247], a[68:71], v[40:43]
    s_mov_b32 s36, 0
    ds_read_b64_tr_b16 a[18:19], v6 offset:38496
    v_mfma_f32_16x16x32_bf16 v[40:43], a[240:243], a[64:67], v[40:43]
    ds_read_b128 a[172:175], v13 offset:0
    v_mfma_f32_16x16x32_bf16 v[48:51], a[240:243], a[72:75], v[48:51]
    buffer_load_dwordx4 v7, s[20:23], s36 offen nt lds
    v_mfma_f32_16x16x32_bf16 v[48:51], a[244:247], a[76:79], v[48:51]
    s_waitcnt lgkmcnt(7)
    v_mfma_f32_16x16x32_bf16 v[52:55], a[252:255], a[76:79], v[52:55]
    s_add_u32 m0, s34, 0
    ds_read_b64_tr_b16 a[240:241], v6 offset:24648
    v_mfma_f32_16x16x32_bf16 v[52:55], a[248:251], a[72:75], v[52:55]
    s_mov_b32 s36, 0
    ds_read_b64_tr_b16 a[242:243], v6 offset:26184
    v_mfma_f32_16x16x32_bf16 v[44:47], a[248:251], a[64:67], v[44:47]
    s_waitcnt vmcnt(14)
    ds_read_b128 a[56:59], v12 offset:8192
    v_mfma_f32_16x16x32_bf16 v[44:47], a[252:255], a[68:71], v[44:47]
    buffer_load_dwordx4 v8, s[20:23], s36 offen offset:1024 nt lds
    v_mfma_f32_16x16x32_bf16 v[36:39], a[252:255], a[60:63], v[36:39]
    v_mfma_f32_16x16x32_bf16 v[36:39], a[248:251], a[52:55], v[36:39]
    s_add_u32 m0, s34, 0
    ds_read_b64_tr_b16 a[244:245], v6 offset:36968
    v_mfma_f32_16x16x32_bf16 v[28:31], a[248:251], a[44:47], v[28:31]
    s_mov_b32 s36, 0
    ds_read_b64_tr_b16 a[246:247], v6 offset:38504
    v_mfma_f32_16x16x32_bf16 v[28:31], a[252:255], a[48:51], v[28:31]
    ds_read_b128 a[80:83], v13 offset:8192
    v_mfma_f32_16x16x32_bf16 v[20:23], a[252:255], a[40:43], v[20:23]
    buffer_load_dwordx4 v9, s[20:23], s36 offen offset:2048 nt lds
    v_mfma_f32_16x16x32_bf16 v[20:23], a[248:251], a[224:227], v[20:23]
    s_waitcnt lgkmcnt(7)
    v_mfma_f32_16x16x32_bf16 v[56:59], a[12:15], a[224:227], v[56:59]
    s_add_u32 m0, s34, 3072
    ds_read_b64_tr_b16 a[248:249], v5 offset:24768
    v_mfma_f32_16x16x32_bf16 v[56:59], a[16:19], a[40:43], v[56:59]
    s_mov_b32 s36, 3072
    ds_read_b64_tr_b16 a[250:251], v5 offset:26304
    v_mfma_f32_16x16x32_bf16 v[64:67], a[16:19], a[48:51], v[64:67]
    s_waitcnt vmcnt(14)
    ds_read_b128 a[84:87], v12 offset:16384
    v_mfma_f32_16x16x32_bf16 v[64:67], a[12:15], a[44:47], v[64:67]
    buffer_load_dwordx4 v7, s[20:23], s36 offen nt lds
    v_mfma_f32_16x16x32_bf16 v[72:75], a[12:15], a[52:55], v[72:75]
    v_mfma_f32_16x16x32_bf16 v[72:75], a[16:19], a[60:63], v[72:75]
    s_add_u32 m0, s34, 3072
    ds_read_b64_tr_b16 a[252:253], v5 offset:37088
    v_mfma_f32_16x16x32_bf16 v[80:83], a[16:19], a[68:71], v[80:83]
    s_mov_b32 s36, 3072
    ds_read_b64_tr_b16 a[254:255], v5 offset:38624
    v_mfma_f32_16x16x32_bf16 v[80:83], a[12:15], a[64:67], v[80:83]
    ds_read_b128 a[88:91], v13 offset:16384
    v_mfma_f32_16x16x32_bf16 v[88:91], a[12:15], a[72:75], v[88:91]
    buffer_load_dwordx4 v8, s[20:23], s36 offen offset:1024 nt lds
    v_mfma_f32_16x16x32_bf16 v[88:91], a[16:19], a[76:79], v[88:91]
    s_waitcnt lgkmcnt(7)
    v_mfma_f32_16x16x32_bf16 v[92:95], a[244:247], a[76:79], v[92:95]
    s_add_u32 m0, s34, 3072
    ds_read_b64_tr_b16 a[12:13], v5 offset:24776
    v_mfma_f32_16x16x32_bf16 v[92:95], a[240:243], a[72:75], v[92:95]
    s_mov_b32 s36, 3072
    ds_read_b64_tr_b16 a[14:15], v5 offset:26312
    v_mfma_f32_16x16x32_bf16 v[84:87], a[240:243], a[64:67], v[84:87]
    s_waitcnt vmcnt(14)
    ds_read_b128 a[92:95], v12 offset:24576
    v_mfma_f32_16x16x32_bf16 v[84:87], a[244:247], a[68:71], v[84:87]
    buffer_load_dwordx4 v9, s[20:23], s36 offen offset:2048 nt lds
    v_mfma_f32_16x16x32_bf16 v[76:79], a[244:247], a[60:63], v[76:79]
    v_mfma_f32_16x16x32_bf16 v[76:79], a[240:243], a[52:55], v[76:79]
    s_add_u32 m0, s31, 12320
    ds_read_b64_tr_b16 a[16:17], v5 offset:37096
    v_mfma_f32_16x16x32_bf16 v[68:71], a[240:243], a[44:47], v[68:71]
    s_mul_i32 s32, s60, 6144
    ds_read_b64_tr_b16 a[18:19], v5 offset:38632
    v_mfma_f32_16x16x32_bf16 v[68:71], a[244:247], a[48:51], v[68:71]
    ds_read_b128 a[144:147], v13 offset:24576
    v_mfma_f32_16x16x32_bf16 v[60:63], a[244:247], a[40:43], v[60:63]
    buffer_load_dwordx4 v2, s[12:15], s32 offen lds
    v_mfma_f32_16x16x32_bf16 v[60:63], a[240:243], a[224:227], v[60:63]
    s_waitcnt lgkmcnt(7)
    v_mfma_f32_16x16x32_bf16 v[96:99], a[248:251], a[224:227], v[96:99]
    ds_read_b64_tr_b16 a[240:241], v6 offset:24768
    v_mfma_f32_16x16x32_bf16 v[96:99], a[252:255], a[40:43], v[96:99]
    ds_read_b64_tr_b16 a[242:243], v6 offset:26304
    v_mfma_f32_16x16x32_bf16 v[104:107], a[252:255], a[48:51], v[104:107]
    s_waitcnt vmcnt(14)
    ds_read_b128 a[148:151], v12 offset:32768
    v_mfma_f32_16x16x32_bf16 v[104:107], a[248:251], a[44:47], v[104:107]
    buffer_load_dwordx4 v3, s[12:15], s32 offen offset:1024 lds
    v_mfma_f32_16x16x32_bf16 v[112:115], a[248:251], a[52:55], v[112:115]
    v_mfma_f32_16x16x32_bf16 v[112:115], a[252:255], a[60:63], v[112:115]
    ds_read_b64_tr_b16 a[244:245], v6 offset:37088
    v_mfma_f32_16x16x32_bf16 v[120:123], a[252:255], a[68:71], v[120:123]
    ds_read_b64_tr_b16 a[246:247], v6 offset:38624
    v_mfma_f32_16x16x32_bf16 v[120:123], a[248:251], a[64:67], v[120:123]
    ds_read_b128 a[152:155], v13 offset:32768
    v_mfma_f32_16x16x32_bf16 v[128:131], a[248:251], a[72:75], v[128:131]
    buffer_load_dwordx4 v4, s[12:15], s32 offen offset:2048 lds
    v_mfma_f32_16x16x32_bf16 v[128:131], a[252:255], a[76:79], v[128:131]
    s_waitcnt lgkmcnt(7)
    v_mfma_f32_16x16x32_bf16 v[132:135], a[16:19], a[76:79], v[132:135]
    s_add_u32 m0, s38, 57344
    ds_read_b64_tr_b16 a[248:249], v6 offset:24776
    v_mfma_f32_16x16x32_bf16 v[132:135], a[12:15], a[72:75], v[132:135]
    s_add_u32 s39, s61, s63
    ds_read_b64_tr_b16 a[250:251], v6 offset:26312
    v_mfma_f32_16x16x32_bf16 v[124:127], a[12:15], a[64:67], v[124:127]
    s_waitcnt vmcnt(14)
    ds_read_b128 a[156:159], v12 offset:40960
    v_mfma_f32_16x16x32_bf16 v[124:127], a[16:19], a[68:71], v[124:127]
    buffer_load_dwordx4 v1, s[8:11], s39 offen lds
    v_mfma_f32_16x16x32_bf16 v[116:119], a[16:19], a[60:63], v[116:119]
    v_mfma_f32_16x16x32_bf16 v[116:119], a[12:15], a[52:55], v[116:119]
    s_add_u32 s39, s39, 9216
    ds_read_b64_tr_b16 a[252:253], v6 offset:37096
    v_mfma_f32_16x16x32_bf16 v[108:111], a[12:15], a[44:47], v[108:111]
    ds_read_b64_tr_b16 a[254:255], v6 offset:38632
    v_mfma_f32_16x16x32_bf16 v[108:111], a[16:19], a[48:51], v[108:111]
    ds_read_b128 a[180:183], v13 offset:40960
    v_mfma_f32_16x16x32_bf16 v[100:103], a[16:19], a[40:43], v[100:103]
    buffer_load_dwordx4 v1, s[8:11], s39 offen offset:1024 lds
    v_mfma_f32_16x16x32_bf16 v[100:103], a[12:15], a[224:227], v[100:103]
    s_waitcnt lgkmcnt(7)
    v_mfma_f32_16x16x32_bf16 v[136:139], a[240:243], a[224:227], v[136:139]
    s_add_u32 m0, s38, 0
    ds_read_b64_tr_b16 a[12:13], v5 offset:24896
    v_mfma_f32_16x16x32_bf16 v[136:139], a[244:247], a[40:43], v[136:139]
    s_add_u32 s39, s61, s87
    ds_read_b64_tr_b16 a[14:15], v5 offset:26432
    v_mfma_f32_16x16x32_bf16 v[144:147], a[244:247], a[48:51], v[144:147]
    s_waitcnt vmcnt(14)
    ds_read_b128 a[176:179], v12 offset:49152
    v_mfma_f32_16x16x32_bf16 v[144:147], a[240:243], a[44:47], v[144:147]
    buffer_load_dwordx4 v1, s[8:11], s39 offen lds
    v_mfma_f32_16x16x32_bf16 v[152:155], a[240:243], a[52:55], v[152:155]
    v_mfma_f32_16x16x32_bf16 v[152:155], a[244:247], a[60:63], v[152:155]
    s_add_u32 s39, s39, 9216
    ds_read_b64_tr_b16 a[16:17], v5 offset:37216
    v_mfma_f32_16x16x32_bf16 v[160:163], a[244:247], a[68:71], v[160:163]
    ds_read_b64_tr_b16 a[18:19], v5 offset:38752
    v_mfma_f32_16x16x32_bf16 v[160:163], a[240:243], a[64:67], v[160:163]
    ds_read_b128 a[200:203], v13 offset:49152
    v_mfma_f32_16x16x32_bf16 v[168:171], a[240:243], a[72:75], v[168:171]
    buffer_load_dwordx4 v1, s[8:11], s39 offen offset:1024 lds
    v_mfma_f32_16x16x32_bf16 v[168:171], a[244:247], a[76:79], v[168:171]
    s_waitcnt lgkmcnt(7)
    v_mfma_f32_16x16x32_bf16 v[172:175], a[252:255], a[76:79], v[172:175]
    s_add_u32 m0, s38, 8192
    ds_read_b64_tr_b16 a[240:241], v5 offset:24904
    v_mfma_f32_16x16x32_bf16 v[172:175], a[248:251], a[72:75], v[172:175]
    s_add_u32 s39, s61, 81920
    ds_read_b64_tr_b16 a[242:243], v5 offset:26440
    v_mfma_f32_16x16x32_bf16 v[164:167], a[248:251], a[64:67], v[164:167]
    v_mfma_f32_16x16x32_bf16 v[164:167], a[252:255], a[68:71], v[164:167]
    buffer_load_dwordx4 v1, s[8:11], s39 offen lds
    v_mfma_f32_16x16x32_bf16 v[156:159], a[252:255], a[60:63], v[156:159]
    v_mfma_f32_16x16x32_bf16 v[156:159], a[248:251], a[52:55], v[156:159]
    s_add_u32 s39, s39, 9216
    ds_read_b64_tr_b16 a[244:245], v5 offset:37224
    v_mfma_f32_16x16x32_bf16 v[148:151], a[248:251], a[44:47], v[148:151]
    ds_read_b64_tr_b16 a[246:247], v5 offset:38760
    v_mfma_f32_16x16x32_bf16 v[148:151], a[252:255], a[48:51], v[148:151]
    v_mfma_f32_16x16x32_bf16 v[140:143], a[252:255], a[40:43], v[140:143]
    buffer_load_dwordx4 v1, s[8:11], s39 offen offset:1024 lds
    v_mfma_f32_16x16x32_bf16 v[140:143], a[248:251], a[224:227], v[140:143]
    s_waitcnt lgkmcnt(5)
    v_mfma_f32_16x16x32_bf16 v[176:179], a[12:15], a[224:227], v[176:179]
    ds_read_b64_tr_b16 a[248:249], v6 offset:24896
    v_mfma_f32_16x16x32_bf16 v[176:179], a[16:19], a[40:43], v[176:179]
    ds_read_b64_tr_b16 a[250:251], v6 offset:26432
    v_mfma_f32_16x16x32_bf16 v[184:187], a[16:19], a[48:51], v[184:187]
    v_mfma_f32_16x16x32_bf16 v[184:187], a[12:15], a[44:47], v[184:187]
    v_mfma_f32_16x16x32_bf16 v[192:195], a[12:15], a[52:55], v[192:195]
    v_mfma_f32_16x16x32_bf16 v[192:195], a[16:19], a[60:63], v[192:195]
    ds_read_b64_tr_b16 a[252:253], v6 offset:37216
    v_mfma_f32_16x16x32_bf16 v[200:203], a[16:19], a[68:71], v[200:203]
    ds_read_b64_tr_b16 a[254:255], v6 offset:38752
    v_mfma_f32_16x16x32_bf16 v[200:203], a[12:15], a[64:67], v[200:203]
    v_mfma_f32_16x16x32_bf16 v[208:211], a[12:15], a[72:75], v[208:211]
    v_mfma_f32_16x16x32_bf16 v[208:211], a[16:19], a[76:79], v[208:211]
    s_waitcnt lgkmcnt(4)
    v_mfma_f32_16x16x32_bf16 v[212:215], a[244:247], a[76:79], v[212:215]
    ds_read_b64_tr_b16 a[12:13], v6 offset:24904
    v_mfma_f32_16x16x32_bf16 v[212:215], a[240:243], a[72:75], v[212:215]
    ds_read_b64_tr_b16 a[14:15], v6 offset:26440
    v_mfma_f32_16x16x32_bf16 v[204:207], a[240:243], a[64:67], v[204:207]
    v_mfma_f32_16x16x32_bf16 v[204:207], a[244:247], a[68:71], v[204:207]
    v_mfma_f32_16x16x32_bf16 v[196:199], a[244:247], a[60:63], v[196:199]
    v_mfma_f32_16x16x32_bf16 v[196:199], a[240:243], a[52:55], v[196:199]
    ds_read_b64_tr_b16 a[16:17], v6 offset:37224
    v_mfma_f32_16x16x32_bf16 v[188:191], a[240:243], a[44:47], v[188:191]
    ds_read_b64_tr_b16 a[18:19], v6 offset:38760
    v_mfma_f32_16x16x32_bf16 v[188:191], a[244:247], a[48:51], v[188:191]
    v_mfma_f32_16x16x32_bf16 v[180:183], a[244:247], a[40:43], v[180:183]
    v_mfma_f32_16x16x32_bf16 v[180:183], a[240:243], a[224:227], v[180:183]
    s_waitcnt lgkmcnt(4)
    s_waitcnt vmcnt(15)
    s_barrier
    v_mfma_f32_16x16x32_bf16 v[216:219], a[248:251], a[224:227], v[216:219]
    s_add_u32 m0, s33, 24576
    ds_read_b64_tr_b16 a[240:241], v5 offset:49280
    v_mfma_f32_16x16x32_bf16 v[216:219], a[252:255], a[40:43], v[216:219]
    s_mov_b32 s35, 12288
    ds_read_b64_tr_b16 a[242:243], v5 offset:50816
    v_mfma_f32_16x16x32_bf16 v[224:227], a[252:255], a[48:51], v[224:227]
    v_mfma_f32_16x16x32_bf16 v[224:227], a[248:251], a[44:47], v[224:227]
    buffer_load_dwordx4 v7, s[16:19], s35 offen nt lds
    v_mfma_f32_16x16x32_bf16 v[232:235], a[248:251], a[52:55], v[232:235]
    v_mfma_f32_16x16x32_bf16 v[232:235], a[252:255], a[60:63], v[232:235]
    s_add_u32 m0, s33, 24576
    ds_read_b64_tr_b16 a[244:245], v5 offset:0
    v_mfma_f32_16x16x32_bf16 v[240:243], a[252:255], a[68:71], v[240:243]
    s_mov_b32 s35, 12288
    ds_read_b64_tr_b16 a[246:247], v5 offset:1536
    v_mfma_f32_16x16x32_bf16 v[240:243], a[248:251], a[64:67], v[240:243]
    v_mfma_f32_16x16x32_bf16 v[248:251], a[248:251], a[72:75], v[248:251]
    buffer_load_dwordx4 v8, s[16:19], s35 offen offset:1024 nt lds
    v_mfma_f32_16x16x32_bf16 v[248:251], a[252:255], a[76:79], v[248:251]
    s_waitcnt lgkmcnt(4)
    s_barrier
    v_mfma_f32_16x16x32_bf16 v[252:255], a[16:19], a[76:79], v[252:255]
    s_add_u32 m0, s33, 24576
    ds_read_b64_tr_b16 a[248:249], v5 offset:49288
    v_mfma_f32_16x16x32_bf16 v[252:255], a[12:15], a[72:75], v[252:255]
    s_mov_b32 s35, 12288
    ds_read_b64_tr_b16 a[250:251], v5 offset:50824
    v_mfma_f32_16x16x32_bf16 v[244:247], a[12:15], a[64:67], v[244:247]
    v_mfma_f32_16x16x32_bf16 v[244:247], a[16:19], a[68:71], v[244:247]
    buffer_load_dwordx4 v9, s[16:19], s35 offen offset:2048 nt lds
    v_mfma_f32_16x16x32_bf16 v[236:239], a[16:19], a[60:63], v[236:239]
    v_mfma_f32_16x16x32_bf16 v[236:239], a[12:15], a[52:55], v[236:239]
    s_add_u32 m0, s31, 24640
    ds_read_b64_tr_b16 a[252:253], v5 offset:8
    v_mfma_f32_16x16x32_bf16 v[228:231], a[12:15], a[44:47], v[228:231]
    s_add_u32 s32, s32, 393216
    ds_read_b64_tr_b16 a[254:255], v5 offset:1544
    v_mfma_f32_16x16x32_bf16 v[228:231], a[16:19], a[48:51], v[228:231]
    v_mfma_f32_16x16x32_bf16 v[220:223], a[16:19], a[40:43], v[220:223]
    buffer_load_dwordx4 v2, s[12:15], s32 offen lds
    v_mfma_f32_16x16x32_bf16 v[220:223], a[12:15], a[224:227], v[220:223]
    s_waitcnt lgkmcnt(4)
    v_mfma_f32_16x16x32_bf16 v[16:19], a[240:243], a[140:143], v[16:19]
    ds_read_b64_tr_b16 a[12:13], v6 offset:49280
    v_mfma_f32_16x16x32_bf16 v[16:19], a[244:247], a[228:231], v[16:19]
    ds_read_b64_tr_b16 a[14:15], v6 offset:50816
    v_mfma_f32_16x16x32_bf16 v[24:27], a[244:247], a[160:163], v[24:27]
    v_mfma_f32_16x16x32_bf16 v[24:27], a[240:243], a[136:139], v[24:27]
    buffer_load_dwordx4 v3, s[12:15], s32 offen offset:1024 lds
    v_mfma_f32_16x16x32_bf16 v[32:35], a[240:243], a[232:235], v[32:35]
    v_mfma_f32_16x16x32_bf16 v[32:35], a[244:247], a[164:167], v[32:35]
    ds_read_b64_tr_b16 a[16:17], v6 offset:0
    v_mfma_f32_16x16x32_bf16 v[40:43], a[244:247], a[0:3], v[40:43]
    ds_read_b64_tr_b16 a[18:19], v6 offset:1536
    v_mfma_f32_16x16x32_bf16 v[40:43], a[240:243], a[236:239], v[40:43]
    v_mfma_f32_16x16x32_bf16 v[48:51], a[240:243], a[4:7], v[48:51]
    buffer_load_dwordx4 v4, s[12:15], s32 offen offset:2048 lds
    v_mfma_f32_16x16x32_bf16 v[48:51], a[244:247], a[8:11], v[48:51]
    s_waitcnt lgkmcnt(4)
    v_mfma_f32_16x16x32_bf16 v[52:55], a[252:255], a[8:11], v[52:55]
    s_add_u32 m0, s33, 27648
    ds_read_b64_tr_b16 a[240:241], v6 offset:49288
    v_mfma_f32_16x16x32_bf16 v[52:55], a[248:251], a[4:7], v[52:55]
    s_mov_b32 s35, 15360
    ds_read_b64_tr_b16 a[242:243], v6 offset:50824
    v_mfma_f32_16x16x32_bf16 v[44:47], a[248:251], a[236:239], v[44:47]
    s_waitcnt vmcnt(10)
    ds_read_b128 a[204:207], v12 offset:57344
    v_mfma_f32_16x16x32_bf16 v[44:47], a[252:255], a[0:3], v[44:47]
    buffer_load_dwordx4 v7, s[16:19], s35 offen nt lds
    v_mfma_f32_16x16x32_bf16 v[36:39], a[252:255], a[164:167], v[36:39]
    v_mfma_f32_16x16x32_bf16 v[36:39], a[248:251], a[232:235], v[36:39]
    s_add_u32 m0, s33, 27648
    ds_read_b64_tr_b16 a[244:245], v6 offset:8
    v_mfma_f32_16x16x32_bf16 v[28:31], a[248:251], a[136:139], v[28:31]
    s_mov_b32 s35, 15360
    ds_read_b64_tr_b16 a[246:247], v6 offset:1544
    v_mfma_f32_16x16x32_bf16 v[28:31], a[252:255], a[160:163], v[28:31]
    ds_read_b128 a[208:211], v13 offset:57344
    v_mfma_f32_16x16x32_bf16 v[20:23], a[252:255], a[228:231], v[20:23]
    buffer_load_dwordx4 v8, s[16:19], s35 offen offset:1024 nt lds
    v_mfma_f32_16x16x32_bf16 v[20:23], a[248:251], a[140:143], v[20:23]
    s_waitcnt lgkmcnt(6)
    v_mfma_f32_16x16x32_bf16 v[56:59], a[12:15], a[140:143], v[56:59]
    s_add_u32 m0, s33, 27648
    ds_read_b64_tr_b16 a[248:249], v5 offset:49408
    v_mfma_f32_16x16x32_bf16 v[56:59], a[16:19], a[228:231], v[56:59]
    s_mov_b32 s35, 15360
    ds_read_b64_tr_b16 a[250:251], v5 offset:50944
    v_mfma_f32_16x16x32_bf16 v[64:67], a[16:19], a[160:163], v[64:67]
    s_waitcnt vmcnt(10)
    ds_read_b128 a[212:215], v12 offset:0
    v_mfma_f32_16x16x32_bf16 v[64:67], a[12:15], a[136:139], v[64:67]
    buffer_load_dwordx4 v9, s[16:19], s35 offen offset:2048 nt lds
    v_mfma_f32_16x16x32_bf16 v[72:75], a[12:15], a[232:235], v[72:75]
    v_mfma_f32_16x16x32_bf16 v[72:75], a[16:19], a[164:167], v[72:75]
    s_add_u32 m0, s31, 36960
    ds_read_b64_tr_b16 a[252:253], v5 offset:128
    v_mfma_f32_16x16x32_bf16 v[80:83], a[16:19], a[0:3], v[80:83]
    s_mul_i32 s32, s61, 6144
    ds_read_b64_tr_b16 a[254:255], v5 offset:1664
    v_mfma_f32_16x16x32_bf16 v[80:83], a[12:15], a[236:239], v[80:83]
    ds_read_b128 a[20:23], v13 offset:0
    v_mfma_f32_16x16x32_bf16 v[88:91], a[12:15], a[4:7], v[88:91]
    buffer_load_dwordx4 v2, s[12:15], s32 offen lds
    v_mfma_f32_16x16x32_bf16 v[88:91], a[16:19], a[8:11], v[88:91]
    s_waitcnt lgkmcnt(7)
    v_mfma_f32_16x16x32_bf16 v[92:95], a[244:247], a[8:11], v[92:95]
    ds_read_b64_tr_b16 a[12:13], v5 offset:49416
    v_mfma_f32_16x16x32_bf16 v[92:95], a[240:243], a[4:7], v[92:95]
    ds_read_b64_tr_b16 a[14:15], v5 offset:50952
    v_mfma_f32_16x16x32_bf16 v[84:87], a[240:243], a[236:239], v[84:87]
    s_waitcnt vmcnt(10)
    ds_read_b128 a[24:27], v12 offset:8192
    v_mfma_f32_16x16x32_bf16 v[84:87], a[244:247], a[0:3], v[84:87]
    buffer_load_dwordx4 v3, s[12:15], s32 offen offset:1024 lds
    v_mfma_f32_16x16x32_bf16 v[76:79], a[244:247], a[164:167], v[76:79]
    v_mfma_f32_16x16x32_bf16 v[76:79], a[240:243], a[232:235], v[76:79]
    ds_read_b64_tr_b16 a[16:17], v5 offset:136
    v_mfma_f32_16x16x32_bf16 v[68:71], a[240:243], a[136:139], v[68:71]
    ds_read_b64_tr_b16 a[18:19], v5 offset:1672
    v_mfma_f32_16x16x32_bf16 v[68:71], a[244:247], a[160:163], v[68:71]
    ds_read_b128 a[28:31], v13 offset:8192
    v_mfma_f32_16x16x32_bf16 v[60:63], a[244:247], a[228:231], v[60:63]
    buffer_load_dwordx4 v4, s[12:15], s32 offen offset:2048 lds
    v_mfma_f32_16x16x32_bf16 v[60:63], a[240:243], a[140:143], v[60:63]
    s_waitcnt lgkmcnt(7)
    v_mfma_f32_16x16x32_bf16 v[96:99], a[248:251], a[140:143], v[96:99]
    ds_read_b64_tr_b16 a[240:241], v6 offset:49408
    v_mfma_f32_16x16x32_bf16 v[96:99], a[252:255], a[228:231], v[96:99]
    ds_read_b64_tr_b16 a[242:243], v6 offset:50944
    v_mfma_f32_16x16x32_bf16 v[104:107], a[252:255], a[160:163], v[104:107]
    v_mfma_f32_16x16x32_bf16 v[104:107], a[248:251], a[136:139], v[104:107]
    v_mfma_f32_16x16x32_bf16 v[112:115], a[248:251], a[232:235], v[112:115]
    v_mfma_f32_16x16x32_bf16 v[112:115], a[252:255], a[164:167], v[112:115]
    ds_read_b64_tr_b16 a[244:245], v6 offset:128
    v_mfma_f32_16x16x32_bf16 v[120:123], a[252:255], a[0:3], v[120:123]
    ds_read_b64_tr_b16 a[246:247], v6 offset:1664
    v_mfma_f32_16x16x32_bf16 v[120:123], a[248:251], a[236:239], v[120:123]
    v_mfma_f32_16x16x32_bf16 v[128:131], a[248:251], a[4:7], v[128:131]
    v_mfma_f32_16x16x32_bf16 v[128:131], a[252:255], a[8:11], v[128:131]
    s_waitcnt lgkmcnt(5)
    v_mfma_f32_16x16x32_bf16 v[132:135], a[16:19], a[8:11], v[132:135]
    ds_read_b64_tr_b16 a[248:249], v6 offset:49416
    v_mfma_f32_16x16x32_bf16 v[132:135], a[12:15], a[4:7], v[132:135]
    ds_read_b64_tr_b16 a[250:251], v6 offset:50952
    v_mfma_f32_16x16x32_bf16 v[124:127], a[12:15], a[236:239], v[124:127]
    v_mfma_f32_16x16x32_bf16 v[124:127], a[16:19], a[0:3], v[124:127]
    v_mfma_f32_16x16x32_bf16 v[116:119], a[16:19], a[164:167], v[116:119]
    v_mfma_f32_16x16x32_bf16 v[116:119], a[12:15], a[232:235], v[116:119]
    ds_read_b64_tr_b16 a[252:253], v6 offset:136
    v_mfma_f32_16x16x32_bf16 v[108:111], a[12:15], a[136:139], v[108:111]
    ds_read_b64_tr_b16 a[254:255], v6 offset:1672
    v_mfma_f32_16x16x32_bf16 v[108:111], a[16:19], a[160:163], v[108:111]
    v_mfma_f32_16x16x32_bf16 v[100:103], a[16:19], a[228:231], v[100:103]
    v_mfma_f32_16x16x32_bf16 v[100:103], a[12:15], a[140:143], v[100:103]
    s_waitcnt lgkmcnt(4)
    v_mfma_f32_16x16x32_bf16 v[136:139], a[240:243], a[140:143], v[136:139]
    ds_read_b64_tr_b16 a[12:13], v5 offset:49536
    v_mfma_f32_16x16x32_bf16 v[136:139], a[244:247], a[228:231], v[136:139]
    ds_read_b64_tr_b16 a[14:15], v5 offset:51072
    v_mfma_f32_16x16x32_bf16 v[144:147], a[244:247], a[160:163], v[144:147]
    v_mfma_f32_16x16x32_bf16 v[144:147], a[240:243], a[136:139], v[144:147]
    v_mfma_f32_16x16x32_bf16 v[152:155], a[240:243], a[232:235], v[152:155]
    v_mfma_f32_16x16x32_bf16 v[152:155], a[244:247], a[164:167], v[152:155]
    ds_read_b64_tr_b16 a[16:17], v5 offset:256
    v_mfma_f32_16x16x32_bf16 v[160:163], a[244:247], a[0:3], v[160:163]
    ds_read_b64_tr_b16 a[18:19], v5 offset:1792
    v_mfma_f32_16x16x32_bf16 v[160:163], a[240:243], a[236:239], v[160:163]
    v_mfma_f32_16x16x32_bf16 v[168:171], a[240:243], a[4:7], v[168:171]
    v_mfma_f32_16x16x32_bf16 v[168:171], a[244:247], a[8:11], v[168:171]
    s_waitcnt lgkmcnt(4)
    v_mfma_f32_16x16x32_bf16 v[172:175], a[252:255], a[8:11], v[172:175]
    ds_read_b64_tr_b16 a[240:241], v5 offset:49544
    v_mfma_f32_16x16x32_bf16 v[172:175], a[248:251], a[4:7], v[172:175]
    ds_read_b64_tr_b16 a[242:243], v5 offset:51080
    v_mfma_f32_16x16x32_bf16 v[164:167], a[248:251], a[236:239], v[164:167]
    v_mfma_f32_16x16x32_bf16 v[164:167], a[252:255], a[0:3], v[164:167]
    v_mfma_f32_16x16x32_bf16 v[156:159], a[252:255], a[164:167], v[156:159]
    v_mfma_f32_16x16x32_bf16 v[156:159], a[248:251], a[232:235], v[156:159]
    ds_read_b64_tr_b16 a[244:245], v5 offset:264
    v_mfma_f32_16x16x32_bf16 v[148:151], a[248:251], a[136:139], v[148:151]
    ds_read_b64_tr_b16 a[246:247], v5 offset:1800
    v_mfma_f32_16x16x32_bf16 v[148:151], a[252:255], a[160:163], v[148:151]
    v_mfma_f32_16x16x32_bf16 v[140:143], a[252:255], a[228:231], v[140:143]
    v_mfma_f32_16x16x32_bf16 v[140:143], a[248:251], a[140:143], v[140:143]
    s_waitcnt lgkmcnt(4)
    v_mfma_f32_16x16x32_bf16 v[176:179], a[12:15], a[140:143], v[176:179]
    ds_read_b64_tr_b16 a[248:249], v6 offset:49536
    v_mfma_f32_16x16x32_bf16 v[176:179], a[16:19], a[228:231], v[176:179]
    ds_read_b64_tr_b16 a[250:251], v6 offset:51072
    v_mfma_f32_16x16x32_bf16 v[184:187], a[16:19], a[160:163], v[184:187]
    v_mfma_f32_16x16x32_bf16 v[184:187], a[12:15], a[136:139], v[184:187]
    v_mfma_f32_16x16x32_bf16 v[192:195], a[12:15], a[232:235], v[192:195]
    v_mfma_f32_16x16x32_bf16 v[192:195], a[16:19], a[164:167], v[192:195]
    ds_read_b64_tr_b16 a[252:253], v6 offset:256
    v_mfma_f32_16x16x32_bf16 v[200:203], a[16:19], a[0:3], v[200:203]
    ds_read_b64_tr_b16 a[254:255], v6 offset:1792
    v_mfma_f32_16x16x32_bf16 v[200:203], a[12:15], a[236:239], v[200:203]
    v_mfma_f32_16x16x32_bf16 v[208:211], a[12:15], a[4:7], v[208:211]
    v_mfma_f32_16x16x32_bf16 v[208:211], a[16:19], a[8:11], v[208:211]
    s_waitcnt lgkmcnt(4)
    v_mfma_f32_16x16x32_bf16 v[212:215], a[244:247], a[8:11], v[212:215]
    ds_read_b64_tr_b16 a[12:13], v6 offset:49544
    v_mfma_f32_16x16x32_bf16 v[212:215], a[240:243], a[4:7], v[212:215]
    ds_read_b64_tr_b16 a[14:15], v6 offset:51080
    v_mfma_f32_16x16x32_bf16 v[204:207], a[240:243], a[236:239], v[204:207]
    v_mfma_f32_16x16x32_bf16 v[204:207], a[244:247], a[0:3], v[204:207]
    v_mfma_f32_16x16x32_bf16 v[196:199], a[244:247], a[164:167], v[196:199]
    v_mfma_f32_16x16x32_bf16 v[196:199], a[240:243], a[232:235], v[196:199]
    ds_read_b64_tr_b16 a[16:17], v6 offset:264
    v_mfma_f32_16x16x32_bf16 v[188:191], a[240:243], a[136:139], v[188:191]
    ds_read_b64_tr_b16 a[18:19], v6 offset:1800
    v_mfma_f32_16x16x32_bf16 v[188:191], a[244:247], a[160:163], v[188:191]
    v_mfma_f32_16x16x32_bf16 v[180:183], a[244:247], a[228:231], v[180:183]
    v_mfma_f32_16x16x32_bf16 v[180:183], a[240:243], a[140:143], v[180:183]
    s_waitcnt lgkmcnt(4)
    s_waitcnt vmcnt(6)
    s_barrier
    v_mfma_f32_16x16x32_bf16 v[216:219], a[248:251], a[140:143], v[216:219]
    s_add_u32 m0, s33, 0
    ds_read_b64_tr_b16 a[240:241], v5 offset:12320
    v_mfma_f32_16x16x32_bf16 v[216:219], a[252:255], a[228:231], v[216:219]
    s_mov_b32 s35, 0
    ds_read_b64_tr_b16 a[242:243], v5 offset:13856
    v_mfma_f32_16x16x32_bf16 v[224:227], a[252:255], a[160:163], v[224:227]
    v_mfma_f32_16x16x32_bf16 v[224:227], a[248:251], a[136:139], v[224:227]
    buffer_load_dwordx4 v7, s[16:19], s35 offen nt lds
    v_mfma_f32_16x16x32_bf16 v[232:235], a[248:251], a[232:235], v[232:235]
    v_mfma_f32_16x16x32_bf16 v[232:235], a[252:255], a[164:167], v[232:235]
    s_add_u32 m0, s33, 0
    ds_read_b64_tr_b16 a[244:245], v5 offset:24640
    v_mfma_f32_16x16x32_bf16 v[240:243], a[252:255], a[0:3], v[240:243]
    s_mov_b32 s35, 0
    ds_read_b64_tr_b16 a[246:247], v5 offset:26176
    v_mfma_f32_16x16x32_bf16 v[240:243], a[248:251], a[236:239], v[240:243]
    v_mfma_f32_16x16x32_bf16 v[248:251], a[248:251], a[4:7], v[248:251]
    buffer_load_dwordx4 v8, s[16:19], s35 offen offset:1024 nt lds
    v_mfma_f32_16x16x32_bf16 v[248:251], a[252:255], a[8:11], v[248:251]
    s_waitcnt lgkmcnt(4)
    s_barrier
    v_mfma_f32_16x16x32_bf16 v[252:255], a[16:19], a[8:11], v[252:255]
    s_add_u32 m0, s33, 0
    ds_read_b64_tr_b16 a[248:249], v5 offset:12328
    v_mfma_f32_16x16x32_bf16 v[252:255], a[12:15], a[4:7], v[252:255]
    s_mov_b32 s35, 0
    ds_read_b64_tr_b16 a[250:251], v5 offset:13864
    v_mfma_f32_16x16x32_bf16 v[244:247], a[12:15], a[236:239], v[244:247]
    v_mfma_f32_16x16x32_bf16 v[244:247], a[16:19], a[0:3], v[244:247]
    buffer_load_dwordx4 v9, s[16:19], s35 offen offset:2048 nt lds
    v_mfma_f32_16x16x32_bf16 v[236:239], a[16:19], a[164:167], v[236:239]
    v_mfma_f32_16x16x32_bf16 v[236:239], a[12:15], a[232:235], v[236:239]
    s_add_u32 m0, s31, 49280
    ds_read_b64_tr_b16 a[252:253], v5 offset:24648
    v_mfma_f32_16x16x32_bf16 v[228:231], a[12:15], a[136:139], v[228:231]
    s_add_u32 s32, s32, 393216
    ds_read_b64_tr_b16 a[254:255], v5 offset:26184
    v_mfma_f32_16x16x32_bf16 v[228:231], a[16:19], a[160:163], v[228:231]
    v_mfma_f32_16x16x32_bf16 v[220:223], a[16:19], a[228:231], v[220:223]
    buffer_load_dwordx4 v2, s[12:15], s32 offen lds
    v_mfma_f32_16x16x32_bf16 v[220:223], a[12:15], a[140:143], v[220:223]
    s_waitcnt lgkmcnt(4)
    v_mfma_f32_16x16x32_bf16 v[16:19], a[240:243], a[168:171], v[16:19]
    ds_read_b64_tr_b16 a[12:13], v6 offset:12320
    v_mfma_f32_16x16x32_bf16 v[16:19], a[244:247], a[172:175], v[16:19]
    ds_read_b64_tr_b16 a[14:15], v6 offset:13856
    v_mfma_f32_16x16x32_bf16 v[24:27], a[244:247], a[80:83], v[24:27]
    v_mfma_f32_16x16x32_bf16 v[24:27], a[240:243], a[56:59], v[24:27]
    buffer_load_dwordx4 v3, s[12:15], s32 offen offset:1024 lds
    v_mfma_f32_16x16x32_bf16 v[32:35], a[240:243], a[84:87], v[32:35]
    v_mfma_f32_16x16x32_bf16 v[32:35], a[244:247], a[88:91], v[32:35]
    ds_read_b64_tr_b16 a[16:17], v6 offset:24640
    v_mfma_f32_16x16x32_bf16 v[40:43], a[244:247], a[144:147], v[40:43]
    ds_read_b64_tr_b16 a[18:19], v6 offset:26176
    v_mfma_f32_16x16x32_bf16 v[40:43], a[240:243], a[92:95], v[40:43]
    v_mfma_f32_16x16x32_bf16 v[48:51], a[240:243], a[148:151], v[48:51]
    buffer_load_dwordx4 v4, s[12:15], s32 offen offset:2048 lds
    v_mfma_f32_16x16x32_bf16 v[48:51], a[244:247], a[152:155], v[48:51]
    s_waitcnt lgkmcnt(4)
    v_mfma_f32_16x16x32_bf16 v[52:55], a[252:255], a[152:155], v[52:55]
    s_add_u32 m0, s33, 3072
    ds_read_b64_tr_b16 a[240:241], v6 offset:12328
    v_mfma_f32_16x16x32_bf16 v[52:55], a[248:251], a[148:151], v[52:55]
    s_mov_b32 s35, 3072
    ds_read_b64_tr_b16 a[242:243], v6 offset:13864
    v_mfma_f32_16x16x32_bf16 v[44:47], a[248:251], a[92:95], v[44:47]
    v_mfma_f32_16x16x32_bf16 v[44:47], a[252:255], a[144:147], v[44:47]
    buffer_load_dwordx4 v7, s[16:19], s35 offen nt lds
    v_mfma_f32_16x16x32_bf16 v[36:39], a[252:255], a[88:91], v[36:39]
    v_mfma_f32_16x16x32_bf16 v[36:39], a[248:251], a[84:87], v[36:39]
    s_add_u32 m0, s33, 3072
    ds_read_b64_tr_b16 a[244:245], v6 offset:24648
    v_mfma_f32_16x16x32_bf16 v[28:31], a[248:251], a[56:59], v[28:31]
    s_mov_b32 s35, 3072
    ds_read_b64_tr_b16 a[246:247], v6 offset:26184
    v_mfma_f32_16x16x32_bf16 v[28:31], a[252:255], a[80:83], v[28:31]
    v_mfma_f32_16x16x32_bf16 v[20:23], a[252:255], a[172:175], v[20:23]
    buffer_load_dwordx4 v8, s[16:19], s35 offen offset:1024 nt lds
    v_mfma_f32_16x16x32_bf16 v[20:23], a[248:251], a[168:171], v[20:23]
    s_waitcnt lgkmcnt(4)
    v_mfma_f32_16x16x32_bf16 v[56:59], a[12:15], a[168:171], v[56:59]
    s_add_u32 m0, s33, 3072
    ds_read_b64_tr_b16 a[248:249], v5 offset:12448
    v_mfma_f32_16x16x32_bf16 v[56:59], a[16:19], a[172:175], v[56:59]
    s_mov_b32 s35, 3072
    ds_read_b64_tr_b16 a[250:251], v5 offset:13984
    v_mfma_f32_16x16x32_bf16 v[64:67], a[16:19], a[80:83], v[64:67]
    v_mfma_f32_16x16x32_bf16 v[64:67], a[12:15], a[56:59], v[64:67]
    buffer_load_dwordx4 v9, s[16:19], s35 offen offset:2048 nt lds
    v_mfma_f32_16x16x32_bf16 v[72:75], a[12:15], a[84:87], v[72:75]
    v_mfma_f32_16x16x32_bf16 v[72:75], a[16:19], a[88:91], v[72:75]
    s_add_u32 m0, s33, 49152
    ds_read_b64_tr_b16 a[252:253], v5 offset:24768
    v_mfma_f32_16x16x32_bf16 v[80:83], a[16:19], a[144:147], v[80:83]
    s_mov_b32 s35, 24576
    ds_read_b64_tr_b16 a[254:255], v5 offset:26304
    v_mfma_f32_16x16x32_bf16 v[80:83], a[12:15], a[92:95], v[80:83]
    v_mfma_f32_16x16x32_bf16 v[88:91], a[12:15], a[148:151], v[88:91]
    buffer_load_dwordx4 v7, s[16:19], s35 offen nt lds
    v_mfma_f32_16x16x32_bf16 v[88:91], a[16:19], a[152:155], v[88:91]
    s_waitcnt lgkmcnt(4)
    v_mfma_f32_16x16x32_bf16 v[92:95], a[244:247], a[152:155], v[92:95]
    s_add_u32 m0, s33, 49152
    ds_read_b64_tr_b16 a[12:13], v5 offset:12456
    v_mfma_f32_16x16x32_bf16 v[92:95], a[240:243], a[148:151], v[92:95]
    s_mov_b32 s35, 24576
    ds_read_b64_tr_b16 a[14:15], v5 offset:13992
    v_mfma_f32_16x16x32_bf16 v[84:87], a[240:243], a[92:95], v[84:87]
    v_mfma_f32_16x16x32_bf16 v[84:87], a[244:247], a[144:147], v[84:87]
    buffer_load_dwordx4 v8, s[16:19], s35 offen offset:1024 nt lds
    v_mfma_f32_16x16x32_bf16 v[76:79], a[244:247], a[88:91], v[76:79]
    v_mfma_f32_16x16x32_bf16 v[76:79], a[240:243], a[84:87], v[76:79]
    s_add_u32 m0, s33, 49152
    ds_read_b64_tr_b16 a[16:17], v5 offset:24776
    v_mfma_f32_16x16x32_bf16 v[68:71], a[240:243], a[56:59], v[68:71]
    s_mov_b32 s35, 24576
    ds_read_b64_tr_b16 a[18:19], v5 offset:26312
    v_mfma_f32_16x16x32_bf16 v[68:71], a[244:247], a[80:83], v[68:71]
    v_mfma_f32_16x16x32_bf16 v[60:63], a[244:247], a[172:175], v[60:63]
    buffer_load_dwordx4 v9, s[16:19], s35 offen offset:2048 nt lds
    v_mfma_f32_16x16x32_bf16 v[60:63], a[240:243], a[168:171], v[60:63]
    s_waitcnt lgkmcnt(4)
    v_mfma_f32_16x16x32_bf16 v[96:99], a[248:251], a[168:171], v[96:99]
    s_add_u32 m0, s33, 52224
    ds_read_b64_tr_b16 a[240:241], v6 offset:12448
    v_mfma_f32_16x16x32_bf16 v[96:99], a[252:255], a[172:175], v[96:99]
    s_mov_b32 s35, 27648
    ds_read_b64_tr_b16 a[242:243], v6 offset:13984
    v_mfma_f32_16x16x32_bf16 v[104:107], a[252:255], a[80:83], v[104:107]
    v_mfma_f32_16x16x32_bf16 v[104:107], a[248:251], a[56:59], v[104:107]
    buffer_load_dwordx4 v7, s[16:19], s35 offen nt lds
    v_mfma_f32_16x16x32_bf16 v[112:115], a[248:251], a[84:87], v[112:115]
    v_mfma_f32_16x16x32_bf16 v[112:115], a[252:255], a[88:91], v[112:115]
    s_add_u32 m0, s33, 52224
    ds_read_b64_tr_b16 a[244:245], v6 offset:24768
    v_mfma_f32_16x16x32_bf16 v[120:123], a[252:255], a[144:147], v[120:123]
    s_mov_b32 s35, 27648
    ds_read_b64_tr_b16 a[246:247], v6 offset:26304
    v_mfma_f32_16x16x32_bf16 v[120:123], a[248:251], a[92:95], v[120:123]
    v_mfma_f32_16x16x32_bf16 v[128:131], a[248:251], a[148:151], v[128:131]
    buffer_load_dwordx4 v8, s[16:19], s35 offen offset:1024 nt lds
    v_mfma_f32_16x16x32_bf16 v[128:131], a[252:255], a[152:155], v[128:131]
    s_waitcnt lgkmcnt(4)
    v_mfma_f32_16x16x32_bf16 v[132:135], a[16:19], a[152:155], v[132:135]
    s_add_u32 m0, s33, 52224
    ds_read_b64_tr_b16 a[248:249], v6 offset:12456
    v_mfma_f32_16x16x32_bf16 v[132:135], a[12:15], a[148:151], v[132:135]
    s_mov_b32 s35, 27648
    ds_read_b64_tr_b16 a[250:251], v6 offset:13992
    v_mfma_f32_16x16x32_bf16 v[124:127], a[12:15], a[92:95], v[124:127]
    v_mfma_f32_16x16x32_bf16 v[124:127], a[16:19], a[144:147], v[124:127]
    buffer_load_dwordx4 v9, s[16:19], s35 offen offset:2048 nt lds
    v_mfma_f32_16x16x32_bf16 v[116:119], a[16:19], a[88:91], v[116:119]
    v_mfma_f32_16x16x32_bf16 v[116:119], a[12:15], a[84:87], v[116:119]
    s_mov_b32 s6, s37
    ds_read_b64_tr_b16 a[252:253], v6 offset:24776
    v_mfma_f32_16x16x32_bf16 v[108:111], a[12:15], a[56:59], v[108:111]
    ds_read_b64_tr_b16 a[254:255], v6 offset:26312
    v_mfma_f32_16x16x32_bf16 v[108:111], a[16:19], a[80:83], v[108:111]
    v_mfma_f32_16x16x32_bf16 v[100:103], a[16:19], a[172:175], v[100:103]
    buffer_atomic_add v14, v0, s[4:7], 0 offen
    v_mfma_f32_16x16x32_bf16 v[100:103], a[12:15], a[168:171], v[100:103]
    s_waitcnt lgkmcnt(4)
    v_mfma_f32_16x16x32_bf16 v[136:139], a[240:243], a[168:171], v[136:139]
    ds_read_b64_tr_b16 a[12:13], v5 offset:12576
    v_mfma_f32_16x16x32_bf16 v[136:139], a[244:247], a[172:175], v[136:139]
    ds_read_b64_tr_b16 a[14:15], v5 offset:14112
    v_mfma_f32_16x16x32_bf16 v[144:147], a[244:247], a[80:83], v[144:147]
    v_mfma_f32_16x16x32_bf16 v[144:147], a[240:243], a[56:59], v[144:147]
    v_mfma_f32_16x16x32_bf16 v[152:155], a[240:243], a[84:87], v[152:155]
    v_mfma_f32_16x16x32_bf16 v[152:155], a[244:247], a[88:91], v[152:155]
    ds_read_b64_tr_b16 a[16:17], v5 offset:24896
    v_mfma_f32_16x16x32_bf16 v[160:163], a[244:247], a[144:147], v[160:163]
    ds_read_b64_tr_b16 a[18:19], v5 offset:26432
    v_mfma_f32_16x16x32_bf16 v[160:163], a[240:243], a[92:95], v[160:163]
    v_mfma_f32_16x16x32_bf16 v[168:171], a[240:243], a[148:151], v[168:171]
    v_mfma_f32_16x16x32_bf16 v[168:171], a[244:247], a[152:155], v[168:171]
    s_waitcnt lgkmcnt(4)
    v_mfma_f32_16x16x32_bf16 v[172:175], a[252:255], a[152:155], v[172:175]
    ds_read_b64_tr_b16 a[240:241], v5 offset:12584
    v_mfma_f32_16x16x32_bf16 v[172:175], a[248:251], a[148:151], v[172:175]
    ds_read_b64_tr_b16 a[242:243], v5 offset:14120
    v_mfma_f32_16x16x32_bf16 v[164:167], a[248:251], a[92:95], v[164:167]
    v_mfma_f32_16x16x32_bf16 v[164:167], a[252:255], a[144:147], v[164:167]
    v_mfma_f32_16x16x32_bf16 v[156:159], a[252:255], a[88:91], v[156:159]
    v_mfma_f32_16x16x32_bf16 v[156:159], a[248:251], a[84:87], v[156:159]
    ds_read_b64_tr_b16 a[244:245], v5 offset:24904
    v_mfma_f32_16x16x32_bf16 v[148:151], a[248:251], a[56:59], v[148:151]
    ds_read_b64_tr_b16 a[246:247], v5 offset:26440
    v_mfma_f32_16x16x32_bf16 v[148:151], a[252:255], a[80:83], v[148:151]
    v_mfma_f32_16x16x32_bf16 v[140:143], a[252:255], a[172:175], v[140:143]
    v_mfma_f32_16x16x32_bf16 v[140:143], a[248:251], a[168:171], v[140:143]
    s_waitcnt lgkmcnt(4)
    v_mfma_f32_16x16x32_bf16 v[176:179], a[12:15], a[168:171], v[176:179]
    ds_read_b64_tr_b16 a[248:249], v6 offset:12576
    v_mfma_f32_16x16x32_bf16 v[176:179], a[16:19], a[172:175], v[176:179]
    ds_read_b64_tr_b16 a[250:251], v6 offset:14112
    v_mfma_f32_16x16x32_bf16 v[184:187], a[16:19], a[80:83], v[184:187]
    v_mfma_f32_16x16x32_bf16 v[184:187], a[12:15], a[56:59], v[184:187]
    v_mfma_f32_16x16x32_bf16 v[192:195], a[12:15], a[84:87], v[192:195]
    v_mfma_f32_16x16x32_bf16 v[192:195], a[16:19], a[88:91], v[192:195]
    ds_read_b64_tr_b16 a[252:253], v6 offset:24896
    v_mfma_f32_16x16x32_bf16 v[200:203], a[16:19], a[144:147], v[200:203]
    ds_read_b64_tr_b16 a[254:255], v6 offset:26432
    v_mfma_f32_16x16x32_bf16 v[200:203], a[12:15], a[92:95], v[200:203]
    v_mfma_f32_16x16x32_bf16 v[208:211], a[12:15], a[148:151], v[208:211]
    v_mfma_f32_16x16x32_bf16 v[208:211], a[16:19], a[152:155], v[208:211]
    s_waitcnt lgkmcnt(4)
    v_mfma_f32_16x16x32_bf16 v[212:215], a[244:247], a[152:155], v[212:215]
    ds_read_b64_tr_b16 a[12:13], v6 offset:12584
    v_mfma_f32_16x16x32_bf16 v[212:215], a[240:243], a[148:151], v[212:215]
    ds_read_b64_tr_b16 a[14:15], v6 offset:14120
    v_mfma_f32_16x16x32_bf16 v[204:207], a[240:243], a[92:95], v[204:207]
    v_mfma_f32_16x16x32_bf16 v[204:207], a[244:247], a[144:147], v[204:207]
    v_mfma_f32_16x16x32_bf16 v[196:199], a[244:247], a[88:91], v[196:199]
    v_mfma_f32_16x16x32_bf16 v[196:199], a[240:243], a[84:87], v[196:199]
    ds_read_b64_tr_b16 a[16:17], v6 offset:24904
    v_mfma_f32_16x16x32_bf16 v[188:191], a[240:243], a[56:59], v[188:191]
    ds_read_b64_tr_b16 a[18:19], v6 offset:26440
    v_mfma_f32_16x16x32_bf16 v[188:191], a[244:247], a[80:83], v[188:191]
    v_mfma_f32_16x16x32_bf16 v[180:183], a[244:247], a[172:175], v[180:183]
    v_mfma_f32_16x16x32_bf16 v[180:183], a[240:243], a[168:171], v[180:183]
    s_waitcnt lgkmcnt(4)
    s_waitcnt vmcnt(10)
    s_barrier
    v_mfma_f32_16x16x32_bf16 v[216:219], a[248:251], a[168:171], v[216:219]
    ds_read_b64_tr_b16 a[240:241], v5 offset:36960
    v_mfma_f32_16x16x32_bf16 v[216:219], a[252:255], a[172:175], v[216:219]
    ds_read_b64_tr_b16 a[242:243], v5 offset:38496
    v_mfma_f32_16x16x32_bf16 v[224:227], a[252:255], a[80:83], v[224:227]
    v_mfma_f32_16x16x32_bf16 v[224:227], a[248:251], a[56:59], v[224:227]
    v_mfma_f32_16x16x32_bf16 v[232:235], a[248:251], a[84:87], v[232:235]
    v_mfma_f32_16x16x32_bf16 v[232:235], a[252:255], a[88:91], v[232:235]
    ds_read_b64_tr_b16 a[244:245], v5 offset:49280
    v_mfma_f32_16x16x32_bf16 v[240:243], a[252:255], a[144:147], v[240:243]
    ds_read_b64_tr_b16 a[246:247], v5 offset:50816
    v_mfma_f32_16x16x32_bf16 v[240:243], a[248:251], a[92:95], v[240:243]
    v_mfma_f32_16x16x32_bf16 v[248:251], a[248:251], a[148:151], v[248:251]
    v_mfma_f32_16x16x32_bf16 v[248:251], a[252:255], a[152:155], v[248:251]
    s_waitcnt lgkmcnt(4)
    s_barrier
    v_mfma_f32_16x16x32_bf16 v[252:255], a[16:19], a[152:155], v[252:255]
    s_add_u32 m0, s34, 24576
    ds_read_b64_tr_b16 a[248:249], v5 offset:36968
    v_mfma_f32_16x16x32_bf16 v[252:255], a[12:15], a[148:151], v[252:255]
    s_mov_b32 s36, 12288
    ds_read_b64_tr_b16 a[250:251], v5 offset:38504
    v_mfma_f32_16x16x32_bf16 v[244:247], a[12:15], a[92:95], v[244:247]
    v_mfma_f32_16x16x32_bf16 v[244:247], a[16:19], a[144:147], v[244:247]
    buffer_load_dwordx4 v7, s[20:23], s36 offen nt lds
    v_mfma_f32_16x16x32_bf16 v[236:239], a[16:19], a[88:91], v[236:239]
    v_mfma_f32_16x16x32_bf16 v[236:239], a[12:15], a[84:87], v[236:239]
    s_add_u32 m0, s34, 24576
    ds_read_b64_tr_b16 a[252:253], v5 offset:49288
    v_mfma_f32_16x16x32_bf16 v[228:231], a[12:15], a[56:59], v[228:231]
    s_mov_b32 s36, 12288
    ds_read_b64_tr_b16 a[254:255], v5 offset:50824
    v_mfma_f32_16x16x32_bf16 v[228:231], a[16:19], a[80:83], v[228:231]
    v_mfma_f32_16x16x32_bf16 v[220:223], a[16:19], a[172:175], v[220:223]
    buffer_load_dwordx4 v8, s[20:23], s36 offen offset:1024 nt lds
    v_mfma_f32_16x16x32_bf16 v[220:223], a[12:15], a[168:171], v[220:223]
    s_waitcnt lgkmcnt(4)
    v_mfma_f32_16x16x32_bf16 v[16:19], a[240:243], a[156:159], v[16:19]
    s_add_u32 m0, s34, 24576
    ds_read_b64_tr_b16 a[12:13], v6 offset:36960
    v_mfma_f32_16x16x32_bf16 v[16:19], a[244:247], a[180:183], v[16:19]
    s_mov_b32 s36, 12288
    ds_read_b64_tr_b16 a[14:15], v6 offset:38496
    v_mfma_f32_16x16x32_bf16 v[24:27], a[244:247], a[200:203], v[24:27]
    v_mfma_f32_16x16x32_bf16 v[24:27], a[240:243], a[176:179], v[24:27]
    buffer_load_dwordx4 v9, s[20:23], s36 offen offset:2048 nt lds
    v_mfma_f32_16x16x32_bf16 v[32:35], a[240:243], a[204:207], v[32:35]
    v_mfma_f32_16x16x32_bf16 v[32:35], a[244:247], a[208:211], v[32:35]
    s_add_u32 m0, s34, 27648
    ds_read_b64_tr_b16 a[16:17], v6 offset:49280
    v_mfma_f32_16x16x32_bf16 v[40:43], a[244:247], a[20:23], v[40:43]
    s_mov_b32 s36, 15360
    ds_read_b64_tr_b16 a[18:19], v6 offset:50816
    v_mfma_f32_16x16x32_bf16 v[40:43], a[240:243], a[212:215], v[40:43]
    v_mfma_f32_16x16x32_bf16 v[48:51], a[240:243], a[24:27], v[48:51]
    buffer_load_dwordx4 v7, s[20:23], s36 offen nt lds
    v_mfma_f32_16x16x32_bf16 v[48:51], a[244:247], a[28:31], v[48:51]
    s_waitcnt lgkmcnt(4)
    v_mfma_f32_16x16x32_bf16 v[52:55], a[252:255], a[28:31], v[52:55]
    s_add_u32 m0, s34, 27648
    ds_read_b64_tr_b16 a[240:241], v6 offset:36968
    v_mfma_f32_16x16x32_bf16 v[52:55], a[248:251], a[24:27], v[52:55]
    s_mov_b32 s36, 15360
    ds_read_b64_tr_b16 a[242:243], v6 offset:38504
    v_mfma_f32_16x16x32_bf16 v[44:47], a[248:251], a[212:215], v[44:47]
    v_mfma_f32_16x16x32_bf16 v[44:47], a[252:255], a[20:23], v[44:47]
    buffer_load_dwordx4 v8, s[20:23], s36 offen offset:1024 nt lds
    v_mfma_f32_16x16x32_bf16 v[36:39], a[252:255], a[208:211], v[36:39]
    v_mfma_f32_16x16x32_bf16 v[36:39], a[248:251], a[204:207], v[36:39]
    s_add_u32 m0, s34, 27648
    ds_read_b64_tr_b16 a[244:245], v6 offset:49288
    v_mfma_f32_16x16x32_bf16 v[28:31], a[248:251], a[176:179], v[28:31]
    s_mov_b32 s36, 15360
    ds_read_b64_tr_b16 a[246:247], v6 offset:50824
    v_mfma_f32_16x16x32_bf16 v[28:31], a[252:255], a[200:203], v[28:31]
    v_xor_b32 v13, 64, v10
    v_mfma_f32_16x16x32_bf16 v[20:23], a[252:255], a[180:183], v[20:23]
    buffer_load_dwordx4 v9, s[20:23], s36 offen offset:2048 nt lds
    v_mfma_f32_16x16x32_bf16 v[20:23], a[248:251], a[156:159], v[20:23]
    s_waitcnt lgkmcnt(4)
    v_mfma_f32_16x16x32_bf16 v[56:59], a[12:15], a[156:159], v[56:59]
    ds_read_b64_tr_b16 a[248:249], v5 offset:37088
    v_mfma_f32_16x16x32_bf16 v[56:59], a[16:19], a[180:183], v[56:59]
    ds_read_b64_tr_b16 a[250:251], v5 offset:38624
    v_mfma_f32_16x16x32_bf16 v[64:67], a[16:19], a[200:203], v[64:67]
    v_mfma_f32_16x16x32_bf16 v[64:67], a[12:15], a[176:179], v[64:67]
    v_mul_f32 v16, s42, v16
    v_mul_f32 v17, s42, v17
    v_mfma_f32_16x16x32_bf16 v[72:75], a[12:15], a[204:207], v[72:75]
    v_mul_f32 v18, s42, v18
    v_mul_f32 v19, s42, v19
    v_mfma_f32_16x16x32_bf16 v[72:75], a[16:19], a[208:211], v[72:75]
    ds_read_b64_tr_b16 a[252:253], v5 offset:49408
    v_mul_f32 v20, s42, v20
    v_mfma_f32_16x16x32_bf16 v[80:83], a[16:19], a[20:23], v[80:83]
    ds_read_b64_tr_b16 a[254:255], v5 offset:50944
    v_mul_f32 v21, s42, v21
    v_mfma_f32_16x16x32_bf16 v[80:83], a[12:15], a[212:215], v[80:83]
    v_mul_f32 v22, s42, v22
    v_mul_f32 v23, s42, v23
    v_mfma_f32_16x16x32_bf16 v[88:91], a[12:15], a[24:27], v[88:91]
    v_cvt_pk_bf16_f32 v16, v16, v17
    v_cvt_pk_bf16_f32 v17, v18, v19
    v_mfma_f32_16x16x32_bf16 v[88:91], a[16:19], a[28:31], v[88:91]
    s_waitcnt lgkmcnt(4)
    v_cvt_pk_bf16_f32 v18, v20, v21
    v_cvt_pk_bf16_f32 v19, v22, v23
    v_mfma_f32_16x16x32_bf16 v[92:95], a[244:247], a[28:31], v[92:95]
    ds_read_b64_tr_b16 a[12:13], v5 offset:37096
    v_mul_f32 v24, s42, v24
    v_mfma_f32_16x16x32_bf16 v[92:95], a[240:243], a[24:27], v[92:95]
    ds_read_b64_tr_b16 a[14:15], v5 offset:38632
    v_mul_f32 v25, s42, v25
    v_mfma_f32_16x16x32_bf16 v[84:87], a[240:243], a[212:215], v[84:87]
    v_mul_f32 v26, s42, v26
    v_mul_f32 v27, s42, v27
    v_mfma_f32_16x16x32_bf16 v[84:87], a[244:247], a[20:23], v[84:87]
    v_mul_f32 v28, s42, v28
    v_mul_f32 v29, s42, v29
    v_mfma_f32_16x16x32_bf16 v[76:79], a[244:247], a[208:211], v[76:79]
    v_mul_f32 v30, s42, v30
    v_mul_f32 v31, s42, v31
    v_mfma_f32_16x16x32_bf16 v[76:79], a[240:243], a[204:207], v[76:79]
    ds_read_b64_tr_b16 a[16:17], v5 offset:49416
    v_cvt_pk_bf16_f32 v20, v24, v25
    v_mfma_f32_16x16x32_bf16 v[68:71], a[240:243], a[176:179], v[68:71]
    ds_read_b64_tr_b16 a[18:19], v5 offset:50952
    v_cvt_pk_bf16_f32 v21, v26, v27
    v_mfma_f32_16x16x32_bf16 v[68:71], a[244:247], a[200:203], v[68:71]
    v_cvt_pk_bf16_f32 v22, v28, v29
    v_cvt_pk_bf16_f32 v23, v30, v31
    v_mfma_f32_16x16x32_bf16 v[60:63], a[244:247], a[180:183], v[60:63]
    v_mul_f32 v32, s42, v32
    v_mul_f32 v33, s42, v33
    v_mfma_f32_16x16x32_bf16 v[60:63], a[240:243], a[156:159], v[60:63]
    s_waitcnt lgkmcnt(4)
    v_mul_f32 v34, s42, v34
    v_mul_f32 v35, s42, v35
    v_mfma_f32_16x16x32_bf16 v[96:99], a[248:251], a[156:159], v[96:99]
    ds_read_b64_tr_b16 a[240:241], v6 offset:37088
    v_mul_f32 v36, s42, v36
    v_mfma_f32_16x16x32_bf16 v[96:99], a[252:255], a[180:183], v[96:99]
    ds_read_b64_tr_b16 a[242:243], v6 offset:38624
    v_mul_f32 v37, s42, v37
    v_mfma_f32_16x16x32_bf16 v[104:107], a[252:255], a[200:203], v[104:107]
    v_mul_f32 v38, s42, v38
    v_mul_f32 v39, s42, v39
    v_mfma_f32_16x16x32_bf16 v[104:107], a[248:251], a[176:179], v[104:107]
    v_cvt_pk_bf16_f32 v24, v32, v33
    v_cvt_pk_bf16_f32 v25, v34, v35
    v_mfma_f32_16x16x32_bf16 v[112:115], a[248:251], a[204:207], v[112:115]
    v_cvt_pk_bf16_f32 v26, v36, v37
    v_cvt_pk_bf16_f32 v27, v38, v39
    v_mfma_f32_16x16x32_bf16 v[112:115], a[252:255], a[208:211], v[112:115]
    ds_read_b64_tr_b16 a[244:245], v6 offset:49408
    v_mul_f32 v40, s42, v40
    v_mfma_f32_16x16x32_bf16 v[120:123], a[252:255], a[20:23], v[120:123]
    ds_read_b64_tr_b16 a[246:247], v6 offset:50944
    v_mul_f32 v41, s42, v41
    v_mfma_f32_16x16x32_bf16 v[120:123], a[248:251], a[212:215], v[120:123]
    v_mul_f32 v42, s42, v42
    v_mul_f32 v43, s42, v43
    v_mfma_f32_16x16x32_bf16 v[128:131], a[248:251], a[24:27], v[128:131]
    v_mul_f32 v44, s42, v44
    v_mul_f32 v45, s42, v45
    v_mfma_f32_16x16x32_bf16 v[128:131], a[252:255], a[28:31], v[128:131]
    s_waitcnt lgkmcnt(4)
    v_mul_f32 v46, s42, v46
    v_mul_f32 v47, s42, v47
    v_mfma_f32_16x16x32_bf16 v[132:135], a[16:19], a[28:31], v[132:135]
    ds_read_b64_tr_b16 a[248:249], v6 offset:37096
    v_cvt_pk_bf16_f32 v28, v40, v41
    v_mfma_f32_16x16x32_bf16 v[132:135], a[12:15], a[24:27], v[132:135]
    ds_read_b64_tr_b16 a[250:251], v6 offset:38632
    v_cvt_pk_bf16_f32 v29, v42, v43
    v_mfma_f32_16x16x32_bf16 v[124:127], a[12:15], a[212:215], v[124:127]
    v_cvt_pk_bf16_f32 v30, v44, v45
    v_cvt_pk_bf16_f32 v31, v46, v47
    v_mfma_f32_16x16x32_bf16 v[124:127], a[16:19], a[20:23], v[124:127]
    v_mul_f32 v48, s42, v48
    v_mul_f32 v49, s42, v49
    v_mfma_f32_16x16x32_bf16 v[116:119], a[16:19], a[208:211], v[116:119]
    v_mul_f32 v50, s42, v50
    v_mul_f32 v51, s42, v51
    v_mfma_f32_16x16x32_bf16 v[116:119], a[12:15], a[204:207], v[116:119]
    ds_read_b64_tr_b16 a[252:253], v6 offset:49416
    v_mul_f32 v52, s42, v52
    v_mfma_f32_16x16x32_bf16 v[108:111], a[12:15], a[176:179], v[108:111]
    ds_read_b64_tr_b16 a[254:255], v6 offset:50952
    v_mul_f32 v53, s42, v53
    v_mfma_f32_16x16x32_bf16 v[108:111], a[16:19], a[200:203], v[108:111]
    v_mul_f32 v54, s42, v54
    v_mul_f32 v55, s42, v55
    v_mfma_f32_16x16x32_bf16 v[100:103], a[16:19], a[180:183], v[100:103]
    v_cvt_pk_bf16_f32 v32, v48, v49
    v_cvt_pk_bf16_f32 v33, v50, v51
    v_mfma_f32_16x16x32_bf16 v[100:103], a[12:15], a[156:159], v[100:103]
    s_waitcnt lgkmcnt(4)
    v_cvt_pk_bf16_f32 v34, v52, v53
    v_cvt_pk_bf16_f32 v35, v54, v55
    v_mfma_f32_16x16x32_bf16 v[136:139], a[240:243], a[156:159], v[136:139]
    ds_read_b64_tr_b16 a[12:13], v5 offset:37216
    v_mul_f32 v56, s42, v56
    v_mfma_f32_16x16x32_bf16 v[136:139], a[244:247], a[180:183], v[136:139]
    ds_read_b64_tr_b16 a[14:15], v5 offset:38752
    v_mul_f32 v57, s42, v57
    v_mfma_f32_16x16x32_bf16 v[144:147], a[244:247], a[200:203], v[144:147]
    v_mul_f32 v58, s42, v58
    v_mul_f32 v59, s42, v59
    v_mfma_f32_16x16x32_bf16 v[144:147], a[240:243], a[176:179], v[144:147]
    v_mul_f32 v60, s42, v60
    v_mul_f32 v61, s42, v61
    v_mfma_f32_16x16x32_bf16 v[152:155], a[240:243], a[204:207], v[152:155]
    v_mul_f32 v62, s42, v62
    v_mul_f32 v63, s42, v63
    v_mfma_f32_16x16x32_bf16 v[152:155], a[244:247], a[208:211], v[152:155]
    ds_read_b64_tr_b16 a[16:17], v5 offset:49536
    v_cvt_pk_bf16_f32 v36, v56, v57
    v_mfma_f32_16x16x32_bf16 v[160:163], a[244:247], a[20:23], v[160:163]
    ds_read_b64_tr_b16 a[18:19], v5 offset:51072
    v_cvt_pk_bf16_f32 v37, v58, v59
    v_mfma_f32_16x16x32_bf16 v[160:163], a[240:243], a[212:215], v[160:163]
    v_cvt_pk_bf16_f32 v38, v60, v61
    v_cvt_pk_bf16_f32 v39, v62, v63
    v_mfma_f32_16x16x32_bf16 v[168:171], a[240:243], a[24:27], v[168:171]
    v_mul_f32 v64, s42, v64
    v_mul_f32 v65, s42, v65
    v_mfma_f32_16x16x32_bf16 v[168:171], a[244:247], a[28:31], v[168:171]
    s_waitcnt lgkmcnt(4)
    v_mul_f32 v66, s42, v66
    v_mul_f32 v67, s42, v67
    v_mfma_f32_16x16x32_bf16 v[172:175], a[252:255], a[28:31], v[172:175]
    s_add_u32 s24, s24, 245760
    s_addc_u32 s25, s25, 0
    ds_read_b64_tr_b16 a[240:241], v5 offset:37224
    v_mfma_f32_16x16x32_bf16 v[172:175], a[248:251], a[24:27], v[172:175]
    ds_read_b64_tr_b16 a[242:243], v5 offset:38760
    v_mul_f32 v68, s42, v68
    v_mfma_f32_16x16x32_bf16 v[164:167], a[248:251], a[212:215], v[164:167]
    v_mul_f32 v69, s42, v69
    v_mul_f32 v70, s42, v70
    v_mfma_f32_16x16x32_bf16 v[164:167], a[252:255], a[20:23], v[164:167]
    v_mul_f32 v71, s42, v71
    v_cvt_pk_bf16_f32 v40, v64, v65
    v_mfma_f32_16x16x32_bf16 v[156:159], a[252:255], a[208:211], v[156:159]
    v_cvt_pk_bf16_f32 v41, v66, v67
    v_cvt_pk_bf16_f32 v42, v68, v69
    v_mfma_f32_16x16x32_bf16 v[156:159], a[248:251], a[204:207], v[156:159]
    ds_read_b64_tr_b16 a[244:245], v5 offset:49544
    v_cvt_pk_bf16_f32 v43, v70, v71
    v_mfma_f32_16x16x32_bf16 v[148:151], a[248:251], a[176:179], v[148:151]
    ds_read_b64_tr_b16 a[246:247], v5 offset:51080
    v_mul_f32 v72, s42, v72
    v_mfma_f32_16x16x32_bf16 v[148:151], a[252:255], a[200:203], v[148:151]
    v_mul_f32 v73, s42, v73
    v_mul_f32 v74, s42, v74
    v_mfma_f32_16x16x32_bf16 v[140:143], a[252:255], a[180:183], v[140:143]
    v_mul_f32 v75, s42, v75
    v_mul_f32 v76, s42, v76
    v_mfma_f32_16x16x32_bf16 v[140:143], a[248:251], a[156:159], v[140:143]
    s_waitcnt lgkmcnt(4)
    v_mul_f32 v77, s42, v77
    v_mul_f32 v78, s42, v78
    v_mfma_f32_16x16x32_bf16 v[176:179], a[12:15], a[156:159], v[176:179]
    ds_read_b64_tr_b16 a[248:249], v6 offset:37216
    v_mul_f32 v79, s42, v79
    v_mfma_f32_16x16x32_bf16 v[176:179], a[16:19], a[180:183], v[176:179]
    ds_read_b64_tr_b16 a[250:251], v6 offset:38752
    v_cvt_pk_bf16_f32 v44, v72, v73
    v_mfma_f32_16x16x32_bf16 v[184:187], a[16:19], a[200:203], v[184:187]
    v_cvt_pk_bf16_f32 v45, v74, v75
    v_cvt_pk_bf16_f32 v46, v76, v77
    v_mfma_f32_16x16x32_bf16 v[184:187], a[12:15], a[176:179], v[184:187]
    v_cvt_pk_bf16_f32 v47, v78, v79
    v_mul_f32 v80, s42, v80
    v_mfma_f32_16x16x32_bf16 v[192:195], a[12:15], a[204:207], v[192:195]
    v_mul_f32 v81, s42, v81
    v_mul_f32 v82, s42, v82
    v_mfma_f32_16x16x32_bf16 v[192:195], a[16:19], a[208:211], v[192:195]
    ds_read_b64_tr_b16 a[252:253], v6 offset:49536
    v_mul_f32 v83, s42, v83
    v_mfma_f32_16x16x32_bf16 v[200:203], a[16:19], a[20:23], v[200:203]
    ds_read_b64_tr_b16 a[254:255], v6 offset:51072
    v_mul_f32 v84, s42, v84
    v_mfma_f32_16x16x32_bf16 v[200:203], a[12:15], a[212:215], v[200:203]
    v_mul_f32 v85, s42, v85
    v_mul_f32 v86, s42, v86
    v_mfma_f32_16x16x32_bf16 v[208:211], a[12:15], a[24:27], v[208:211]
    v_mul_f32 v87, s42, v87
    v_cvt_pk_bf16_f32 v48, v80, v81
    v_mfma_f32_16x16x32_bf16 v[208:211], a[16:19], a[28:31], v[208:211]
    s_waitcnt lgkmcnt(4)
    v_cvt_pk_bf16_f32 v49, v82, v83
    v_cvt_pk_bf16_f32 v50, v84, v85
    v_mfma_f32_16x16x32_bf16 v[212:215], a[244:247], a[28:31], v[212:215]
    ds_read_b64_tr_b16 a[12:13], v6 offset:37224
    v_cvt_pk_bf16_f32 v51, v86, v87
    v_mfma_f32_16x16x32_bf16 v[212:215], a[240:243], a[24:27], v[212:215]
    ds_read_b64_tr_b16 a[14:15], v6 offset:38760
    v_mul_f32 v88, s42, v88
    v_mfma_f32_16x16x32_bf16 v[204:207], a[240:243], a[212:215], v[204:207]
    v_mul_f32 v89, s42, v89
    v_mul_f32 v90, s42, v90
    v_mfma_f32_16x16x32_bf16 v[204:207], a[244:247], a[20:23], v[204:207]
    v_mul_f32 v91, s42, v91
    v_mul_f32 v92, s42, v92
    v_mfma_f32_16x16x32_bf16 v[196:199], a[244:247], a[208:211], v[196:199]
    v_mul_f32 v93, s42, v93
    v_mul_f32 v94, s42, v94
    v_mfma_f32_16x16x32_bf16 v[196:199], a[240:243], a[204:207], v[196:199]
    ds_read_b64_tr_b16 a[16:17], v6 offset:49544
    v_mul_f32 v95, s42, v95
    v_mfma_f32_16x16x32_bf16 v[188:191], a[240:243], a[176:179], v[188:191]
    ds_read_b64_tr_b16 a[18:19], v6 offset:51080
    v_cvt_pk_bf16_f32 v52, v88, v89
    v_mfma_f32_16x16x32_bf16 v[188:191], a[244:247], a[200:203], v[188:191]
    v_cvt_pk_bf16_f32 v53, v90, v91
    v_cvt_pk_bf16_f32 v54, v92, v93
    v_mfma_f32_16x16x32_bf16 v[180:183], a[244:247], a[180:183], v[180:183]
    v_cvt_pk_bf16_f32 v55, v94, v95
    v_mul_f32 v96, s42, v96
    v_mfma_f32_16x16x32_bf16 v[180:183], a[240:243], a[156:159], v[180:183]
    s_waitcnt lgkmcnt(4)
    s_waitcnt vmcnt(13)
    s_barrier
    v_mfma_f32_16x16x32_bf16 v[216:219], a[248:251], a[156:159], v[216:219]
    ds_read_b128 a[240:243], v10 offset:0
    v_mul_f32 v97, s42, v97
    v_mfma_f32_16x16x32_bf16 v[216:219], a[252:255], a[180:183], v[216:219]
    v_mul_f32 v98, s42, v98
    v_mul_f32 v99, s42, v99
    v_mfma_f32_16x16x32_bf16 v[224:227], a[252:255], a[200:203], v[224:227]
    v_mul_f32 v100, s42, v100
    v_mul_f32 v101, s42, v101
    v_mfma_f32_16x16x32_bf16 v[224:227], a[248:251], a[176:179], v[224:227]
    v_mul_f32 v102, s42, v102
    v_mul_f32 v103, s42, v103
    v_mfma_f32_16x16x32_bf16 v[232:235], a[248:251], a[204:207], v[232:235]
    v_cvt_pk_bf16_f32 v56, v96, v97
    v_cvt_pk_bf16_f32 v57, v98, v99
    v_mfma_f32_16x16x32_bf16 v[232:235], a[252:255], a[208:211], v[232:235]
    ds_read_b128 a[244:247], v13 offset:0
    v_cvt_pk_bf16_f32 v58, v100, v101
    v_mfma_f32_16x16x32_bf16 v[240:243], a[252:255], a[20:23], v[240:243]
    v_cvt_pk_bf16_f32 v59, v102, v103
    v_mul_f32 v104, s42, v104
    v_mfma_f32_16x16x32_bf16 v[240:243], a[248:251], a[212:215], v[240:243]
    v_mul_f32 v105, s42, v105
    v_mul_f32 v106, s42, v106
    v_mfma_f32_16x16x32_bf16 v[248:251], a[248:251], a[24:27], v[248:251]
    v_mul_f32 v107, s42, v107
    v_mul_f32 v108, s42, v108
    v_mfma_f32_16x16x32_bf16 v[248:251], a[252:255], a[28:31], v[248:251]
    s_waitcnt lgkmcnt(2)
    v_mul_f32 v109, s42, v109
    v_mul_f32 v110, s42, v110
    v_mfma_f32_16x16x32_bf16 v[252:255], a[16:19], a[28:31], v[252:255]
    v_mul_f32 v111, s42, v111
    v_cvt_pk_bf16_f32 v60, v104, v105
    v_mfma_f32_16x16x32_bf16 v[252:255], a[12:15], a[24:27], v[252:255]
    v_cvt_pk_bf16_f32 v61, v106, v107
    v_cvt_pk_bf16_f32 v62, v108, v109
    v_mfma_f32_16x16x32_bf16 v[244:247], a[12:15], a[212:215], v[244:247]
    v_cvt_pk_bf16_f32 v63, v110, v111
    v_mul_f32 v112, s42, v112
    v_mfma_f32_16x16x32_bf16 v[244:247], a[16:19], a[20:23], v[244:247]
    v_mul_f32 v113, s42, v113
    v_mul_f32 v114, s42, v114
    v_mfma_f32_16x16x32_bf16 v[236:239], a[16:19], a[208:211], v[236:239]
    v_mul_f32 v115, s42, v115
    v_mul_f32 v116, s42, v116
    v_mfma_f32_16x16x32_bf16 v[236:239], a[12:15], a[204:207], v[236:239]
    v_mul_f32 v117, s42, v117
    v_mul_f32 v118, s42, v118
    v_mfma_f32_16x16x32_bf16 v[228:231], a[12:15], a[176:179], v[228:231]
    v_mul_f32 v119, s42, v119
    v_cvt_pk_bf16_f32 v64, v112, v113
    v_mfma_f32_16x16x32_bf16 v[228:231], a[16:19], a[200:203], v[228:231]
    v_cvt_pk_bf16_f32 v65, v114, v115
    v_cvt_pk_bf16_f32 v66, v116, v117
    v_mfma_f32_16x16x32_bf16 v[220:223], a[16:19], a[180:183], v[220:223]
    v_cvt_pk_bf16_f32 v67, v118, v119
    v_mul_f32 v120, s42, v120
    v_mfma_f32_16x16x32_bf16 v[220:223], a[12:15], a[156:159], v[220:223]
    s_waitcnt lgkmcnt(0)
    s_mov_b32 s35, 36864
    s_mov_b32 s36, 24576
    v_mul_f32 v121, s42, v121
    v_mul_f32 v122, s42, v122
    v_mul_f32 v123, s42, v123
    v_mul_f32 v124, s42, v124
    v_mul_f32 v125, s42, v125
    v_mul_f32 v126, s42, v126
    v_mul_f32 v127, s42, v127
    v_cvt_pk_bf16_f32 v68, v120, v121
    v_cvt_pk_bf16_f32 v69, v122, v123
    v_cvt_pk_bf16_f32 v70, v124, v125
    v_cvt_pk_bf16_f32 v71, v126, v127
    v_pk_mul_f32 v[128:129], v[128:129], s[42:43]
    v_pk_mul_f32 v[130:131], v[130:131], s[42:43]
    v_pk_mul_f32 v[132:133], v[132:133], s[42:43]
    v_pk_mul_f32 v[134:135], v[134:135], s[42:43]
    v_cvt_pk_bf16_f32 v72, v128, v129
    v_cvt_pk_bf16_f32 v73, v130, v131
    v_cvt_pk_bf16_f32 v74, v132, v133
    v_cvt_pk_bf16_f32 v75, v134, v135
    v_pk_mul_f32 v[136:137], v[136:137], s[42:43]
    v_pk_mul_f32 v[138:139], v[138:139], s[42:43]
    v_pk_mul_f32 v[140:141], v[140:141], s[42:43]
    v_pk_mul_f32 v[142:143], v[142:143], s[42:43]
    v_cvt_pk_bf16_f32 v76, v136, v137
    v_cvt_pk_bf16_f32 v77, v138, v139
    v_cvt_pk_bf16_f32 v78, v140, v141
    v_cvt_pk_bf16_f32 v79, v142, v143
    v_pk_mul_f32 v[144:145], v[144:145], s[42:43]
    v_pk_mul_f32 v[146:147], v[146:147], s[42:43]
    v_pk_mul_f32 v[148:149], v[148:149], s[42:43]
    v_pk_mul_f32 v[150:151], v[150:151], s[42:43]
    v_cvt_pk_bf16_f32 v80, v144, v145
    v_cvt_pk_bf16_f32 v81, v146, v147
    v_cvt_pk_bf16_f32 v82, v148, v149
    v_cvt_pk_bf16_f32 v83, v150, v151
    v_pk_mul_f32 v[152:153], v[152:153], s[42:43]
    v_pk_mul_f32 v[154:155], v[154:155], s[42:43]
    v_pk_mul_f32 v[156:157], v[156:157], s[42:43]
    v_pk_mul_f32 v[158:159], v[158:159], s[42:43]
    v_cvt_pk_bf16_f32 v84, v152, v153
    v_cvt_pk_bf16_f32 v85, v154, v155
    v_cvt_pk_bf16_f32 v86, v156, v157
    v_cvt_pk_bf16_f32 v87, v158, v159
    v_pk_mul_f32 v[160:161], v[160:161], s[42:43]
    v_pk_mul_f32 v[162:163], v[162:163], s[42:43]
    v_pk_mul_f32 v[164:165], v[164:165], s[42:43]
    v_pk_mul_f32 v[166:167], v[166:167], s[42:43]
    v_cvt_pk_bf16_f32 v88, v160, v161
    v_cvt_pk_bf16_f32 v89, v162, v163
    v_cvt_pk_bf16_f32 v90, v164, v165
    v_cvt_pk_bf16_f32 v91, v166, v167
    v_pk_mul_f32 v[168:169], v[168:169], s[42:43]
    v_pk_mul_f32 v[170:171], v[170:171], s[42:43]
    v_pk_mul_f32 v[172:173], v[172:173], s[42:43]
    v_pk_mul_f32 v[174:175], v[174:175], s[42:43]
    v_cvt_pk_bf16_f32 v92, v168, v169
    v_cvt_pk_bf16_f32 v93, v170, v171
    v_cvt_pk_bf16_f32 v94, v172, v173
    v_cvt_pk_bf16_f32 v95, v174, v175
    v_pk_mul_f32 v[176:177], v[176:177], s[42:43]
    v_pk_mul_f32 v[178:179], v[178:179], s[42:43]
    v_pk_mul_f32 v[180:181], v[180:181], s[42:43]
    v_pk_mul_f32 v[182:183], v[182:183], s[42:43]
    v_cvt_pk_bf16_f32 v96, v176, v177
    v_cvt_pk_bf16_f32 v97, v178, v179
    v_cvt_pk_bf16_f32 v98, v180, v181
    v_cvt_pk_bf16_f32 v99, v182, v183
    v_pk_mul_f32 v[184:185], v[184:185], s[42:43]
    v_pk_mul_f32 v[186:187], v[186:187], s[42:43]
    v_pk_mul_f32 v[188:189], v[188:189], s[42:43]
    v_pk_mul_f32 v[190:191], v[190:191], s[42:43]
    v_cvt_pk_bf16_f32 v100, v184, v185
    v_cvt_pk_bf16_f32 v101, v186, v187
    v_cvt_pk_bf16_f32 v102, v188, v189
    v_cvt_pk_bf16_f32 v103, v190, v191
    v_pk_mul_f32 v[192:193], v[192:193], s[42:43]
    v_pk_mul_f32 v[194:195], v[194:195], s[42:43]
    v_pk_mul_f32 v[196:197], v[196:197], s[42:43]
    v_pk_mul_f32 v[198:199], v[198:199], s[42:43]
    v_cvt_pk_bf16_f32 v104, v192, v193
    v_cvt_pk_bf16_f32 v105, v194, v195
    v_cvt_pk_bf16_f32 v106, v196, v197
    v_cvt_pk_bf16_f32 v107, v198, v199
    v_pk_mul_f32 v[200:201], v[200:201], s[42:43]
    v_pk_mul_f32 v[202:203], v[202:203], s[42:43]
    v_pk_mul_f32 v[204:205], v[204:205], s[42:43]
    v_pk_mul_f32 v[206:207], v[206:207], s[42:43]
    v_cvt_pk_bf16_f32 v108, v200, v201
    v_cvt_pk_bf16_f32 v109, v202, v203
    v_cvt_pk_bf16_f32 v110, v204, v205
    v_cvt_pk_bf16_f32 v111, v206, v207
    v_pk_mul_f32 v[208:209], v[208:209], s[42:43]
    v_pk_mul_f32 v[210:211], v[210:211], s[42:43]
    v_pk_mul_f32 v[212:213], v[212:213], s[42:43]
    v_pk_mul_f32 v[214:215], v[214:215], s[42:43]
    v_cvt_pk_bf16_f32 v112, v208, v209
    v_cvt_pk_bf16_f32 v113, v210, v211
    v_cvt_pk_bf16_f32 v114, v212, v213
    v_cvt_pk_bf16_f32 v115, v214, v215
    v_pk_mul_f32 v[216:217], v[216:217], s[42:43]
    v_pk_mul_f32 v[218:219], v[218:219], s[42:43]
    v_pk_mul_f32 v[220:221], v[220:221], s[42:43]
    v_pk_mul_f32 v[222:223], v[222:223], s[42:43]
    v_cvt_pk_bf16_f32 v116, v216, v217
    v_cvt_pk_bf16_f32 v117, v218, v219
    v_cvt_pk_bf16_f32 v118, v220, v221
    v_cvt_pk_bf16_f32 v119, v222, v223
    v_pk_mul_f32 v[224:225], v[224:225], s[42:43]
    v_pk_mul_f32 v[226:227], v[226:227], s[42:43]
    v_pk_mul_f32 v[228:229], v[228:229], s[42:43]
    v_pk_mul_f32 v[230:231], v[230:231], s[42:43]
    v_cvt_pk_bf16_f32 v120, v224, v225
    v_cvt_pk_bf16_f32 v121, v226, v227
    v_cvt_pk_bf16_f32 v122, v228, v229
    v_cvt_pk_bf16_f32 v123, v230, v231
    s_branch L_sm1
.p2align 6
L_t1:
    v_readfirstlane_b32 s3, v209
    s_mul_i32 s31, s28, 3080
    s_nop 2
    s_cmp_ge_u32 s3, 16
    s_cbranch_scc0 L_w1
L_t2:
    s_waitcnt lgkmcnt(0)
    s_waitcnt vmcnt(0)
    s_barrier
    ds_read_b64_tr_b16 a[240:241], v11 offset:0
    ds_read_b64_tr_b16 a[242:243], v11 offset:6144
    ds_read_b64_tr_b16 a[244:245], v206 offset:0
    ds_read_b64_tr_b16 a[246:247], v206 offset:6144
    ds_read_b64_tr_b16 a[248:249], v207 offset:0
    ds_read_b64_tr_b16 a[250:251], v207 offset:6144
    s_add_u32 m0, s31, 0
    s_xor_b32 s3, s62, 0
    s_mul_i32 s32, s3, 40960
    v_add_f32 v196, v196, v197
    v_add_f32 v198, v198, v199
    v_add_f32 v200, v200, v201
    v_add_f32 v202, v202, v203
    v_add_f32 v204, v204, v205
    v_mov_b32 v210, v196
    v_mov_b32 v211, v198
    v_mov_b32 v212, v200
    v_mov_b32 v213, v202
    v_mov_b32 v214, v204
    buffer_load_dwordx4 v242, s[64:67], s32 offen lds
    v_permlane32_swap_b32 v210, v196
    v_permlane32_swap_b32 v211, v198
    v_permlane32_swap_b32 v212, v200
    v_permlane32_swap_b32 v213, v202
    v_permlane32_swap_b32 v214, v204
    v_add_f32 v196, v196, v210
    v_add_f32 v198, v198, v211
    v_add_f32 v200, v200, v212
    v_add_f32 v202, v202, v213
    v_add_f32 v204, v204, v214
    s_lshl_b32 s29, s28, 2
    s_add_u32 s29, s29, 160000
    s_waitcnt lgkmcnt(4)
    v_mfma_f32_16x16x32_bf16 a[0:3], a[240:243], v[136:139], a[0:3]
    ds_read_b64_tr_b16 a[252:253], v208 offset:0
    v_mov_b32 v210, v196
    v_mfma_f32_16x16x32_bf16 a[4:7], a[240:243], v[140:143], a[4:7]
    ds_read_b64_tr_b16 a[254:255], v208 offset:6144
    v_mov_b32 v211, v198
    v_mfma_f32_16x16x32_bf16 a[8:11], a[240:243], v[144:147], a[8:11]
    v_mov_b32 v212, v200
    v_mov_b32 v213, v202
    v_mfma_f32_16x16x32_bf16 a[12:15], a[240:243], v[148:151], a[12:15]
    buffer_load_dwordx4 v243, s[64:67], s32 offen offset:1024 lds
    v_mov_b32 v214, v204
    v_mfma_f32_16x16x32_bf16 a[16:19], a[240:243], v[152:155], a[16:19]
    s_waitcnt lgkmcnt(4)
    v_permlane16_swap_b32 v210, v196
    v_permlane16_swap_b32 v211, v198
    v_mfma_f32_16x16x32_bf16 a[36:39], a[244:247], v[152:155], a[36:39]
    ds_read_b64_tr_b16 a[240:241], v11 offset:128
    v_permlane16_swap_b32 v212, v200
    v_mfma_f32_16x16x32_bf16 a[32:35], a[244:247], v[148:151], a[32:35]
    ds_read_b64_tr_b16 a[242:243], v11 offset:6272
    v_permlane16_swap_b32 v213, v202
    v_mfma_f32_16x16x32_bf16 a[28:31], a[244:247], v[144:147], a[28:31]
    v_permlane16_swap_b32 v214, v204
    v_add_f32 v196, v196, v210
    v_mfma_f32_16x16x32_bf16 a[24:27], a[244:247], v[140:143], a[24:27]
    buffer_load_dwordx4 v244, s[64:67], s32 offen offset:2048 lds
    v_add_f32 v198, v198, v211
    v_mfma_f32_16x16x32_bf16 a[20:23], a[244:247], v[136:139], a[20:23]
    s_waitcnt lgkmcnt(4)
    v_add_f32 v200, v200, v212
    v_add_f32 v202, v202, v213
    v_mfma_f32_16x16x32_bf16 a[40:43], a[248:251], v[136:139], a[40:43]
    s_xor_b32 s3, s62, 0
    ds_read_b64_tr_b16 a[244:245], v206 offset:128
    v_add_f32 v204, v204, v214
    v_mfma_f32_16x16x32_bf16 a[44:47], a[248:251], v[140:143], a[44:47]
    s_mul_i32 s35, s3, 10240
    ds_read_b64_tr_b16 a[246:247], v206 offset:6272
    v_max3_f32 v176, v196, v198, v200
    v_mfma_f32_16x16x32_bf16 a[48:51], a[248:251], v[144:147], a[48:51]
    s_add_u32 s36, s35, 4096
    v_min3_f32 v177, v196, v198, v200
    v_max3_f32 v176, v176, v202, v204
    v_mfma_f32_16x16x32_bf16 a[52:55], a[248:251], v[148:151], a[52:55]
    buffer_load_dwordx4 v[216:219], v0, s[44:47], s35 offen sc1
    v_min3_f32 v177, v177, v202, v204
    v_mfma_f32_16x16x32_bf16 a[56:59], a[248:251], v[152:155], a[56:59]
    s_waitcnt lgkmcnt(4)
    v_cmp_lt_f32 vcc, s41, v176
    v_cmp_gt_f32 s[100:101], s40, v177
    v_mfma_f32_16x16x32_bf16 a[76:79], a[252:255], v[152:155], a[76:79]
    ds_read_b64_tr_b16 a[248:249], v207 offset:128
    v_accvgpr_read_b32 v156, a0
    v_mfma_f32_16x16x32_bf16 a[72:75], a[252:255], v[148:151], a[72:75]
    ds_read_b64_tr_b16 a[250:251], v207 offset:6272
    v_accvgpr_read_b32 v157, a1
    v_mfma_f32_16x16x32_bf16 a[68:71], a[252:255], v[144:147], a[68:71]
    v_rcp_f32 v236, v196
    v_mfma_f32_16x16x32_bf16 a[64:67], a[252:255], v[140:143], a[64:67]
    buffer_load_dwordx4 v[220:223], v0, s[44:47], s35 offen offset:1024 sc1
    v_accvgpr_read_b32 v158, a2
    v_mfma_f32_16x16x32_bf16 a[60:63], a[252:255], v[136:139], a[60:63]
    s_waitcnt lgkmcnt(4)
    s_or_b64 vcc, vcc, s[100:101]
    s_cselect_b32 s86, 1, 0
    v_rcp_f32 v237, v198
    v_mfma_f32_16x16x32_bf16 a[80:83], a[240:243], v[136:139], a[80:83]
    ds_read_b64_tr_b16 a[252:253], v208 offset:128
    v_mov_b32 v176, s86
    v_mfma_f32_16x16x32_bf16 a[84:87], a[240:243], v[140:143], a[84:87]
    ds_read_b64_tr_b16 a[254:255], v208 offset:6272
    v_mov_b32 v177, s29
    v_mfma_f32_16x16x32_bf16 a[88:91], a[240:243], v[144:147], a[88:91]
    ds_write_b32 v177, v176 offset:0
    v_mov_b32 v178, 160000
    v_mfma_f32_16x16x32_bf16 a[92:95], a[240:243], v[148:151], a[92:95]
    buffer_load_dwordx4 v[224:227], v0, s[44:47], s35 offen offset:2048 sc1
    v_accvgpr_read_b32 v159, a3
    v_mfma_f32_16x16x32_bf16 a[96:99], a[240:243], v[152:155], a[96:99]
    s_waitcnt lgkmcnt(5)
    v_rcp_f32 v238, v200
    v_mfma_f32_16x16x32_bf16 a[116:119], a[244:247], v[152:155], a[116:119]
    ds_read_b64_tr_b16 a[240:241], v11 offset:256
    v_accvgpr_read_b32 v160, a20
    v_mfma_f32_16x16x32_bf16 a[112:115], a[244:247], v[148:151], a[112:115]
    ds_read_b64_tr_b16 a[242:243], v11 offset:6400
    v_accvgpr_read_b32 v161, a21
    v_mfma_f32_16x16x32_bf16 a[108:111], a[244:247], v[144:147], a[108:111]
    v_rcp_f32 v239, v202
    v_mfma_f32_16x16x32_bf16 a[104:107], a[244:247], v[140:143], a[104:107]
    buffer_load_dwordx4 v[228:231], v0, s[44:47], s35 offen offset:3072 sc1
    v_accvgpr_read_b32 v162, a22
    v_mfma_f32_16x16x32_bf16 a[100:103], a[244:247], v[136:139], a[100:103]
    s_waitcnt lgkmcnt(5)
    s_waitcnt lgkmcnt(2)
    s_barrier
    v_rcp_f32 v240, v204
    v_mfma_f32_16x16x32_bf16 a[120:123], a[248:251], v[136:139], a[120:123]
    ds_read_b64_tr_b16 a[244:245], v206 offset:256
    v_accvgpr_read_b32 v163, a23
    v_mfma_f32_16x16x32_bf16 a[124:127], a[248:251], v[140:143], a[124:127]
    ds_read_b64_tr_b16 a[246:247], v206 offset:6400
    v_mul_f32 v156, v156, v236
    v_mfma_f32_16x16x32_bf16 a[128:131], a[248:251], v[144:147], a[128:131]
    ds_read_b128 v[180:183], v178 offset:0
    v_mul_f32 v157, v157, v236
    v_mfma_f32_16x16x32_bf16 a[132:135], a[248:251], v[148:151], a[132:135]
    buffer_load_dwordx4 v[232:235], v0, s[44:47], s36 offen sc1
    v_mul_f32 v158, v158, v236
    v_mfma_f32_16x16x32_bf16 a[136:139], a[248:251], v[152:155], a[136:139]
    s_waitcnt lgkmcnt(6)
    v_mul_f32 v159, v159, v236
    v_mul_f32 v160, v160, v236
    v_mfma_f32_16x16x32_bf16 a[156:159], a[252:255], v[152:155], a[156:159]
    s_add_u32 m0, s31, 12320
    ds_read_b64_tr_b16 a[248:249], v207 offset:256
    v_mul_f32 v161, v161, v236
    v_mfma_f32_16x16x32_bf16 a[152:155], a[252:255], v[148:151], a[152:155]
    s_xor_b32 s3, s62, 1
    ds_read_b64_tr_b16 a[250:251], v207 offset:6400
    v_mul_f32 v162, v162, v236
    v_mfma_f32_16x16x32_bf16 a[148:151], a[252:255], v[144:147], a[148:151]
    s_mul_i32 s32, s3, 40960
    v_mul_f32 v163, v163, v236
    v_cvt_pk_bf16_f32 v184, v156, v157
    v_mfma_f32_16x16x32_bf16 a[144:147], a[252:255], v[140:143], a[144:147]
    buffer_load_dwordx4 v242, s[64:67], s32 offen lds
    v_cvt_pk_bf16_f32 v185, v158, v159
    v_mfma_f32_16x16x32_bf16 a[140:143], a[252:255], v[136:139], a[140:143]
    s_waitcnt lgkmcnt(5)
    s_waitcnt lgkmcnt(2)
    v_or3_b32 v178, v180, v181, v182
    v_or_b32 v178, v178, v183
    v_mfma_f32_16x16x32_bf16 a[160:163], a[240:243], v[136:139], a[160:163]
    ds_read_b64_tr_b16 a[252:253], v208 offset:256
    v_readfirstlane_b32 s86, v178
    v_mfma_f32_16x16x32_bf16 a[164:167], a[240:243], v[140:143], a[164:167]
    ds_read_b64_tr_b16 a[254:255], v208 offset:6400
    v_cvt_pk_bf16_f32 v186, v160, v161
    v_mfma_f32_16x16x32_bf16 a[168:171], a[240:243], v[144:147], a[168:171]
    v_cvt_pk_bf16_f32 v187, v162, v163
    v_accvgpr_read_b32 v164, a4
    v_mfma_f32_16x16x32_bf16 a[172:175], a[240:243], v[148:151], a[172:175]
    buffer_load_dwordx4 v243, s[64:67], s32 offen offset:1024 lds
    v_accvgpr_read_b32 v165, a5
    v_mfma_f32_16x16x32_bf16 a[176:179], a[240:243], v[152:155], a[176:179]
    s_waitcnt lgkmcnt(5)
    v_accvgpr_read_b32 v166, a6
    v_accvgpr_read_b32 v167, a7
    v_mfma_f32_16x16x32_bf16 a[196:199], a[244:247], v[152:155], a[196:199]
    v_accvgpr_read_b32 v168, a24
    v_accvgpr_read_b32 v169, a25
    v_mfma_f32_16x16x32_bf16 a[192:195], a[244:247], v[148:151], a[192:195]
    v_accvgpr_read_b32 v170, a26
    v_accvgpr_read_b32 v171, a27
    v_mfma_f32_16x16x32_bf16 a[188:191], a[244:247], v[144:147], a[188:191]
    v_mul_f32 v164, v164, v237
    v_mul_f32 v165, v165, v237
    v_mfma_f32_16x16x32_bf16 a[184:187], a[244:247], v[140:143], a[184:187]
    buffer_load_dwordx4 v244, s[64:67], s32 offen offset:2048 lds
    v_mul_f32 v166, v166, v237
    v_mfma_f32_16x16x32_bf16 a[180:183], a[244:247], v[136:139], a[180:183]
    s_waitcnt lgkmcnt(2)
    v_mul_f32 v167, v167, v237
    v_mul_f32 v168, v168, v237
    v_mfma_f32_16x16x32_bf16 a[200:203], a[248:251], v[136:139], a[200:203]
    s_add_u32 m0, s31, 24640
    v_mul_f32 v169, v169, v237
    v_mul_f32 v170, v170, v237
    v_mfma_f32_16x16x32_bf16 a[204:207], a[248:251], v[140:143], a[204:207]
    s_xor_b32 s3, s62, 2
    v_mul_f32 v171, v171, v237
    v_cvt_pk_bf16_f32 v188, v164, v165
    v_mfma_f32_16x16x32_bf16 a[208:211], a[248:251], v[144:147], a[208:211]
    s_mul_i32 s32, s3, 40960
    v_cvt_pk_bf16_f32 v189, v166, v167
    v_cvt_pk_bf16_f32 v190, v168, v169
    v_mfma_f32_16x16x32_bf16 a[212:215], a[248:251], v[148:151], a[212:215]
    buffer_load_dwordx4 v242, s[64:67], s32 offen lds
    v_cvt_pk_bf16_f32 v191, v170, v171
    v_mfma_f32_16x16x32_bf16 a[216:219], a[248:251], v[152:155], a[216:219]
    s_waitcnt lgkmcnt(0)
    v_accvgpr_read_b32 v156, a8
    v_accvgpr_read_b32 v157, a9
    v_mfma_f32_16x16x32_bf16 a[236:239], a[252:255], v[152:155], a[236:239]
    v_accvgpr_read_b32 v158, a10
    v_accvgpr_read_b32 v159, a11
    v_mfma_f32_16x16x32_bf16 a[232:235], a[252:255], v[148:151], a[232:235]
    v_accvgpr_read_b32 v160, a28
    v_accvgpr_read_b32 v161, a29
    v_mfma_f32_16x16x32_bf16 a[228:231], a[252:255], v[144:147], a[228:231]
    v_accvgpr_read_b32 v162, a30
    v_accvgpr_read_b32 v163, a31
    v_mfma_f32_16x16x32_bf16 a[224:227], a[252:255], v[140:143], a[224:227]
    buffer_load_dwordx4 v243, s[64:67], s32 offen offset:1024 lds
    v_mul_f32 v156, v156, v238
    v_mfma_f32_16x16x32_bf16 a[220:223], a[252:255], v[136:139], a[220:223]
    v_mul_f32 v157, v157, v238
    v_mul_f32 v158, v158, v238
    s_cmp_lg_u32 s86, 0
    s_cbranch_scc1 L_slow
    v_mul_f32 v159, v159, v238
    v_mul_f32 v160, v160, v238
    v_mul_f32 v161, v161, v238
    v_mul_f32 v162, v162, v238
    v_mul_f32 v163, v163, v238
    v_cvt_pk_bf16_f32 v192, v156, v157
    v_cvt_pk_bf16_f32 v193, v158, v159
    v_cvt_pk_bf16_f32 v194, v160, v161
    v_cvt_pk_bf16_f32 v195, v162, v163
    v_accvgpr_write_b32 a0, v184
    v_accvgpr_write_b32 a1, v185
    v_accvgpr_write_b32 a2, v186
    v_accvgpr_write_b32 a3, v187
    v_accvgpr_write_b32 a4, v188
    v_accvgpr_write_b32 a5, v189
    v_accvgpr_write_b32 a6, v190
    v_accvgpr_write_b32 a7, v191
    v_accvgpr_write_b32 a8, v192
    v_accvgpr_write_b32 a9, v193
    v_accvgpr_write_b32 a10, v194
    v_accvgpr_write_b32 a11, v195
    v_accvgpr_read_b32 v164, a12
    v_accvgpr_read_b32 v165, a13
    v_accvgpr_read_b32 v166, a14
    v_accvgpr_read_b32 v167, a15
    v_accvgpr_read_b32 v168, a32
    v_accvgpr_read_b32 v169, a33
    v_accvgpr_read_b32 v170, a34
    v_accvgpr_read_b32 v171, a35
    buffer_load_dwordx4 v244, s[64:67], s32 offen offset:2048 lds
    v_pk_mul_f32 v[164:165], v[164:165], v[238:239] op_sel:[0,1]
    v_pk_mul_f32 v[166:167], v[166:167], v[238:239] op_sel:[0,1]
    v_pk_mul_f32 v[168:169], v[168:169], v[238:239] op_sel:[0,1]
    v_pk_mul_f32 v[170:171], v[170:171], v[238:239] op_sel:[0,1]
    v_cvt_pk_bf16_f32 v28, v164, v165
    v_cvt_pk_bf16_f32 v29, v166, v167
    v_cvt_pk_bf16_f32 v30, v168, v169
    v_cvt_pk_bf16_f32 v31, v170, v171
    s_xor_b32 s3, s62, 1
    s_mul_i32 s35, s3, 10240
    s_add_u32 s36, s35, 4096
    buffer_load_dwordx4 a[20:23], v0, s[44:47], s35 offen sc1
    v_accvgpr_write_b32 a12, v28
    v_accvgpr_write_b32 a13, v29
    v_accvgpr_write_b32 a14, v30
    v_accvgpr_write_b32 a15, v31
    v_accvgpr_read_b32 v156, a16
    v_accvgpr_read_b32 v157, a17
    v_accvgpr_read_b32 v158, a18
    v_accvgpr_read_b32 v159, a19
    v_accvgpr_read_b32 v160, a36
    v_accvgpr_read_b32 v161, a37
    v_accvgpr_read_b32 v162, a38
    v_accvgpr_read_b32 v163, a39
    buffer_load_dwordx4 a[24:27], v0, s[44:47], s35 offen offset:1024 sc1
    v_lshrrev_b32 v140, 4, v0
    s_getpc_b64 s[100:101]
    s_add_u32 s100, s100, L_o-.
    s_addc_u32 s101, s101, 0
    s_lshr_b32 s29, s2, 3
    s_lshl_b32 s29, s29, 2
    s_add_u32 s29, s29, s28
    s_mul_i32 s29, s29, 3
    s_mov_b32 s86, L_w1-L_o
    v_min_u32 v138, 2, v140
    v_add_u32 v138, s29, v138
    v_lshlrev_b32 v138, 7, v138
    v_min_u32 v138, s86, v138
    v_mov_b32 v139, s101
    v_add_co_u32 v138, vcc, s100, v138
    s_nop 1
    v_addc_co_u32 v139, vcc, 0, v139, vcc
    global_load_dword v241, v[138:139], off
    v_pk_mul_f32 v[156:157], v[156:157], v[240:241] op_sel_hi:[1,0]
    v_pk_mul_f32 v[158:159], v[158:159], v[240:241] op_sel_hi:[1,0]
    v_pk_mul_f32 v[160:161], v[160:161], v[240:241] op_sel_hi:[1,0]
    v_pk_mul_f32 v[162:163], v[162:163], v[240:241] op_sel_hi:[1,0]
    v_cvt_pk_bf16_f32 v32, v156, v157
    v_cvt_pk_bf16_f32 v33, v158, v159
    v_cvt_pk_bf16_f32 v34, v160, v161
    v_cvt_pk_bf16_f32 v35, v162, v163
    buffer_load_dwordx4 a[28:31], v0, s[44:47], s35 offen offset:2048 sc1
    v_accvgpr_write_b32 a16, v32
    v_accvgpr_write_b32 a17, v33
    v_accvgpr_write_b32 a18, v34
    v_accvgpr_write_b32 a19, v35
    v_accvgpr_read_b32 v164, a40
    v_accvgpr_read_b32 v165, a41
    v_accvgpr_read_b32 v166, a42
    v_accvgpr_read_b32 v167, a43
    v_accvgpr_read_b32 v168, a60
    v_accvgpr_read_b32 v169, a61
    v_accvgpr_read_b32 v170, a62
    v_accvgpr_read_b32 v171, a63
    buffer_load_dwordx4 a[32:35], v0, s[44:47], s35 offen offset:3072 sc1
    v_pk_mul_f32 v[164:165], v[164:165], v[236:237] op_sel_hi:[1,0]
    v_pk_mul_f32 v[166:167], v[166:167], v[236:237] op_sel_hi:[1,0]
    v_pk_mul_f32 v[168:169], v[168:169], v[236:237] op_sel_hi:[1,0]
    v_pk_mul_f32 v[170:171], v[170:171], v[236:237] op_sel_hi:[1,0]
    v_cvt_pk_bf16_f32 v36, v164, v165
    v_cvt_pk_bf16_f32 v37, v166, v167
    v_cvt_pk_bf16_f32 v38, v168, v169
    v_cvt_pk_bf16_f32 v39, v170, v171
    buffer_load_dwordx4 a[36:39], v0, s[44:47], s36 offen sc1
    v_accvgpr_write_b32 a40, v36
    v_accvgpr_write_b32 a41, v37
    v_accvgpr_write_b32 a42, v38
    v_accvgpr_write_b32 a43, v39
    v_accvgpr_read_b32 v156, a44
    v_accvgpr_read_b32 v157, a45
    v_accvgpr_read_b32 v158, a46
    v_accvgpr_read_b32 v159, a47
    v_accvgpr_read_b32 v160, a64
    v_accvgpr_read_b32 v161, a65
    v_accvgpr_read_b32 v162, a66
    v_accvgpr_read_b32 v163, a67
    s_xor_b32 s3, s62, 2
    s_mul_i32 s35, s3, 10240
    s_add_u32 s36, s35, 4096
    buffer_load_dwordx4 a[60:63], v0, s[44:47], s35 offen sc1
    v_pk_mul_f32 v[156:157], v[156:157], v[236:237] op_sel:[0,1]
    v_pk_mul_f32 v[158:159], v[158:159], v[236:237] op_sel:[0,1]
    v_pk_mul_f32 v[160:161], v[160:161], v[236:237] op_sel:[0,1]
    v_pk_mul_f32 v[162:163], v[162:163], v[236:237] op_sel:[0,1]
    v_cvt_pk_bf16_f32 v40, v156, v157
    v_cvt_pk_bf16_f32 v41, v158, v159
    v_cvt_pk_bf16_f32 v42, v160, v161
    v_cvt_pk_bf16_f32 v43, v162, v163
    buffer_load_dwordx4 a[64:67], v0, s[44:47], s35 offen offset:1024 sc1
    v_accvgpr_write_b32 a44, v40
    v_accvgpr_write_b32 a45, v41
    v_accvgpr_write_b32 a46, v42
    v_accvgpr_write_b32 a47, v43
    v_accvgpr_read_b32 v164, a48
    v_accvgpr_read_b32 v165, a49
    v_accvgpr_read_b32 v166, a50
    v_accvgpr_read_b32 v167, a51
    v_accvgpr_read_b32 v168, a68
    v_accvgpr_read_b32 v169, a69
    v_accvgpr_read_b32 v170, a70
    v_accvgpr_read_b32 v171, a71
    buffer_load_dwordx4 a[68:71], v0, s[44:47], s35 offen offset:2048 sc1
    v_pk_mul_f32 v[164:165], v[164:165], v[238:239] op_sel_hi:[1,0]
    v_pk_mul_f32 v[166:167], v[166:167], v[238:239] op_sel_hi:[1,0]
    v_pk_mul_f32 v[168:169], v[168:169], v[238:239] op_sel_hi:[1,0]
    v_pk_mul_f32 v[170:171], v[170:171], v[238:239] op_sel_hi:[1,0]
    v_cvt_pk_bf16_f32 v44, v164, v165
    v_cvt_pk_bf16_f32 v45, v166, v167
    v_cvt_pk_bf16_f32 v46, v168, v169
    v_cvt_pk_bf16_f32 v47, v170, v171
    v_accvgpr_write_b32 a48, v44
    v_accvgpr_write_b32 a49, v45
    v_accvgpr_write_b32 a50, v46
    v_accvgpr_write_b32 a51, v47
    v_accvgpr_read_b32 v156, a52
    v_accvgpr_read_b32 v157, a53
    v_accvgpr_read_b32 v158, a54
    v_accvgpr_read_b32 v159, a55
    v_accvgpr_read_b32 v160, a72
    v_accvgpr_read_b32 v161, a73
    v_accvgpr_read_b32 v162, a74
    v_accvgpr_read_b32 v163, a75
    buffer_load_dwordx4 a[72:75], v0, s[44:47], s35 offen offset:3072 sc1
    s_add_u32 s78, s84, s37
    s_add_u32 s50, s82, 16
    s_waitcnt vmcnt(21)
    s_barrier
    ds_read_b64_tr_b16 a[240:241], v245 offset:0
    ds_read_b64_tr_b16 a[242:243], v245 offset:1536
    ds_read_b64_tr_b16 a[244:245], v245 offset:8
    ds_read_b64_tr_b16 a[246:247], v245 offset:1544
    ds_read_b64_tr_b16 a[248:249], v246 offset:0
    ds_read_b64_tr_b16 a[250:251], v246 offset:1536
    ds_read_b64_tr_b16 a[252:253], v246 offset:8
    ds_read_b64_tr_b16 a[254:255], v246 offset:1544
    v_pk_mul_f32 v[156:157], v[156:157], v[238:239] op_sel:[0,1]
    v_pk_mul_f32 v[158:159], v[158:159], v[238:239] op_sel:[0,1]
    v_pk_mul_f32 v[160:161], v[160:161], v[238:239] op_sel:[0,1]
    v_pk_mul_f32 v[162:163], v[162:163], v[238:239] op_sel:[0,1]
    v_cvt_pk_bf16_f32 v48, v156, v157
    v_cvt_pk_bf16_f32 v49, v158, v159
    v_cvt_pk_bf16_f32 v50, v160, v161
    v_cvt_pk_bf16_f32 v51, v162, v163
    v_accvgpr_write_b32 a52, v48
    v_accvgpr_write_b32 a53, v49
    v_accvgpr_write_b32 a54, v50
    v_accvgpr_write_b32 a55, v51
    v_accvgpr_read_b32 v164, a56
    v_accvgpr_read_b32 v165, a57
    v_accvgpr_read_b32 v166, a58
    v_accvgpr_read_b32 v167, a59
    v_accvgpr_read_b32 v168, a76
    v_accvgpr_read_b32 v169, a77
    v_accvgpr_read_b32 v170, a78
    v_accvgpr_read_b32 v171, a79
    buffer_load_dwordx4 a[76:79], v0, s[44:47], s36 offen sc1
    v_pk_mul_f32 v[164:165], v[164:165], v[240:241] op_sel_hi:[1,0]
    v_pk_mul_f32 v[166:167], v[166:167], v[240:241] op_sel_hi:[1,0]
    v_pk_mul_f32 v[168:169], v[168:169], v[240:241] op_sel_hi:[1,0]
    v_pk_mul_f32 v[170:171], v[170:171], v[240:241] op_sel_hi:[1,0]
    v_cvt_pk_bf16_f32 v52, v164, v165
    v_cvt_pk_bf16_f32 v53, v166, v167
    v_cvt_pk_bf16_f32 v54, v168, v169
    v_cvt_pk_bf16_f32 v55, v170, v171
    v_accvgpr_write_b32 a56, v52
    v_accvgpr_write_b32 a57, v53
    v_accvgpr_write_b32 a58, v54
    v_accvgpr_write_b32 a59, v55
L_o:
    s_waitcnt vmcnt(17)
    s_waitcnt lgkmcnt(6)
    v_mfma_f32_16x16x32_bf16 v[16:19], a[240:243], v[216:219], 0
    s_add_u32 m0, s31, 36960
    ds_read_b64_tr_b16 v[6:7], v247 offset:0
    v_accvgpr_read_b32 v1, a80
    v_mfma_f32_16x16x32_bf16 v[56:59], a[240:243], v[220:223], 0
    s_xor_b32 s3, s62, 3
    ds_read_b64_tr_b16 v[8:9], v247 offset:1536
    v_accvgpr_read_b32 v2, a81
    v_mfma_f32_16x16x32_bf16 v[96:99], a[240:243], v[224:227], 0
    s_mul_i32 s32, s3, 40960
    v_mul_f32 v1, v1, v236
    v_mul_f32 v2, v2, v236
    v_mfma_f32_16x16x32_bf16 v[136:139], a[240:243], v[228:231], 0
    buffer_load_dwordx4 v242, s[64:67], s32 offen lds
    v_cvt_pk_bf16_f32 v1, v1, v2
    v_mfma_f32_16x16x32_bf16 v[176:179], a[240:243], v[232:235], 0
    s_waitcnt lgkmcnt(6)
    v_accvgpr_read_b32 v2, a82
    v_accvgpr_read_b32 v3, a83
    v_mfma_f32_16x16x32_bf16 v[180:183], a[244:247], v[232:235], 0
    ds_read_b64_tr_b16 v[10:11], v247 offset:8
    v_mul_f32 v2, v2, v236
    v_mfma_f32_16x16x32_bf16 v[140:143], a[244:247], v[228:231], 0
    ds_read_b64_tr_b16 v[12:13], v247 offset:1544
    v_mul_f32 v3, v3, v236
    v_mfma_f32_16x16x32_bf16 v[100:103], a[244:247], v[224:227], 0
    v_cvt_pk_bf16_f32 v2, v2, v3
    v_accvgpr_read_b32 v3, a100
    v_mfma_f32_16x16x32_bf16 v[60:63], a[244:247], v[220:223], 0
    buffer_load_dwordx4 v243, s[64:67], s32 offen offset:1024 lds
    v_accvgpr_read_b32 v4, a101
    v_mfma_f32_16x16x32_bf16 v[20:23], a[244:247], v[216:219], 0
    s_waitcnt lgkmcnt(6)
    v_mul_f32 v3, v3, v236
    v_mul_f32 v4, v4, v236
    v_mfma_f32_16x16x32_bf16 v[24:27], a[248:251], v[216:219], 0
    ds_read_b64_tr_b16 a[240:241], v248 offset:0
    v_cvt_pk_bf16_f32 v3, v3, v4
    v_mfma_f32_16x16x32_bf16 v[64:67], a[248:251], v[220:223], 0
    ds_read_b64_tr_b16 a[242:243], v248 offset:1536
    v_accvgpr_read_b32 v4, a102
    v_mfma_f32_16x16x32_bf16 v[104:107], a[248:251], v[224:227], 0
    v_accvgpr_read_b32 v5, a103
    v_mul_f32 v4, v4, v236
    v_mfma_f32_16x16x32_bf16 v[144:147], a[248:251], v[228:231], 0
    buffer_load_dwordx4 v244, s[64:67], s32 offen offset:2048 lds
    v_mul_f32 v5, v5, v236
    v_mfma_f32_16x16x32_bf16 v[184:187], a[248:251], v[232:235], 0
    s_waitcnt lgkmcnt(6)
    v_cvt_pk_bf16_f32 v4, v4, v5
    v_accvgpr_write_b32 a80, v1
    v_mfma_f32_16x16x32_bf16 v[188:191], a[252:255], v[232:235], 0
    s_add_u32 m0, s31, 49280
    ds_read_b64_tr_b16 a[244:245], v248 offset:8
    v_accvgpr_write_b32 a81, v2
    v_mfma_f32_16x16x32_bf16 v[148:151], a[252:255], v[228:231], 0
    s_xor_b32 s3, s62, 4
    ds_read_b64_tr_b16 a[246:247], v248 offset:1544
    v_accvgpr_write_b32 a82, v3
    v_mfma_f32_16x16x32_bf16 v[108:111], a[252:255], v[224:227], 0
    s_mul_i32 s32, s3, 40960
    v_accvgpr_write_b32 a83, v4
    v_accvgpr_read_b32 v1, a84
    v_mfma_f32_16x16x32_bf16 v[68:71], a[252:255], v[220:223], 0
    buffer_load_dwordx4 v242, s[64:67], s32 offen lds
    v_accvgpr_read_b32 v2, a85
    v_mfma_f32_16x16x32_bf16 v[28:31], a[252:255], v[216:219], 0
    s_waitcnt lgkmcnt(6)
    v_mul_f32 v1, v1, v237
    v_mul_f32 v2, v2, v237
    v_mfma_f32_16x16x32_bf16 v[32:35], v[6:9], v[216:219], 0
    ds_read_b64_tr_b16 a[248:249], v249 offset:0
    v_cvt_pk_bf16_f32 v1, v1, v2
    v_mfma_f32_16x16x32_bf16 v[72:75], v[6:9], v[220:223], 0
    ds_read_b64_tr_b16 a[250:251], v249 offset:1536
    v_accvgpr_read_b32 v2, a86
    v_mfma_f32_16x16x32_bf16 v[112:115], v[6:9], v[224:227], 0
    v_accvgpr_read_b32 v3, a87
    v_mul_f32 v2, v2, v237
    v_mfma_f32_16x16x32_bf16 v[152:155], v[6:9], v[228:231], 0
    buffer_load_dwordx4 v243, s[64:67], s32 offen offset:1024 lds
    v_mul_f32 v3, v3, v237
    v_mfma_f32_16x16x32_bf16 v[192:195], v[6:9], v[232:235], 0
    s_waitcnt lgkmcnt(6)
    v_cvt_pk_bf16_f32 v2, v2, v3
    v_accvgpr_read_b32 v3, a104
    v_mfma_f32_16x16x32_bf16 v[196:199], v[10:13], v[232:235], 0
    ds_read_b64_tr_b16 a[252:253], v249 offset:8
    v_accvgpr_read_b32 v4, a105
    v_mfma_f32_16x16x32_bf16 v[156:159], v[10:13], v[228:231], 0
    ds_read_b64_tr_b16 a[254:255], v249 offset:1544
    v_mul_f32 v3, v3, v237
    v_mfma_f32_16x16x32_bf16 v[116:119], v[10:13], v[224:227], 0
    v_mul_f32 v4, v4, v237
    v_cvt_pk_bf16_f32 v3, v3, v4
    v_mfma_f32_16x16x32_bf16 v[76:79], v[10:13], v[220:223], 0
    buffer_load_dwordx4 v244, s[64:67], s32 offen offset:2048 lds
    v_accvgpr_read_b32 v4, a106
    v_mfma_f32_16x16x32_bf16 v[36:39], v[10:13], v[216:219], 0
    s_waitcnt lgkmcnt(6)
    s_waitcnt vmcnt(20)
    s_barrier
    v_accvgpr_read_b32 v5, a107
    v_mfma_f32_16x16x32_bf16 v[40:43], a[240:243], v[216:219], 0
    s_add_u32 m0, s31, 61600
    ds_read_b64_tr_b16 v[6:7], v245 offset:12320
    v_mul_f32 v4, v4, v237
    v_mfma_f32_16x16x32_bf16 v[80:83], a[240:243], v[220:223], 0
    s_xor_b32 s3, s62, 5
    ds_read_b64_tr_b16 v[8:9], v245 offset:13856
    v_mul_f32 v5, v5, v237
    v_mfma_f32_16x16x32_bf16 v[120:123], a[240:243], v[224:227], 0
    s_mul_i32 s32, s3, 40960
    v_cvt_pk_bf16_f32 v4, v4, v5
    v_accvgpr_write_b32 a84, v1
    v_mfma_f32_16x16x32_bf16 v[160:163], a[240:243], v[228:231], 0
    buffer_load_dwordx4 v242, s[64:67], s32 offen lds
    v_accvgpr_write_b32 a85, v2
    v_mfma_f32_16x16x32_bf16 v[200:203], a[240:243], v[232:235], 0
    s_waitcnt lgkmcnt(6)
    v_accvgpr_write_b32 a86, v3
    v_accvgpr_write_b32 a87, v4
    v_mfma_f32_16x16x32_bf16 v[204:207], a[244:247], v[232:235], 0
    ds_read_b64_tr_b16 v[10:11], v245 offset:12328
    v_accvgpr_read_b32 v1, a88
    v_mfma_f32_16x16x32_bf16 v[164:167], a[244:247], v[228:231], 0
    ds_read_b64_tr_b16 v[12:13], v245 offset:13864
    v_accvgpr_read_b32 v2, a89
    v_mfma_f32_16x16x32_bf16 v[124:127], a[244:247], v[224:227], 0
    v_mul_f32 v1, v1, v238
    v_mul_f32 v2, v2, v238
    v_mfma_f32_16x16x32_bf16 v[84:87], a[244:247], v[220:223], 0
    buffer_load_dwordx4 v243, s[64:67], s32 offen offset:1024 lds
    v_cvt_pk_bf16_f32 v1, v1, v2
    v_mfma_f32_16x16x32_bf16 v[44:47], a[244:247], v[216:219], 0
    s_waitcnt lgkmcnt(6)
    v_accvgpr_read_b32 v2, a90
    v_accvgpr_read_b32 v3, a91
    v_mfma_f32_16x16x32_bf16 v[48:51], a[248:251], v[216:219], 0
    ds_read_b64_tr_b16 a[240:241], v246 offset:12320
    v_mul_f32 v2, v2, v238
    v_mfma_f32_16x16x32_bf16 v[88:91], a[248:251], v[220:223], 0
    ds_read_b64_tr_b16 a[242:243], v246 offset:13856
    v_mul_f32 v3, v3, v238
    v_mfma_f32_16x16x32_bf16 v[128:131], a[248:251], v[224:227], 0
    v_cvt_pk_bf16_f32 v2, v2, v3
    v_accvgpr_read_b32 v3, a108
    v_mfma_f32_16x16x32_bf16 v[168:171], a[248:251], v[228:231], 0
    buffer_load_dwordx4 v244, s[64:67], s32 offen offset:2048 lds
    v_accvgpr_read_b32 v4, a109
    v_mfma_f32_16x16x32_bf16 v[208:211], a[248:251], v[232:235], 0
    s_waitcnt lgkmcnt(6)
    v_mul_f32 v3, v3, v238
    v_mul_f32 v4, v4, v238
    v_mfma_f32_16x16x32_bf16 v[212:215], a[252:255], v[232:235], 0
    ds_read_b64_tr_b16 a[244:245], v246 offset:12328
    v_cvt_pk_bf16_f32 v3, v3, v4
    v_mfma_f32_16x16x32_bf16 v[172:175], a[252:255], v[228:231], 0
    ds_read_b64_tr_b16 a[246:247], v246 offset:13864
    v_accvgpr_read_b32 v4, a110
    v_mfma_f32_16x16x32_bf16 v[132:135], a[252:255], v[224:227], 0
    v_accvgpr_read_b32 v5, a111
    v_mul_f32 v4, v4, v238
    v_mfma_f32_16x16x32_bf16 v[92:95], a[252:255], v[220:223], 0
    v_mul_f32 v5, v5, v238
    v_mfma_f32_16x16x32_bf16 v[52:55], a[252:255], v[216:219], 0
    s_waitcnt lgkmcnt(6)
    s_waitcnt vmcnt(14)
    v_cvt_pk_bf16_f32 v4, v4, v5
    v_accvgpr_write_b32 a88, v1
    v_mfma_f32_16x16x32_bf16 v[16:19], v[6:9], a[20:23], v[16:19]
    s_xor_b32 s3, s62, 3
    ds_read_b64_tr_b16 a[248:249], v247 offset:12320
    v_accvgpr_write_b32 a89, v2
    v_mfma_f32_16x16x32_bf16 v[56:59], v[6:9], a[24:27], v[56:59]
    s_mul_i32 s35, s3, 10240
    ds_read_b64_tr_b16 a[250:251], v247 offset:13856
    v_accvgpr_write_b32 a90, v3
    v_mfma_f32_16x16x32_bf16 v[96:99], v[6:9], a[28:31], v[96:99]
    s_add_u32 s36, s35, 4096
    v_accvgpr_write_b32 a91, v4
    v_accvgpr_read_b32 v1, a92
    v_mfma_f32_16x16x32_bf16 v[136:139], v[6:9], a[32:35], v[136:139]
    buffer_load_dwordx4 v[216:219], v0, s[44:47], s35 offen sc1
    v_accvgpr_read_b32 v2, a93
    v_mfma_f32_16x16x32_bf16 v[176:179], v[6:9], a[36:39], v[176:179]
    s_waitcnt lgkmcnt(6)
    v_mul_f32 v1, v1, v239
    v_mul_f32 v2, v2, v239
    v_mfma_f32_16x16x32_bf16 v[180:183], v[10:13], a[36:39], v[180:183]
    ds_read_b64_tr_b16 a[252:253], v247 offset:12328
    v_cvt_pk_bf16_f32 v1, v1, v2
    v_mfma_f32_16x16x32_bf16 v[140:143], v[10:13], a[32:35], v[140:143]
    ds_read_b64_tr_b16 a[254:255], v247 offset:13864
    v_accvgpr_read_b32 v2, a94
    v_mfma_f32_16x16x32_bf16 v[100:103], v[10:13], a[28:31], v[100:103]
    v_accvgpr_read_b32 v3, a95
    v_mul_f32 v2, v2, v239
    v_mfma_f32_16x16x32_bf16 v[60:63], v[10:13], a[24:27], v[60:63]
    buffer_load_dwordx4 v[220:223], v0, s[44:47], s35 offen offset:1024 sc1
    v_mul_f32 v3, v3, v239
    v_mfma_f32_16x16x32_bf16 v[20:23], v[10:13], a[20:23], v[20:23]
    s_waitcnt lgkmcnt(6)
    v_cvt_pk_bf16_f32 v2, v2, v3
    v_accvgpr_read_b32 v3, a112
    v_mfma_f32_16x16x32_bf16 v[24:27], a[240:243], a[20:23], v[24:27]
    ds_read_b64_tr_b16 v[6:7], v248 offset:12320
    v_accvgpr_read_b32 v4, a113
    v_mfma_f32_16x16x32_bf16 v[64:67], a[240:243], a[24:27], v[64:67]
    ds_read_b64_tr_b16 v[8:9], v248 offset:13856
    v_mul_f32 v3, v3, v239
    v_mfma_f32_16x16x32_bf16 v[104:107], a[240:243], a[28:31], v[104:107]
    v_mul_f32 v4, v4, v239
    v_cvt_pk_bf16_f32 v3, v3, v4
    v_mfma_f32_16x16x32_bf16 v[144:147], a[240:243], a[32:35], v[144:147]
    buffer_load_dwordx4 v[224:227], v0, s[44:47], s35 offen offset:2048 sc1
    v_accvgpr_read_b32 v4, a114
    v_mfma_f32_16x16x32_bf16 v[184:187], a[240:243], a[36:39], v[184:187]
    s_waitcnt lgkmcnt(6)
    v_accvgpr_read_b32 v5, a115
    v_mul_f32 v4, v4, v239
    v_mfma_f32_16x16x32_bf16 v[188:191], a[244:247], a[36:39], v[188:191]
    ds_read_b64_tr_b16 v[10:11], v248 offset:12328
    v_mul_f32 v5, v5, v239
    v_mfma_f32_16x16x32_bf16 v[148:151], a[244:247], a[32:35], v[148:151]
    ds_read_b64_tr_b16 v[12:13], v248 offset:13864
    v_cvt_pk_bf16_f32 v4, v4, v5
    v_mfma_f32_16x16x32_bf16 v[108:111], a[244:247], a[28:31], v[108:111]
    v_accvgpr_write_b32 a92, v1
    v_accvgpr_write_b32 a93, v2
    v_mfma_f32_16x16x32_bf16 v[68:71], a[244:247], a[24:27], v[68:71]
    buffer_load_dwordx4 v[228:231], v0, s[44:47], s35 offen offset:3072 sc1
    v_accvgpr_write_b32 a94, v3
    v_mfma_f32_16x16x32_bf16 v[28:31], a[244:247], a[20:23], v[28:31]
    s_waitcnt lgkmcnt(6)
    v_accvgpr_write_b32 a95, v4
    v_accvgpr_read_b32 v1, a96
    v_mfma_f32_16x16x32_bf16 v[32:35], a[248:251], a[20:23], v[32:35]
    ds_read_b64_tr_b16 a[240:241], v249 offset:12320
    v_accvgpr_read_b32 v2, a97
    v_mfma_f32_16x16x32_bf16 v[72:75], a[248:251], a[24:27], v[72:75]
    ds_read_b64_tr_b16 a[242:243], v249 offset:13856
    v_mul_f32 v1, v1, v240
    v_mfma_f32_16x16x32_bf16 v[112:115], a[248:251], a[28:31], v[112:115]
    v_mul_f32 v2, v2, v240
    v_cvt_pk_bf16_f32 v1, v1, v2
    v_mfma_f32_16x16x32_bf16 v[152:155], a[248:251], a[32:35], v[152:155]
    buffer_load_dwordx4 v[232:235], v0, s[44:47], s36 offen sc1
    v_accvgpr_read_b32 v2, a98
    v_mfma_f32_16x16x32_bf16 v[192:195], a[248:251], a[36:39], v[192:195]
    s_waitcnt lgkmcnt(6)
    v_accvgpr_read_b32 v3, a99
    v_mul_f32 v2, v2, v240
    v_mfma_f32_16x16x32_bf16 v[196:199], a[252:255], a[36:39], v[196:199]
    s_xor_b32 s3, s62, 4
    ds_read_b64_tr_b16 a[244:245], v249 offset:12328
    v_mul_f32 v3, v3, v240
    v_mfma_f32_16x16x32_bf16 v[156:159], a[252:255], a[32:35], v[156:159]
    s_mul_i32 s35, s3, 10240
    ds_read_b64_tr_b16 a[246:247], v249 offset:13864
    v_cvt_pk_bf16_f32 v2, v2, v3
    v_mfma_f32_16x16x32_bf16 v[116:119], a[252:255], a[28:31], v[116:119]
    s_add_u32 s36, s35, 4096
    v_accvgpr_read_b32 v3, a116
    v_accvgpr_read_b32 v4, a117
    v_mfma_f32_16x16x32_bf16 v[76:79], a[252:255], a[24:27], v[76:79]
    buffer_load_dwordx4 a[100:103], v0, s[44:47], s35 offen sc1
    v_mul_f32 v3, v3, v240
    v_mfma_f32_16x16x32_bf16 v[36:39], a[252:255], a[20:23], v[36:39]
    s_waitcnt lgkmcnt(6)
    s_waitcnt vmcnt(26)
    s_barrier
    v_mul_f32 v4, v4, v240
    v_mfma_f32_16x16x32_bf16 v[40:43], v[6:9], a[20:23], v[40:43]
    ds_read_b64_tr_b16 a[248:249], v245 offset:24640
    v_cvt_pk_bf16_f32 v3, v3, v4
    v_mfma_f32_16x16x32_bf16 v[80:83], v[6:9], a[24:27], v[80:83]
    ds_read_b64_tr_b16 a[250:251], v245 offset:26176
    v_accvgpr_read_b32 v4, a118
    v_mfma_f32_16x16x32_bf16 v[120:123], v[6:9], a[28:31], v[120:123]
    v_accvgpr_read_b32 v5, a119
    v_mul_f32 v4, v4, v240
    v_mfma_f32_16x16x32_bf16 v[160:163], v[6:9], a[32:35], v[160:163]
    buffer_load_dwordx4 a[104:107], v0, s[44:47], s35 offen offset:1024 sc1
    v_mul_f32 v5, v5, v240
    v_mfma_f32_16x16x32_bf16 v[200:203], v[6:9], a[36:39], v[200:203]
    s_waitcnt lgkmcnt(6)
    v_cvt_pk_bf16_f32 v4, v4, v5
    v_accvgpr_write_b32 a96, v1
    v_mfma_f32_16x16x32_bf16 v[204:207], v[10:13], a[36:39], v[204:207]
    ds_read_b64_tr_b16 a[252:253], v245 offset:24648
    v_accvgpr_write_b32 a97, v2
    v_mfma_f32_16x16x32_bf16 v[164:167], v[10:13], a[32:35], v[164:167]
    ds_read_b64_tr_b16 a[254:255], v245 offset:26184
    v_accvgpr_write_b32 a98, v3
    v_mfma_f32_16x16x32_bf16 v[124:127], v[10:13], a[28:31], v[124:127]
    v_accvgpr_write_b32 a99, v4
    v_accvgpr_read_b32 v1, a120
    v_mfma_f32_16x16x32_bf16 v[84:87], v[10:13], a[24:27], v[84:87]
    buffer_load_dwordx4 a[108:111], v0, s[44:47], s35 offen offset:2048 sc1
    v_accvgpr_read_b32 v2, a121
    v_mfma_f32_16x16x32_bf16 v[44:47], v[10:13], a[20:23], v[44:47]
    s_waitcnt lgkmcnt(6)
    v_mul_f32 v1, v1, v236
    v_mul_f32 v2, v2, v236
    v_mfma_f32_16x16x32_bf16 v[48:51], a[240:243], a[20:23], v[48:51]
    ds_read_b64_tr_b16 v[6:7], v246 offset:24640
    v_cvt_pk_bf16_f32 v1, v1, v2
    v_mfma_f32_16x16x32_bf16 v[88:91], a[240:243], a[24:27], v[88:91]
    ds_read_b64_tr_b16 v[8:9], v246 offset:26176
    v_accvgpr_read_b32 v2, a122
    v_mfma_f32_16x16x32_bf16 v[128:131], a[240:243], a[28:31], v[128:131]
    v_accvgpr_read_b32 v3, a123
    v_mul_f32 v2, v2, v236
    v_mfma_f32_16x16x32_bf16 v[168:171], a[240:243], a[32:35], v[168:171]
    buffer_load_dwordx4 a[112:115], v0, s[44:47], s35 offen offset:3072 sc1
    v_mul_f32 v3, v3, v236
    v_mfma_f32_16x16x32_bf16 v[208:211], a[240:243], a[36:39], v[208:211]
    s_waitcnt lgkmcnt(6)
    v_cvt_pk_bf16_f32 v2, v2, v3
    v_accvgpr_read_b32 v3, a140
    v_mfma_f32_16x16x32_bf16 v[212:215], a[244:247], a[36:39], v[212:215]
    ds_read_b64_tr_b16 v[10:11], v246 offset:24648
    v_accvgpr_read_b32 v4, a141
    v_mfma_f32_16x16x32_bf16 v[172:175], a[244:247], a[32:35], v[172:175]
    ds_read_b64_tr_b16 v[12:13], v246 offset:26184
    v_mul_f32 v3, v3, v236
    v_mfma_f32_16x16x32_bf16 v[132:135], a[244:247], a[28:31], v[132:135]
    v_mul_f32 v4, v4, v236
    v_cvt_pk_bf16_f32 v3, v3, v4
    v_mfma_f32_16x16x32_bf16 v[92:95], a[244:247], a[24:27], v[92:95]
    buffer_load_dwordx4 a[116:119], v0, s[44:47], s36 offen sc1
    v_accvgpr_read_b32 v4, a142
    v_mfma_f32_16x16x32_bf16 v[52:55], a[244:247], a[20:23], v[52:55]
    s_waitcnt lgkmcnt(6)
    s_waitcnt vmcnt(19)
    v_accvgpr_read_b32 v5, a143
    v_mul_f32 v4, v4, v236
    v_mfma_f32_16x16x32_bf16 v[16:19], a[248:251], a[60:63], v[16:19]
    s_xor_b32 s3, s62, 5
    ds_read_b64_tr_b16 a[240:241], v247 offset:24640
    v_mul_f32 v5, v5, v236
    v_mfma_f32_16x16x32_bf16 v[56:59], a[248:251], a[64:67], v[56:59]
    s_mul_i32 s35, s3, 10240
    ds_read_b64_tr_b16 a[242:243], v247 offset:26176
    v_cvt_pk_bf16_f32 v4, v4, v5
    v_mfma_f32_16x16x32_bf16 v[96:99], a[248:251], a[68:71], v[96:99]
    s_add_u32 s36, s35, 4096
    v_accvgpr_write_b32 a120, v1
    v_accvgpr_write_b32 a121, v2
    v_mfma_f32_16x16x32_bf16 v[136:139], a[248:251], a[72:75], v[136:139]
    s_bfe_u32 s100, s2, 131077
    buffer_load_dwordx4 a[20:23], v0, s[44:47], s35 offen sc1
    v_accvgpr_write_b32 a122, v3
    v_mfma_f32_16x16x32_bf16 v[176:179], a[248:251], a[76:79], v[176:179]
    s_waitcnt lgkmcnt(6)
    v_accvgpr_write_b32 a123, v4
    v_accvgpr_read_b32 v1, a124
    v_mfma_f32_16x16x32_bf16 v[180:183], a[252:255], a[76:79], v[180:183]
    s_add_u32 s101, s100, 0
    ds_read_b64_tr_b16 a[244:245], v247 offset:24648
    v_accvgpr_read_b32 v2, a125
    v_mfma_f32_16x16x32_bf16 v[140:143], a[252:255], a[72:75], v[140:143]
    s_and_b32 s101, s101, 3
    ds_read_b64_tr_b16 a[246:247], v247 offset:26184
    v_mul_f32 v1, v1, v237
    v_mfma_f32_16x16x32_bf16 v[100:103], a[252:255], a[68:71], v[100:103]
    s_mul_i32 s101, s101, 6
    v_mul_f32 v2, v2, v237
    v_cvt_pk_bf16_f32 v1, v1, v2
    v_mfma_f32_16x16x32_bf16 v[60:63], a[252:255], a[64:67], v[60:63]
    s_add_u32 s52, s101, 24
    buffer_load_dwordx4 a[24:27], v0, s[44:47], s35 offen offset:1024 sc1
    v_accvgpr_read_b32 v2, a126
    v_mfma_f32_16x16x32_bf16 v[20:23], a[252:255], a[60:63], v[20:23]
    s_waitcnt lgkmcnt(6)
    v_accvgpr_read_b32 v3, a127
    v_mul_f32 v2, v2, v237
    v_mfma_f32_16x16x32_bf16 v[24:27], v[6:9], a[60:63], v[24:27]
    s_add_u32 s101, s100, 1
    ds_read_b64_tr_b16 a[248:249], v248 offset:24640
    v_mul_f32 v3, v3, v237
    v_mfma_f32_16x16x32_bf16 v[64:67], v[6:9], a[64:67], v[64:67]
    s_and_b32 s101, s101, 3
    ds_read_b64_tr_b16 a[250:251], v248 offset:26176
    v_cvt_pk_bf16_f32 v2, v2, v3
    v_mfma_f32_16x16x32_bf16 v[104:107], v[6:9], a[68:71], v[104:107]
    s_mul_i32 s101, s101, 6
    v_accvgpr_read_b32 v3, a144
    v_accvgpr_read_b32 v4, a145
    v_mfma_f32_16x16x32_bf16 v[144:147], v[6:9], a[72:75], v[144:147]
    s_add_u32 s53, s101, 24
    buffer_load_dwordx4 a[28:31], v0, s[44:47], s35 offen offset:2048 sc1
    v_mul_f32 v3, v3, v237
    v_mfma_f32_16x16x32_bf16 v[184:187], v[6:9], a[76:79], v[184:187]
    s_waitcnt lgkmcnt(6)
    v_mul_f32 v4, v4, v237
    v_cvt_pk_bf16_f32 v3, v3, v4
    v_mfma_f32_16x16x32_bf16 v[188:191], v[10:13], a[76:79], v[188:191]
    s_add_u32 s101, s100, 2
    ds_read_b64_tr_b16 a[252:253], v248 offset:24648
    v_accvgpr_read_b32 v4, a146
    v_mfma_f32_16x16x32_bf16 v[148:151], v[10:13], a[72:75], v[148:151]
    s_and_b32 s101, s101, 3
    ds_read_b64_tr_b16 a[254:255], v248 offset:26184
    v_accvgpr_read_b32 v5, a147
    v_mfma_f32_16x16x32_bf16 v[108:111], v[10:13], a[68:71], v[108:111]
    s_mul_i32 s101, s101, 6
    v_mul_f32 v4, v4, v237
    v_mul_f32 v5, v5, v237
    v_mfma_f32_16x16x32_bf16 v[68:71], v[10:13], a[64:67], v[68:71]
    s_add_u32 s54, s101, 24
    buffer_load_dwordx4 a[32:35], v0, s[44:47], s35 offen offset:3072 sc1
    v_cvt_pk_bf16_f32 v4, v4, v5
    v_mfma_f32_16x16x32_bf16 v[28:31], v[10:13], a[60:63], v[28:31]
    s_waitcnt lgkmcnt(6)
    v_accvgpr_write_b32 a124, v1
    v_accvgpr_write_b32 a125, v2
    v_mfma_f32_16x16x32_bf16 v[32:35], a[240:243], a[60:63], v[32:35]
    s_add_u32 s101, s100, 3
    ds_read_b64_tr_b16 v[6:7], v249 offset:24640
    v_accvgpr_write_b32 a126, v3
    v_mfma_f32_16x16x32_bf16 v[72:75], a[240:243], a[64:67], v[72:75]
    s_and_b32 s101, s101, 3
    ds_read_b64_tr_b16 v[8:9], v249 offset:26176
    v_accvgpr_write_b32 a127, v4
    v_mfma_f32_16x16x32_bf16 v[112:115], a[240:243], a[68:71], v[112:115]
    s_mul_i32 s101, s101, 6
    v_accvgpr_read_b32 v1, a128
    v_accvgpr_read_b32 v2, a129
    v_mfma_f32_16x16x32_bf16 v[152:155], a[240:243], a[72:75], v[152:155]
    s_add_u32 s55, s101, 24
    buffer_load_dwordx4 a[36:39], v0, s[44:47], s36 offen sc1
    v_mul_f32 v1, v1, v238
    v_mfma_f32_16x16x32_bf16 v[192:195], a[240:243], a[76:79], v[192:195]
    s_waitcnt lgkmcnt(6)
    v_mul_f32 v2, v2, v238
    v_cvt_pk_bf16_f32 v1, v1, v2
    v_mfma_f32_16x16x32_bf16 v[196:199], a[244:247], a[76:79], v[196:199]
    s_add_u32 m0, s31, 73920
    ds_read_b64_tr_b16 v[10:11], v249 offset:24648
    v_accvgpr_read_b32 v2, a130
    v_mfma_f32_16x16x32_bf16 v[156:159], a[244:247], a[72:75], v[156:159]
    s_xor_b32 s3, s62, 6
    ds_read_b64_tr_b16 v[12:13], v249 offset:26184
    v_accvgpr_read_b32 v3, a131
    v_mfma_f32_16x16x32_bf16 v[116:119], a[244:247], a[68:71], v[116:119]
    s_mul_i32 s32, s3, 40960
    v_mul_f32 v2, v2, v238
    v_mul_f32 v3, v3, v238
    v_mfma_f32_16x16x32_bf16 v[76:79], a[244:247], a[64:67], v[76:79]
    s_bfe_u32 s100, s2, 131075
    buffer_load_dwordx4 v242, s[64:67], s32 offen lds
    v_cvt_pk_bf16_f32 v2, v2, v3
    v_mfma_f32_16x16x32_bf16 v[36:39], a[244:247], a[60:63], v[36:39]
    s_waitcnt lgkmcnt(6)
    s_waitcnt vmcnt(22)
    s_barrier
    v_accvgpr_read_b32 v3, a148
    v_mfma_f32_16x16x32_bf16 v[40:43], a[248:251], a[60:63], v[40:43]
    s_lshr_b32 s101, s100, 1
    ds_read_b64_tr_b16 a[240:241], v245 offset:36960
    v_accvgpr_read_b32 v4, a149
    v_mfma_f32_16x16x32_bf16 v[80:83], a[248:251], a[64:67], v[80:83]
    s_add_u32 s56, s100, s101
    ds_read_b64_tr_b16 a[242:243], v245 offset:38496
    v_mul_f32 v3, v3, v238
    v_mfma_f32_16x16x32_bf16 v[120:123], a[248:251], a[68:71], v[120:123]
    s_and_b32 s100, s2, 1
    v_mul_f32 v4, v4, v238
    v_cvt_pk_bf16_f32 v3, v3, v4
    v_mfma_f32_16x16x32_bf16 v[160:163], a[248:251], a[72:75], v[160:163]
    s_lshl_b32 s100, s100, 1
    buffer_load_dwordx4 v243, s[64:67], s32 offen offset:1024 lds
    v_accvgpr_read_b32 v4, a150
    v_mfma_f32_16x16x32_bf16 v[200:203], a[248:251], a[76:79], v[200:203]
    s_waitcnt lgkmcnt(6)
    v_accvgpr_read_b32 v5, a151
    v_mul_f32 v4, v4, v238
    v_mfma_f32_16x16x32_bf16 v[204:207], a[252:255], a[76:79], v[204:207]
    s_add_u32 s100, s100, s56
    ds_read_b64_tr_b16 a[244:245], v245 offset:36968
    v_mul_f32 v5, v5, v238
    v_mfma_f32_16x16x32_bf16 v[164:167], a[252:255], a[72:75], v[164:167]
    s_sub_u32 s101, s100, 6
    ds_read_b64_tr_b16 a[246:247], v245 offset:38504
    v_cvt_pk_bf16_f32 v4, v4, v5
    v_mfma_f32_16x16x32_bf16 v[124:127], a[252:255], a[68:71], v[124:127]
    s_min_u32 s56, s100, s101
    v_accvgpr_write_b32 a128, v1
    v_accvgpr_write_b32 a129, v2
    v_mfma_f32_16x16x32_bf16 v[84:87], a[252:255], a[64:67], v[84:87]
    s_add_u32 s100, s56, 1
    buffer_load_dwordx4 v244, s[64:67], s32 offen offset:2048 lds
    v_accvgpr_write_b32 a130, v3
    v_mfma_f32_16x16x32_bf16 v[44:47], a[252:255], a[60:63], v[44:47]
    s_waitcnt lgkmcnt(6)
    v_accvgpr_write_b32 a131, v4
    v_accvgpr_read_b32 v1, a132
    v_mfma_f32_16x16x32_bf16 v[48:51], v[6:9], a[60:63], v[48:51]
    s_add_u32 m0, s31, 86240
    ds_read_b64_tr_b16 a[248:249], v246 offset:36960
    v_accvgpr_read_b32 v2, a133
    v_mfma_f32_16x16x32_bf16 v[88:91], v[6:9], a[64:67], v[88:91]
    s_xor_b32 s3, s62, 7
    ds_read_b64_tr_b16 a[250:251], v246 offset:38496
    v_mul_f32 v1, v1, v239
    v_mfma_f32_16x16x32_bf16 v[128:131], v[6:9], a[68:71], v[128:131]
    s_mul_i32 s32, s3, 40960
    v_mul_f32 v2, v2, v239
    v_cvt_pk_bf16_f32 v1, v1, v2
    v_mfma_f32_16x16x32_bf16 v[168:171], v[6:9], a[72:75], v[168:171]
    s_sub_u32 s101, s100, 6
    buffer_load_dwordx4 v242, s[64:67], s32 offen lds
    v_accvgpr_read_b32 v2, a134
    v_mfma_f32_16x16x32_bf16 v[208:211], v[6:9], a[76:79], v[208:211]
    s_waitcnt lgkmcnt(6)
    v_accvgpr_read_b32 v3, a135
    v_mul_f32 v2, v2, v239
    v_mfma_f32_16x16x32_bf16 v[212:215], v[10:13], a[76:79], v[212:215]
    s_min_u32 s57, s100, s101
    ds_read_b64_tr_b16 a[252:253], v246 offset:36968
    v_mul_f32 v3, v3, v239
    v_mfma_f32_16x16x32_bf16 v[172:175], v[10:13], a[72:75], v[172:175]
    s_add_u32 s100, s56, 2
    ds_read_b64_tr_b16 a[254:255], v246 offset:38504
    v_cvt_pk_bf16_f32 v2, v2, v3
    v_mfma_f32_16x16x32_bf16 v[132:135], v[10:13], a[68:71], v[132:135]
    s_sub_u32 s101, s100, 6
    v_accvgpr_read_b32 v3, a152
    v_accvgpr_read_b32 v4, a153
    v_mfma_f32_16x16x32_bf16 v[92:95], v[10:13], a[64:67], v[92:95]
    s_min_u32 s58, s100, s101
    buffer_load_dwordx4 v243, s[64:67], s32 offen offset:1024 lds
    v_mul_f32 v3, v3, v239
    v_mfma_f32_16x16x32_bf16 v[52:55], v[10:13], a[60:63], v[52:55]
    s_waitcnt lgkmcnt(6)
    s_waitcnt vmcnt(15)
    v_mul_f32 v4, v4, v239
    v_cvt_pk_bf16_f32 v3, v3, v4
    v_mfma_f32_16x16x32_bf16 v[16:19], a[240:243], v[216:219], v[16:19]
    s_add_u32 s100, s56, 3
    ds_read_b64_tr_b16 v[6:7], v247 offset:36960
    v_accvgpr_read_b32 v4, a154
    v_mfma_f32_16x16x32_bf16 v[56:59], a[240:243], v[220:223], v[56:59]
    s_sub_u32 s101, s100, 6
    ds_read_b64_tr_b16 v[8:9], v247 offset:38496
    v_accvgpr_read_b32 v5, a155
    v_mfma_f32_16x16x32_bf16 v[96:99], a[240:243], v[224:227], v[96:99]
    s_min_u32 s59, s100, s101
    v_mul_f32 v4, v4, v239
    v_mul_f32 v5, v5, v239
    v_mfma_f32_16x16x32_bf16 v[136:139], a[240:243], v[228:231], v[136:139]
    s_add_u32 s100, s56, 4
    buffer_load_dwordx4 v244, s[64:67], s32 offen offset:2048 lds
    v_cvt_pk_bf16_f32 v4, v4, v5
    v_mfma_f32_16x16x32_bf16 v[176:179], a[240:243], v[232:235], v[176:179]
    s_waitcnt lgkmcnt(6)
    v_accvgpr_write_b32 a132, v1
    v_accvgpr_write_b32 a133, v2
    v_mfma_f32_16x16x32_bf16 v[180:183], a[244:247], v[232:235], v[180:183]
    s_xor_b32 s3, s62, 6
    ds_read_b64_tr_b16 v[10:11], v247 offset:36968
    v_accvgpr_write_b32 a134, v3
    v_mfma_f32_16x16x32_bf16 v[140:143], a[244:247], v[228:231], v[140:143]
    s_mul_i32 s35, s3, 10240
    ds_read_b64_tr_b16 v[12:13], v247 offset:38504
    v_accvgpr_write_b32 a135, v4
    v_mfma_f32_16x16x32_bf16 v[100:103], a[244:247], v[224:227], v[100:103]
    s_add_u32 s36, s35, 4096
    v_accvgpr_read_b32 v1, a136
    v_accvgpr_read_b32 v2, a137
    v_mfma_f32_16x16x32_bf16 v[60:63], a[244:247], v[220:223], v[60:63]
    s_sub_u32 s101, s100, 6
    buffer_load_dwordx4 a[60:63], v0, s[44:47], s35 offen sc1
    v_mul_f32 v1, v1, v240
    v_mfma_f32_16x16x32_bf16 v[20:23], a[244:247], v[216:219], v[20:23]
    s_waitcnt lgkmcnt(6)
    v_mul_f32 v2, v2, v240
    v_cvt_pk_bf16_f32 v1, v1, v2
    v_mfma_f32_16x16x32_bf16 v[24:27], a[248:251], v[216:219], v[24:27]
    s_min_u32 s60, s100, s101
    ds_read_b64_tr_b16 a[240:241], v248 offset:36960
    v_accvgpr_read_b32 v2, a138
    v_mfma_f32_16x16x32_bf16 v[64:67], a[248:251], v[220:223], v[64:67]
    s_add_u32 s100, s56, 5
    ds_read_b64_tr_b16 a[242:243], v248 offset:38496
    v_accvgpr_read_b32 v3, a139
    v_mfma_f32_16x16x32_bf16 v[104:107], a[248:251], v[224:227], v[104:107]
    s_sub_u32 s101, s100, 6
    v_mul_f32 v2, v2, v240
    v_mul_f32 v3, v3, v240
    v_mfma_f32_16x16x32_bf16 v[144:147], a[248:251], v[228:231], v[144:147]
    s_min_u32 s61, s100, s101
    buffer_load_dwordx4 a[64:67], v0, s[44:47], s35 offen offset:1024 sc1
    v_cvt_pk_bf16_f32 v2, v2, v3
    v_mfma_f32_16x16x32_bf16 v[184:187], a[248:251], v[232:235], v[184:187]
    s_waitcnt lgkmcnt(6)
    v_accvgpr_read_b32 v3, a156
    v_accvgpr_read_b32 v4, a157
    v_mfma_f32_16x16x32_bf16 v[188:191], a[252:255], v[232:235], v[188:191]
    s_add_u32 s8, s80, 0
    ds_read_b64_tr_b16 a[244:245], v248 offset:36968
    v_mul_f32 v3, v3, v240
    v_mfma_f32_16x16x32_bf16 v[148:151], a[252:255], v[228:231], v[148:151]
    s_and_b32 s8, s8, 3
    ds_read_b64_tr_b16 a[246:247], v248 offset:38504
    v_mul_f32 v4, v4, v240
    v_mfma_f32_16x16x32_bf16 v[108:111], a[252:255], v[224:227], v[108:111]
    s_add_u32 s9, s80, 1
    v_cvt_pk_bf16_f32 v3, v3, v4
    v_accvgpr_read_b32 v4, a158
    v_mfma_f32_16x16x32_bf16 v[68:71], a[252:255], v[220:223], v[68:71]
    s_and_b32 s9, s9, 3
    buffer_load_dwordx4 a[68:71], v0, s[44:47], s35 offen offset:2048 sc1
    v_accvgpr_read_b32 v5, a159
    v_mfma_f32_16x16x32_bf16 v[28:31], a[252:255], v[216:219], v[28:31]
    s_waitcnt lgkmcnt(6)
    v_mul_f32 v4, v4, v240
    v_mul_f32 v5, v5, v240
    v_mfma_f32_16x16x32_bf16 v[32:35], v[6:9], v[216:219], v[32:35]
    s_add_u32 s10, s80, 2
    ds_read_b64_tr_b16 a[248:249], v249 offset:36960
    v_cvt_pk_bf16_f32 v4, v4, v5
    v_mfma_f32_16x16x32_bf16 v[72:75], v[6:9], v[220:223], v[72:75]
    s_and_b32 s10, s10, 3
    ds_read_b64_tr_b16 a[250:251], v249 offset:38496
    v_accvgpr_write_b32 a136, v1
    v_mfma_f32_16x16x32_bf16 v[112:115], v[6:9], v[224:227], v[112:115]
    s_add_u32 s11, s80, 3
    v_accvgpr_write_b32 a137, v2
    v_accvgpr_write_b32 a138, v3
    v_mfma_f32_16x16x32_bf16 v[152:155], v[6:9], v[228:231], v[152:155]
    s_and_b32 s11, s11, 3
    buffer_load_dwordx4 a[72:75], v0, s[44:47], s35 offen offset:3072 sc1
    v_accvgpr_write_b32 a139, v4
    v_mfma_f32_16x16x32_bf16 v[192:195], v[6:9], v[232:235], v[192:195]
    s_waitcnt lgkmcnt(6)
    v_accvgpr_read_b32 v1, a160
    v_accvgpr_read_b32 v2, a161
    v_mfma_f32_16x16x32_bf16 v[196:199], v[10:13], v[232:235], v[196:199]
    s_mov_b32 s12, 4
    ds_read_b64_tr_b16 a[252:253], v249 offset:36968
    v_mul_f32 v1, v1, v236
    v_mfma_f32_16x16x32_bf16 v[156:159], v[10:13], v[228:231], v[156:159]
    s_mov_b32 s13, 0
    ds_read_b64_tr_b16 a[254:255], v249 offset:38504
    v_mul_f32 v2, v2, v236
    v_mfma_f32_16x16x32_bf16 v[116:119], v[10:13], v[224:227], v[116:119]
    s_add_u32 s14, s9, 1
    v_cvt_pk_bf16_f32 v1, v1, v2
    v_accvgpr_read_b32 v2, a162
    v_mfma_f32_16x16x32_bf16 v[76:79], v[10:13], v[220:223], v[76:79]
    s_add_u32 s15, s10, 1
    buffer_load_dwordx4 a[76:79], v0, s[44:47], s36 offen sc1
    v_accvgpr_read_b32 v3, a163
    v_mfma_f32_16x16x32_bf16 v[36:39], v[10:13], v[216:219], v[36:39]
    s_waitcnt lgkmcnt(6)
    s_waitcnt vmcnt(26)
    s_barrier
    v_mul_f32 v2, v2, v236
    v_mfma_f32_16x16x32_bf16 v[40:43], a[240:243], v[216:219], v[40:43]
    s_xor_b32 s3, s62, 7
    ds_read_b64_tr_b16 v[6:7], v245 offset:49280
    v_mul_f32 v3, v3, v236
    v_mfma_f32_16x16x32_bf16 v[80:83], a[240:243], v[220:223], v[80:83]
    s_mul_i32 s35, s3, 10240
    ds_read_b64_tr_b16 v[8:9], v245 offset:50816
    v_cvt_pk_bf16_f32 v2, v2, v3
    v_mfma_f32_16x16x32_bf16 v[120:123], a[240:243], v[224:227], v[120:123]
    s_add_u32 s36, s35, 4096
    v_accvgpr_read_b32 v3, a180
    v_accvgpr_read_b32 v4, a181
    v_mfma_f32_16x16x32_bf16 v[160:163], a[240:243], v[228:231], v[160:163]
    s_add_u32 s16, s11, 1
    buffer_load_dwordx4 a[140:143], v0, s[44:47], s35 offen sc1
    v_mul_f32 v3, v3, v236
    v_mfma_f32_16x16x32_bf16 v[200:203], a[240:243], v[232:235], v[200:203]
    s_waitcnt lgkmcnt(6)
    v_mul_f32 v4, v4, v236
    v_cvt_pk_bf16_f32 v3, v3, v4
    v_mfma_f32_16x16x32_bf16 v[204:207], a[244:247], v[232:235], v[204:207]
    s_add_u32 s17, s8, 1
    ds_read_b64_tr_b16 v[10:11], v250 offset:0
    v_accvgpr_read_b32 v4, a182
    v_mfma_f32_16x16x32_bf16 v[164:167], a[244:247], v[228:231], v[164:167]
    s_mul_i32 s18, s8, 102400
    ds_read_b64_tr_b16 v[12:13], v250 offset:1536
    v_accvgpr_read_b32 v5, a183
    v_mfma_f32_16x16x32_bf16 v[124:127], a[244:247], v[224:227], v[124:127]
    s_mul_i32 s19, s11, 102400
    v_mul_f32 v4, v4, v236
    v_mul_f32 v5, v5, v236
    v_mfma_f32_16x16x32_bf16 v[84:87], a[244:247], v[220:223], v[84:87]
    s_mul_i32 s20, s10, 102400
    buffer_load_dwordx4 a[144:147], v0, s[44:47], s35 offen offset:1024 sc1
    v_cvt_pk_bf16_f32 v4, v4, v5
    v_mfma_f32_16x16x32_bf16 v[44:47], a[244:247], v[216:219], v[44:47]
    s_waitcnt lgkmcnt(6)
    v_accvgpr_write_b32 a160, v1
    v_accvgpr_write_b32 a161, v2
    v_mfma_f32_16x16x32_bf16 v[48:51], a[248:251], v[216:219], v[48:51]
    s_mul_i32 s21, s9, 102400
    ds_read_b64_tr_b16 a[240:241], v245 offset:49288
    v_accvgpr_write_b32 a162, v3
    v_mfma_f32_16x16x32_bf16 v[88:91], a[248:251], v[220:223], v[88:91]
    s_xor_b32 s22, s80, s28
    ds_read_b64_tr_b16 a[242:243], v245 offset:50824
    v_accvgpr_write_b32 a163, v4
    v_mfma_f32_16x16x32_bf16 v[128:131], a[248:251], v[224:227], v[128:131]
    s_lshl_b32 s22, s22, 28
    v_accvgpr_read_b32 v1, a164
    v_accvgpr_read_b32 v2, a165
    v_mfma_f32_16x16x32_bf16 v[168:171], a[248:251], v[228:231], v[168:171]
    buffer_load_dwordx4 a[148:151], v0, s[44:47], s35 offen offset:2048 sc1
    v_mul_f32 v1, v1, v237
    v_mfma_f32_16x16x32_bf16 v[208:211], a[248:251], v[232:235], v[208:211]
    s_waitcnt lgkmcnt(6)
    v_mul_f32 v2, v2, v237
    v_cvt_pk_bf16_f32 v1, v1, v2
    v_mfma_f32_16x16x32_bf16 v[212:215], a[252:255], v[232:235], v[212:215]
    ds_read_b64_tr_b16 a[244:245], v250 offset:8
    v_accvgpr_read_b32 v2, a166
    v_mfma_f32_16x16x32_bf16 v[172:175], a[252:255], v[228:231], v[172:175]
    ds_read_b64_tr_b16 a[246:247], v250 offset:1544
    v_accvgpr_read_b32 v3, a167
    v_mfma_f32_16x16x32_bf16 v[132:135], a[252:255], v[224:227], v[132:135]
    v_mul_f32 v2, v2, v237
    v_mul_f32 v3, v3, v237
    v_mfma_f32_16x16x32_bf16 v[92:95], a[252:255], v[220:223], v[92:95]
    buffer_load_dwordx4 a[152:155], v0, s[44:47], s35 offen offset:3072 sc1
    v_cvt_pk_bf16_f32 v2, v2, v3
    v_mfma_f32_16x16x32_bf16 v[52:55], a[252:255], v[216:219], v[52:55]
    s_waitcnt lgkmcnt(4)
    s_waitcnt vmcnt(15)
    v_accvgpr_read_b32 v3, a184
    v_accvgpr_read_b32 v4, a185
    v_mfma_f32_16x16x32_bf16 v[16:19], v[6:9], a[100:103], v[16:19]
    ds_read_b64_tr_b16 a[248:249], v246 offset:49280
    v_mul_f32 v3, v3, v237
    v_mfma_f32_16x16x32_bf16 v[16:19], v[10:13], a[20:23], v[16:19]
    ds_read_b64_tr_b16 a[250:251], v246 offset:50816
    v_mul_f32 v4, v4, v237
    v_mfma_f32_16x16x32_bf16 v[56:59], v[10:13], a[24:27], v[56:59]
    v_cvt_pk_bf16_f32 v3, v3, v4
    v_accvgpr_read_b32 v4, a186
    v_mfma_f32_16x16x32_bf16 v[56:59], v[6:9], a[104:107], v[56:59]
    buffer_load_dwordx4 a[156:159], v0, s[44:47], s36 offen sc1
    v_accvgpr_read_b32 v5, a187
    v_mfma_f32_16x16x32_bf16 v[96:99], v[6:9], a[108:111], v[96:99]
    v_mul_f32 v4, v4, v237
    v_mul_f32 v5, v5, v237
    v_mfma_f32_16x16x32_bf16 v[96:99], v[10:13], a[28:31], v[96:99]
    s_add_u32 m0, s31, 98560
    ds_read_b64_tr_b16 a[252:253], v251 offset:0
    v_cvt_pk_bf16_f32 v4, v4, v5
    v_mfma_f32_16x16x32_bf16 v[136:139], v[10:13], a[32:35], v[136:139]
    s_xor_b32 s3, s62, 8
    ds_read_b64_tr_b16 a[254:255], v251 offset:1536
    v_accvgpr_write_b32 a164, v1
    v_mfma_f32_16x16x32_bf16 v[136:139], v[6:9], a[112:115], v[136:139]
    s_mul_i32 s32, s3, 40960
    v_accvgpr_write_b32 a165, v2
    v_accvgpr_write_b32 a166, v3
    v_mfma_f32_16x16x32_bf16 v[176:179], v[6:9], a[116:119], v[176:179]
    buffer_load_dwordx4 v242, s[64:67], s32 offen lds
    v_accvgpr_write_b32 a167, v4
    v_mfma_f32_16x16x32_bf16 v[176:179], v[10:13], a[36:39], v[176:179]
    s_waitcnt lgkmcnt(4)
    v_accvgpr_read_b32 v1, a168
    v_accvgpr_read_b32 v2, a169
    v_mfma_f32_16x16x32_bf16 v[180:183], a[244:247], a[36:39], v[180:183]
    ds_read_b64_tr_b16 v[6:7], v246 offset:49288
    v_mul_f32 v1, v1, v238
    v_mfma_f32_16x16x32_bf16 v[180:183], a[240:243], a[116:119], v[180:183]
    ds_read_b64_tr_b16 v[8:9], v246 offset:50824
    v_mul_f32 v2, v2, v238
    v_mfma_f32_16x16x32_bf16 v[140:143], a[240:243], a[112:115], v[140:143]
    v_cvt_pk_bf16_f32 v1, v1, v2
    v_accvgpr_read_b32 v2, a170
    v_mfma_f32_16x16x32_bf16 v[140:143], a[244:247], a[32:35], v[140:143]
    buffer_load_dwordx4 v243, s[64:67], s32 offen offset:1024 lds
    v_accvgpr_read_b32 v3, a171
    v_mfma_f32_16x16x32_bf16 v[100:103], a[244:247], a[28:31], v[100:103]
    v_mul_f32 v2, v2, v238
    v_mul_f32 v3, v3, v238
    v_mfma_f32_16x16x32_bf16 v[100:103], a[240:243], a[108:111], v[100:103]
    ds_read_b64_tr_b16 v[10:11], v251 offset:8
    v_cvt_pk_bf16_f32 v2, v2, v3
    v_mfma_f32_16x16x32_bf16 v[60:63], a[240:243], a[104:107], v[60:63]
    ds_read_b64_tr_b16 v[12:13], v251 offset:1544
    v_accvgpr_read_b32 v3, a188
    v_mfma_f32_16x16x32_bf16 v[60:63], a[244:247], a[24:27], v[60:63]
    v_accvgpr_read_b32 v4, a189
    v_mul_f32 v3, v3, v238
    v_mfma_f32_16x16x32_bf16 v[20:23], a[244:247], a[20:23], v[20:23]
    buffer_load_dwordx4 v244, s[64:67], s32 offen offset:2048 lds
    v_mul_f32 v4, v4, v238
    v_mfma_f32_16x16x32_bf16 v[20:23], a[240:243], a[100:103], v[20:23]
    s_waitcnt lgkmcnt(4)
    v_cvt_pk_bf16_f32 v3, v3, v4
    v_accvgpr_read_b32 v4, a190
    v_mfma_f32_16x16x32_bf16 v[24:27], a[248:251], a[100:103], v[24:27]
    s_xor_b32 s3, s62, 8
    ds_read_b64_tr_b16 a[240:241], v247 offset:49280
    v_accvgpr_read_b32 v5, a191
    v_mfma_f32_16x16x32_bf16 v[24:27], a[252:255], a[20:23], v[24:27]
    s_mul_i32 s35, s3, 10240
    ds_read_b64_tr_b16 a[242:243], v247 offset:50816
    v_mul_f32 v4, v4, v238
    v_mfma_f32_16x16x32_bf16 v[64:67], a[252:255], a[24:27], v[64:67]
    s_add_u32 s36, s35, 4096
    v_mul_f32 v5, v5, v238
    v_cvt_pk_bf16_f32 v4, v4, v5
    v_mfma_f32_16x16x32_bf16 v[64:67], a[248:251], a[104:107], v[64:67]
    buffer_load_dwordx4 v[216:219], v0, s[44:47], s35 offen sc1
    v_accvgpr_write_b32 a168, v1
    v_mfma_f32_16x16x32_bf16 v[104:107], a[248:251], a[108:111], v[104:107]
    v_accvgpr_write_b32 a169, v2
    v_accvgpr_write_b32 a170, v3
    v_mfma_f32_16x16x32_bf16 v[104:107], a[252:255], a[28:31], v[104:107]
    ds_read_b64_tr_b16 a[244:245], v252 offset:0
    v_accvgpr_write_b32 a171, v4
    v_mfma_f32_16x16x32_bf16 v[144:147], a[252:255], a[32:35], v[144:147]
    ds_read_b64_tr_b16 a[246:247], v252 offset:1536
    v_accvgpr_read_b32 v1, a172
    v_mfma_f32_16x16x32_bf16 v[144:147], a[248:251], a[112:115], v[144:147]
    v_accvgpr_read_b32 v2, a173
    v_mul_f32 v1, v1, v239
    v_mfma_f32_16x16x32_bf16 v[184:187], a[248:251], a[116:119], v[184:187]
    buffer_load_dwordx4 v[220:223], v0, s[44:47], s35 offen offset:1024 sc1
    v_mul_f32 v2, v2, v239
    v_mfma_f32_16x16x32_bf16 v[184:187], a[252:255], a[36:39], v[184:187]
    s_waitcnt lgkmcnt(4)
    v_cvt_pk_bf16_f32 v1, v1, v2
    v_accvgpr_read_b32 v2, a174
    v_mfma_f32_16x16x32_bf16 v[188:191], v[10:13], a[36:39], v[188:191]
    ds_read_b64_tr_b16 a[248:249], v247 offset:49288
    v_accvgpr_read_b32 v3, a175
    v_mfma_f32_16x16x32_bf16 v[188:191], v[6:9], a[116:119], v[188:191]
    ds_read_b64_tr_b16 a[250:251], v247 offset:50824
    v_mul_f32 v2, v2, v239
    v_mfma_f32_16x16x32_bf16 v[148:151], v[6:9], a[112:115], v[148:151]
    v_mul_f32 v3, v3, v239
    v_cvt_pk_bf16_f32 v2, v2, v3
    v_mfma_f32_16x16x32_bf16 v[148:151], v[10:13], a[32:35], v[148:151]
    buffer_load_dwordx4 v[224:227], v0, s[44:47], s35 offen offset:2048 sc1
    v_accvgpr_read_b32 v3, a192
    v_mfma_f32_16x16x32_bf16 v[108:111], v[10:13], a[28:31], v[108:111]
    v_accvgpr_read_b32 v4, a193
    v_mul_f32 v3, v3, v239
    v_mfma_f32_16x16x32_bf16 v[108:111], v[6:9], a[108:111], v[108:111]
    ds_read_b64_tr_b16 a[252:253], v252 offset:8
    v_mul_f32 v4, v4, v239
    v_mfma_f32_16x16x32_bf16 v[68:71], v[6:9], a[104:107], v[68:71]
    ds_read_b64_tr_b16 a[254:255], v252 offset:1544
    v_cvt_pk_bf16_f32 v3, v3, v4
    v_mfma_f32_16x16x32_bf16 v[68:71], v[10:13], a[24:27], v[68:71]
    v_accvgpr_read_b32 v4, a194
    v_accvgpr_read_b32 v5, a195
    v_mfma_f32_16x16x32_bf16 v[28:31], v[10:13], a[20:23], v[28:31]
    buffer_load_dwordx4 v[228:231], v0, s[44:47], s35 offen offset:3072 sc1
    v_mul_f32 v4, v4, v239
    v_mfma_f32_16x16x32_bf16 v[28:31], v[6:9], a[100:103], v[28:31]
    s_waitcnt lgkmcnt(4)
    v_mul_f32 v5, v5, v239
    v_cvt_pk_bf16_f32 v4, v4, v5
    v_mfma_f32_16x16x32_bf16 v[32:35], a[240:243], a[100:103], v[32:35]
    ds_read_b64_tr_b16 v[6:7], v248 offset:49280
    v_accvgpr_write_b32 a172, v1
    v_mfma_f32_16x16x32_bf16 v[32:35], a[244:247], a[20:23], v[32:35]
    ds_read_b64_tr_b16 v[8:9], v248 offset:50816
    v_accvgpr_write_b32 a173, v2
    v_mfma_f32_16x16x32_bf16 v[72:75], a[244:247], a[24:27], v[72:75]
    v_accvgpr_write_b32 a174, v3
    v_accvgpr_write_b32 a175, v4
    v_mfma_f32_16x16x32_bf16 v[72:75], a[240:243], a[104:107], v[72:75]
    buffer_load_dwordx4 v[232:235], v0, s[44:47], s36 offen sc1
    v_accvgpr_read_b32 v1, a176
    v_mfma_f32_16x16x32_bf16 v[112:115], a[240:243], a[108:111], v[112:115]
    v_accvgpr_read_b32 v2, a177
    v_mul_f32 v1, v1, v240
    v_mfma_f32_16x16x32_bf16 v[112:115], a[244:247], a[28:31], v[112:115]
    s_add_u32 m0, s31, 110880
    ds_read_b64_tr_b16 v[10:11], v253 offset:0
    v_mul_f32 v2, v2, v240
    v_mfma_f32_16x16x32_bf16 v[152:155], a[244:247], a[32:35], v[152:155]
    s_xor_b32 s3, s62, 9
    ds_read_b64_tr_b16 v[12:13], v253 offset:1536
    v_cvt_pk_bf16_f32 v1, v1, v2
    v_mfma_f32_16x16x32_bf16 v[152:155], a[240:243], a[112:115], v[152:155]
    s_mul_i32 s32, s3, 40960
    v_accvgpr_read_b32 v2, a178
    v_accvgpr_read_b32 v3, a179
    v_mfma_f32_16x16x32_bf16 v[192:195], a[240:243], a[116:119], v[192:195]
    buffer_load_dwordx4 v242, s[64:67], s32 offen lds
    v_mul_f32 v2, v2, v240
    v_mfma_f32_16x16x32_bf16 v[192:195], a[244:247], a[36:39], v[192:195]
    s_waitcnt lgkmcnt(4)
    v_mul_f32 v3, v3, v240
    v_cvt_pk_bf16_f32 v2, v2, v3
    v_mfma_f32_16x16x32_bf16 v[196:199], a[252:255], a[36:39], v[196:199]
    ds_read_b64_tr_b16 a[240:241], v248 offset:49288
    v_accvgpr_read_b32 v3, a196
    v_mfma_f32_16x16x32_bf16 v[196:199], a[248:251], a[116:119], v[196:199]
    ds_read_b64_tr_b16 a[242:243], v248 offset:50824
    v_accvgpr_read_b32 v4, a197
    v_mfma_f32_16x16x32_bf16 v[156:159], a[248:251], a[112:115], v[156:159]
    v_mul_f32 v3, v3, v240
    v_mul_f32 v4, v4, v240
    v_mfma_f32_16x16x32_bf16 v[156:159], a[252:255], a[32:35], v[156:159]
    buffer_load_dwordx4 v243, s[64:67], s32 offen offset:1024 lds
    v_cvt_pk_bf16_f32 v3, v3, v4
    v_mfma_f32_16x16x32_bf16 v[116:119], a[252:255], a[28:31], v[116:119]
    v_accvgpr_read_b32 v4, a198
    v_accvgpr_read_b32 v5, a199
    v_mfma_f32_16x16x32_bf16 v[116:119], a[248:251], a[108:111], v[116:119]
    ds_read_b64_tr_b16 a[244:245], v253 offset:8
    v_mul_f32 v4, v4, v240
    v_mfma_f32_16x16x32_bf16 v[76:79], a[248:251], a[104:107], v[76:79]
    ds_read_b64_tr_b16 a[246:247], v253 offset:1544
    v_mul_f32 v5, v5, v240
    v_mfma_f32_16x16x32_bf16 v[76:79], a[252:255], a[24:27], v[76:79]
    v_cvt_pk_bf16_f32 v4, v4, v5
    v_accvgpr_write_b32 a176, v1
    v_mfma_f32_16x16x32_bf16 v[36:39], a[252:255], a[20:23], v[36:39]
    buffer_load_dwordx4 v244, s[64:67], s32 offen offset:2048 lds
    v_accvgpr_write_b32 a177, v2
    v_mfma_f32_16x16x32_bf16 v[36:39], a[248:251], a[100:103], v[36:39]
    s_waitcnt lgkmcnt(4)
    v_accvgpr_write_b32 a178, v3
    v_accvgpr_write_b32 a179, v4
    v_mfma_f32_16x16x32_bf16 v[40:43], v[6:9], a[100:103], v[40:43]
    s_mov_b32 s88, 0
    ds_read_b64_tr_b16 a[248:249], v249 offset:49280
    v_accvgpr_read_b32 v1, a200
    v_mfma_f32_16x16x32_bf16 v[40:43], v[10:13], a[20:23], v[40:43]
    ds_read_b64_tr_b16 a[250:251], v249 offset:50816
    v_accvgpr_read_b32 v2, a201
    v_mfma_f32_16x16x32_bf16 v[80:83], v[10:13], a[24:27], v[80:83]
    v_mul_f32 v1, v1, v236
    v_mul_f32 v2, v2, v236
    v_mfma_f32_16x16x32_bf16 v[80:83], v[6:9], a[104:107], v[80:83]
    buffer_store_dwordx4 a[0:3], v0, s[24:27], s88 offen sc1
    v_cvt_pk_bf16_f32 v1, v1, v2
    v_mfma_f32_16x16x32_bf16 v[120:123], v[6:9], a[108:111], v[120:123]
    v_accvgpr_read_b32 v2, a202
    v_accvgpr_read_b32 v3, a203
    v_mfma_f32_16x16x32_bf16 v[120:123], v[10:13], a[28:31], v[120:123]
    s_xor_b32 s3, s62, 9
    ds_read_b64_tr_b16 a[252:253], v254 offset:0
    v_mul_f32 v2, v2, v236
    v_mfma_f32_16x16x32_bf16 v[160:163], v[10:13], a[32:35], v[160:163]
    s_mul_i32 s35, s3, 10240
    ds_read_b64_tr_b16 a[254:255], v254 offset:1536
    v_mul_f32 v3, v3, v236
    v_mfma_f32_16x16x32_bf16 v[160:163], v[6:9], a[112:115], v[160:163]
    s_add_u32 s36, s35, 4096
    v_cvt_pk_bf16_f32 v2, v2, v3
    v_accvgpr_read_b32 v3, a220
    v_mfma_f32_16x16x32_bf16 v[200:203], v[6:9], a[116:119], v[200:203]
    buffer_load_dwordx4 a[180:183], v0, s[44:47], s35 offen sc1
    v_accvgpr_read_b32 v4, a221
    v_mfma_f32_16x16x32_bf16 v[200:203], v[10:13], a[36:39], v[200:203]
    s_waitcnt lgkmcnt(4)
    v_mul_f32 v3, v3, v236
    v_mul_f32 v4, v4, v236
    v_mfma_f32_16x16x32_bf16 v[204:207], a[244:247], a[36:39], v[204:207]
    ds_read_b64_tr_b16 v[6:7], v249 offset:49288
    v_cvt_pk_bf16_f32 v3, v3, v4
    v_mfma_f32_16x16x32_bf16 v[204:207], a[240:243], a[116:119], v[204:207]
    ds_read_b64_tr_b16 v[8:9], v249 offset:50824
    v_accvgpr_read_b32 v4, a222
    v_mfma_f32_16x16x32_bf16 v[164:167], a[240:243], a[112:115], v[164:167]
    v_accvgpr_read_b32 v5, a223
    v_mul_f32 v4, v4, v236
    v_mfma_f32_16x16x32_bf16 v[164:167], a[244:247], a[32:35], v[164:167]
    buffer_load_dwordx4 a[184:187], v0, s[44:47], s35 offen offset:1024 sc1
    v_mul_f32 v5, v5, v236
    v_mfma_f32_16x16x32_bf16 v[124:127], a[244:247], a[28:31], v[124:127]
    v_cvt_pk_bf16_f32 v4, v4, v5
    v_accvgpr_write_b32 a200, v1
    v_mfma_f32_16x16x32_bf16 v[124:127], a[240:243], a[108:111], v[124:127]
    ds_read_b64_tr_b16 v[10:11], v254 offset:8
    v_accvgpr_write_b32 a201, v2
    v_mfma_f32_16x16x32_bf16 v[84:87], a[240:243], a[104:107], v[84:87]
    ds_read_b64_tr_b16 v[12:13], v254 offset:1544
    v_accvgpr_write_b32 a202, v3
    v_mfma_f32_16x16x32_bf16 v[84:87], a[244:247], a[24:27], v[84:87]
    v_accvgpr_write_b32 a203, v4
    v_accvgpr_read_b32 v1, a204
    v_mfma_f32_16x16x32_bf16 v[44:47], a[244:247], a[20:23], v[44:47]
    buffer_load_dwordx4 a[188:191], v0, s[44:47], s35 offen offset:2048 sc1
    v_accvgpr_read_b32 v2, a205
    v_mfma_f32_16x16x32_bf16 v[44:47], a[240:243], a[100:103], v[44:47]
    s_waitcnt lgkmcnt(4)
    s_waitcnt vmcnt(25)
    s_barrier
    v_mul_f32 v1, v1, v237
    v_mfma_f32_16x16x32_bf16 v[48:51], a[248:251], a[100:103], v[48:51]
    ds_read_b64_tr_b16 a[240:241], v250 offset:12320
    v_mul_f32 v2, v2, v237
    v_mfma_f32_16x16x32_bf16 v[48:51], a[252:255], a[20:23], v[48:51]
    ds_read_b64_tr_b16 a[242:243], v250 offset:13856
    v_cvt_pk_bf16_f32 v1, v1, v2
    v_mfma_f32_16x16x32_bf16 v[88:91], a[252:255], a[24:27], v[88:91]
    v_accvgpr_read_b32 v2, a206
    v_accvgpr_read_b32 v3, a207
    v_mfma_f32_16x16x32_bf16 v[88:91], a[248:251], a[104:107], v[88:91]
    buffer_load_dwordx4 a[192:195], v0, s[44:47], s35 offen offset:3072 sc1
    v_mul_f32 v2, v2, v237
    v_mfma_f32_16x16x32_bf16 v[128:131], a[248:251], a[108:111], v[128:131]
    v_mul_f32 v3, v3, v237
    v_cvt_pk_bf16_f32 v2, v2, v3
    v_mfma_f32_16x16x32_bf16 v[128:131], a[252:255], a[28:31], v[128:131]
    ds_read_b64_tr_b16 a[244:245], v250 offset:24640
    v_accvgpr_read_b32 v3, a224
    v_mfma_f32_16x16x32_bf16 v[168:171], a[252:255], a[32:35], v[168:171]
    ds_read_b64_tr_b16 a[246:247], v250 offset:26176
    v_accvgpr_read_b32 v4, a225
    v_mfma_f32_16x16x32_bf16 v[168:171], a[248:251], a[112:115], v[168:171]
    v_mul_f32 v3, v3, v237
    v_mul_f32 v4, v4, v237
    v_mfma_f32_16x16x32_bf16 v[208:211], a[248:251], a[116:119], v[208:211]
    buffer_load_dwordx4 a[196:199], v0, s[44:47], s36 offen sc1
    v_cvt_pk_bf16_f32 v3, v3, v4
    v_mfma_f32_16x16x32_bf16 v[208:211], a[252:255], a[36:39], v[208:211]
    s_waitcnt lgkmcnt(4)
    v_accvgpr_read_b32 v4, a226
    v_accvgpr_read_b32 v5, a227
    v_mfma_f32_16x16x32_bf16 v[212:215], v[10:13], a[36:39], v[212:215]
    s_mov_b32 s88, 1024
    ds_read_b64_tr_b16 a[248:249], v250 offset:12328
    v_mul_f32 v4, v4, v237
    v_mfma_f32_16x16x32_bf16 v[212:215], v[6:9], a[116:119], v[212:215]
    ds_read_b64_tr_b16 a[250:251], v250 offset:13864
    v_mul_f32 v5, v5, v237
    v_mfma_f32_16x16x32_bf16 v[172:175], v[6:9], a[112:115], v[172:175]
    v_cvt_pk_bf16_f32 v4, v4, v5
    v_accvgpr_write_b32 a204, v1
    v_mfma_f32_16x16x32_bf16 v[172:175], v[10:13], a[32:35], v[172:175]
    buffer_store_dwordx4 a[4:7], v0, s[24:27], s88 offen sc1
    v_accvgpr_write_b32 a205, v2
    v_mfma_f32_16x16x32_bf16 v[132:135], v[10:13], a[28:31], v[132:135]
    v_accvgpr_write_b32 a206, v3
    v_accvgpr_write_b32 a207, v4
    v_mfma_f32_16x16x32_bf16 v[132:135], v[6:9], a[108:111], v[132:135]
    s_add_u32 m0, s31, 0
    ds_read_b64_tr_b16 a[252:253], v250 offset:24648
    v_accvgpr_read_b32 v1, a208
    v_mfma_f32_16x16x32_bf16 v[92:95], v[6:9], a[104:107], v[92:95]
    s_xor_b32 s3, s62, 10
    ds_read_b64_tr_b16 a[254:255], v250 offset:26184
    v_accvgpr_read_b32 v2, a209
    v_mfma_f32_16x16x32_bf16 v[92:95], v[10:13], a[24:27], v[92:95]
    s_mul_i32 s32, s3, 40960
    v_mul_f32 v1, v1, v238
    v_mul_f32 v2, v2, v238
    v_mfma_f32_16x16x32_bf16 v[52:55], v[10:13], a[20:23], v[52:55]
    buffer_load_dwordx4 v242, s[64:67], s32 offen lds
    v_cvt_pk_bf16_f32 v1, v1, v2
    v_mfma_f32_16x16x32_bf16 v[52:55], v[6:9], a[100:103], v[52:55]
    s_waitcnt lgkmcnt(4)
    s_waitcnt vmcnt(19)
    v_accvgpr_read_b32 v2, a210
    v_accvgpr_read_b32 v3, a211
    v_mfma_f32_16x16x32_bf16 v[16:19], a[240:243], a[60:63], v[16:19]
    ds_read_b64_tr_b16 v[6:7], v251 offset:12320
    v_mul_f32 v2, v2, v238
    v_mfma_f32_16x16x32_bf16 v[16:19], a[244:247], a[140:143], v[16:19]
    ds_read_b64_tr_b16 v[8:9], v251 offset:13856
    v_mul_f32 v3, v3, v238
    v_mfma_f32_16x16x32_bf16 v[56:59], a[244:247], a[144:147], v[56:59]
    v_cvt_pk_bf16_f32 v2, v2, v3
    v_accvgpr_read_b32 v3, a228
    v_mfma_f32_16x16x32_bf16 v[56:59], a[240:243], a[64:67], v[56:59]
    buffer_load_dwordx4 v243, s[64:67], s32 offen offset:1024 lds
    v_accvgpr_read_b32 v4, a229
    v_mfma_f32_16x16x32_bf16 v[96:99], a[240:243], a[68:71], v[96:99]
    v_mul_f32 v3, v3, v238
    v_mul_f32 v4, v4, v238
    v_mfma_f32_16x16x32_bf16 v[96:99], a[244:247], a[148:151], v[96:99]
    ds_read_b64_tr_b16 v[10:11], v251 offset:24640
    v_cvt_pk_bf16_f32 v3, v3, v4
    v_mfma_f32_16x16x32_bf16 v[136:139], a[244:247], a[152:155], v[136:139]
    ds_read_b64_tr_b16 v[12:13], v251 offset:26176
    v_accvgpr_read_b32 v4, a230
    v_mfma_f32_16x16x32_bf16 v[136:139], a[240:243], a[72:75], v[136:139]
    v_accvgpr_read_b32 v5, a231
    v_mul_f32 v4, v4, v238
    v_mfma_f32_16x16x32_bf16 v[176:179], a[240:243], a[76:79], v[176:179]
    buffer_load_dwordx4 v244, s[64:67], s32 offen offset:2048 lds
    v_mul_f32 v5, v5, v238
    v_mfma_f32_16x16x32_bf16 v[176:179], a[244:247], a[156:159], v[176:179]
    s_waitcnt lgkmcnt(4)
    v_cvt_pk_bf16_f32 v4, v4, v5
    v_accvgpr_write_b32 a208, v1
    v_mfma_f32_16x16x32_bf16 v[180:183], a[252:255], a[156:159], v[180:183]
    s_mov_b32 s88, 2048
    ds_read_b64_tr_b16 a[240:241], v251 offset:12328
    v_accvgpr_write_b32 a209, v2
    v_mfma_f32_16x16x32_bf16 v[180:183], a[248:251], a[76:79], v[180:183]
    ds_read_b64_tr_b16 a[242:243], v251 offset:13864
    v_accvgpr_write_b32 a210, v3
    v_mfma_f32_16x16x32_bf16 v[140:143], a[248:251], a[72:75], v[140:143]
    v_accvgpr_write_b32 a211, v4
    v_accvgpr_read_b32 v1, a212
    v_mfma_f32_16x16x32_bf16 v[140:143], a[252:255], a[152:155], v[140:143]
    buffer_store_dwordx4 a[8:11], v0, s[24:27], s88 offen sc1
    v_accvgpr_read_b32 v2, a213
    v_mfma_f32_16x16x32_bf16 v[100:103], a[252:255], a[148:151], v[100:103]
    v_mul_f32 v1, v1, v239
    v_mul_f32 v2, v2, v239
    v_mfma_f32_16x16x32_bf16 v[100:103], a[248:251], a[68:71], v[100:103]
    s_xor_b32 s3, s62, 10
    ds_read_b64_tr_b16 a[244:245], v251 offset:24648
    v_cvt_pk_bf16_f32 v1, v1, v2
    v_mfma_f32_16x16x32_bf16 v[60:63], a[248:251], a[64:67], v[60:63]
    s_mul_i32 s35, s3, 10240
    ds_read_b64_tr_b16 a[246:247], v251 offset:26184
    v_accvgpr_read_b32 v2, a214
    v_mfma_f32_16x16x32_bf16 v[60:63], a[252:255], a[144:147], v[60:63]
    s_add_u32 s36, s35, 4096
    v_accvgpr_read_b32 v3, a215
    v_mul_f32 v2, v2, v239
    v_mfma_f32_16x16x32_bf16 v[20:23], a[252:255], a[140:143], v[20:23]
    buffer_load_dwordx4 a[20:23], v0, s[44:47], s35 offen sc1
    v_mul_f32 v3, v3, v239
    v_mfma_f32_16x16x32_bf16 v[20:23], a[248:251], a[60:63], v[20:23]
    s_waitcnt lgkmcnt(4)
    v_cvt_pk_bf16_f32 v2, v2, v3
    v_accvgpr_read_b32 v3, a232
    v_mfma_f32_16x16x32_bf16 v[24:27], v[6:9], a[60:63], v[24:27]
    ds_read_b64_tr_b16 a[248:249], v252 offset:12320
    v_accvgpr_read_b32 v4, a233
    v_mfma_f32_16x16x32_bf16 v[24:27], v[10:13], a[140:143], v[24:27]
    ds_read_b64_tr_b16 a[250:251], v252 offset:13856
    v_mul_f32 v3, v3, v239
    v_mfma_f32_16x16x32_bf16 v[64:67], v[10:13], a[144:147], v[64:67]
    v_mul_f32 v4, v4, v239
    v_cvt_pk_bf16_f32 v3, v3, v4
    v_mfma_f32_16x16x32_bf16 v[64:67], v[6:9], a[64:67], v[64:67]
    buffer_load_dwordx4 a[24:27], v0, s[44:47], s35 offen offset:1024 sc1
    v_accvgpr_read_b32 v4, a234
    v_mfma_f32_16x16x32_bf16 v[104:107], v[6:9], a[68:71], v[104:107]
    v_accvgpr_read_b32 v5, a235
    v_mul_f32 v4, v4, v239
    v_mfma_f32_16x16x32_bf16 v[104:107], v[10:13], a[148:151], v[104:107]
    ds_read_b64_tr_b16 a[252:253], v252 offset:24640
    v_mul_f32 v5, v5, v239
    v_mfma_f32_16x16x32_bf16 v[144:147], v[10:13], a[152:155], v[144:147]
    ds_read_b64_tr_b16 a[254:255], v252 offset:26176
    v_cvt_pk_bf16_f32 v4, v4, v5
    v_mfma_f32_16x16x32_bf16 v[144:147], v[6:9], a[72:75], v[144:147]
    v_accvgpr_write_b32 a212, v1
    v_accvgpr_write_b32 a213, v2
    v_mfma_f32_16x16x32_bf16 v[184:187], v[6:9], a[76:79], v[184:187]
    buffer_load_dwordx4 a[28:31], v0, s[44:47], s35 offen offset:2048 sc1
    v_accvgpr_write_b32 a214, v3
    v_mfma_f32_16x16x32_bf16 v[184:187], v[10:13], a[156:159], v[184:187]
    s_waitcnt lgkmcnt(4)
    v_accvgpr_write_b32 a215, v4
    v_accvgpr_read_b32 v1, a216
    v_mfma_f32_16x16x32_bf16 v[188:191], a[244:247], a[156:159], v[188:191]
    ds_read_b64_tr_b16 v[6:7], v252 offset:12328
    v_accvgpr_read_b32 v2, a217
    v_mfma_f32_16x16x32_bf16 v[188:191], a[240:243], a[76:79], v[188:191]
    ds_read_b64_tr_b16 v[8:9], v252 offset:13864
    v_mul_f32 v1, v1, v240
    v_mfma_f32_16x16x32_bf16 v[148:151], a[240:243], a[72:75], v[148:151]
    v_mul_f32 v2, v2, v240
    v_cvt_pk_bf16_f32 v1, v1, v2
    v_mfma_f32_16x16x32_bf16 v[148:151], a[244:247], a[152:155], v[148:151]
    buffer_load_dwordx4 a[32:35], v0, s[44:47], s35 offen offset:3072 sc1
    v_accvgpr_read_b32 v2, a218
    v_mfma_f32_16x16x32_bf16 v[108:111], a[244:247], a[148:151], v[108:111]
    v_accvgpr_read_b32 v3, a219
    v_mul_f32 v2, v2, v240
    v_mfma_f32_16x16x32_bf16 v[108:111], a[240:243], a[68:71], v[108:111]
    ds_read_b64_tr_b16 v[10:11], v252 offset:24648
    v_mul_f32 v3, v3, v240
    v_mfma_f32_16x16x32_bf16 v[68:71], a[240:243], a[64:67], v[68:71]
    ds_read_b64_tr_b16 v[12:13], v252 offset:26184
    v_cvt_pk_bf16_f32 v2, v2, v3
    v_mfma_f32_16x16x32_bf16 v[68:71], a[244:247], a[144:147], v[68:71]
    v_accvgpr_read_b32 v3, a236
    v_accvgpr_read_b32 v4, a237
    v_mfma_f32_16x16x32_bf16 v[28:31], a[244:247], a[140:143], v[28:31]
    buffer_load_dwordx4 a[36:39], v0, s[44:47], s36 offen sc1
    v_mul_f32 v3, v3, v240
    v_mfma_f32_16x16x32_bf16 v[28:31], a[240:243], a[60:63], v[28:31]
    s_waitcnt lgkmcnt(4)
    v_mul_f32 v4, v4, v240
    v_cvt_pk_bf16_f32 v3, v3, v4
    v_mfma_f32_16x16x32_bf16 v[32:35], a[248:251], a[60:63], v[32:35]
    s_mov_b32 s88, 3072
    ds_read_b64_tr_b16 a[240:241], v253 offset:12320
    v_accvgpr_read_b32 v4, a238
    v_mfma_f32_16x16x32_bf16 v[32:35], a[252:255], a[140:143], v[32:35]
    ds_read_b64_tr_b16 a[242:243], v253 offset:13856
    v_accvgpr_read_b32 v5, a239
    v_mfma_f32_16x16x32_bf16 v[72:75], a[252:255], a[144:147], v[72:75]
    v_mul_f32 v4, v4, v240
    v_mul_f32 v5, v5, v240
    v_mfma_f32_16x16x32_bf16 v[72:75], a[248:251], a[64:67], v[72:75]
    buffer_store_dwordx4 a[12:15], v0, s[24:27], s88 offen sc1
    v_cvt_pk_bf16_f32 v4, v4, v5
    v_mfma_f32_16x16x32_bf16 v[112:115], a[248:251], a[68:71], v[112:115]
    v_accvgpr_write_b32 a216, v1
    v_accvgpr_write_b32 a217, v2
    v_mfma_f32_16x16x32_bf16 v[112:115], a[252:255], a[148:151], v[112:115]
    s_add_u32 m0, s31, 12320
    ds_read_b64_tr_b16 a[244:245], v253 offset:24640
    v_accvgpr_write_b32 a218, v3
    v_mfma_f32_16x16x32_bf16 v[152:155], a[252:255], a[152:155], v[152:155]
    s_xor_b32 s3, s62, 11
    ds_read_b64_tr_b16 a[246:247], v253 offset:26176
    v_accvgpr_write_b32 a219, v4
    v_mfma_f32_16x16x32_bf16 v[152:155], a[248:251], a[72:75], v[152:155]
    s_mul_i32 s32, s3, 40960
    v_mfma_f32_16x16x32_bf16 v[192:195], a[248:251], a[76:79], v[192:195]
    buffer_load_dwordx4 v242, s[64:67], s32 offen lds
    v_mfma_f32_16x16x32_bf16 v[192:195], a[252:255], a[156:159], v[192:195]
    s_waitcnt lgkmcnt(4)
    v_mfma_f32_16x16x32_bf16 v[196:199], v[10:13], a[156:159], v[196:199]
    ds_read_b64_tr_b16 a[248:249], v253 offset:12328
    v_mfma_f32_16x16x32_bf16 v[196:199], v[6:9], a[76:79], v[196:199]
    ds_read_b64_tr_b16 a[250:251], v253 offset:13864
    v_mfma_f32_16x16x32_bf16 v[156:159], v[6:9], a[72:75], v[156:159]
    v_mfma_f32_16x16x32_bf16 v[156:159], v[10:13], a[152:155], v[156:159]
    buffer_load_dwordx4 v243, s[64:67], s32 offen offset:1024 lds
    v_mfma_f32_16x16x32_bf16 v[116:119], v[10:13], a[148:151], v[116:119]
    v_mfma_f32_16x16x32_bf16 v[116:119], v[6:9], a[68:71], v[116:119]
    ds_read_b64_tr_b16 a[252:253], v253 offset:24648
    v_mfma_f32_16x16x32_bf16 v[76:79], v[6:9], a[64:67], v[76:79]
    ds_read_b64_tr_b16 a[254:255], v253 offset:26184
    v_mfma_f32_16x16x32_bf16 v[76:79], v[10:13], a[144:147], v[76:79]
    v_mfma_f32_16x16x32_bf16 v[36:39], v[10:13], a[140:143], v[36:39]
    buffer_load_dwordx4 v244, s[64:67], s32 offen offset:2048 lds
    v_mfma_f32_16x16x32_bf16 v[36:39], v[6:9], a[60:63], v[36:39]
    s_waitcnt lgkmcnt(4)
    v_mfma_f32_16x16x32_bf16 v[40:43], a[240:243], a[60:63], v[40:43]
    s_mov_b32 s88, 4096
    ds_read_b64_tr_b16 v[6:7], v254 offset:12320
    v_mfma_f32_16x16x32_bf16 v[40:43], a[244:247], a[140:143], v[40:43]
    ds_read_b64_tr_b16 v[8:9], v254 offset:13856
    v_mfma_f32_16x16x32_bf16 v[80:83], a[244:247], a[144:147], v[80:83]
    v_mfma_f32_16x16x32_bf16 v[80:83], a[240:243], a[64:67], v[80:83]
    buffer_store_dwordx4 a[16:19], v0, s[24:27], s88 offen sc1
    v_mfma_f32_16x16x32_bf16 v[120:123], a[240:243], a[68:71], v[120:123]
    v_mfma_f32_16x16x32_bf16 v[120:123], a[244:247], a[148:151], v[120:123]
    s_xor_b32 s3, s62, 11
    ds_read_b64_tr_b16 v[10:11], v254 offset:24640
    v_mfma_f32_16x16x32_bf16 v[160:163], a[244:247], a[152:155], v[160:163]
    s_mul_i32 s35, s3, 10240
    ds_read_b64_tr_b16 v[12:13], v254 offset:26176
    v_mfma_f32_16x16x32_bf16 v[160:163], a[240:243], a[72:75], v[160:163]
    s_add_u32 s36, s35, 4096
    v_mfma_f32_16x16x32_bf16 v[200:203], a[240:243], a[76:79], v[200:203]
    buffer_load_dwordx4 a[100:103], v0, s[44:47], s35 offen sc1
    v_mfma_f32_16x16x32_bf16 v[200:203], a[244:247], a[156:159], v[200:203]
    s_waitcnt lgkmcnt(4)
    v_mfma_f32_16x16x32_bf16 v[204:207], a[252:255], a[156:159], v[204:207]
    ds_read_b64_tr_b16 a[240:241], v254 offset:12328
    v_mfma_f32_16x16x32_bf16 v[204:207], a[248:251], a[76:79], v[204:207]
    ds_read_b64_tr_b16 a[242:243], v254 offset:13864
    v_mfma_f32_16x16x32_bf16 v[164:167], a[248:251], a[72:75], v[164:167]
    v_mfma_f32_16x16x32_bf16 v[164:167], a[252:255], a[152:155], v[164:167]
    buffer_load_dwordx4 a[104:107], v0, s[44:47], s35 offen offset:1024 sc1
    v_mfma_f32_16x16x32_bf16 v[124:127], a[252:255], a[148:151], v[124:127]
    v_mfma_f32_16x16x32_bf16 v[124:127], a[248:251], a[68:71], v[124:127]
    ds_read_b64_tr_b16 a[244:245], v254 offset:24648
    v_mfma_f32_16x16x32_bf16 v[84:87], a[248:251], a[64:67], v[84:87]
    ds_read_b64_tr_b16 a[246:247], v254 offset:26184
    v_mfma_f32_16x16x32_bf16 v[84:87], a[252:255], a[144:147], v[84:87]
    v_mfma_f32_16x16x32_bf16 v[44:47], a[252:255], a[140:143], v[44:47]
    buffer_load_dwordx4 a[108:111], v0, s[44:47], s35 offen offset:2048 sc1
    v_mfma_f32_16x16x32_bf16 v[44:47], a[248:251], a[60:63], v[44:47]
    s_waitcnt lgkmcnt(4)
    s_waitcnt vmcnt(24)
    s_barrier
    v_mfma_f32_16x16x32_bf16 v[48:51], v[6:9], a[60:63], v[48:51]
    ds_read_b64_tr_b16 a[248:249], v250 offset:36960
    v_mfma_f32_16x16x32_bf16 v[48:51], v[10:13], a[140:143], v[48:51]
    ds_read_b64_tr_b16 a[250:251], v250 offset:38496
    v_mfma_f32_16x16x32_bf16 v[88:91], v[10:13], a[144:147], v[88:91]
    v_mfma_f32_16x16x32_bf16 v[88:91], v[6:9], a[64:67], v[88:91]
    buffer_load_dwordx4 a[112:115], v0, s[44:47], s35 offen offset:3072 sc1
    v_mfma_f32_16x16x32_bf16 v[128:131], v[6:9], a[68:71], v[128:131]
    v_mfma_f32_16x16x32_bf16 v[128:131], v[10:13], a[148:151], v[128:131]
    ds_read_b64_tr_b16 a[252:253], v250 offset:49280
    v_mfma_f32_16x16x32_bf16 v[168:171], v[10:13], a[152:155], v[168:171]
    ds_read_b64_tr_b16 a[254:255], v250 offset:50816
    v_mfma_f32_16x16x32_bf16 v[168:171], v[6:9], a[72:75], v[168:171]
    v_mfma_f32_16x16x32_bf16 v[208:211], v[6:9], a[76:79], v[208:211]
    buffer_load_dwordx4 a[116:119], v0, s[44:47], s36 offen sc1
    v_mfma_f32_16x16x32_bf16 v[208:211], v[10:13], a[156:159], v[208:211]
    s_waitcnt lgkmcnt(4)
    v_mfma_f32_16x16x32_bf16 v[212:215], a[244:247], a[156:159], v[212:215]
    s_mov_b32 s88, 10240
    ds_read_b64_tr_b16 v[6:7], v250 offset:36968
    v_mfma_f32_16x16x32_bf16 v[212:215], a[240:243], a[76:79], v[212:215]
    ds_read_b64_tr_b16 v[8:9], v250 offset:38504
    v_mfma_f32_16x16x32_bf16 v[172:175], a[240:243], a[72:75], v[172:175]
    v_mfma_f32_16x16x32_bf16 v[172:175], a[244:247], a[152:155], v[172:175]
    buffer_store_dwordx4 a[40:43], v0, s[24:27], s88 offen sc1
    v_mfma_f32_16x16x32_bf16 v[132:135], a[244:247], a[148:151], v[132:135]
    v_mfma_f32_16x16x32_bf16 v[132:135], a[240:243], a[68:71], v[132:135]
    s_add_u32 m0, s31, 24640
    ds_read_b64_tr_b16 v[10:11], v250 offset:49288
    v_mfma_f32_16x16x32_bf16 v[92:95], a[240:243], a[64:67], v[92:95]
    s_xor_b32 s3, s62, 12
    ds_read_b64_tr_b16 v[12:13], v250 offset:50824
    v_mfma_f32_16x16x32_bf16 v[92:95], a[244:247], a[144:147], v[92:95]
    s_mul_i32 s32, s3, 40960
    v_mfma_f32_16x16x32_bf16 v[52:55], a[244:247], a[140:143], v[52:55]
    buffer_load_dwordx4 v242, s[64:67], s32 offen lds
    v_mfma_f32_16x16x32_bf16 v[52:55], a[240:243], a[60:63], v[52:55]
    s_waitcnt lgkmcnt(4)
    s_waitcnt vmcnt(22)
    v_mfma_f32_16x16x32_bf16 v[16:19], a[248:251], v[216:219], v[16:19]
    ds_read_b64_tr_b16 a[240:241], v251 offset:36960
    v_mfma_f32_16x16x32_bf16 v[16:19], a[252:255], a[180:183], v[16:19]
    ds_read_b64_tr_b16 a[242:243], v251 offset:38496
    v_mfma_f32_16x16x32_bf16 v[56:59], a[252:255], a[184:187], v[56:59]
    v_mfma_f32_16x16x32_bf16 v[56:59], a[248:251], v[220:223], v[56:59]
    buffer_load_dwordx4 v243, s[64:67], s32 offen offset:1024 lds
    v_mfma_f32_16x16x32_bf16 v[96:99], a[248:251], v[224:227], v[96:99]
    v_mfma_f32_16x16x32_bf16 v[96:99], a[252:255], a[188:191], v[96:99]
    ds_read_b64_tr_b16 a[244:245], v251 offset:49280
    v_mfma_f32_16x16x32_bf16 v[136:139], a[252:255], a[192:195], v[136:139]
    ds_read_b64_tr_b16 a[246:247], v251 offset:50816
    v_mfma_f32_16x16x32_bf16 v[136:139], a[248:251], v[228:231], v[136:139]
    v_mfma_f32_16x16x32_bf16 v[176:179], a[248:251], v[232:235], v[176:179]
    buffer_load_dwordx4 v244, s[64:67], s32 offen offset:2048 lds
    v_mfma_f32_16x16x32_bf16 v[176:179], a[252:255], a[196:199], v[176:179]
    s_waitcnt lgkmcnt(4)
    v_mfma_f32_16x16x32_bf16 v[180:183], v[10:13], a[196:199], v[180:183]
    s_mov_b32 s88, 11264
    ds_read_b64_tr_b16 a[248:249], v251 offset:36968
    v_mfma_f32_16x16x32_bf16 v[180:183], v[6:9], v[232:235], v[180:183]
    ds_read_b64_tr_b16 a[250:251], v251 offset:38504
    v_mfma_f32_16x16x32_bf16 v[140:143], v[6:9], v[228:231], v[140:143]
    v_mfma_f32_16x16x32_bf16 v[140:143], v[10:13], a[192:195], v[140:143]
    buffer_store_dwordx4 a[44:47], v0, s[24:27], s88 offen sc1
    v_mfma_f32_16x16x32_bf16 v[100:103], v[10:13], a[188:191], v[100:103]
    v_mfma_f32_16x16x32_bf16 v[100:103], v[6:9], v[224:227], v[100:103]
    s_xor_b32 s3, s62, 12
    ds_read_b64_tr_b16 a[252:253], v251 offset:49288
    v_mfma_f32_16x16x32_bf16 v[60:63], v[6:9], v[220:223], v[60:63]
    s_mul_i32 s35, s3, 10240
    ds_read_b64_tr_b16 a[254:255], v251 offset:50824
    v_mfma_f32_16x16x32_bf16 v[60:63], v[10:13], a[184:187], v[60:63]
    s_add_u32 s36, s35, 4096
    v_mfma_f32_16x16x32_bf16 v[20:23], v[10:13], a[180:183], v[20:23]
    buffer_load_dwordx4 a[220:223], v0, s[44:47], s35 offen sc1
    v_mfma_f32_16x16x32_bf16 v[20:23], v[6:9], v[216:219], v[20:23]
    s_waitcnt lgkmcnt(4)
    v_mfma_f32_16x16x32_bf16 v[24:27], a[240:243], v[216:219], v[24:27]
    ds_read_b64_tr_b16 v[6:7], v252 offset:36960
    v_mfma_f32_16x16x32_bf16 v[24:27], a[244:247], a[180:183], v[24:27]
    ds_read_b64_tr_b16 v[8:9], v252 offset:38496
    v_mfma_f32_16x16x32_bf16 v[64:67], a[244:247], a[184:187], v[64:67]
    v_mfma_f32_16x16x32_bf16 v[64:67], a[240:243], v[220:223], v[64:67]
    buffer_load_dwordx4 a[224:227], v0, s[44:47], s35 offen offset:1024 sc1
    v_mfma_f32_16x16x32_bf16 v[104:107], a[240:243], v[224:227], v[104:107]
    v_mfma_f32_16x16x32_bf16 v[104:107], a[244:247], a[188:191], v[104:107]
    ds_read_b64_tr_b16 v[10:11], v252 offset:49280
    v_mfma_f32_16x16x32_bf16 v[144:147], a[244:247], a[192:195], v[144:147]
    ds_read_b64_tr_b16 v[12:13], v252 offset:50816
    v_mfma_f32_16x16x32_bf16 v[144:147], a[240:243], v[228:231], v[144:147]
    v_mfma_f32_16x16x32_bf16 v[184:187], a[240:243], v[232:235], v[184:187]
    buffer_load_dwordx4 a[228:231], v0, s[44:47], s35 offen offset:2048 sc1
    v_mfma_f32_16x16x32_bf16 v[184:187], a[244:247], a[196:199], v[184:187]
    s_waitcnt lgkmcnt(4)
    v_mfma_f32_16x16x32_bf16 v[188:191], a[252:255], a[196:199], v[188:191]
    ds_read_b64_tr_b16 a[240:241], v252 offset:36968
    v_mfma_f32_16x16x32_bf16 v[188:191], a[248:251], v[232:235], v[188:191]
    ds_read_b64_tr_b16 a[242:243], v252 offset:38504
    v_mfma_f32_16x16x32_bf16 v[148:151], a[248:251], v[228:231], v[148:151]
    v_mfma_f32_16x16x32_bf16 v[148:151], a[252:255], a[192:195], v[148:151]
    buffer_load_dwordx4 a[232:235], v0, s[44:47], s35 offen offset:3072 sc1
    v_mfma_f32_16x16x32_bf16 v[108:111], a[252:255], a[188:191], v[108:111]
    v_mfma_f32_16x16x32_bf16 v[108:111], a[248:251], v[224:227], v[108:111]
    ds_read_b64_tr_b16 a[244:245], v252 offset:49288
    v_mfma_f32_16x16x32_bf16 v[68:71], a[248:251], v[220:223], v[68:71]
    ds_read_b64_tr_b16 a[246:247], v252 offset:50824
    v_mfma_f32_16x16x32_bf16 v[68:71], a[252:255], a[184:187], v[68:71]
    v_mfma_f32_16x16x32_bf16 v[28:31], a[252:255], a[180:183], v[28:31]
    buffer_load_dwordx4 a[236:239], v0, s[44:47], s36 offen sc1
    v_mfma_f32_16x16x32_bf16 v[28:31], a[248:251], v[216:219], v[28:31]
    s_waitcnt lgkmcnt(4)
    v_mfma_f32_16x16x32_bf16 v[32:35], v[6:9], v[216:219], v[32:35]
    s_mov_b32 s88, 12288
    ds_read_b64_tr_b16 a[248:249], v253 offset:36960
    v_mfma_f32_16x16x32_bf16 v[32:35], v[10:13], a[180:183], v[32:35]
    ds_read_b64_tr_b16 a[250:251], v253 offset:38496
    v_mfma_f32_16x16x32_bf16 v[72:75], v[10:13], a[184:187], v[72:75]
    v_mfma_f32_16x16x32_bf16 v[72:75], v[6:9], v[220:223], v[72:75]
    buffer_store_dwordx4 a[48:51], v0, s[24:27], s88 offen sc1
    v_mfma_f32_16x16x32_bf16 v[112:115], v[6:9], v[224:227], v[112:115]
    v_mfma_f32_16x16x32_bf16 v[112:115], v[10:13], a[188:191], v[112:115]
    s_add_u32 m0, s31, 36960
    ds_read_b64_tr_b16 a[252:253], v253 offset:49280
    v_mfma_f32_16x16x32_bf16 v[152:155], v[10:13], a[192:195], v[152:155]
    s_xor_b32 s3, s62, 13
    ds_read_b64_tr_b16 a[254:255], v253 offset:50816
    v_mfma_f32_16x16x32_bf16 v[152:155], v[6:9], v[228:231], v[152:155]
    s_mul_i32 s32, s3, 40960
    v_mfma_f32_16x16x32_bf16 v[192:195], v[6:9], v[232:235], v[192:195]
    buffer_load_dwordx4 v242, s[64:67], s32 offen lds
    v_mfma_f32_16x16x32_bf16 v[192:195], v[10:13], a[196:199], v[192:195]
    s_waitcnt lgkmcnt(4)
    v_mfma_f32_16x16x32_bf16 v[196:199], a[244:247], a[196:199], v[196:199]
    ds_read_b64_tr_b16 v[6:7], v253 offset:36968
    v_mfma_f32_16x16x32_bf16 v[196:199], a[240:243], v[232:235], v[196:199]
    ds_read_b64_tr_b16 v[8:9], v253 offset:38504
    v_mfma_f32_16x16x32_bf16 v[156:159], a[240:243], v[228:231], v[156:159]
    v_mfma_f32_16x16x32_bf16 v[156:159], a[244:247], a[192:195], v[156:159]
    buffer_load_dwordx4 v243, s[64:67], s32 offen offset:1024 lds
    v_mfma_f32_16x16x32_bf16 v[116:119], a[244:247], a[188:191], v[116:119]
    v_mfma_f32_16x16x32_bf16 v[116:119], a[240:243], v[224:227], v[116:119]
    ds_read_b64_tr_b16 v[10:11], v253 offset:49288
    v_mfma_f32_16x16x32_bf16 v[76:79], a[240:243], v[220:223], v[76:79]
    ds_read_b64_tr_b16 v[12:13], v253 offset:50824
    v_mfma_f32_16x16x32_bf16 v[76:79], a[244:247], a[184:187], v[76:79]
    v_mfma_f32_16x16x32_bf16 v[36:39], a[244:247], a[180:183], v[36:39]
    buffer_load_dwordx4 v244, s[64:67], s32 offen offset:2048 lds
    v_mfma_f32_16x16x32_bf16 v[36:39], a[240:243], v[216:219], v[36:39]
    s_waitcnt lgkmcnt(4)
    v_mfma_f32_16x16x32_bf16 v[40:43], a[248:251], v[216:219], v[40:43]
    s_mov_b32 s88, 13312
    ds_read_b64_tr_b16 a[240:241], v254 offset:36960
    v_mfma_f32_16x16x32_bf16 v[40:43], a[252:255], a[180:183], v[40:43]
    ds_read_b64_tr_b16 a[242:243], v254 offset:38496
    v_mfma_f32_16x16x32_bf16 v[80:83], a[252:255], a[184:187], v[80:83]
    v_mfma_f32_16x16x32_bf16 v[80:83], a[248:251], v[220:223], v[80:83]
    buffer_store_dwordx4 a[52:55], v0, s[24:27], s88 offen sc1
    v_mfma_f32_16x16x32_bf16 v[120:123], a[248:251], v[224:227], v[120:123]
    v_mfma_f32_16x16x32_bf16 v[120:123], a[252:255], a[188:191], v[120:123]
    s_xor_b32 s3, s62, 13
    ds_read_b64_tr_b16 a[244:245], v254 offset:49280
    v_mfma_f32_16x16x32_bf16 v[160:163], a[252:255], a[192:195], v[160:163]
    s_mul_i32 s35, s3, 10240
    ds_read_b64_tr_b16 a[246:247], v254 offset:50816
    v_mfma_f32_16x16x32_bf16 v[160:163], a[248:251], v[228:231], v[160:163]
    s_add_u32 s36, s35, 4096
    v_mfma_f32_16x16x32_bf16 v[200:203], a[248:251], v[232:235], v[200:203]
    buffer_load_dwordx4 a[60:63], v0, s[44:47], s35 offen sc1
    v_mfma_f32_16x16x32_bf16 v[200:203], a[252:255], a[196:199], v[200:203]
    s_waitcnt lgkmcnt(4)
    v_mfma_f32_16x16x32_bf16 v[204:207], v[10:13], a[196:199], v[204:207]
    ds_read_b64_tr_b16 a[248:249], v254 offset:36968
    v_mfma_f32_16x16x32_bf16 v[204:207], v[6:9], v[232:235], v[204:207]
    ds_read_b64_tr_b16 a[250:251], v254 offset:38504
    v_mfma_f32_16x16x32_bf16 v[164:167], v[6:9], v[228:231], v[164:167]
    v_mfma_f32_16x16x32_bf16 v[164:167], v[10:13], a[192:195], v[164:167]
    buffer_load_dwordx4 a[64:67], v0, s[44:47], s35 offen offset:1024 sc1
    v_mfma_f32_16x16x32_bf16 v[124:127], v[10:13], a[188:191], v[124:127]
    v_mfma_f32_16x16x32_bf16 v[124:127], v[6:9], v[224:227], v[124:127]
    ds_read_b64_tr_b16 a[252:253], v254 offset:49288
    v_mfma_f32_16x16x32_bf16 v[84:87], v[6:9], v[220:223], v[84:87]
    ds_read_b64_tr_b16 a[254:255], v254 offset:50824
    v_mfma_f32_16x16x32_bf16 v[84:87], v[10:13], a[184:187], v[84:87]
    v_mfma_f32_16x16x32_bf16 v[44:47], v[10:13], a[180:183], v[44:47]
    buffer_load_dwordx4 a[68:71], v0, s[44:47], s35 offen offset:2048 sc1
    v_mfma_f32_16x16x32_bf16 v[44:47], v[6:9], v[216:219], v[44:47]
    s_waitcnt lgkmcnt(4)
    s_waitcnt vmcnt(24)
    s_barrier
    v_mfma_f32_16x16x32_bf16 v[48:51], a[240:243], v[216:219], v[48:51]
    ds_read_b64_tr_b16 v[6:7], v245 offset:0
    v_mfma_f32_16x16x32_bf16 v[48:51], a[244:247], a[180:183], v[48:51]
    ds_read_b64_tr_b16 v[8:9], v245 offset:1536
    v_mfma_f32_16x16x32_bf16 v[88:91], a[244:247], a[184:187], v[88:91]
    v_mfma_f32_16x16x32_bf16 v[88:91], a[240:243], v[220:223], v[88:91]
    buffer_load_dwordx4 a[72:75], v0, s[44:47], s35 offen offset:3072 sc1
    v_mfma_f32_16x16x32_bf16 v[128:131], a[240:243], v[224:227], v[128:131]
    v_mfma_f32_16x16x32_bf16 v[128:131], a[244:247], a[188:191], v[128:131]
    ds_read_b64_tr_b16 v[10:11], v245 offset:12320
    v_mfma_f32_16x16x32_bf16 v[168:171], a[244:247], a[192:195], v[168:171]
    ds_read_b64_tr_b16 v[12:13], v245 offset:13856
    v_mfma_f32_16x16x32_bf16 v[168:171], a[240:243], v[228:231], v[168:171]
    v_mfma_f32_16x16x32_bf16 v[208:211], a[240:243], v[232:235], v[208:211]
    buffer_load_dwordx4 a[76:79], v0, s[44:47], s36 offen sc1
    v_mfma_f32_16x16x32_bf16 v[208:211], a[244:247], a[196:199], v[208:211]
    s_waitcnt lgkmcnt(4)
    v_mfma_f32_16x16x32_bf16 v[212:215], a[252:255], a[196:199], v[212:215]
    s_mov_b32 s88, 14336
    ds_read_b64_tr_b16 a[240:241], v245 offset:8
    v_mfma_f32_16x16x32_bf16 v[212:215], a[248:251], v[232:235], v[212:215]
    ds_read_b64_tr_b16 a[242:243], v245 offset:1544
    v_mfma_f32_16x16x32_bf16 v[172:175], a[248:251], v[228:231], v[172:175]
    v_mfma_f32_16x16x32_bf16 v[172:175], a[252:255], a[192:195], v[172:175]
    buffer_store_dwordx4 a[56:59], v0, s[24:27], s88 offen sc1
    v_mfma_f32_16x16x32_bf16 v[132:135], a[252:255], a[188:191], v[132:135]
    v_mfma_f32_16x16x32_bf16 v[132:135], a[248:251], v[224:227], v[132:135]
    s_add_u32 m0, s31, 49280
    ds_read_b64_tr_b16 a[244:245], v245 offset:12328
    v_mfma_f32_16x16x32_bf16 v[92:95], a[248:251], v[220:223], v[92:95]
    s_xor_b32 s3, s62, 14
    ds_read_b64_tr_b16 a[246:247], v245 offset:13864
    v_mfma_f32_16x16x32_bf16 v[92:95], a[252:255], a[184:187], v[92:95]
    s_mul_i32 s32, s3, 40960
    v_mfma_f32_16x16x32_bf16 v[52:55], a[252:255], a[180:183], v[52:55]
    buffer_load_dwordx4 v242, s[64:67], s32 offen lds
    v_mfma_f32_16x16x32_bf16 v[52:55], a[248:251], v[216:219], v[52:55]
    s_waitcnt lgkmcnt(4)
    s_waitcnt vmcnt(22)
    v_mfma_f32_16x16x32_bf16 v[16:19], v[6:9], a[20:23], v[16:19]
    ds_read_b64_tr_b16 a[248:249], v246 offset:0
    v_mfma_f32_16x16x32_bf16 v[16:19], v[10:13], a[100:103], v[16:19]
    ds_read_b64_tr_b16 a[250:251], v246 offset:1536
    v_mfma_f32_16x16x32_bf16 v[56:59], v[10:13], a[104:107], v[56:59]
    v_mfma_f32_16x16x32_bf16 v[56:59], v[6:9], a[24:27], v[56:59]
    buffer_load_dwordx4 v243, s[64:67], s32 offen offset:1024 lds
    v_mfma_f32_16x16x32_bf16 v[96:99], v[6:9], a[28:31], v[96:99]
    v_mfma_f32_16x16x32_bf16 v[96:99], v[10:13], a[108:111], v[96:99]
    ds_read_b64_tr_b16 a[252:253], v246 offset:12320
    v_mfma_f32_16x16x32_bf16 v[136:139], v[10:13], a[112:115], v[136:139]
    ds_read_b64_tr_b16 a[254:255], v246 offset:13856
    v_mfma_f32_16x16x32_bf16 v[136:139], v[6:9], a[32:35], v[136:139]
    v_mfma_f32_16x16x32_bf16 v[176:179], v[6:9], a[36:39], v[176:179]
    buffer_load_dwordx4 v244, s[64:67], s32 offen offset:2048 lds
    v_mfma_f32_16x16x32_bf16 v[176:179], v[10:13], a[116:119], v[176:179]
    s_waitcnt lgkmcnt(4)
    v_mfma_f32_16x16x32_bf16 v[180:183], a[244:247], a[116:119], v[180:183]
    s_mov_b32 s88, 20480
    ds_read_b64_tr_b16 v[6:7], v246 offset:8
    v_mfma_f32_16x16x32_bf16 v[180:183], a[240:243], a[36:39], v[180:183]
    ds_read_b64_tr_b16 v[8:9], v246 offset:1544
    v_mfma_f32_16x16x32_bf16 v[140:143], a[240:243], a[32:35], v[140:143]
    v_mfma_f32_16x16x32_bf16 v[140:143], a[244:247], a[112:115], v[140:143]
    buffer_store_dwordx4 a[80:83], v0, s[24:27], s88 offen sc1
    v_mfma_f32_16x16x32_bf16 v[100:103], a[244:247], a[108:111], v[100:103]
    v_mfma_f32_16x16x32_bf16 v[100:103], a[240:243], a[28:31], v[100:103]
    s_xor_b32 s3, s62, 14
    ds_read_b64_tr_b16 v[10:11], v246 offset:12328
    v_mfma_f32_16x16x32_bf16 v[60:63], a[240:243], a[24:27], v[60:63]
    s_mul_i32 s35, s3, 10240
    ds_read_b64_tr_b16 v[12:13], v246 offset:13864
    v_mfma_f32_16x16x32_bf16 v[60:63], a[244:247], a[104:107], v[60:63]
    s_add_u32 s36, s35, 4096
    v_mfma_f32_16x16x32_bf16 v[20:23], a[244:247], a[100:103], v[20:23]
    buffer_load_dwordx4 a[140:143], v0, s[44:47], s35 offen sc1
    v_mfma_f32_16x16x32_bf16 v[20:23], a[240:243], a[20:23], v[20:23]
    s_waitcnt lgkmcnt(4)
    v_mfma_f32_16x16x32_bf16 v[24:27], a[248:251], a[20:23], v[24:27]
    ds_read_b64_tr_b16 a[240:241], v247 offset:0
    v_mfma_f32_16x16x32_bf16 v[24:27], a[252:255], a[100:103], v[24:27]
    ds_read_b64_tr_b16 a[242:243], v247 offset:1536
    v_mfma_f32_16x16x32_bf16 v[64:67], a[252:255], a[104:107], v[64:67]
    v_mfma_f32_16x16x32_bf16 v[64:67], a[248:251], a[24:27], v[64:67]
    buffer_load_dwordx4 a[144:147], v0, s[44:47], s35 offen offset:1024 sc1
    v_mfma_f32_16x16x32_bf16 v[104:107], a[248:251], a[28:31], v[104:107]
    v_mfma_f32_16x16x32_bf16 v[104:107], a[252:255], a[108:111], v[104:107]
    ds_read_b64_tr_b16 a[244:245], v247 offset:12320
    v_mfma_f32_16x16x32_bf16 v[144:147], a[252:255], a[112:115], v[144:147]
    ds_read_b64_tr_b16 a[246:247], v247 offset:13856
    v_mfma_f32_16x16x32_bf16 v[144:147], a[248:251], a[32:35], v[144:147]
    v_mfma_f32_16x16x32_bf16 v[184:187], a[248:251], a[36:39], v[184:187]
    buffer_load_dwordx4 a[148:151], v0, s[44:47], s35 offen offset:2048 sc1
    v_mfma_f32_16x16x32_bf16 v[184:187], a[252:255], a[116:119], v[184:187]
    s_waitcnt lgkmcnt(4)
    v_mfma_f32_16x16x32_bf16 v[188:191], v[10:13], a[116:119], v[188:191]
    ds_read_b64_tr_b16 a[248:249], v247 offset:8
    v_mfma_f32_16x16x32_bf16 v[188:191], v[6:9], a[36:39], v[188:191]
    ds_read_b64_tr_b16 a[250:251], v247 offset:1544
    v_mfma_f32_16x16x32_bf16 v[148:151], v[6:9], a[32:35], v[148:151]
    v_mfma_f32_16x16x32_bf16 v[148:151], v[10:13], a[112:115], v[148:151]
    buffer_load_dwordx4 a[152:155], v0, s[44:47], s35 offen offset:3072 sc1
    v_mfma_f32_16x16x32_bf16 v[108:111], v[10:13], a[108:111], v[108:111]
    v_mfma_f32_16x16x32_bf16 v[108:111], v[6:9], a[28:31], v[108:111]
    ds_read_b64_tr_b16 a[252:253], v247 offset:12328
    v_mfma_f32_16x16x32_bf16 v[68:71], v[6:9], a[24:27], v[68:71]
    ds_read_b64_tr_b16 a[254:255], v247 offset:13864
    v_mfma_f32_16x16x32_bf16 v[68:71], v[10:13], a[104:107], v[68:71]
    v_mfma_f32_16x16x32_bf16 v[28:31], v[10:13], a[100:103], v[28:31]
    buffer_load_dwordx4 a[156:159], v0, s[44:47], s36 offen sc1
    v_mfma_f32_16x16x32_bf16 v[28:31], v[6:9], a[20:23], v[28:31]
    s_waitcnt lgkmcnt(4)
    v_mfma_f32_16x16x32_bf16 v[32:35], a[240:243], a[20:23], v[32:35]
    s_mov_b32 s88, 21504
    ds_read_b64_tr_b16 v[6:7], v248 offset:0
    v_mfma_f32_16x16x32_bf16 v[32:35], a[244:247], a[100:103], v[32:35]
    ds_read_b64_tr_b16 v[8:9], v248 offset:1536
    v_mfma_f32_16x16x32_bf16 v[72:75], a[244:247], a[104:107], v[72:75]
    v_mfma_f32_16x16x32_bf16 v[72:75], a[240:243], a[24:27], v[72:75]
    buffer_store_dwordx4 a[84:87], v0, s[24:27], s88 offen sc1
    v_mfma_f32_16x16x32_bf16 v[112:115], a[240:243], a[28:31], v[112:115]
    v_mfma_f32_16x16x32_bf16 v[112:115], a[244:247], a[108:111], v[112:115]
    s_add_u32 m0, s31, 61600
    ds_read_b64_tr_b16 v[10:11], v248 offset:12320
    v_mfma_f32_16x16x32_bf16 v[152:155], a[244:247], a[112:115], v[152:155]
    s_xor_b32 s3, s62, 15
    ds_read_b64_tr_b16 v[12:13], v248 offset:13856
    v_mfma_f32_16x16x32_bf16 v[152:155], a[240:243], a[32:35], v[152:155]
    s_mul_i32 s32, s3, 40960
    v_mfma_f32_16x16x32_bf16 v[192:195], a[240:243], a[36:39], v[192:195]
    buffer_load_dwordx4 v242, s[64:67], s32 offen lds
    v_mfma_f32_16x16x32_bf16 v[192:195], a[244:247], a[116:119], v[192:195]
    s_waitcnt lgkmcnt(4)
    v_mfma_f32_16x16x32_bf16 v[196:199], a[252:255], a[116:119], v[196:199]
    ds_read_b64_tr_b16 a[240:241], v248 offset:8
    v_mfma_f32_16x16x32_bf16 v[196:199], a[248:251], a[36:39], v[196:199]
    ds_read_b64_tr_b16 a[242:243], v248 offset:1544
    v_mfma_f32_16x16x32_bf16 v[156:159], a[248:251], a[32:35], v[156:159]
    v_mfma_f32_16x16x32_bf16 v[156:159], a[252:255], a[112:115], v[156:159]
    buffer_load_dwordx4 v243, s[64:67], s32 offen offset:1024 lds
    v_mfma_f32_16x16x32_bf16 v[116:119], a[252:255], a[108:111], v[116:119]
    v_mfma_f32_16x16x32_bf16 v[116:119], a[248:251], a[28:31], v[116:119]
    ds_read_b64_tr_b16 a[244:245], v248 offset:12328
    v_mfma_f32_16x16x32_bf16 v[76:79], a[248:251], a[24:27], v[76:79]
    ds_read_b64_tr_b16 a[246:247], v248 offset:13864
    v_mfma_f32_16x16x32_bf16 v[76:79], a[252:255], a[104:107], v[76:79]
    v_mfma_f32_16x16x32_bf16 v[36:39], a[252:255], a[100:103], v[36:39]
    buffer_load_dwordx4 v244, s[64:67], s32 offen offset:2048 lds
    v_mfma_f32_16x16x32_bf16 v[36:39], a[248:251], a[20:23], v[36:39]
    s_waitcnt lgkmcnt(4)
    v_mfma_f32_16x16x32_bf16 v[40:43], v[6:9], a[20:23], v[40:43]
    s_mov_b32 s88, 22528
    ds_read_b64_tr_b16 a[248:249], v249 offset:0
    v_mfma_f32_16x16x32_bf16 v[40:43], v[10:13], a[100:103], v[40:43]
    ds_read_b64_tr_b16 a[250:251], v249 offset:1536
    v_mfma_f32_16x16x32_bf16 v[80:83], v[10:13], a[104:107], v[80:83]
    v_mfma_f32_16x16x32_bf16 v[80:83], v[6:9], a[24:27], v[80:83]
    buffer_store_dwordx4 a[88:91], v0, s[24:27], s88 offen sc1
    v_mfma_f32_16x16x32_bf16 v[120:123], v[6:9], a[28:31], v[120:123]
    v_mfma_f32_16x16x32_bf16 v[120:123], v[10:13], a[108:111], v[120:123]
    s_xor_b32 s3, s62, 15
    ds_read_b64_tr_b16 a[252:253], v249 offset:12320
    v_mfma_f32_16x16x32_bf16 v[160:163], v[10:13], a[112:115], v[160:163]
    s_mul_i32 s35, s3, 10240
    ds_read_b64_tr_b16 a[254:255], v249 offset:13856
    v_mfma_f32_16x16x32_bf16 v[160:163], v[6:9], a[32:35], v[160:163]
    s_add_u32 s36, s35, 4096
    v_mfma_f32_16x16x32_bf16 v[200:203], v[6:9], a[36:39], v[200:203]
    buffer_load_dwordx4 a[180:183], v0, s[44:47], s35 offen sc1
    v_mfma_f32_16x16x32_bf16 v[200:203], v[10:13], a[116:119], v[200:203]
    s_waitcnt lgkmcnt(4)
    v_mfma_f32_16x16x32_bf16 v[204:207], a[244:247], a[116:119], v[204:207]
    ds_read_b64_tr_b16 v[6:7], v249 offset:8
    v_mfma_f32_16x16x32_bf16 v[204:207], a[240:243], a[36:39], v[204:207]
    ds_read_b64_tr_b16 v[8:9], v249 offset:1544
    v_mfma_f32_16x16x32_bf16 v[164:167], a[240:243], a[32:35], v[164:167]
    v_mfma_f32_16x16x32_bf16 v[164:167], a[244:247], a[112:115], v[164:167]
    buffer_load_dwordx4 a[184:187], v0, s[44:47], s35 offen offset:1024 sc1
    v_mfma_f32_16x16x32_bf16 v[124:127], a[244:247], a[108:111], v[124:127]
    v_mfma_f32_16x16x32_bf16 v[124:127], a[240:243], a[28:31], v[124:127]
    ds_read_b64_tr_b16 v[10:11], v249 offset:12328
    v_mfma_f32_16x16x32_bf16 v[84:87], a[240:243], a[24:27], v[84:87]
    ds_read_b64_tr_b16 v[12:13], v249 offset:13864
    v_mfma_f32_16x16x32_bf16 v[84:87], a[244:247], a[104:107], v[84:87]
    v_mfma_f32_16x16x32_bf16 v[44:47], a[244:247], a[100:103], v[44:47]
    buffer_load_dwordx4 a[188:191], v0, s[44:47], s35 offen offset:2048 sc1
    v_mfma_f32_16x16x32_bf16 v[44:47], a[240:243], a[20:23], v[44:47]
    s_waitcnt lgkmcnt(4)
    s_waitcnt vmcnt(24)
    s_barrier
    v_mfma_f32_16x16x32_bf16 v[48:51], a[248:251], a[20:23], v[48:51]
    ds_read_b64_tr_b16 a[240:241], v245 offset:24640
    v_mfma_f32_16x16x32_bf16 v[48:51], a[252:255], a[100:103], v[48:51]
    ds_read_b64_tr_b16 a[242:243], v245 offset:26176
    v_mfma_f32_16x16x32_bf16 v[88:91], a[252:255], a[104:107], v[88:91]
    v_mfma_f32_16x16x32_bf16 v[88:91], a[248:251], a[24:27], v[88:91]
    buffer_load_dwordx4 a[192:195], v0, s[44:47], s35 offen offset:3072 sc1
    v_mfma_f32_16x16x32_bf16 v[128:131], a[248:251], a[28:31], v[128:131]
    v_mfma_f32_16x16x32_bf16 v[128:131], a[252:255], a[108:111], v[128:131]
    ds_read_b64_tr_b16 a[244:245], v245 offset:36960
    v_mfma_f32_16x16x32_bf16 v[168:171], a[252:255], a[112:115], v[168:171]
    ds_read_b64_tr_b16 a[246:247], v245 offset:38496
    v_mfma_f32_16x16x32_bf16 v[168:171], a[248:251], a[32:35], v[168:171]
    v_mfma_f32_16x16x32_bf16 v[208:211], a[248:251], a[36:39], v[208:211]
    buffer_load_dwordx4 a[196:199], v0, s[44:47], s36 offen sc1
    v_mfma_f32_16x16x32_bf16 v[208:211], a[252:255], a[116:119], v[208:211]
    s_waitcnt lgkmcnt(4)
    v_mfma_f32_16x16x32_bf16 v[212:215], v[10:13], a[116:119], v[212:215]
    s_mov_b32 s88, 23552
    ds_read_b64_tr_b16 a[248:249], v245 offset:24648
    v_mfma_f32_16x16x32_bf16 v[212:215], v[6:9], a[36:39], v[212:215]
    ds_read_b64_tr_b16 a[250:251], v245 offset:26184
    v_mfma_f32_16x16x32_bf16 v[172:175], v[6:9], a[32:35], v[172:175]
    v_mfma_f32_16x16x32_bf16 v[172:175], v[10:13], a[112:115], v[172:175]
    buffer_store_dwordx4 a[92:95], v0, s[24:27], s88 offen sc1
    v_mfma_f32_16x16x32_bf16 v[132:135], v[10:13], a[108:111], v[132:135]
    v_mfma_f32_16x16x32_bf16 v[132:135], v[6:9], a[28:31], v[132:135]
    s_add_u32 m0, s31, 73920
    ds_read_b64_tr_b16 a[252:253], v245 offset:36968
    v_mfma_f32_16x16x32_bf16 v[92:95], v[6:9], a[24:27], v[92:95]
    s_xor_b32 s3, s62, 16
    ds_read_b64_tr_b16 a[254:255], v245 offset:38504
    v_mfma_f32_16x16x32_bf16 v[92:95], v[10:13], a[104:107], v[92:95]
    s_mul_i32 s32, s3, 40960
    v_mfma_f32_16x16x32_bf16 v[52:55], v[10:13], a[100:103], v[52:55]
    buffer_load_dwordx4 v242, s[64:67], s32 offen lds
    v_mfma_f32_16x16x32_bf16 v[52:55], v[6:9], a[20:23], v[52:55]
    s_waitcnt lgkmcnt(4)
    s_waitcnt vmcnt(22)
    v_mfma_f32_16x16x32_bf16 v[16:19], a[240:243], a[220:223], v[16:19]
    ds_read_b64_tr_b16 v[6:7], v246 offset:24640
    v_mfma_f32_16x16x32_bf16 v[16:19], a[244:247], a[60:63], v[16:19]
    ds_read_b64_tr_b16 v[8:9], v246 offset:26176
    v_mfma_f32_16x16x32_bf16 v[56:59], a[244:247], a[64:67], v[56:59]
    v_mfma_f32_16x16x32_bf16 v[56:59], a[240:243], a[224:227], v[56:59]
    buffer_load_dwordx4 v243, s[64:67], s32 offen offset:1024 lds
    v_mfma_f32_16x16x32_bf16 v[96:99], a[240:243], a[228:231], v[96:99]
    v_mfma_f32_16x16x32_bf16 v[96:99], a[244:247], a[68:71], v[96:99]
    ds_read_b64_tr_b16 v[10:11], v246 offset:36960
    v_mfma_f32_16x16x32_bf16 v[136:139], a[244:247], a[72:75], v[136:139]
    ds_read_b64_tr_b16 v[12:13], v246 offset:38496
    v_mfma_f32_16x16x32_bf16 v[136:139], a[240:243], a[232:235], v[136:139]
    v_mfma_f32_16x16x32_bf16 v[176:179], a[240:243], a[236:239], v[176:179]
    buffer_load_dwordx4 v244, s[64:67], s32 offen offset:2048 lds
    v_mfma_f32_16x16x32_bf16 v[176:179], a[244:247], a[76:79], v[176:179]
    s_waitcnt lgkmcnt(4)
    v_mfma_f32_16x16x32_bf16 v[180:183], a[252:255], a[76:79], v[180:183]
    s_mov_b32 s88, 24576
    ds_read_b64_tr_b16 a[240:241], v246 offset:24648
    v_mfma_f32_16x16x32_bf16 v[180:183], a[248:251], a[236:239], v[180:183]
    ds_read_b64_tr_b16 a[242:243], v246 offset:26184
    v_mfma_f32_16x16x32_bf16 v[140:143], a[248:251], a[232:235], v[140:143]
    v_mfma_f32_16x16x32_bf16 v[140:143], a[252:255], a[72:75], v[140:143]
    buffer_store_dwordx4 a[96:99], v0, s[24:27], s88 offen sc1
    v_mfma_f32_16x16x32_bf16 v[100:103], a[252:255], a[68:71], v[100:103]
    v_mfma_f32_16x16x32_bf16 v[100:103], a[248:251], a[228:231], v[100:103]
    s_xor_b32 s3, s62, 16
    ds_read_b64_tr_b16 a[244:245], v246 offset:36968
    v_mfma_f32_16x16x32_bf16 v[60:63], a[248:251], a[224:227], v[60:63]
    s_mul_i32 s35, s3, 10240
    ds_read_b64_tr_b16 a[246:247], v246 offset:38504
    v_mfma_f32_16x16x32_bf16 v[60:63], a[252:255], a[64:67], v[60:63]
    s_add_u32 s36, s35, 4096
    v_mfma_f32_16x16x32_bf16 v[20:23], a[252:255], a[60:63], v[20:23]
    buffer_load_dwordx4 v[216:219], v0, s[44:47], s35 offen sc1
    v_mfma_f32_16x16x32_bf16 v[20:23], a[248:251], a[220:223], v[20:23]
    s_waitcnt lgkmcnt(4)
    v_mfma_f32_16x16x32_bf16 v[24:27], v[6:9], a[220:223], v[24:27]
    ds_read_b64_tr_b16 a[248:249], v247 offset:24640
    v_mfma_f32_16x16x32_bf16 v[24:27], v[10:13], a[60:63], v[24:27]
    ds_read_b64_tr_b16 a[250:251], v247 offset:26176
    v_mfma_f32_16x16x32_bf16 v[64:67], v[10:13], a[64:67], v[64:67]
    v_mfma_f32_16x16x32_bf16 v[64:67], v[6:9], a[224:227], v[64:67]
    buffer_load_dwordx4 v[220:223], v0, s[44:47], s35 offen offset:1024 sc1
    v_mfma_f32_16x16x32_bf16 v[104:107], v[6:9], a[228:231], v[104:107]
    v_mfma_f32_16x16x32_bf16 v[104:107], v[10:13], a[68:71], v[104:107]
    ds_read_b64_tr_b16 a[252:253], v247 offset:36960
    v_mfma_f32_16x16x32_bf16 v[144:147], v[10:13], a[72:75], v[144:147]
    ds_read_b64_tr_b16 a[254:255], v247 offset:38496
    v_mfma_f32_16x16x32_bf16 v[144:147], v[6:9], a[232:235], v[144:147]
    v_mfma_f32_16x16x32_bf16 v[184:187], v[6:9], a[236:239], v[184:187]
    buffer_load_dwordx4 v[224:227], v0, s[44:47], s35 offen offset:2048 sc1
    v_mfma_f32_16x16x32_bf16 v[184:187], v[10:13], a[76:79], v[184:187]
    s_waitcnt lgkmcnt(4)
    v_mfma_f32_16x16x32_bf16 v[188:191], a[244:247], a[76:79], v[188:191]
    ds_read_b64_tr_b16 v[6:7], v247 offset:24648
    v_mfma_f32_16x16x32_bf16 v[188:191], a[240:243], a[236:239], v[188:191]
    ds_read_b64_tr_b16 v[8:9], v247 offset:26184
    v_mfma_f32_16x16x32_bf16 v[148:151], a[240:243], a[232:235], v[148:151]
    v_mfma_f32_16x16x32_bf16 v[148:151], a[244:247], a[72:75], v[148:151]
    buffer_load_dwordx4 v[228:231], v0, s[44:47], s35 offen offset:3072 sc1
    v_mfma_f32_16x16x32_bf16 v[108:111], a[244:247], a[68:71], v[108:111]
    v_mfma_f32_16x16x32_bf16 v[108:111], a[240:243], a[228:231], v[108:111]
    ds_read_b64_tr_b16 v[10:11], v247 offset:36968
    v_mfma_f32_16x16x32_bf16 v[68:71], a[240:243], a[224:227], v[68:71]
    ds_read_b64_tr_b16 v[12:13], v247 offset:38504
    v_mfma_f32_16x16x32_bf16 v[68:71], a[244:247], a[64:67], v[68:71]
    v_mfma_f32_16x16x32_bf16 v[28:31], a[244:247], a[60:63], v[28:31]
    buffer_load_dwordx4 v[232:235], v0, s[44:47], s36 offen sc1
    v_mfma_f32_16x16x32_bf16 v[28:31], a[240:243], a[220:223], v[28:31]
    s_waitcnt lgkmcnt(4)
    v_mfma_f32_16x16x32_bf16 v[32:35], a[248:251], a[220:223], v[32:35]
    s_mov_b32 s88, 30720
    ds_read_b64_tr_b16 a[240:241], v248 offset:24640
    v_mfma_f32_16x16x32_bf16 v[32:35], a[252:255], a[60:63], v[32:35]
    ds_read_b64_tr_b16 a[242:243], v248 offset:26176
    v_mfma_f32_16x16x32_bf16 v[72:75], a[252:255], a[64:67], v[72:75]
    v_mfma_f32_16x16x32_bf16 v[72:75], a[248:251], a[224:227], v[72:75]
    buffer_store_dwordx4 a[120:123], v0, s[24:27], s88 offen sc1
    v_mfma_f32_16x16x32_bf16 v[112:115], a[248:251], a[228:231], v[112:115]
    v_mfma_f32_16x16x32_bf16 v[112:115], a[252:255], a[68:71], v[112:115]
    s_add_u32 m0, s31, 86240
    ds_read_b64_tr_b16 a[244:245], v248 offset:36960
    v_mfma_f32_16x16x32_bf16 v[152:155], a[252:255], a[72:75], v[152:155]
    s_xor_b32 s3, s62, 17
    ds_read_b64_tr_b16 a[246:247], v248 offset:38496
    v_mfma_f32_16x16x32_bf16 v[152:155], a[248:251], a[232:235], v[152:155]
    s_mul_i32 s32, s3, 40960
    v_mfma_f32_16x16x32_bf16 v[192:195], a[248:251], a[236:239], v[192:195]
    buffer_load_dwordx4 v242, s[64:67], s32 offen lds
    v_mfma_f32_16x16x32_bf16 v[192:195], a[252:255], a[76:79], v[192:195]
    s_waitcnt lgkmcnt(4)
    v_mfma_f32_16x16x32_bf16 v[196:199], v[10:13], a[76:79], v[196:199]
    ds_read_b64_tr_b16 a[248:249], v248 offset:24648
    v_mfma_f32_16x16x32_bf16 v[196:199], v[6:9], a[236:239], v[196:199]
    ds_read_b64_tr_b16 a[250:251], v248 offset:26184
    v_mfma_f32_16x16x32_bf16 v[156:159], v[6:9], a[232:235], v[156:159]
    v_mfma_f32_16x16x32_bf16 v[156:159], v[10:13], a[72:75], v[156:159]
    buffer_load_dwordx4 v243, s[64:67], s32 offen offset:1024 lds
    v_mfma_f32_16x16x32_bf16 v[116:119], v[10:13], a[68:71], v[116:119]
    v_mfma_f32_16x16x32_bf16 v[116:119], v[6:9], a[228:231], v[116:119]
    ds_read_b64_tr_b16 a[252:253], v248 offset:36968
    v_mfma_f32_16x16x32_bf16 v[76:79], v[6:9], a[224:227], v[76:79]
    ds_read_b64_tr_b16 a[254:255], v248 offset:38504
    v_mfma_f32_16x16x32_bf16 v[76:79], v[10:13], a[64:67], v[76:79]
    v_mfma_f32_16x16x32_bf16 v[36:39], v[10:13], a[60:63], v[36:39]
    buffer_load_dwordx4 v244, s[64:67], s32 offen offset:2048 lds
    v_mfma_f32_16x16x32_bf16 v[36:39], v[6:9], a[220:223], v[36:39]
    s_waitcnt lgkmcnt(4)
    v_mfma_f32_16x16x32_bf16 v[40:43], a[240:243], a[220:223], v[40:43]
    s_mov_b32 s88, 31744
    ds_read_b64_tr_b16 v[6:7], v249 offset:24640
    v_mfma_f32_16x16x32_bf16 v[40:43], a[244:247], a[60:63], v[40:43]
    ds_read_b64_tr_b16 v[8:9], v249 offset:26176
    v_mfma_f32_16x16x32_bf16 v[80:83], a[244:247], a[64:67], v[80:83]
    v_mfma_f32_16x16x32_bf16 v[80:83], a[240:243], a[224:227], v[80:83]
    buffer_store_dwordx4 a[124:127], v0, s[24:27], s88 offen sc1
    v_mfma_f32_16x16x32_bf16 v[120:123], a[240:243], a[228:231], v[120:123]
    v_mfma_f32_16x16x32_bf16 v[120:123], a[244:247], a[68:71], v[120:123]
    s_xor_b32 s3, s62, 17
    ds_read_b64_tr_b16 v[10:11], v249 offset:36960
    v_mfma_f32_16x16x32_bf16 v[160:163], a[244:247], a[72:75], v[160:163]
    s_mul_i32 s35, s3, 10240
    ds_read_b64_tr_b16 v[12:13], v249 offset:38496
    v_mfma_f32_16x16x32_bf16 v[160:163], a[240:243], a[232:235], v[160:163]
    s_add_u32 s36, s35, 4096
    v_mfma_f32_16x16x32_bf16 v[200:203], a[240:243], a[236:239], v[200:203]
    buffer_load_dwordx4 a[20:23], v0, s[44:47], s35 offen sc1
    v_mfma_f32_16x16x32_bf16 v[200:203], a[244:247], a[76:79], v[200:203]
    s_waitcnt lgkmcnt(4)
    v_mfma_f32_16x16x32_bf16 v[204:207], a[252:255], a[76:79], v[204:207]
    ds_read_b64_tr_b16 a[240:241], v249 offset:24648
    v_mfma_f32_16x16x32_bf16 v[204:207], a[248:251], a[236:239], v[204:207]
    ds_read_b64_tr_b16 a[242:243], v249 offset:26184
    v_mfma_f32_16x16x32_bf16 v[164:167], a[248:251], a[232:235], v[164:167]
    v_mfma_f32_16x16x32_bf16 v[164:167], a[252:255], a[72:75], v[164:167]
    buffer_load_dwordx4 a[24:27], v0, s[44:47], s35 offen offset:1024 sc1
    v_mfma_f32_16x16x32_bf16 v[124:127], a[252:255], a[68:71], v[124:127]
    v_mfma_f32_16x16x32_bf16 v[124:127], a[248:251], a[228:231], v[124:127]
    ds_read_b64_tr_b16 a[244:245], v249 offset:36968
    v_mfma_f32_16x16x32_bf16 v[84:87], a[248:251], a[224:227], v[84:87]
    ds_read_b64_tr_b16 a[246:247], v249 offset:38504
    v_mfma_f32_16x16x32_bf16 v[84:87], a[252:255], a[64:67], v[84:87]
    v_mfma_f32_16x16x32_bf16 v[44:47], a[252:255], a[60:63], v[44:47]
    buffer_load_dwordx4 a[28:31], v0, s[44:47], s35 offen offset:2048 sc1
    v_mfma_f32_16x16x32_bf16 v[44:47], a[248:251], a[220:223], v[44:47]
    s_waitcnt lgkmcnt(4)
    s_waitcnt vmcnt(24)
    s_barrier
    v_mfma_f32_16x16x32_bf16 v[48:51], v[6:9], a[220:223], v[48:51]
    ds_read_b64_tr_b16 a[248:249], v245 offset:49280
    v_mfma_f32_16x16x32_bf16 v[48:51], v[10:13], a[60:63], v[48:51]
    ds_read_b64_tr_b16 a[250:251], v245 offset:50816
    v_mfma_f32_16x16x32_bf16 v[88:91], v[10:13], a[64:67], v[88:91]
    v_mfma_f32_16x16x32_bf16 v[88:91], v[6:9], a[224:227], v[88:91]
    buffer_load_dwordx4 a[32:35], v0, s[44:47], s35 offen offset:3072 sc1
    v_mfma_f32_16x16x32_bf16 v[128:131], v[6:9], a[228:231], v[128:131]
    v_mfma_f32_16x16x32_bf16 v[128:131], v[10:13], a[68:71], v[128:131]
    ds_read_b64_tr_b16 a[252:253], v250 offset:0
    v_mfma_f32_16x16x32_bf16 v[168:171], v[10:13], a[72:75], v[168:171]
    ds_read_b64_tr_b16 a[254:255], v250 offset:1536
    v_mfma_f32_16x16x32_bf16 v[168:171], v[6:9], a[232:235], v[168:171]
    v_mfma_f32_16x16x32_bf16 v[208:211], v[6:9], a[236:239], v[208:211]
    buffer_load_dwordx4 a[36:39], v0, s[44:47], s36 offen sc1
    v_mfma_f32_16x16x32_bf16 v[208:211], v[10:13], a[76:79], v[208:211]
    s_waitcnt lgkmcnt(4)
    v_mfma_f32_16x16x32_bf16 v[212:215], a[244:247], a[76:79], v[212:215]
    s_mov_b32 s88, 32768
    ds_read_b64_tr_b16 v[6:7], v245 offset:49288
    v_mfma_f32_16x16x32_bf16 v[212:215], a[240:243], a[236:239], v[212:215]
    ds_read_b64_tr_b16 v[8:9], v245 offset:50824
    v_mfma_f32_16x16x32_bf16 v[172:175], a[240:243], a[232:235], v[172:175]
    v_mfma_f32_16x16x32_bf16 v[172:175], a[244:247], a[72:75], v[172:175]
    buffer_store_dwordx4 a[128:131], v0, s[24:27], s88 offen sc1
    v_mfma_f32_16x16x32_bf16 v[132:135], a[244:247], a[68:71], v[132:135]
    v_mfma_f32_16x16x32_bf16 v[132:135], a[240:243], a[228:231], v[132:135]
    s_add_u32 m0, s31, 98560
    ds_read_b64_tr_b16 v[10:11], v250 offset:8
    v_mfma_f32_16x16x32_bf16 v[92:95], a[240:243], a[224:227], v[92:95]
    s_xor_b32 s3, s62, 18
    ds_read_b64_tr_b16 v[12:13], v250 offset:1544
    v_mfma_f32_16x16x32_bf16 v[92:95], a[244:247], a[64:67], v[92:95]
    s_mul_i32 s32, s3, 40960
    v_mfma_f32_16x16x32_bf16 v[52:55], a[244:247], a[60:63], v[52:55]
    buffer_load_dwordx4 v242, s[64:67], s32 offen lds
    v_mfma_f32_16x16x32_bf16 v[52:55], a[240:243], a[220:223], v[52:55]
    s_waitcnt lgkmcnt(4)
    s_waitcnt vmcnt(22)
    v_mfma_f32_16x16x32_bf16 v[16:19], a[248:251], a[140:143], v[16:19]
    ds_read_b64_tr_b16 a[240:241], v246 offset:49280
    v_mfma_f32_16x16x32_bf16 v[16:19], a[252:255], a[180:183], v[16:19]
    ds_read_b64_tr_b16 a[242:243], v246 offset:50816
    v_mfma_f32_16x16x32_bf16 v[56:59], a[252:255], a[184:187], v[56:59]
    v_mfma_f32_16x16x32_bf16 v[56:59], a[248:251], a[144:147], v[56:59]
    buffer_load_dwordx4 v243, s[64:67], s32 offen offset:1024 lds
    v_mfma_f32_16x16x32_bf16 v[96:99], a[248:251], a[148:151], v[96:99]
    v_mfma_f32_16x16x32_bf16 v[96:99], a[252:255], a[188:191], v[96:99]
    ds_read_b64_tr_b16 a[244:245], v251 offset:0
    v_mfma_f32_16x16x32_bf16 v[136:139], a[252:255], a[192:195], v[136:139]
    ds_read_b64_tr_b16 a[246:247], v251 offset:1536
    v_mfma_f32_16x16x32_bf16 v[136:139], a[248:251], a[152:155], v[136:139]
    v_mfma_f32_16x16x32_bf16 v[176:179], a[248:251], a[156:159], v[176:179]
    buffer_load_dwordx4 v244, s[64:67], s32 offen offset:2048 lds
    v_mfma_f32_16x16x32_bf16 v[176:179], a[252:255], a[196:199], v[176:179]
    s_waitcnt lgkmcnt(4)
    v_mfma_f32_16x16x32_bf16 v[180:183], v[10:13], a[196:199], v[180:183]
    s_mov_b32 s88, 33792
    ds_read_b64_tr_b16 a[248:249], v246 offset:49288
    v_mfma_f32_16x16x32_bf16 v[180:183], v[6:9], a[156:159], v[180:183]
    ds_read_b64_tr_b16 a[250:251], v246 offset:50824
    v_mfma_f32_16x16x32_bf16 v[140:143], v[6:9], a[152:155], v[140:143]
    v_mfma_f32_16x16x32_bf16 v[140:143], v[10:13], a[192:195], v[140:143]
    buffer_store_dwordx4 a[132:135], v0, s[24:27], s88 offen sc1
    v_mfma_f32_16x16x32_bf16 v[100:103], v[10:13], a[188:191], v[100:103]
    v_mfma_f32_16x16x32_bf16 v[100:103], v[6:9], a[148:151], v[100:103]
    s_xor_b32 s3, s62, 18
    ds_read_b64_tr_b16 a[252:253], v251 offset:8
    v_mfma_f32_16x16x32_bf16 v[60:63], v[6:9], a[144:147], v[60:63]
    s_mul_i32 s35, s3, 10240
    ds_read_b64_tr_b16 a[254:255], v251 offset:1544
    v_mfma_f32_16x16x32_bf16 v[60:63], v[10:13], a[184:187], v[60:63]
    s_add_u32 s36, s35, 4096
    v_mfma_f32_16x16x32_bf16 v[20:23], v[10:13], a[180:183], v[20:23]
    buffer_load_dwordx4 a[100:103], v0, s[44:47], s35 offen sc1
    v_mfma_f32_16x16x32_bf16 v[20:23], v[6:9], a[140:143], v[20:23]
    s_waitcnt lgkmcnt(4)
    v_mfma_f32_16x16x32_bf16 v[24:27], a[240:243], a[140:143], v[24:27]
    ds_read_b64_tr_b16 v[6:7], v247 offset:49280
    v_mfma_f32_16x16x32_bf16 v[24:27], a[244:247], a[180:183], v[24:27]
    ds_read_b64_tr_b16 v[8:9], v247 offset:50816
    v_mfma_f32_16x16x32_bf16 v[64:67], a[244:247], a[184:187], v[64:67]
    v_mfma_f32_16x16x32_bf16 v[64:67], a[240:243], a[144:147], v[64:67]
    buffer_load_dwordx4 a[104:107], v0, s[44:47], s35 offen offset:1024 sc1
    v_mfma_f32_16x16x32_bf16 v[104:107], a[240:243], a[148:151], v[104:107]
    v_mfma_f32_16x16x32_bf16 v[104:107], a[244:247], a[188:191], v[104:107]
    ds_read_b64_tr_b16 v[10:11], v252 offset:0
    v_mfma_f32_16x16x32_bf16 v[144:147], a[244:247], a[192:195], v[144:147]
    ds_read_b64_tr_b16 v[12:13], v252 offset:1536
    v_mfma_f32_16x16x32_bf16 v[144:147], a[240:243], a[152:155], v[144:147]
    v_mfma_f32_16x16x32_bf16 v[184:187], a[240:243], a[156:159], v[184:187]
    buffer_load_dwordx4 a[108:111], v0, s[44:47], s35 offen offset:2048 sc1
    v_mfma_f32_16x16x32_bf16 v[184:187], a[244:247], a[196:199], v[184:187]
    s_waitcnt lgkmcnt(4)
    v_mfma_f32_16x16x32_bf16 v[188:191], a[252:255], a[196:199], v[188:191]
    ds_read_b64_tr_b16 a[240:241], v247 offset:49288
    v_mfma_f32_16x16x32_bf16 v[188:191], a[248:251], a[156:159], v[188:191]
    ds_read_b64_tr_b16 a[242:243], v247 offset:50824
    v_mfma_f32_16x16x32_bf16 v[148:151], a[248:251], a[152:155], v[148:151]
    v_mfma_f32_16x16x32_bf16 v[148:151], a[252:255], a[192:195], v[148:151]
    buffer_load_dwordx4 a[112:115], v0, s[44:47], s35 offen offset:3072 sc1
    v_mfma_f32_16x16x32_bf16 v[108:111], a[252:255], a[188:191], v[108:111]
    v_mfma_f32_16x16x32_bf16 v[108:111], a[248:251], a[148:151], v[108:111]
    ds_read_b64_tr_b16 a[244:245], v252 offset:8
    v_mfma_f32_16x16x32_bf16 v[68:71], a[248:251], a[144:147], v[68:71]
    ds_read_b64_tr_b16 a[246:247], v252 offset:1544
    v_mfma_f32_16x16x32_bf16 v[68:71], a[252:255], a[184:187], v[68:71]
    v_mfma_f32_16x16x32_bf16 v[28:31], a[252:255], a[180:183], v[28:31]
    buffer_load_dwordx4 a[116:119], v0, s[44:47], s36 offen sc1
    v_mfma_f32_16x16x32_bf16 v[28:31], a[248:251], a[140:143], v[28:31]
    s_waitcnt lgkmcnt(4)
    v_mfma_f32_16x16x32_bf16 v[32:35], v[6:9], a[140:143], v[32:35]
    s_mov_b32 s88, 34816
    ds_read_b64_tr_b16 a[248:249], v248 offset:49280
    v_mfma_f32_16x16x32_bf16 v[32:35], v[10:13], a[180:183], v[32:35]
    ds_read_b64_tr_b16 a[250:251], v248 offset:50816
    v_mfma_f32_16x16x32_bf16 v[72:75], v[10:13], a[184:187], v[72:75]
    v_mfma_f32_16x16x32_bf16 v[72:75], v[6:9], a[144:147], v[72:75]
    buffer_store_dwordx4 a[136:139], v0, s[24:27], s88 offen sc1
    v_mfma_f32_16x16x32_bf16 v[112:115], v[6:9], a[148:151], v[112:115]
    v_mfma_f32_16x16x32_bf16 v[112:115], v[10:13], a[188:191], v[112:115]
    s_add_u32 m0, s31, 110880
    ds_read_b64_tr_b16 a[252:253], v253 offset:0
    v_mfma_f32_16x16x32_bf16 v[152:155], v[10:13], a[192:195], v[152:155]
    s_xor_b32 s3, s62, 19
    ds_read_b64_tr_b16 a[254:255], v253 offset:1536
    v_mfma_f32_16x16x32_bf16 v[152:155], v[6:9], a[152:155], v[152:155]
    s_mul_i32 s32, s3, 40960
    v_mfma_f32_16x16x32_bf16 v[192:195], v[6:9], a[156:159], v[192:195]
    buffer_load_dwordx4 v242, s[64:67], s32 offen lds
    v_mfma_f32_16x16x32_bf16 v[192:195], v[10:13], a[196:199], v[192:195]
    s_waitcnt lgkmcnt(4)
    v_mfma_f32_16x16x32_bf16 v[196:199], a[244:247], a[196:199], v[196:199]
    ds_read_b64_tr_b16 v[6:7], v248 offset:49288
    v_mfma_f32_16x16x32_bf16 v[196:199], a[240:243], a[156:159], v[196:199]
    ds_read_b64_tr_b16 v[8:9], v248 offset:50824
    v_mfma_f32_16x16x32_bf16 v[156:159], a[240:243], a[152:155], v[156:159]
    v_mfma_f32_16x16x32_bf16 v[156:159], a[244:247], a[192:195], v[156:159]
    buffer_load_dwordx4 v243, s[64:67], s32 offen offset:1024 lds
    v_mfma_f32_16x16x32_bf16 v[116:119], a[244:247], a[188:191], v[116:119]
    v_mfma_f32_16x16x32_bf16 v[116:119], a[240:243], a[148:151], v[116:119]
    ds_read_b64_tr_b16 v[10:11], v253 offset:8
    v_mfma_f32_16x16x32_bf16 v[76:79], a[240:243], a[144:147], v[76:79]
    ds_read_b64_tr_b16 v[12:13], v253 offset:1544
    v_mfma_f32_16x16x32_bf16 v[76:79], a[244:247], a[184:187], v[76:79]
    v_mfma_f32_16x16x32_bf16 v[36:39], a[244:247], a[180:183], v[36:39]
    buffer_load_dwordx4 v244, s[64:67], s32 offen offset:2048 lds
    v_mfma_f32_16x16x32_bf16 v[36:39], a[240:243], a[140:143], v[36:39]
    s_waitcnt lgkmcnt(4)
    v_mfma_f32_16x16x32_bf16 v[40:43], a[248:251], a[140:143], v[40:43]
    s_mov_b32 s88, 40960
    ds_read_b64_tr_b16 a[240:241], v249 offset:49280
    v_mfma_f32_16x16x32_bf16 v[40:43], a[252:255], a[180:183], v[40:43]
    ds_read_b64_tr_b16 a[242:243], v249 offset:50816
    v_mfma_f32_16x16x32_bf16 v[80:83], a[252:255], a[184:187], v[80:83]
    v_mfma_f32_16x16x32_bf16 v[80:83], a[248:251], a[144:147], v[80:83]
    buffer_store_dwordx4 a[160:163], v0, s[24:27], s88 offen sc1
    v_mfma_f32_16x16x32_bf16 v[120:123], a[248:251], a[148:151], v[120:123]
    v_mfma_f32_16x16x32_bf16 v[120:123], a[252:255], a[188:191], v[120:123]
    s_xor_b32 s3, s62, 19
    ds_read_b64_tr_b16 a[244:245], v254 offset:0
    v_mfma_f32_16x16x32_bf16 v[160:163], a[252:255], a[192:195], v[160:163]
    s_mul_i32 s35, s3, 10240
    ds_read_b64_tr_b16 a[246:247], v254 offset:1536
    v_mfma_f32_16x16x32_bf16 v[160:163], a[248:251], a[152:155], v[160:163]
    s_add_u32 s36, s35, 4096
    v_mfma_f32_16x16x32_bf16 v[200:203], a[248:251], a[156:159], v[200:203]
    buffer_load_dwordx4 a[60:63], v0, s[44:47], s35 offen sc1
    v_mfma_f32_16x16x32_bf16 v[200:203], a[252:255], a[196:199], v[200:203]
    s_waitcnt lgkmcnt(4)
    v_mfma_f32_16x16x32_bf16 v[204:207], v[10:13], a[196:199], v[204:207]
    ds_read_b64_tr_b16 a[248:249], v249 offset:49288
    v_mfma_f32_16x16x32_bf16 v[204:207], v[6:9], a[156:159], v[204:207]
    ds_read_b64_tr_b16 a[250:251], v249 offset:50824
    v_mfma_f32_16x16x32_bf16 v[164:167], v[6:9], a[152:155], v[164:167]
    v_mfma_f32_16x16x32_bf16 v[164:167], v[10:13], a[192:195], v[164:167]
    buffer_load_dwordx4 a[64:67], v0, s[44:47], s35 offen offset:1024 sc1
    v_mfma_f32_16x16x32_bf16 v[124:127], v[10:13], a[188:191], v[124:127]
    v_mfma_f32_16x16x32_bf16 v[124:127], v[6:9], a[148:151], v[124:127]
    ds_read_b64_tr_b16 a[252:253], v254 offset:8
    v_mfma_f32_16x16x32_bf16 v[84:87], v[6:9], a[144:147], v[84:87]
    ds_read_b64_tr_b16 a[254:255], v254 offset:1544
    v_mfma_f32_16x16x32_bf16 v[84:87], v[10:13], a[184:187], v[84:87]
    v_mfma_f32_16x16x32_bf16 v[44:47], v[10:13], a[180:183], v[44:47]
    buffer_load_dwordx4 a[68:71], v0, s[44:47], s35 offen offset:2048 sc1
    v_mfma_f32_16x16x32_bf16 v[44:47], v[6:9], a[140:143], v[44:47]
    s_waitcnt lgkmcnt(4)
    s_waitcnt vmcnt(24)
    s_barrier
    v_mfma_f32_16x16x32_bf16 v[48:51], a[240:243], a[140:143], v[48:51]
    ds_read_b64_tr_b16 v[6:7], v250 offset:12320
    v_mfma_f32_16x16x32_bf16 v[48:51], a[244:247], a[180:183], v[48:51]
    ds_read_b64_tr_b16 v[8:9], v250 offset:13856
    v_mfma_f32_16x16x32_bf16 v[88:91], a[244:247], a[184:187], v[88:91]
    v_mfma_f32_16x16x32_bf16 v[88:91], a[240:243], a[144:147], v[88:91]
    buffer_load_dwordx4 a[72:75], v0, s[44:47], s35 offen offset:3072 sc1
    v_mfma_f32_16x16x32_bf16 v[128:131], a[240:243], a[148:151], v[128:131]
    v_mfma_f32_16x16x32_bf16 v[128:131], a[244:247], a[188:191], v[128:131]
    ds_read_b64_tr_b16 v[10:11], v250 offset:24640
    v_mfma_f32_16x16x32_bf16 v[168:171], a[244:247], a[192:195], v[168:171]
    ds_read_b64_tr_b16 v[12:13], v250 offset:26176
    v_mfma_f32_16x16x32_bf16 v[168:171], a[240:243], a[152:155], v[168:171]
    v_mfma_f32_16x16x32_bf16 v[208:211], a[240:243], a[156:159], v[208:211]
    buffer_load_dwordx4 a[76:79], v0, s[44:47], s36 offen sc1
    v_mfma_f32_16x16x32_bf16 v[208:211], a[244:247], a[196:199], v[208:211]
    s_waitcnt lgkmcnt(4)
    v_mfma_f32_16x16x32_bf16 v[212:215], a[252:255], a[196:199], v[212:215]
    s_mov_b32 s88, 41984
    ds_read_b64_tr_b16 a[240:241], v250 offset:12328
    v_mfma_f32_16x16x32_bf16 v[212:215], a[248:251], a[156:159], v[212:215]
    ds_read_b64_tr_b16 a[242:243], v250 offset:13864
    v_mfma_f32_16x16x32_bf16 v[172:175], a[248:251], a[152:155], v[172:175]
    v_mfma_f32_16x16x32_bf16 v[172:175], a[252:255], a[192:195], v[172:175]
    buffer_store_dwordx4 a[164:167], v0, s[24:27], s88 offen sc1
    v_mfma_f32_16x16x32_bf16 v[132:135], a[252:255], a[188:191], v[132:135]
    v_mfma_f32_16x16x32_bf16 v[132:135], a[248:251], a[148:151], v[132:135]
    s_add_u32 m0, s31, 0
    ds_read_b64_tr_b16 a[244:245], v250 offset:24648
    v_mfma_f32_16x16x32_bf16 v[92:95], a[248:251], a[144:147], v[92:95]
    s_xor_b32 s3, s62, 20
    ds_read_b64_tr_b16 a[246:247], v250 offset:26184
    v_mfma_f32_16x16x32_bf16 v[92:95], a[252:255], a[184:187], v[92:95]
    s_mul_i32 s32, s3, 40960
    v_mfma_f32_16x16x32_bf16 v[52:55], a[252:255], a[180:183], v[52:55]
    buffer_load_dwordx4 v242, s[64:67], s32 offen lds
    v_mfma_f32_16x16x32_bf16 v[52:55], a[248:251], a[140:143], v[52:55]
    s_waitcnt lgkmcnt(4)
    s_waitcnt vmcnt(22)
    v_mfma_f32_16x16x32_bf16 v[16:19], v[6:9], v[216:219], v[16:19]
    ds_read_b64_tr_b16 a[248:249], v251 offset:12320
    v_mfma_f32_16x16x32_bf16 v[16:19], v[10:13], a[20:23], v[16:19]
    ds_read_b64_tr_b16 a[250:251], v251 offset:13856
    v_mfma_f32_16x16x32_bf16 v[56:59], v[10:13], a[24:27], v[56:59]
    v_mfma_f32_16x16x32_bf16 v[56:59], v[6:9], v[220:223], v[56:59]
    buffer_load_dwordx4 v243, s[64:67], s32 offen offset:1024 lds
    v_mfma_f32_16x16x32_bf16 v[96:99], v[6:9], v[224:227], v[96:99]
    v_mfma_f32_16x16x32_bf16 v[96:99], v[10:13], a[28:31], v[96:99]
    ds_read_b64_tr_b16 a[252:253], v251 offset:24640
    v_mfma_f32_16x16x32_bf16 v[136:139], v[10:13], a[32:35], v[136:139]
    ds_read_b64_tr_b16 a[254:255], v251 offset:26176
    v_mfma_f32_16x16x32_bf16 v[136:139], v[6:9], v[228:231], v[136:139]
    v_mfma_f32_16x16x32_bf16 v[176:179], v[6:9], v[232:235], v[176:179]
    buffer_load_dwordx4 v244, s[64:67], s32 offen offset:2048 lds
    v_mfma_f32_16x16x32_bf16 v[176:179], v[10:13], a[36:39], v[176:179]
    s_waitcnt lgkmcnt(4)
    v_mfma_f32_16x16x32_bf16 v[180:183], a[244:247], a[36:39], v[180:183]
    s_mov_b32 s88, 43008
    ds_read_b64_tr_b16 v[6:7], v251 offset:12328
    v_mfma_f32_16x16x32_bf16 v[180:183], a[240:243], v[232:235], v[180:183]
    ds_read_b64_tr_b16 v[8:9], v251 offset:13864
    v_mfma_f32_16x16x32_bf16 v[140:143], a[240:243], v[228:231], v[140:143]
    v_mfma_f32_16x16x32_bf16 v[140:143], a[244:247], a[32:35], v[140:143]
    buffer_store_dwordx4 a[168:171], v0, s[24:27], s88 offen sc1
    v_mfma_f32_16x16x32_bf16 v[100:103], a[244:247], a[28:31], v[100:103]
    v_mfma_f32_16x16x32_bf16 v[100:103], a[240:243], v[224:227], v[100:103]
    s_xor_b32 s3, s62, 20
    ds_read_b64_tr_b16 v[10:11], v251 offset:24648
    v_mfma_f32_16x16x32_bf16 v[60:63], a[240:243], v[220:223], v[60:63]
    s_mul_i32 s35, s3, 10240
    ds_read_b64_tr_b16 v[12:13], v251 offset:26184
    v_mfma_f32_16x16x32_bf16 v[60:63], a[244:247], a[24:27], v[60:63]
    s_add_u32 s36, s35, 4096
    v_mfma_f32_16x16x32_bf16 v[20:23], a[244:247], a[20:23], v[20:23]
    buffer_load_dwordx4 a[220:223], v0, s[44:47], s35 offen sc1
    v_mfma_f32_16x16x32_bf16 v[20:23], a[240:243], v[216:219], v[20:23]
    s_waitcnt lgkmcnt(4)
    v_mfma_f32_16x16x32_bf16 v[24:27], a[248:251], v[216:219], v[24:27]
    ds_read_b64_tr_b16 a[240:241], v252 offset:12320
    v_mfma_f32_16x16x32_bf16 v[24:27], a[252:255], a[20:23], v[24:27]
    ds_read_b64_tr_b16 a[242:243], v252 offset:13856
    v_mfma_f32_16x16x32_bf16 v[64:67], a[252:255], a[24:27], v[64:67]
    v_mfma_f32_16x16x32_bf16 v[64:67], a[248:251], v[220:223], v[64:67]
    buffer_load_dwordx4 a[224:227], v0, s[44:47], s35 offen offset:1024 sc1
    v_mfma_f32_16x16x32_bf16 v[104:107], a[248:251], v[224:227], v[104:107]
    v_mfma_f32_16x16x32_bf16 v[104:107], a[252:255], a[28:31], v[104:107]
    ds_read_b64_tr_b16 a[244:245], v252 offset:24640
    v_mfma_f32_16x16x32_bf16 v[144:147], a[252:255], a[32:35], v[144:147]
    ds_read_b64_tr_b16 a[246:247], v252 offset:26176
    v_mfma_f32_16x16x32_bf16 v[144:147], a[248:251], v[228:231], v[144:147]
    v_mfma_f32_16x16x32_bf16 v[184:187], a[248:251], v[232:235], v[184:187]
    buffer_load_dwordx4 a[228:231], v0, s[44:47], s35 offen offset:2048 sc1
    v_mfma_f32_16x16x32_bf16 v[184:187], a[252:255], a[36:39], v[184:187]
    s_waitcnt lgkmcnt(4)
    v_mfma_f32_16x16x32_bf16 v[188:191], v[10:13], a[36:39], v[188:191]
    ds_read_b64_tr_b16 a[248:249], v252 offset:12328
    v_mfma_f32_16x16x32_bf16 v[188:191], v[6:9], v[232:235], v[188:191]
    ds_read_b64_tr_b16 a[250:251], v252 offset:13864
    v_mfma_f32_16x16x32_bf16 v[148:151], v[6:9], v[228:231], v[148:151]
    v_mfma_f32_16x16x32_bf16 v[148:151], v[10:13], a[32:35], v[148:151]
    buffer_load_dwordx4 a[232:235], v0, s[44:47], s35 offen offset:3072 sc1
    v_mfma_f32_16x16x32_bf16 v[108:111], v[10:13], a[28:31], v[108:111]
    v_mfma_f32_16x16x32_bf16 v[108:111], v[6:9], v[224:227], v[108:111]
    ds_read_b64_tr_b16 a[252:253], v252 offset:24648
    v_mfma_f32_16x16x32_bf16 v[68:71], v[6:9], v[220:223], v[68:71]
    ds_read_b64_tr_b16 a[254:255], v252 offset:26184
    v_mfma_f32_16x16x32_bf16 v[68:71], v[10:13], a[24:27], v[68:71]
    v_mfma_f32_16x16x32_bf16 v[28:31], v[10:13], a[20:23], v[28:31]
    buffer_load_dwordx4 a[236:239], v0, s[44:47], s36 offen sc1
    v_mfma_f32_16x16x32_bf16 v[28:31], v[6:9], v[216:219], v[28:31]
    s_waitcnt lgkmcnt(4)
    v_mfma_f32_16x16x32_bf16 v[32:35], a[240:243], v[216:219], v[32:35]
    s_mov_b32 s88, 44032
    ds_read_b64_tr_b16 v[6:7], v253 offset:12320
    v_mfma_f32_16x16x32_bf16 v[32:35], a[244:247], a[20:23], v[32:35]
    ds_read_b64_tr_b16 v[8:9], v253 offset:13856
    v_mfma_f32_16x16x32_bf16 v[72:75], a[244:247], a[24:27], v[72:75]
    v_mfma_f32_16x16x32_bf16 v[72:75], a[240:243], v[220:223], v[72:75]
    buffer_store_dwordx4 a[172:175], v0, s[24:27], s88 offen sc1
    v_mfma_f32_16x16x32_bf16 v[112:115], a[240:243], v[224:227], v[112:115]
    v_mfma_f32_16x16x32_bf16 v[112:115], a[244:247], a[28:31], v[112:115]
    s_add_u32 m0, s31, 12320
    ds_read_b64_tr_b16 v[10:11], v253 offset:24640
    v_mfma_f32_16x16x32_bf16 v[152:155], a[244:247], a[32:35], v[152:155]
    s_xor_b32 s3, s62, 21
    ds_read_b64_tr_b16 v[12:13], v253 offset:26176
    v_mfma_f32_16x16x32_bf16 v[152:155], a[240:243], v[228:231], v[152:155]
    s_mul_i32 s32, s3, 40960
    v_mfma_f32_16x16x32_bf16 v[192:195], a[240:243], v[232:235], v[192:195]
    buffer_load_dwordx4 v242, s[64:67], s32 offen lds
    v_mfma_f32_16x16x32_bf16 v[192:195], a[244:247], a[36:39], v[192:195]
    s_waitcnt lgkmcnt(4)
    v_mfma_f32_16x16x32_bf16 v[196:199], a[252:255], a[36:39], v[196:199]
    ds_read_b64_tr_b16 a[240:241], v253 offset:12328
    v_mfma_f32_16x16x32_bf16 v[196:199], a[248:251], v[232:235], v[196:199]
    ds_read_b64_tr_b16 a[242:243], v253 offset:13864
    v_mfma_f32_16x16x32_bf16 v[156:159], a[248:251], v[228:231], v[156:159]
    v_mfma_f32_16x16x32_bf16 v[156:159], a[252:255], a[32:35], v[156:159]
    buffer_load_dwordx4 v243, s[64:67], s32 offen offset:1024 lds
    v_mfma_f32_16x16x32_bf16 v[116:119], a[252:255], a[28:31], v[116:119]
    v_mfma_f32_16x16x32_bf16 v[116:119], a[248:251], v[224:227], v[116:119]
    ds_read_b64_tr_b16 a[244:245], v253 offset:24648
    v_mfma_f32_16x16x32_bf16 v[76:79], a[248:251], v[220:223], v[76:79]
    ds_read_b64_tr_b16 a[246:247], v253 offset:26184
    v_mfma_f32_16x16x32_bf16 v[76:79], a[252:255], a[24:27], v[76:79]
    v_mfma_f32_16x16x32_bf16 v[36:39], a[252:255], a[20:23], v[36:39]
    buffer_load_dwordx4 v244, s[64:67], s32 offen offset:2048 lds
    v_mfma_f32_16x16x32_bf16 v[36:39], a[248:251], v[216:219], v[36:39]
    s_waitcnt lgkmcnt(4)
    v_mfma_f32_16x16x32_bf16 v[40:43], v[6:9], v[216:219], v[40:43]
    s_mov_b32 s88, 45056
    ds_read_b64_tr_b16 a[248:249], v254 offset:12320
    v_mfma_f32_16x16x32_bf16 v[40:43], v[10:13], a[20:23], v[40:43]
    ds_read_b64_tr_b16 a[250:251], v254 offset:13856
    v_mfma_f32_16x16x32_bf16 v[80:83], v[10:13], a[24:27], v[80:83]
    v_mfma_f32_16x16x32_bf16 v[80:83], v[6:9], v[220:223], v[80:83]
    buffer_store_dwordx4 a[176:179], v0, s[24:27], s88 offen sc1
    v_mfma_f32_16x16x32_bf16 v[120:123], v[6:9], v[224:227], v[120:123]
    v_mfma_f32_16x16x32_bf16 v[120:123], v[10:13], a[28:31], v[120:123]
    s_xor_b32 s3, s62, 21
    ds_read_b64_tr_b16 a[252:253], v254 offset:24640
    v_mfma_f32_16x16x32_bf16 v[160:163], v[10:13], a[32:35], v[160:163]
    s_mul_i32 s35, s3, 10240
    ds_read_b64_tr_b16 a[254:255], v254 offset:26176
    v_mfma_f32_16x16x32_bf16 v[160:163], v[6:9], v[228:231], v[160:163]
    s_add_u32 s36, s35, 4096
    v_mfma_f32_16x16x32_bf16 v[200:203], v[6:9], v[232:235], v[200:203]
    buffer_load_dwordx4 a[140:143], v0, s[44:47], s35 offen sc1
    v_mfma_f32_16x16x32_bf16 v[200:203], v[10:13], a[36:39], v[200:203]
    s_waitcnt lgkmcnt(4)
    v_mfma_f32_16x16x32_bf16 v[204:207], a[244:247], a[36:39], v[204:207]
    ds_read_b64_tr_b16 v[6:7], v254 offset:12328
    v_mfma_f32_16x16x32_bf16 v[204:207], a[240:243], v[232:235], v[204:207]
    ds_read_b64_tr_b16 v[8:9], v254 offset:13864
    v_mfma_f32_16x16x32_bf16 v[164:167], a[240:243], v[228:231], v[164:167]
    v_mfma_f32_16x16x32_bf16 v[164:167], a[244:247], a[32:35], v[164:167]
    buffer_load_dwordx4 a[144:147], v0, s[44:47], s35 offen offset:1024 sc1
    v_mfma_f32_16x16x32_bf16 v[124:127], a[244:247], a[28:31], v[124:127]
    v_mfma_f32_16x16x32_bf16 v[124:127], a[240:243], v[224:227], v[124:127]
    ds_read_b64_tr_b16 v[10:11], v254 offset:24648
    v_mfma_f32_16x16x32_bf16 v[84:87], a[240:243], v[220:223], v[84:87]
    ds_read_b64_tr_b16 v[12:13], v254 offset:26184
    v_mfma_f32_16x16x32_bf16 v[84:87], a[244:247], a[24:27], v[84:87]
    v_mfma_f32_16x16x32_bf16 v[44:47], a[244:247], a[20:23], v[44:47]
    buffer_load_dwordx4 a[148:151], v0, s[44:47], s35 offen offset:2048 sc1
    v_mfma_f32_16x16x32_bf16 v[44:47], a[240:243], v[216:219], v[44:47]
    s_waitcnt lgkmcnt(4)
    s_waitcnt vmcnt(24)
    s_barrier
    v_mfma_f32_16x16x32_bf16 v[48:51], a[248:251], v[216:219], v[48:51]
    ds_read_b64_tr_b16 a[240:241], v250 offset:36960
    v_mfma_f32_16x16x32_bf16 v[48:51], a[252:255], a[20:23], v[48:51]
    ds_read_b64_tr_b16 a[242:243], v250 offset:38496
    v_mfma_f32_16x16x32_bf16 v[88:91], a[252:255], a[24:27], v[88:91]
    v_mfma_f32_16x16x32_bf16 v[88:91], a[248:251], v[220:223], v[88:91]
    buffer_load_dwordx4 a[152:155], v0, s[44:47], s35 offen offset:3072 sc1
    v_mfma_f32_16x16x32_bf16 v[128:131], a[248:251], v[224:227], v[128:131]
    v_mfma_f32_16x16x32_bf16 v[128:131], a[252:255], a[28:31], v[128:131]
    ds_read_b64_tr_b16 a[244:245], v250 offset:49280
    v_mfma_f32_16x16x32_bf16 v[168:171], a[252:255], a[32:35], v[168:171]
    ds_read_b64_tr_b16 a[246:247], v250 offset:50816
    v_mfma_f32_16x16x32_bf16 v[168:171], a[248:251], v[228:231], v[168:171]
    v_mfma_f32_16x16x32_bf16 v[208:211], a[248:251], v[232:235], v[208:211]
    buffer_load_dwordx4 a[156:159], v0, s[44:47], s36 offen sc1
    v_mfma_f32_16x16x32_bf16 v[208:211], a[252:255], a[36:39], v[208:211]
    s_waitcnt lgkmcnt(4)
    v_mfma_f32_16x16x32_bf16 v[212:215], v[10:13], a[36:39], v[212:215]
    s_mov_b32 s88, 51200
    ds_read_b64_tr_b16 a[248:249], v250 offset:36968
    v_mfma_f32_16x16x32_bf16 v[212:215], v[6:9], v[232:235], v[212:215]
    ds_read_b64_tr_b16 a[250:251], v250 offset:38504
    v_mfma_f32_16x16x32_bf16 v[172:175], v[6:9], v[228:231], v[172:175]
    v_mfma_f32_16x16x32_bf16 v[172:175], v[10:13], a[32:35], v[172:175]
    buffer_store_dwordx4 a[200:203], v0, s[24:27], s88 offen sc1
    v_mfma_f32_16x16x32_bf16 v[132:135], v[10:13], a[28:31], v[132:135]
    v_mfma_f32_16x16x32_bf16 v[132:135], v[6:9], v[224:227], v[132:135]
    s_add_u32 m0, s31, 24640
    ds_read_b64_tr_b16 a[252:253], v250 offset:49288
    v_mfma_f32_16x16x32_bf16 v[92:95], v[6:9], v[220:223], v[92:95]
    s_xor_b32 s3, s62, 22
    ds_read_b64_tr_b16 a[254:255], v250 offset:50824
    v_mfma_f32_16x16x32_bf16 v[92:95], v[10:13], a[24:27], v[92:95]
    s_mul_i32 s32, s3, 40960
    v_mfma_f32_16x16x32_bf16 v[52:55], v[10:13], a[20:23], v[52:55]
    buffer_load_dwordx4 v242, s[64:67], s32 offen lds
    v_mfma_f32_16x16x32_bf16 v[52:55], v[6:9], v[216:219], v[52:55]
    s_waitcnt lgkmcnt(4)
    s_waitcnt vmcnt(22)
    v_mfma_f32_16x16x32_bf16 v[16:19], a[240:243], a[100:103], v[16:19]
    ds_read_b64_tr_b16 v[6:7], v251 offset:36960
    v_mfma_f32_16x16x32_bf16 v[16:19], a[244:247], a[60:63], v[16:19]
    ds_read_b64_tr_b16 v[8:9], v251 offset:38496
    v_mfma_f32_16x16x32_bf16 v[56:59], a[244:247], a[64:67], v[56:59]
    v_mfma_f32_16x16x32_bf16 v[56:59], a[240:243], a[104:107], v[56:59]
    buffer_load_dwordx4 v243, s[64:67], s32 offen offset:1024 lds
    v_mfma_f32_16x16x32_bf16 v[96:99], a[240:243], a[108:111], v[96:99]
    v_mfma_f32_16x16x32_bf16 v[96:99], a[244:247], a[68:71], v[96:99]
    ds_read_b64_tr_b16 v[10:11], v251 offset:49280
    v_mfma_f32_16x16x32_bf16 v[136:139], a[244:247], a[72:75], v[136:139]
    ds_read_b64_tr_b16 v[12:13], v251 offset:50816
    v_mfma_f32_16x16x32_bf16 v[136:139], a[240:243], a[112:115], v[136:139]
    v_mfma_f32_16x16x32_bf16 v[176:179], a[240:243], a[116:119], v[176:179]
    buffer_load_dwordx4 v244, s[64:67], s32 offen offset:2048 lds
    v_mfma_f32_16x16x32_bf16 v[176:179], a[244:247], a[76:79], v[176:179]
    s_waitcnt lgkmcnt(4)
    v_mfma_f32_16x16x32_bf16 v[180:183], a[252:255], a[76:79], v[180:183]
    s_mov_b32 s88, 52224
    ds_read_b64_tr_b16 a[240:241], v251 offset:36968
    v_mfma_f32_16x16x32_bf16 v[180:183], a[248:251], a[116:119], v[180:183]
    ds_read_b64_tr_b16 a[242:243], v251 offset:38504
    v_mfma_f32_16x16x32_bf16 v[140:143], a[248:251], a[112:115], v[140:143]
    v_mfma_f32_16x16x32_bf16 v[140:143], a[252:255], a[72:75], v[140:143]
    buffer_store_dwordx4 a[204:207], v0, s[24:27], s88 offen sc1
    v_mfma_f32_16x16x32_bf16 v[100:103], a[252:255], a[68:71], v[100:103]
    v_mfma_f32_16x16x32_bf16 v[100:103], a[248:251], a[108:111], v[100:103]
    s_xor_b32 s3, s62, 22
    ds_read_b64_tr_b16 a[244:245], v251 offset:49288
    v_mfma_f32_16x16x32_bf16 v[60:63], a[248:251], a[104:107], v[60:63]
    s_mul_i32 s35, s3, 10240
    ds_read_b64_tr_b16 a[246:247], v251 offset:50824
    v_mfma_f32_16x16x32_bf16 v[60:63], a[252:255], a[64:67], v[60:63]
    s_add_u32 s36, s35, 4096
    v_mfma_f32_16x16x32_bf16 v[20:23], a[252:255], a[60:63], v[20:23]
    buffer_load_dwordx4 a[180:183], v0, s[44:47], s35 offen sc1
    v_mfma_f32_16x16x32_bf16 v[20:23], a[248:251], a[100:103], v[20:23]
    s_waitcnt lgkmcnt(4)
    v_mfma_f32_16x16x32_bf16 v[24:27], v[6:9], a[100:103], v[24:27]
    ds_read_b64_tr_b16 a[248:249], v252 offset:36960
    v_mfma_f32_16x16x32_bf16 v[24:27], v[10:13], a[60:63], v[24:27]
    ds_read_b64_tr_b16 a[250:251], v252 offset:38496
    v_mfma_f32_16x16x32_bf16 v[64:67], v[10:13], a[64:67], v[64:67]
    v_mfma_f32_16x16x32_bf16 v[64:67], v[6:9], a[104:107], v[64:67]
    buffer_load_dwordx4 a[184:187], v0, s[44:47], s35 offen offset:1024 sc1
    v_mfma_f32_16x16x32_bf16 v[104:107], v[6:9], a[108:111], v[104:107]
    v_mfma_f32_16x16x32_bf16 v[104:107], v[10:13], a[68:71], v[104:107]
    ds_read_b64_tr_b16 a[252:253], v252 offset:49280
    v_mfma_f32_16x16x32_bf16 v[144:147], v[10:13], a[72:75], v[144:147]
    ds_read_b64_tr_b16 a[254:255], v252 offset:50816
    v_mfma_f32_16x16x32_bf16 v[144:147], v[6:9], a[112:115], v[144:147]
    v_mfma_f32_16x16x32_bf16 v[184:187], v[6:9], a[116:119], v[184:187]
    buffer_load_dwordx4 a[188:191], v0, s[44:47], s35 offen offset:2048 sc1
    v_mfma_f32_16x16x32_bf16 v[184:187], v[10:13], a[76:79], v[184:187]
    s_waitcnt lgkmcnt(4)
    v_mfma_f32_16x16x32_bf16 v[188:191], a[244:247], a[76:79], v[188:191]
    ds_read_b64_tr_b16 v[6:7], v252 offset:36968
    v_mfma_f32_16x16x32_bf16 v[188:191], a[240:243], a[116:119], v[188:191]
    ds_read_b64_tr_b16 v[8:9], v252 offset:38504
    v_mfma_f32_16x16x32_bf16 v[148:151], a[240:243], a[112:115], v[148:151]
    v_mfma_f32_16x16x32_bf16 v[148:151], a[244:247], a[72:75], v[148:151]
    buffer_load_dwordx4 a[192:195], v0, s[44:47], s35 offen offset:3072 sc1
    v_mfma_f32_16x16x32_bf16 v[108:111], a[244:247], a[68:71], v[108:111]
    v_mfma_f32_16x16x32_bf16 v[108:111], a[240:243], a[108:111], v[108:111]
    ds_read_b64_tr_b16 v[10:11], v252 offset:49288
    v_mfma_f32_16x16x32_bf16 v[68:71], a[240:243], a[104:107], v[68:71]
    ds_read_b64_tr_b16 v[12:13], v252 offset:50824
    v_mfma_f32_16x16x32_bf16 v[68:71], a[244:247], a[64:67], v[68:71]
    v_mfma_f32_16x16x32_bf16 v[28:31], a[244:247], a[60:63], v[28:31]
    buffer_load_dwordx4 a[196:199], v0, s[44:47], s36 offen sc1
    v_mfma_f32_16x16x32_bf16 v[28:31], a[240:243], a[100:103], v[28:31]
    s_waitcnt lgkmcnt(4)
    v_mfma_f32_16x16x32_bf16 v[32:35], a[248:251], a[100:103], v[32:35]
    s_mov_b32 s88, 53248
    ds_read_b64_tr_b16 a[240:241], v253 offset:36960
    v_mfma_f32_16x16x32_bf16 v[32:35], a[252:255], a[60:63], v[32:35]
    ds_read_b64_tr_b16 a[242:243], v253 offset:38496
    v_mfma_f32_16x16x32_bf16 v[72:75], a[252:255], a[64:67], v[72:75]
    v_mfma_f32_16x16x32_bf16 v[72:75], a[248:251], a[104:107], v[72:75]
    buffer_store_dwordx4 a[208:211], v0, s[24:27], s88 offen sc1
    v_mfma_f32_16x16x32_bf16 v[112:115], a[248:251], a[108:111], v[112:115]
    v_mfma_f32_16x16x32_bf16 v[112:115], a[252:255], a[68:71], v[112:115]
    s_add_u32 m0, s31, 36960
    ds_read_b64_tr_b16 a[244:245], v253 offset:49280
    v_mfma_f32_16x16x32_bf16 v[152:155], a[252:255], a[72:75], v[152:155]
    s_xor_b32 s3, s62, 23
    ds_read_b64_tr_b16 a[246:247], v253 offset:50816
    v_mfma_f32_16x16x32_bf16 v[152:155], a[248:251], a[112:115], v[152:155]
    s_mul_i32 s32, s3, 40960
    v_mfma_f32_16x16x32_bf16 v[192:195], a[248:251], a[116:119], v[192:195]
    buffer_load_dwordx4 v242, s[64:67], s32 offen lds
    v_mfma_f32_16x16x32_bf16 v[192:195], a[252:255], a[76:79], v[192:195]
    s_waitcnt lgkmcnt(4)
    v_mfma_f32_16x16x32_bf16 v[196:199], v[10:13], a[76:79], v[196:199]
    ds_read_b64_tr_b16 a[248:249], v253 offset:36968
    v_mfma_f32_16x16x32_bf16 v[196:199], v[6:9], a[116:119], v[196:199]
    ds_read_b64_tr_b16 a[250:251], v253 offset:38504
    v_mfma_f32_16x16x32_bf16 v[156:159], v[6:9], a[112:115], v[156:159]
    v_mfma_f32_16x16x32_bf16 v[156:159], v[10:13], a[72:75], v[156:159]
    buffer_load_dwordx4 v243, s[64:67], s32 offen offset:1024 lds
    v_mfma_f32_16x16x32_bf16 v[116:119], v[10:13], a[68:71], v[116:119]
    v_mfma_f32_16x16x32_bf16 v[116:119], v[6:9], a[108:111], v[116:119]
    ds_read_b64_tr_b16 a[252:253], v253 offset:49288
    v_mfma_f32_16x16x32_bf16 v[76:79], v[6:9], a[104:107], v[76:79]
    ds_read_b64_tr_b16 a[254:255], v253 offset:50824
    v_mfma_f32_16x16x32_bf16 v[76:79], v[10:13], a[64:67], v[76:79]
    v_mfma_f32_16x16x32_bf16 v[36:39], v[10:13], a[60:63], v[36:39]
    buffer_load_dwordx4 v244, s[64:67], s32 offen offset:2048 lds
    v_mfma_f32_16x16x32_bf16 v[36:39], v[6:9], a[100:103], v[36:39]
    s_waitcnt lgkmcnt(4)
    v_mfma_f32_16x16x32_bf16 v[40:43], a[240:243], a[100:103], v[40:43]
    s_mov_b32 s88, 54272
    ds_read_b64_tr_b16 v[6:7], v254 offset:36960
    v_mfma_f32_16x16x32_bf16 v[40:43], a[244:247], a[60:63], v[40:43]
    ds_read_b64_tr_b16 v[8:9], v254 offset:38496
    v_mfma_f32_16x16x32_bf16 v[80:83], a[244:247], a[64:67], v[80:83]
    v_mfma_f32_16x16x32_bf16 v[80:83], a[240:243], a[104:107], v[80:83]
    buffer_store_dwordx4 a[212:215], v0, s[24:27], s88 offen sc1
    v_mfma_f32_16x16x32_bf16 v[120:123], a[240:243], a[108:111], v[120:123]
    v_mfma_f32_16x16x32_bf16 v[120:123], a[244:247], a[68:71], v[120:123]
    s_xor_b32 s3, s62, 23
    ds_read_b64_tr_b16 v[10:11], v254 offset:49280
    v_mfma_f32_16x16x32_bf16 v[160:163], a[244:247], a[72:75], v[160:163]
    s_mul_i32 s35, s3, 10240
    ds_read_b64_tr_b16 v[12:13], v254 offset:50816
    v_mfma_f32_16x16x32_bf16 v[160:163], a[240:243], a[112:115], v[160:163]
    s_add_u32 s36, s35, 4096
    v_mfma_f32_16x16x32_bf16 v[200:203], a[240:243], a[116:119], v[200:203]
    buffer_load_dwordx4 a[20:23], v0, s[44:47], s35 offen sc1
    v_mfma_f32_16x16x32_bf16 v[200:203], a[244:247], a[76:79], v[200:203]
    s_waitcnt lgkmcnt(4)
    v_mfma_f32_16x16x32_bf16 v[204:207], a[252:255], a[76:79], v[204:207]
    ds_read_b64_tr_b16 a[240:241], v254 offset:36968
    v_mfma_f32_16x16x32_bf16 v[204:207], a[248:251], a[116:119], v[204:207]
    ds_read_b64_tr_b16 a[242:243], v254 offset:38504
    v_mfma_f32_16x16x32_bf16 v[164:167], a[248:251], a[112:115], v[164:167]
    v_mfma_f32_16x16x32_bf16 v[164:167], a[252:255], a[72:75], v[164:167]
    buffer_load_dwordx4 a[24:27], v0, s[44:47], s35 offen offset:1024 sc1
    v_mfma_f32_16x16x32_bf16 v[124:127], a[252:255], a[68:71], v[124:127]
    v_mfma_f32_16x16x32_bf16 v[124:127], a[248:251], a[108:111], v[124:127]
    ds_read_b64_tr_b16 a[244:245], v254 offset:49288
    v_mfma_f32_16x16x32_bf16 v[84:87], a[248:251], a[104:107], v[84:87]
    ds_read_b64_tr_b16 a[246:247], v254 offset:50824
    v_mfma_f32_16x16x32_bf16 v[84:87], a[252:255], a[64:67], v[84:87]
    v_mfma_f32_16x16x32_bf16 v[44:47], a[252:255], a[60:63], v[44:47]
    buffer_load_dwordx4 a[28:31], v0, s[44:47], s35 offen offset:2048 sc1
    v_mfma_f32_16x16x32_bf16 v[44:47], a[248:251], a[100:103], v[44:47]
    s_waitcnt lgkmcnt(4)
    s_waitcnt vmcnt(24)
    s_barrier
    v_mfma_f32_16x16x32_bf16 v[48:51], v[6:9], a[100:103], v[48:51]
    ds_read_b64_tr_b16 a[248:249], v245 offset:0
    v_mfma_f32_16x16x32_bf16 v[48:51], v[10:13], a[60:63], v[48:51]
    ds_read_b64_tr_b16 a[250:251], v245 offset:1536
    v_mfma_f32_16x16x32_bf16 v[88:91], v[10:13], a[64:67], v[88:91]
    v_mfma_f32_16x16x32_bf16 v[88:91], v[6:9], a[104:107], v[88:91]
    buffer_load_dwordx4 a[32:35], v0, s[44:47], s35 offen offset:3072 sc1
    v_mfma_f32_16x16x32_bf16 v[128:131], v[6:9], a[108:111], v[128:131]
    v_mfma_f32_16x16x32_bf16 v[128:131], v[10:13], a[68:71], v[128:131]
    ds_read_b64_tr_b16 a[252:253], v245 offset:12320
    v_mfma_f32_16x16x32_bf16 v[168:171], v[10:13], a[72:75], v[168:171]
    ds_read_b64_tr_b16 a[254:255], v245 offset:13856
    v_mfma_f32_16x16x32_bf16 v[168:171], v[6:9], a[112:115], v[168:171]
    v_mfma_f32_16x16x32_bf16 v[208:211], v[6:9], a[116:119], v[208:211]
    buffer_load_dwordx4 a[36:39], v0, s[44:47], s36 offen sc1
    v_mfma_f32_16x16x32_bf16 v[208:211], v[10:13], a[76:79], v[208:211]
    s_waitcnt lgkmcnt(4)
    v_mfma_f32_16x16x32_bf16 v[212:215], a[244:247], a[76:79], v[212:215]
    s_mov_b32 s88, 55296
    ds_read_b64_tr_b16 v[6:7], v245 offset:8
    v_mfma_f32_16x16x32_bf16 v[212:215], a[240:243], a[116:119], v[212:215]
    ds_read_b64_tr_b16 v[8:9], v245 offset:1544
    v_mfma_f32_16x16x32_bf16 v[172:175], a[240:243], a[112:115], v[172:175]
    v_mfma_f32_16x16x32_bf16 v[172:175], a[244:247], a[72:75], v[172:175]
    buffer_store_dwordx4 a[216:219], v0, s[24:27], s88 offen sc1
    v_mfma_f32_16x16x32_bf16 v[132:135], a[244:247], a[68:71], v[132:135]
    v_mfma_f32_16x16x32_bf16 v[132:135], a[240:243], a[108:111], v[132:135]
    s_add_u32 m0, s31, 49280
    ds_read_b64_tr_b16 v[10:11], v245 offset:12328
    v_mfma_f32_16x16x32_bf16 v[92:95], a[240:243], a[104:107], v[92:95]
    s_add_u32 s3, s52, 0
    ds_read_b64_tr_b16 v[12:13], v245 offset:13864
    v_mfma_f32_16x16x32_bf16 v[92:95], a[244:247], a[64:67], v[92:95]
    s_mul_i32 s32, s3, 40960
    v_mfma_f32_16x16x32_bf16 v[52:55], a[244:247], a[60:63], v[52:55]
    buffer_load_dwordx4 v242, s[64:67], s32 offen lds
    v_mfma_f32_16x16x32_bf16 v[52:55], a[240:243], a[100:103], v[52:55]
    s_waitcnt lgkmcnt(4)
    s_waitcnt vmcnt(22)
    v_mfma_f32_16x16x32_bf16 v[16:19], a[248:251], a[220:223], v[16:19]
    ds_read_b64_tr_b16 a[240:241], v246 offset:0
    v_mfma_f32_16x16x32_bf16 v[16:19], a[252:255], a[140:143], v[16:19]
    ds_read_b64_tr_b16 a[242:243], v246 offset:1536
    v_mfma_f32_16x16x32_bf16 v[56:59], a[252:255], a[144:147], v[56:59]
    v_mfma_f32_16x16x32_bf16 v[56:59], a[248:251], a[224:227], v[56:59]
    buffer_load_dwordx4 v243, s[64:67], s32 offen offset:1024 lds
    v_mfma_f32_16x16x32_bf16 v[96:99], a[248:251], a[228:231], v[96:99]
    v_mfma_f32_16x16x32_bf16 v[96:99], a[252:255], a[148:151], v[96:99]
    ds_read_b64_tr_b16 a[244:245], v246 offset:12320
    v_mfma_f32_16x16x32_bf16 v[136:139], a[252:255], a[152:155], v[136:139]
    ds_read_b64_tr_b16 a[246:247], v246 offset:13856
    v_mfma_f32_16x16x32_bf16 v[136:139], a[248:251], a[232:235], v[136:139]
    v_mfma_f32_16x16x32_bf16 v[176:179], a[248:251], a[236:239], v[176:179]
    buffer_load_dwordx4 v244, s[64:67], s32 offen offset:2048 lds
    v_mfma_f32_16x16x32_bf16 v[176:179], a[252:255], a[156:159], v[176:179]
    s_waitcnt lgkmcnt(4)
    v_mfma_f32_16x16x32_bf16 v[180:183], v[10:13], a[156:159], v[180:183]
    s_add_u32 m0, s31, 61600
    ds_read_b64_tr_b16 a[248:249], v246 offset:8
    v_mfma_f32_16x16x32_bf16 v[180:183], v[6:9], a[236:239], v[180:183]
    s_add_u32 s3, s52, 1
    ds_read_b64_tr_b16 a[250:251], v246 offset:1544
    v_mfma_f32_16x16x32_bf16 v[140:143], v[6:9], a[232:235], v[140:143]
    s_mul_i32 s32, s3, 40960
    v_mfma_f32_16x16x32_bf16 v[140:143], v[10:13], a[152:155], v[140:143]
    buffer_load_dwordx4 v242, s[64:67], s32 offen lds
    v_mfma_f32_16x16x32_bf16 v[100:103], v[10:13], a[148:151], v[100:103]
    v_mfma_f32_16x16x32_bf16 v[100:103], v[6:9], a[228:231], v[100:103]
    ds_read_b64_tr_b16 a[252:253], v246 offset:12328
    v_mfma_f32_16x16x32_bf16 v[60:63], v[6:9], a[224:227], v[60:63]
    ds_read_b64_tr_b16 a[254:255], v246 offset:13864
    v_mfma_f32_16x16x32_bf16 v[60:63], v[10:13], a[144:147], v[60:63]
    v_mfma_f32_16x16x32_bf16 v[20:23], v[10:13], a[140:143], v[20:23]
    buffer_load_dwordx4 v243, s[64:67], s32 offen offset:1024 lds
    v_mfma_f32_16x16x32_bf16 v[20:23], v[6:9], a[220:223], v[20:23]
    s_waitcnt lgkmcnt(4)
    v_mfma_f32_16x16x32_bf16 v[24:27], a[240:243], a[220:223], v[24:27]
    ds_read_b64_tr_b16 v[6:7], v247 offset:0
    v_mfma_f32_16x16x32_bf16 v[24:27], a[244:247], a[140:143], v[24:27]
    ds_read_b64_tr_b16 v[8:9], v247 offset:1536
    v_mfma_f32_16x16x32_bf16 v[64:67], a[244:247], a[144:147], v[64:67]
    v_mfma_f32_16x16x32_bf16 v[64:67], a[240:243], a[224:227], v[64:67]
    buffer_load_dwordx4 v244, s[64:67], s32 offen offset:2048 lds
    v_mfma_f32_16x16x32_bf16 v[104:107], a[240:243], a[228:231], v[104:107]
    v_mfma_f32_16x16x32_bf16 v[104:107], a[244:247], a[148:151], v[104:107]
    ds_read_b64_tr_b16 v[10:11], v247 offset:12320
    v_mfma_f32_16x16x32_bf16 v[144:147], a[244:247], a[152:155], v[144:147]
    ds_read_b64_tr_b16 v[12:13], v247 offset:13856
    v_mfma_f32_16x16x32_bf16 v[144:147], a[240:243], a[232:235], v[144:147]
    v_mfma_f32_16x16x32_bf16 v[184:187], a[240:243], a[236:239], v[184:187]
    v_mfma_f32_16x16x32_bf16 v[184:187], a[244:247], a[156:159], v[184:187]
    s_waitcnt lgkmcnt(4)
    v_mfma_f32_16x16x32_bf16 v[188:191], a[252:255], a[156:159], v[188:191]
    ds_read_b64_tr_b16 a[240:241], v247 offset:8
    v_mfma_f32_16x16x32_bf16 v[188:191], a[248:251], a[236:239], v[188:191]
    ds_read_b64_tr_b16 a[242:243], v247 offset:1544
    v_mfma_f32_16x16x32_bf16 v[148:151], a[248:251], a[232:235], v[148:151]
    v_mfma_f32_16x16x32_bf16 v[148:151], a[252:255], a[152:155], v[148:151]
    v_mfma_f32_16x16x32_bf16 v[108:111], a[252:255], a[148:151], v[108:111]
    v_mfma_f32_16x16x32_bf16 v[108:111], a[248:251], a[228:231], v[108:111]
    ds_read_b64_tr_b16 a[244:245], v247 offset:12328
    v_mfma_f32_16x16x32_bf16 v[68:71], a[248:251], a[224:227], v[68:71]
    ds_read_b64_tr_b16 a[246:247], v247 offset:13864
    v_mfma_f32_16x16x32_bf16 v[68:71], a[252:255], a[144:147], v[68:71]
    v_mfma_f32_16x16x32_bf16 v[28:31], a[252:255], a[140:143], v[28:31]
    v_mfma_f32_16x16x32_bf16 v[28:31], a[248:251], a[220:223], v[28:31]
    s_waitcnt lgkmcnt(4)
    v_mfma_f32_16x16x32_bf16 v[32:35], v[6:9], a[220:223], v[32:35]
    ds_read_b64_tr_b16 a[248:249], v248 offset:0
    v_mfma_f32_16x16x32_bf16 v[32:35], v[10:13], a[140:143], v[32:35]
    ds_read_b64_tr_b16 a[250:251], v248 offset:1536
    v_mfma_f32_16x16x32_bf16 v[72:75], v[10:13], a[144:147], v[72:75]
    v_mfma_f32_16x16x32_bf16 v[72:75], v[6:9], a[224:227], v[72:75]
    v_mfma_f32_16x16x32_bf16 v[112:115], v[6:9], a[228:231], v[112:115]
    v_mfma_f32_16x16x32_bf16 v[112:115], v[10:13], a[148:151], v[112:115]
    ds_read_b64_tr_b16 a[252:253], v248 offset:12320
    v_mfma_f32_16x16x32_bf16 v[152:155], v[10:13], a[152:155], v[152:155]
    ds_read_b64_tr_b16 a[254:255], v248 offset:13856
    v_mfma_f32_16x16x32_bf16 v[152:155], v[6:9], a[232:235], v[152:155]
    v_mfma_f32_16x16x32_bf16 v[192:195], v[6:9], a[236:239], v[192:195]
    v_mfma_f32_16x16x32_bf16 v[192:195], v[10:13], a[156:159], v[192:195]
    s_waitcnt lgkmcnt(4)
    v_mfma_f32_16x16x32_bf16 v[196:199], a[244:247], a[156:159], v[196:199]
    s_add_u32 m0, s31, 73920
    ds_read_b64_tr_b16 v[6:7], v248 offset:8
    v_mfma_f32_16x16x32_bf16 v[196:199], a[240:243], a[236:239], v[196:199]
    s_add_u32 s3, s52, 2
    ds_read_b64_tr_b16 v[8:9], v248 offset:1544
    v_mfma_f32_16x16x32_bf16 v[156:159], a[240:243], a[232:235], v[156:159]
    s_mul_i32 s32, s3, 40960
    v_mfma_f32_16x16x32_bf16 v[156:159], a[244:247], a[152:155], v[156:159]
    buffer_load_dwordx4 v242, s[64:67], s32 offen lds
    v_mfma_f32_16x16x32_bf16 v[116:119], a[244:247], a[148:151], v[116:119]
    v_mfma_f32_16x16x32_bf16 v[116:119], a[240:243], a[228:231], v[116:119]
    ds_read_b64_tr_b16 v[10:11], v248 offset:12328
    v_mfma_f32_16x16x32_bf16 v[76:79], a[240:243], a[224:227], v[76:79]
    ds_read_b64_tr_b16 v[12:13], v248 offset:13864
    v_mfma_f32_16x16x32_bf16 v[76:79], a[244:247], a[144:147], v[76:79]
    v_mfma_f32_16x16x32_bf16 v[36:39], a[244:247], a[140:143], v[36:39]
    buffer_load_dwordx4 v243, s[64:67], s32 offen offset:1024 lds
    v_mfma_f32_16x16x32_bf16 v[36:39], a[240:243], a[220:223], v[36:39]
    s_waitcnt lgkmcnt(4)
    v_mfma_f32_16x16x32_bf16 v[40:43], a[248:251], a[220:223], v[40:43]
    ds_read_b64_tr_b16 a[240:241], v249 offset:0
    v_mfma_f32_16x16x32_bf16 v[40:43], a[252:255], a[140:143], v[40:43]
    ds_read_b64_tr_b16 a[242:243], v249 offset:1536
    v_mfma_f32_16x16x32_bf16 v[80:83], a[252:255], a[144:147], v[80:83]
    v_mfma_f32_16x16x32_bf16 v[80:83], a[248:251], a[224:227], v[80:83]
    buffer_load_dwordx4 v244, s[64:67], s32 offen offset:2048 lds
    v_mfma_f32_16x16x32_bf16 v[120:123], a[248:251], a[228:231], v[120:123]
    v_mfma_f32_16x16x32_bf16 v[120:123], a[252:255], a[148:151], v[120:123]
    s_add_u32 m0, s31, 86240
    ds_read_b64_tr_b16 a[244:245], v249 offset:12320
    v_mfma_f32_16x16x32_bf16 v[160:163], a[252:255], a[152:155], v[160:163]
    s_add_u32 s3, s52, 3
    ds_read_b64_tr_b16 a[246:247], v249 offset:13856
    v_mfma_f32_16x16x32_bf16 v[160:163], a[248:251], a[232:235], v[160:163]
    s_mul_i32 s32, s3, 40960
    v_mfma_f32_16x16x32_bf16 v[200:203], a[248:251], a[236:239], v[200:203]
    buffer_load_dwordx4 v242, s[64:67], s32 offen lds
    v_mfma_f32_16x16x32_bf16 v[200:203], a[252:255], a[156:159], v[200:203]
    s_waitcnt lgkmcnt(4)
    v_mfma_f32_16x16x32_bf16 v[204:207], v[10:13], a[156:159], v[204:207]
    ds_read_b64_tr_b16 a[248:249], v249 offset:8
    v_mfma_f32_16x16x32_bf16 v[204:207], v[6:9], a[236:239], v[204:207]
    ds_read_b64_tr_b16 a[250:251], v249 offset:1544
    v_mfma_f32_16x16x32_bf16 v[164:167], v[6:9], a[232:235], v[164:167]
    v_mfma_f32_16x16x32_bf16 v[164:167], v[10:13], a[152:155], v[164:167]
    buffer_load_dwordx4 v243, s[64:67], s32 offen offset:1024 lds
    v_mfma_f32_16x16x32_bf16 v[124:127], v[10:13], a[148:151], v[124:127]
    v_mfma_f32_16x16x32_bf16 v[124:127], v[6:9], a[228:231], v[124:127]
    ds_read_b64_tr_b16 a[252:253], v249 offset:12328
    v_mfma_f32_16x16x32_bf16 v[84:87], v[6:9], a[224:227], v[84:87]
    ds_read_b64_tr_b16 a[254:255], v249 offset:13864
    v_mfma_f32_16x16x32_bf16 v[84:87], v[10:13], a[144:147], v[84:87]
    v_mfma_f32_16x16x32_bf16 v[44:47], v[10:13], a[140:143], v[44:47]
    buffer_load_dwordx4 v244, s[64:67], s32 offen offset:2048 lds
    v_mfma_f32_16x16x32_bf16 v[44:47], v[6:9], a[220:223], v[44:47]
    s_waitcnt lgkmcnt(4)
    s_waitcnt vmcnt(19)
    s_barrier
    v_mfma_f32_16x16x32_bf16 v[48:51], a[240:243], a[220:223], v[48:51]
    s_add_u32 m0, s31, 98560
    ds_read_b64_tr_b16 v[6:7], v245 offset:24640
    v_mfma_f32_16x16x32_bf16 v[48:51], a[244:247], a[140:143], v[48:51]
    s_add_u32 s3, s52, 4
    ds_read_b64_tr_b16 v[8:9], v245 offset:26176
    v_mfma_f32_16x16x32_bf16 v[88:91], a[244:247], a[144:147], v[88:91]
    s_mul_i32 s32, s3, 40960
    v_mfma_f32_16x16x32_bf16 v[88:91], a[240:243], a[224:227], v[88:91]
    buffer_load_dwordx4 v242, s[64:67], s32 offen lds
    v_mfma_f32_16x16x32_bf16 v[128:131], a[240:243], a[228:231], v[128:131]
    v_mfma_f32_16x16x32_bf16 v[128:131], a[244:247], a[148:151], v[128:131]
    ds_read_b64_tr_b16 v[10:11], v245 offset:36960
    v_mfma_f32_16x16x32_bf16 v[168:171], a[244:247], a[152:155], v[168:171]
    ds_read_b64_tr_b16 v[12:13], v245 offset:38496
    v_mfma_f32_16x16x32_bf16 v[168:171], a[240:243], a[232:235], v[168:171]
    v_mfma_f32_16x16x32_bf16 v[208:211], a[240:243], a[236:239], v[208:211]
    buffer_load_dwordx4 v243, s[64:67], s32 offen offset:1024 lds
    v_mfma_f32_16x16x32_bf16 v[208:211], a[244:247], a[156:159], v[208:211]
    s_waitcnt lgkmcnt(4)
    v_mfma_f32_16x16x32_bf16 v[212:215], a[252:255], a[156:159], v[212:215]
    ds_read_b64_tr_b16 a[240:241], v245 offset:24648
    v_mfma_f32_16x16x32_bf16 v[212:215], a[248:251], a[236:239], v[212:215]
    ds_read_b64_tr_b16 a[242:243], v245 offset:26184
    v_mfma_f32_16x16x32_bf16 v[172:175], a[248:251], a[232:235], v[172:175]
    v_mfma_f32_16x16x32_bf16 v[172:175], a[252:255], a[152:155], v[172:175]
    buffer_load_dwordx4 v244, s[64:67], s32 offen offset:2048 lds
    v_mfma_f32_16x16x32_bf16 v[132:135], a[252:255], a[148:151], v[132:135]
    v_mfma_f32_16x16x32_bf16 v[132:135], a[248:251], a[228:231], v[132:135]
    s_add_u32 m0, s31, 110880
    ds_read_b64_tr_b16 a[244:245], v245 offset:36968
    v_mfma_f32_16x16x32_bf16 v[92:95], a[248:251], a[224:227], v[92:95]
    s_add_u32 s3, s52, 5
    ds_read_b64_tr_b16 a[246:247], v245 offset:38504
    v_mfma_f32_16x16x32_bf16 v[92:95], a[252:255], a[144:147], v[92:95]
    s_mul_i32 s32, s3, 40960
    v_mfma_f32_16x16x32_bf16 v[52:55], a[252:255], a[140:143], v[52:55]
    buffer_load_dwordx4 v242, s[64:67], s32 offen lds
    v_mfma_f32_16x16x32_bf16 v[52:55], a[248:251], a[220:223], v[52:55]
    s_waitcnt lgkmcnt(4)
    s_waitcnt vmcnt(17)
    v_mfma_f32_16x16x32_bf16 v[16:19], v[6:9], a[180:183], v[16:19]
    ds_read_b64_tr_b16 a[248:249], v246 offset:24640
    v_mfma_f32_16x16x32_bf16 v[16:19], v[10:13], a[20:23], v[16:19]
    ds_read_b64_tr_b16 a[250:251], v246 offset:26176
    v_mfma_f32_16x16x32_bf16 v[56:59], v[10:13], a[24:27], v[56:59]
    v_mfma_f32_16x16x32_bf16 v[56:59], v[6:9], a[184:187], v[56:59]
    buffer_load_dwordx4 v243, s[64:67], s32 offen offset:1024 lds
    v_mfma_f32_16x16x32_bf16 v[96:99], v[6:9], a[188:191], v[96:99]
    v_mfma_f32_16x16x32_bf16 v[96:99], v[10:13], a[28:31], v[96:99]
    ds_read_b64_tr_b16 a[252:253], v246 offset:36960
    v_mfma_f32_16x16x32_bf16 v[136:139], v[10:13], a[32:35], v[136:139]
    ds_read_b64_tr_b16 a[254:255], v246 offset:38496
    v_mfma_f32_16x16x32_bf16 v[136:139], v[6:9], a[192:195], v[136:139]
    v_mfma_f32_16x16x32_bf16 v[176:179], v[6:9], a[196:199], v[176:179]
    buffer_load_dwordx4 v244, s[64:67], s32 offen offset:2048 lds
    v_mfma_f32_16x16x32_bf16 v[176:179], v[10:13], a[36:39], v[176:179]
    s_waitcnt lgkmcnt(4)
    v_mfma_f32_16x16x32_bf16 v[180:183], a[244:247], a[36:39], v[180:183]
    ds_read_b64_tr_b16 v[6:7], v246 offset:24648
    v_mfma_f32_16x16x32_bf16 v[180:183], a[240:243], a[196:199], v[180:183]
    ds_read_b64_tr_b16 v[8:9], v246 offset:26184
    v_mfma_f32_16x16x32_bf16 v[140:143], a[240:243], a[192:195], v[140:143]
    v_mfma_f32_16x16x32_bf16 v[140:143], a[244:247], a[32:35], v[140:143]
    v_mfma_f32_16x16x32_bf16 v[100:103], a[244:247], a[28:31], v[100:103]
    v_mfma_f32_16x16x32_bf16 v[100:103], a[240:243], a[188:191], v[100:103]
    ds_read_b64_tr_b16 v[10:11], v246 offset:36968
    v_mfma_f32_16x16x32_bf16 v[60:63], a[240:243], a[184:187], v[60:63]
    ds_read_b64_tr_b16 v[12:13], v246 offset:38504
    v_mfma_f32_16x16x32_bf16 v[60:63], a[244:247], a[24:27], v[60:63]
    v_mfma_f32_16x16x32_bf16 v[20:23], a[244:247], a[20:23], v[20:23]
    v_mfma_f32_16x16x32_bf16 v[20:23], a[240:243], a[180:183], v[20:23]
    s_waitcnt lgkmcnt(4)
    v_mfma_f32_16x16x32_bf16 v[24:27], a[248:251], a[180:183], v[24:27]
    ds_read_b64_tr_b16 a[240:241], v247 offset:24640
    v_mfma_f32_16x16x32_bf16 v[24:27], a[252:255], a[20:23], v[24:27]
    ds_read_b64_tr_b16 a[242:243], v247 offset:26176
    v_mfma_f32_16x16x32_bf16 v[64:67], a[252:255], a[24:27], v[64:67]
    v_mfma_f32_16x16x32_bf16 v[64:67], a[248:251], a[184:187], v[64:67]
    v_mfma_f32_16x16x32_bf16 v[104:107], a[248:251], a[188:191], v[104:107]
    v_mfma_f32_16x16x32_bf16 v[104:107], a[252:255], a[28:31], v[104:107]
    ds_read_b64_tr_b16 a[244:245], v247 offset:36960
    v_mfma_f32_16x16x32_bf16 v[144:147], a[252:255], a[32:35], v[144:147]
    ds_read_b64_tr_b16 a[246:247], v247 offset:38496
    v_mfma_f32_16x16x32_bf16 v[144:147], a[248:251], a[192:195], v[144:147]
    v_mfma_f32_16x16x32_bf16 v[184:187], a[248:251], a[196:199], v[184:187]
    v_mfma_f32_16x16x32_bf16 v[184:187], a[252:255], a[36:39], v[184:187]
    s_waitcnt lgkmcnt(4)
    v_mfma_f32_16x16x32_bf16 v[188:191], v[10:13], a[36:39], v[188:191]
    ds_read_b64_tr_b16 a[248:249], v247 offset:24648
    v_mfma_f32_16x16x32_bf16 v[188:191], v[6:9], a[196:199], v[188:191]
    ds_read_b64_tr_b16 a[250:251], v247 offset:26184
    v_mfma_f32_16x16x32_bf16 v[148:151], v[6:9], a[192:195], v[148:151]
    v_mfma_f32_16x16x32_bf16 v[148:151], v[10:13], a[32:35], v[148:151]
    v_mfma_f32_16x16x32_bf16 v[108:111], v[10:13], a[28:31], v[108:111]
    v_mfma_f32_16x16x32_bf16 v[108:111], v[6:9], a[188:191], v[108:111]
    ds_read_b64_tr_b16 a[252:253], v247 offset:36968
    v_mfma_f32_16x16x32_bf16 v[68:71], v[6:9], a[184:187], v[68:71]
    ds_read_b64_tr_b16 a[254:255], v247 offset:38504
    v_mfma_f32_16x16x32_bf16 v[68:71], v[10:13], a[24:27], v[68:71]
    v_mfma_f32_16x16x32_bf16 v[28:31], v[10:13], a[20:23], v[28:31]
    v_mfma_f32_16x16x32_bf16 v[28:31], v[6:9], a[180:183], v[28:31]
    s_waitcnt lgkmcnt(4)
    v_mfma_f32_16x16x32_bf16 v[32:35], a[240:243], a[180:183], v[32:35]
    ds_read_b64_tr_b16 v[6:7], v248 offset:24640
    v_mfma_f32_16x16x32_bf16 v[32:35], a[244:247], a[20:23], v[32:35]
    ds_read_b64_tr_b16 v[8:9], v248 offset:26176
    v_mfma_f32_16x16x32_bf16 v[72:75], a[244:247], a[24:27], v[72:75]
    v_mfma_f32_16x16x32_bf16 v[72:75], a[240:243], a[184:187], v[72:75]
    v_mfma_f32_16x16x32_bf16 v[112:115], a[240:243], a[188:191], v[112:115]
    v_mfma_f32_16x16x32_bf16 v[112:115], a[244:247], a[28:31], v[112:115]
    ds_read_b64_tr_b16 v[10:11], v248 offset:36960
    v_mfma_f32_16x16x32_bf16 v[152:155], a[244:247], a[32:35], v[152:155]
    ds_read_b64_tr_b16 v[12:13], v248 offset:38496
    v_mfma_f32_16x16x32_bf16 v[152:155], a[240:243], a[192:195], v[152:155]
    v_mfma_f32_16x16x32_bf16 v[192:195], a[240:243], a[196:199], v[192:195]
    v_mfma_f32_16x16x32_bf16 v[192:195], a[244:247], a[36:39], v[192:195]
    s_waitcnt lgkmcnt(4)
    v_mfma_f32_16x16x32_bf16 v[196:199], a[252:255], a[36:39], v[196:199]
    ds_read_b64_tr_b16 a[240:241], v248 offset:24648
    v_mfma_f32_16x16x32_bf16 v[196:199], a[248:251], a[196:199], v[196:199]
    ds_read_b64_tr_b16 a[242:243], v248 offset:26184
    v_mfma_f32_16x16x32_bf16 v[156:159], a[248:251], a[192:195], v[156:159]
    v_mfma_f32_16x16x32_bf16 v[156:159], a[252:255], a[32:35], v[156:159]
    v_mfma_f32_16x16x32_bf16 v[116:119], a[252:255], a[28:31], v[116:119]
    v_mfma_f32_16x16x32_bf16 v[116:119], a[248:251], a[188:191], v[116:119]
    ds_read_b64_tr_b16 a[244:245], v248 offset:36968
    v_mfma_f32_16x16x32_bf16 v[76:79], a[248:251], a[184:187], v[76:79]
    ds_read_b64_tr_b16 a[246:247], v248 offset:38504
    v_mfma_f32_16x16x32_bf16 v[76:79], a[252:255], a[24:27], v[76:79]
    v_mfma_f32_16x16x32_bf16 v[36:39], a[252:255], a[20:23], v[36:39]
    v_mfma_f32_16x16x32_bf16 v[36:39], a[248:251], a[180:183], v[36:39]
    s_waitcnt lgkmcnt(4)
    v_mfma_f32_16x16x32_bf16 v[40:43], v[6:9], a[180:183], v[40:43]
    ds_read_b64_tr_b16 a[248:249], v249 offset:24640
    v_mfma_f32_16x16x32_bf16 v[40:43], v[10:13], a[20:23], v[40:43]
    ds_read_b64_tr_b16 a[250:251], v249 offset:26176
    v_mfma_f32_16x16x32_bf16 v[80:83], v[10:13], a[24:27], v[80:83]
    v_mfma_f32_16x16x32_bf16 v[80:83], v[6:9], a[184:187], v[80:83]
    v_mfma_f32_16x16x32_bf16 v[120:123], v[6:9], a[188:191], v[120:123]
    v_mfma_f32_16x16x32_bf16 v[120:123], v[10:13], a[28:31], v[120:123]
    ds_read_b64_tr_b16 a[252:253], v249 offset:36960
    v_mfma_f32_16x16x32_bf16 v[160:163], v[10:13], a[32:35], v[160:163]
    ds_read_b64_tr_b16 a[254:255], v249 offset:38496
    v_mfma_f32_16x16x32_bf16 v[160:163], v[6:9], a[192:195], v[160:163]
    v_mfma_f32_16x16x32_bf16 v[200:203], v[6:9], a[196:199], v[200:203]
    v_mfma_f32_16x16x32_bf16 v[200:203], v[10:13], a[36:39], v[200:203]
    s_waitcnt lgkmcnt(4)
    v_mfma_f32_16x16x32_bf16 v[204:207], a[244:247], a[36:39], v[204:207]
    ds_read_b64_tr_b16 v[6:7], v249 offset:24648
    v_mfma_f32_16x16x32_bf16 v[204:207], a[240:243], a[196:199], v[204:207]
    ds_read_b64_tr_b16 v[8:9], v249 offset:26184
    v_mfma_f32_16x16x32_bf16 v[164:167], a[240:243], a[192:195], v[164:167]
    v_mfma_f32_16x16x32_bf16 v[164:167], a[244:247], a[32:35], v[164:167]
    v_mfma_f32_16x16x32_bf16 v[124:127], a[244:247], a[28:31], v[124:127]
    v_mfma_f32_16x16x32_bf16 v[124:127], a[240:243], a[188:191], v[124:127]
    ds_read_b64_tr_b16 v[10:11], v249 offset:36968
    v_mfma_f32_16x16x32_bf16 v[84:87], a[240:243], a[184:187], v[84:87]
    ds_read_b64_tr_b16 v[12:13], v249 offset:38504
    v_mfma_f32_16x16x32_bf16 v[84:87], a[244:247], a[24:27], v[84:87]
    v_mfma_f32_16x16x32_bf16 v[44:47], a[244:247], a[20:23], v[44:47]
    v_mfma_f32_16x16x32_bf16 v[44:47], a[240:243], a[180:183], v[44:47]
    s_waitcnt lgkmcnt(4)
    s_waitcnt vmcnt(12)
    s_barrier
    v_mfma_f32_16x16x32_bf16 v[48:51], a[248:251], a[180:183], v[48:51]
    ds_read_b64_tr_b16 a[240:241], v245 offset:49280
    v_mfma_f32_16x16x32_bf16 v[48:51], a[252:255], a[20:23], v[48:51]
    ds_read_b64_tr_b16 a[242:243], v245 offset:50816
    v_mfma_f32_16x16x32_bf16 v[88:91], a[252:255], a[24:27], v[88:91]
    v_mfma_f32_16x16x32_bf16 v[88:91], a[248:251], a[184:187], v[88:91]
    buffer_store_dword v14, v0, s[76:79], s84 offen sc1
    v_mfma_f32_16x16x32_bf16 v[128:131], a[248:251], a[188:191], v[128:131]
    v_mfma_f32_16x16x32_bf16 v[128:131], a[252:255], a[28:31], v[128:131]
    s_add_u32 m0, s31, 0
    ds_read_b64_tr_b16 a[244:245], v250 offset:0
    v_mfma_f32_16x16x32_bf16 v[168:171], a[252:255], a[32:35], v[168:171]
    s_add_u32 s3, s53, s56
    ds_read_b64_tr_b16 a[246:247], v250 offset:1536
    v_mfma_f32_16x16x32_bf16 v[168:171], a[248:251], a[192:195], v[168:171]
    s_mul_i32 s32, s3, 40960
    v_mfma_f32_16x16x32_bf16 v[208:211], a[248:251], a[196:199], v[208:211]
    buffer_load_dwordx4 v242, s[64:67], s32 offen lds
    v_mfma_f32_16x16x32_bf16 v[208:211], a[252:255], a[36:39], v[208:211]
    s_waitcnt lgkmcnt(4)
    v_mfma_f32_16x16x32_bf16 v[212:215], v[10:13], a[36:39], v[212:215]
    ds_read_b64_tr_b16 a[248:249], v245 offset:49288
    v_mfma_f32_16x16x32_bf16 v[212:215], v[6:9], a[196:199], v[212:215]
    ds_read_b64_tr_b16 a[250:251], v245 offset:50824
    v_mfma_f32_16x16x32_bf16 v[172:175], v[6:9], a[192:195], v[172:175]
    v_mfma_f32_16x16x32_bf16 v[172:175], v[10:13], a[32:35], v[172:175]
    buffer_load_dwordx4 v243, s[64:67], s32 offen offset:1024 lds
    v_mfma_f32_16x16x32_bf16 v[132:135], v[10:13], a[28:31], v[132:135]
    v_mfma_f32_16x16x32_bf16 v[132:135], v[6:9], a[188:191], v[132:135]
    ds_read_b64_tr_b16 a[252:253], v250 offset:8
    v_mfma_f32_16x16x32_bf16 v[92:95], v[6:9], a[184:187], v[92:95]
    ds_read_b64_tr_b16 a[254:255], v250 offset:1544
    v_mfma_f32_16x16x32_bf16 v[92:95], v[10:13], a[24:27], v[92:95]
    v_mfma_f32_16x16x32_bf16 v[52:55], v[10:13], a[20:23], v[52:55]
    buffer_load_dwordx4 v244, s[64:67], s32 offen offset:2048 lds
    v_mfma_f32_16x16x32_bf16 v[52:55], v[6:9], a[180:183], v[52:55]
    s_waitcnt lgkmcnt(4)
    v_mfma_f32_16x16x32_bf16 v[16:19], a[240:243], a[0:3], v[16:19]
    s_add_u32 m0, s31, 12320
    ds_read_b64_tr_b16 v[6:7], v246 offset:49280
    v_mfma_f32_16x16x32_bf16 v[16:19], a[244:247], a[40:43], v[16:19]
    s_add_u32 s3, s54, s56
    ds_read_b64_tr_b16 v[8:9], v246 offset:50816
    v_mfma_f32_16x16x32_bf16 v[56:59], a[244:247], a[44:47], v[56:59]
    s_mul_i32 s32, s3, 40960
    v_mfma_f32_16x16x32_bf16 v[56:59], a[240:243], a[4:7], v[56:59]
    buffer_load_dwordx4 v242, s[64:67], s32 offen lds
    v_mfma_f32_16x16x32_bf16 v[96:99], a[240:243], a[8:11], v[96:99]
    v_mfma_f32_16x16x32_bf16 v[96:99], a[244:247], a[48:51], v[96:99]
    ds_read_b64_tr_b16 v[10:11], v251 offset:0
    v_mfma_f32_16x16x32_bf16 v[136:139], a[244:247], a[52:55], v[136:139]
    ds_read_b64_tr_b16 v[12:13], v251 offset:1536
    v_mfma_f32_16x16x32_bf16 v[136:139], a[240:243], a[12:15], v[136:139]
    v_mfma_f32_16x16x32_bf16 v[176:179], a[240:243], a[16:19], v[176:179]
    buffer_load_dwordx4 v243, s[64:67], s32 offen offset:1024 lds
    v_mfma_f32_16x16x32_bf16 v[176:179], a[244:247], a[56:59], v[176:179]
    s_waitcnt lgkmcnt(4)
    v_mfma_f32_16x16x32_bf16 v[180:183], a[252:255], a[56:59], v[180:183]
    ds_read_b64_tr_b16 a[240:241], v246 offset:49288
    v_mfma_f32_16x16x32_bf16 v[180:183], a[248:251], a[16:19], v[180:183]
    ds_read_b64_tr_b16 a[242:243], v246 offset:50824
    v_mfma_f32_16x16x32_bf16 v[140:143], a[248:251], a[12:15], v[140:143]
    v_mfma_f32_16x16x32_bf16 v[140:143], a[252:255], a[52:55], v[140:143]
    buffer_load_dwordx4 v244, s[64:67], s32 offen offset:2048 lds
    v_mfma_f32_16x16x32_bf16 v[100:103], a[252:255], a[48:51], v[100:103]
    v_mfma_f32_16x16x32_bf16 v[100:103], a[248:251], a[8:11], v[100:103]
    ds_read_b64_tr_b16 a[244:245], v251 offset:8
    v_mfma_f32_16x16x32_bf16 v[60:63], a[248:251], a[4:7], v[60:63]
    ds_read_b64_tr_b16 a[246:247], v251 offset:1544
    v_mfma_f32_16x16x32_bf16 v[60:63], a[252:255], a[44:47], v[60:63]
    v_mfma_f32_16x16x32_bf16 v[20:23], a[252:255], a[40:43], v[20:23]
    v_mfma_f32_16x16x32_bf16 v[20:23], a[248:251], a[0:3], v[20:23]
    s_waitcnt lgkmcnt(4)
    v_mfma_f32_16x16x32_bf16 v[24:27], v[6:9], a[0:3], v[24:27]
    ds_read_b64_tr_b16 a[248:249], v247 offset:49280
    v_mfma_f32_16x16x32_bf16 v[24:27], v[10:13], a[40:43], v[24:27]
    ds_read_b64_tr_b16 a[250:251], v247 offset:50816
    v_mfma_f32_16x16x32_bf16 v[64:67], v[10:13], a[44:47], v[64:67]
    v_mfma_f32_16x16x32_bf16 v[64:67], v[6:9], a[4:7], v[64:67]
    v_mfma_f32_16x16x32_bf16 v[104:107], v[6:9], a[8:11], v[104:107]
    v_mfma_f32_16x16x32_bf16 v[104:107], v[10:13], a[48:51], v[104:107]
    ds_read_b64_tr_b16 a[252:253], v252 offset:0
    v_mfma_f32_16x16x32_bf16 v[144:147], v[10:13], a[52:55], v[144:147]
    ds_read_b64_tr_b16 a[254:255], v252 offset:1536
    v_mfma_f32_16x16x32_bf16 v[144:147], v[6:9], a[12:15], v[144:147]
    v_mfma_f32_16x16x32_bf16 v[184:187], v[6:9], a[16:19], v[184:187]
    v_mfma_f32_16x16x32_bf16 v[184:187], v[10:13], a[56:59], v[184:187]
    s_waitcnt lgkmcnt(4)
    v_mfma_f32_16x16x32_bf16 v[188:191], a[244:247], a[56:59], v[188:191]
    ds_read_b64_tr_b16 v[6:7], v247 offset:49288
    v_mfma_f32_16x16x32_bf16 v[188:191], a[240:243], a[16:19], v[188:191]
    ds_read_b64_tr_b16 v[8:9], v247 offset:50824
    v_mfma_f32_16x16x32_bf16 v[148:151], a[240:243], a[12:15], v[148:151]
    v_mfma_f32_16x16x32_bf16 v[148:151], a[244:247], a[52:55], v[148:151]
    v_mfma_f32_16x16x32_bf16 v[108:111], a[244:247], a[48:51], v[108:111]
    v_mfma_f32_16x16x32_bf16 v[108:111], a[240:243], a[8:11], v[108:111]
    ds_read_b64_tr_b16 v[10:11], v252 offset:8
    v_mfma_f32_16x16x32_bf16 v[68:71], a[240:243], a[4:7], v[68:71]
    ds_read_b64_tr_b16 v[12:13], v252 offset:1544
    v_mfma_f32_16x16x32_bf16 v[68:71], a[244:247], a[44:47], v[68:71]
    v_mfma_f32_16x16x32_bf16 v[28:31], a[244:247], a[40:43], v[28:31]
    v_mfma_f32_16x16x32_bf16 v[28:31], a[240:243], a[0:3], v[28:31]
    s_waitcnt lgkmcnt(4)
    v_mfma_f32_16x16x32_bf16 v[32:35], a[248:251], a[0:3], v[32:35]
    ds_read_b64_tr_b16 a[240:241], v248 offset:49280
    v_mfma_f32_16x16x32_bf16 v[32:35], a[252:255], a[40:43], v[32:35]
    ds_read_b64_tr_b16 a[242:243], v248 offset:50816
    v_mfma_f32_16x16x32_bf16 v[72:75], a[252:255], a[44:47], v[72:75]
    v_mfma_f32_16x16x32_bf16 v[72:75], a[248:251], a[4:7], v[72:75]
    v_mfma_f32_16x16x32_bf16 v[112:115], a[248:251], a[8:11], v[112:115]
    v_mfma_f32_16x16x32_bf16 v[112:115], a[252:255], a[48:51], v[112:115]
    ds_read_b64_tr_b16 a[244:245], v253 offset:0
    v_mfma_f32_16x16x32_bf16 v[152:155], a[252:255], a[52:55], v[152:155]
    ds_read_b64_tr_b16 a[246:247], v253 offset:1536
    v_mfma_f32_16x16x32_bf16 v[152:155], a[248:251], a[12:15], v[152:155]
    v_mfma_f32_16x16x32_bf16 v[192:195], a[248:251], a[16:19], v[192:195]
    v_mfma_f32_16x16x32_bf16 v[192:195], a[252:255], a[56:59], v[192:195]
    s_waitcnt lgkmcnt(4)
    v_mfma_f32_16x16x32_bf16 v[196:199], v[10:13], a[56:59], v[196:199]
    ds_read_b64_tr_b16 a[248:249], v248 offset:49288
    v_mfma_f32_16x16x32_bf16 v[196:199], v[6:9], a[16:19], v[196:199]
    ds_read_b64_tr_b16 a[250:251], v248 offset:50824
    v_mfma_f32_16x16x32_bf16 v[156:159], v[6:9], a[12:15], v[156:159]
    v_mfma_f32_16x16x32_bf16 v[156:159], v[10:13], a[52:55], v[156:159]
    v_mfma_f32_16x16x32_bf16 v[116:119], v[10:13], a[48:51], v[116:119]
    v_mfma_f32_16x16x32_bf16 v[116:119], v[6:9], a[8:11], v[116:119]
    ds_read_b64_tr_b16 a[252:253], v253 offset:8
    v_mfma_f32_16x16x32_bf16 v[76:79], v[6:9], a[4:7], v[76:79]
    ds_read_b64_tr_b16 a[254:255], v253 offset:1544
    v_mfma_f32_16x16x32_bf16 v[76:79], v[10:13], a[44:47], v[76:79]
    v_mfma_f32_16x16x32_bf16 v[36:39], v[10:13], a[40:43], v[36:39]
    v_mfma_f32_16x16x32_bf16 v[36:39], v[6:9], a[0:3], v[36:39]
    s_waitcnt lgkmcnt(4)
    v_mfma_f32_16x16x32_bf16 v[40:43], a[240:243], a[0:3], v[40:43]
    ds_read_b64_tr_b16 v[6:7], v249 offset:49280
    v_mfma_f32_16x16x32_bf16 v[40:43], a[244:247], a[40:43], v[40:43]
    ds_read_b64_tr_b16 v[8:9], v249 offset:50816
    v_mfma_f32_16x16x32_bf16 v[80:83], a[244:247], a[44:47], v[80:83]
    v_mfma_f32_16x16x32_bf16 v[80:83], a[240:243], a[4:7], v[80:83]
    v_mfma_f32_16x16x32_bf16 v[120:123], a[240:243], a[8:11], v[120:123]
    v_mfma_f32_16x16x32_bf16 v[120:123], a[244:247], a[48:51], v[120:123]
    ds_read_b64_tr_b16 v[10:11], v254 offset:0
    v_mfma_f32_16x16x32_bf16 v[160:163], a[244:247], a[52:55], v[160:163]
    ds_read_b64_tr_b16 v[12:13], v254 offset:1536
    v_mfma_f32_16x16x32_bf16 v[160:163], a[240:243], a[12:15], v[160:163]
    v_mfma_f32_16x16x32_bf16 v[200:203], a[240:243], a[16:19], v[200:203]
    v_mfma_f32_16x16x32_bf16 v[200:203], a[244:247], a[56:59], v[200:203]
    s_waitcnt lgkmcnt(4)
    v_mfma_f32_16x16x32_bf16 v[204:207], a[252:255], a[56:59], v[204:207]
    ds_read_b64_tr_b16 a[240:241], v249 offset:49288
    v_mfma_f32_16x16x32_bf16 v[204:207], a[248:251], a[16:19], v[204:207]
    ds_read_b64_tr_b16 a[242:243], v249 offset:50824
    v_mfma_f32_16x16x32_bf16 v[164:167], a[248:251], a[12:15], v[164:167]
    v_mfma_f32_16x16x32_bf16 v[164:167], a[252:255], a[52:55], v[164:167]
    v_mfma_f32_16x16x32_bf16 v[124:127], a[252:255], a[48:51], v[124:127]
    v_mfma_f32_16x16x32_bf16 v[124:127], a[248:251], a[8:11], v[124:127]
    ds_read_b64_tr_b16 a[244:245], v254 offset:8
    v_mfma_f32_16x16x32_bf16 v[84:87], a[248:251], a[4:7], v[84:87]
    ds_read_b64_tr_b16 a[246:247], v254 offset:1544
    v_mfma_f32_16x16x32_bf16 v[84:87], a[252:255], a[44:47], v[84:87]
    v_mfma_f32_16x16x32_bf16 v[44:47], a[252:255], a[40:43], v[44:47]
    v_mfma_f32_16x16x32_bf16 v[44:47], a[248:251], a[0:3], v[44:47]
    s_waitcnt lgkmcnt(4)
    s_waitcnt vmcnt(13)
    s_barrier
    v_mfma_f32_16x16x32_bf16 v[48:51], v[6:9], a[0:3], v[48:51]
    ds_read_b64_tr_b16 a[248:249], v250 offset:12320
    v_mfma_f32_16x16x32_bf16 v[48:51], v[10:13], a[40:43], v[48:51]
    ds_read_b64_tr_b16 a[250:251], v250 offset:13856
    v_mfma_f32_16x16x32_bf16 v[88:91], v[10:13], a[44:47], v[88:91]
    v_mfma_f32_16x16x32_bf16 v[88:91], v[6:9], a[4:7], v[88:91]
    buffer_load_dwordx4 v[216:219], v0, s[48:51], s82 offen sc1
    v_mfma_f32_16x16x32_bf16 v[128:131], v[6:9], a[8:11], v[128:131]
    v_mfma_f32_16x16x32_bf16 v[128:131], v[10:13], a[48:51], v[128:131]
    s_add_u32 m0, s31, 24640
    ds_read_b64_tr_b16 a[252:253], v250 offset:24640
    v_mfma_f32_16x16x32_bf16 v[168:171], v[10:13], a[52:55], v[168:171]
    s_add_u32 s3, s55, s56
    ds_read_b64_tr_b16 a[254:255], v250 offset:26176
    v_mfma_f32_16x16x32_bf16 v[168:171], v[6:9], a[12:15], v[168:171]
    s_mul_i32 s32, s3, 40960
    v_mfma_f32_16x16x32_bf16 v[208:211], v[6:9], a[16:19], v[208:211]
    buffer_load_dwordx4 v242, s[64:67], s32 offen lds
    v_mfma_f32_16x16x32_bf16 v[208:211], v[10:13], a[56:59], v[208:211]
    s_waitcnt lgkmcnt(4)
    v_mfma_f32_16x16x32_bf16 v[212:215], a[244:247], a[56:59], v[212:215]
    ds_read_b64_tr_b16 v[6:7], v250 offset:12328
    v_mfma_f32_16x16x32_bf16 v[212:215], a[240:243], a[16:19], v[212:215]
    ds_read_b64_tr_b16 v[8:9], v250 offset:13864
    v_mfma_f32_16x16x32_bf16 v[172:175], a[240:243], a[12:15], v[172:175]
    v_mfma_f32_16x16x32_bf16 v[172:175], a[244:247], a[52:55], v[172:175]
    buffer_load_dwordx4 v243, s[64:67], s32 offen offset:1024 lds
    v_mfma_f32_16x16x32_bf16 v[132:135], a[244:247], a[48:51], v[132:135]
    v_mfma_f32_16x16x32_bf16 v[132:135], a[240:243], a[8:11], v[132:135]
    ds_read_b64_tr_b16 v[10:11], v250 offset:24648
    v_mfma_f32_16x16x32_bf16 v[92:95], a[240:243], a[4:7], v[92:95]
    ds_read_b64_tr_b16 v[12:13], v250 offset:26184
    v_mfma_f32_16x16x32_bf16 v[92:95], a[244:247], a[44:47], v[92:95]
    v_mfma_f32_16x16x32_bf16 v[52:55], a[244:247], a[40:43], v[52:55]
    buffer_load_dwordx4 v244, s[64:67], s32 offen offset:2048 lds
    v_mfma_f32_16x16x32_bf16 v[52:55], a[240:243], a[0:3], v[52:55]
    s_waitcnt lgkmcnt(4)
    v_mfma_f32_16x16x32_bf16 v[16:19], a[248:251], a[80:83], v[16:19]
    s_add_u32 m0, s31, 36960
    ds_read_b64_tr_b16 a[240:241], v251 offset:12320
    v_mfma_f32_16x16x32_bf16 v[16:19], a[252:255], a[120:123], v[16:19]
    s_add_u32 s3, s53, s57
    ds_read_b64_tr_b16 a[242:243], v251 offset:13856
    v_mfma_f32_16x16x32_bf16 v[56:59], a[252:255], a[124:127], v[56:59]
    s_mul_i32 s32, s3, 40960
    v_mfma_f32_16x16x32_bf16 v[56:59], a[248:251], a[84:87], v[56:59]
    buffer_load_dwordx4 v242, s[64:67], s32 offen lds
    v_mfma_f32_16x16x32_bf16 v[96:99], a[248:251], a[88:91], v[96:99]
    v_mfma_f32_16x16x32_bf16 v[96:99], a[252:255], a[128:131], v[96:99]
    ds_read_b64_tr_b16 a[244:245], v251 offset:24640
    v_mfma_f32_16x16x32_bf16 v[136:139], a[252:255], a[132:135], v[136:139]
    ds_read_b64_tr_b16 a[246:247], v251 offset:26176
    v_mfma_f32_16x16x32_bf16 v[136:139], a[248:251], a[92:95], v[136:139]
    v_mfma_f32_16x16x32_bf16 v[176:179], a[248:251], a[96:99], v[176:179]
    buffer_load_dwordx4 v243, s[64:67], s32 offen offset:1024 lds
    v_mfma_f32_16x16x32_bf16 v[176:179], a[252:255], a[136:139], v[176:179]
    s_waitcnt lgkmcnt(4)
    v_mfma_f32_16x16x32_bf16 v[180:183], v[10:13], a[136:139], v[180:183]
    ds_read_b64_tr_b16 a[248:249], v251 offset:12328
    v_mfma_f32_16x16x32_bf16 v[180:183], v[6:9], a[96:99], v[180:183]
    ds_read_b64_tr_b16 a[250:251], v251 offset:13864
    v_mfma_f32_16x16x32_bf16 v[140:143], v[6:9], a[92:95], v[140:143]
    v_mfma_f32_16x16x32_bf16 v[140:143], v[10:13], a[132:135], v[140:143]
    buffer_load_dwordx4 v244, s[64:67], s32 offen offset:2048 lds
    v_mfma_f32_16x16x32_bf16 v[100:103], v[10:13], a[128:131], v[100:103]
    v_mfma_f32_16x16x32_bf16 v[100:103], v[6:9], a[88:91], v[100:103]
    ds_read_b64_tr_b16 a[252:253], v251 offset:24648
    v_mfma_f32_16x16x32_bf16 v[60:63], v[6:9], a[84:87], v[60:63]
    ds_read_b64_tr_b16 a[254:255], v251 offset:26184
    v_mfma_f32_16x16x32_bf16 v[60:63], v[10:13], a[124:127], v[60:63]
    v_mfma_f32_16x16x32_bf16 v[20:23], v[10:13], a[120:123], v[20:23]
    v_mfma_f32_16x16x32_bf16 v[20:23], v[6:9], a[80:83], v[20:23]
    s_waitcnt lgkmcnt(4)
    v_mfma_f32_16x16x32_bf16 v[24:27], a[240:243], a[80:83], v[24:27]
    ds_read_b64_tr_b16 v[6:7], v252 offset:12320
    v_mfma_f32_16x16x32_bf16 v[24:27], a[244:247], a[120:123], v[24:27]
    ds_read_b64_tr_b16 v[8:9], v252 offset:13856
    v_mfma_f32_16x16x32_bf16 v[64:67], a[244:247], a[124:127], v[64:67]
    v_mfma_f32_16x16x32_bf16 v[64:67], a[240:243], a[84:87], v[64:67]
    v_mfma_f32_16x16x32_bf16 v[104:107], a[240:243], a[88:91], v[104:107]
    v_mfma_f32_16x16x32_bf16 v[104:107], a[244:247], a[128:131], v[104:107]
    ds_read_b64_tr_b16 v[10:11], v252 offset:24640
    v_mfma_f32_16x16x32_bf16 v[144:147], a[244:247], a[132:135], v[144:147]
    ds_read_b64_tr_b16 v[12:13], v252 offset:26176
    v_mfma_f32_16x16x32_bf16 v[144:147], a[240:243], a[92:95], v[144:147]
    v_mfma_f32_16x16x32_bf16 v[184:187], a[240:243], a[96:99], v[184:187]
    v_mfma_f32_16x16x32_bf16 v[184:187], a[244:247], a[136:139], v[184:187]
    s_waitcnt lgkmcnt(4)
    v_mfma_f32_16x16x32_bf16 v[188:191], a[252:255], a[136:139], v[188:191]
    ds_read_b64_tr_b16 a[240:241], v252 offset:12328
    v_mfma_f32_16x16x32_bf16 v[188:191], a[248:251], a[96:99], v[188:191]
    ds_read_b64_tr_b16 a[242:243], v252 offset:13864
    v_mfma_f32_16x16x32_bf16 v[148:151], a[248:251], a[92:95], v[148:151]
    v_mfma_f32_16x16x32_bf16 v[148:151], a[252:255], a[132:135], v[148:151]
    v_mfma_f32_16x16x32_bf16 v[108:111], a[252:255], a[128:131], v[108:111]
    v_mfma_f32_16x16x32_bf16 v[108:111], a[248:251], a[88:91], v[108:111]
    ds_read_b64_tr_b16 a[244:245], v252 offset:24648
    v_mfma_f32_16x16x32_bf16 v[68:71], a[248:251], a[84:87], v[68:71]
    ds_read_b64_tr_b16 a[246:247], v252 offset:26184
    v_mfma_f32_16x16x32_bf16 v[68:71], a[252:255], a[124:127], v[68:71]
    v_mfma_f32_16x16x32_bf16 v[28:31], a[252:255], a[120:123], v[28:31]
    s_waitcnt vmcnt(6)
    v_and_b32 v216, v216, v217
    v_mfma_f32_16x16x32_bf16 v[28:31], a[248:251], a[80:83], v[28:31]
    s_waitcnt lgkmcnt(4)
    v_and_b32 v218, v218, v219
    v_mfma_f32_16x16x32_bf16 v[32:35], v[6:9], a[80:83], v[32:35]
    ds_read_b64_tr_b16 a[248:249], v253 offset:12320
    v_and_b32 v216, v216, v218
    v_mfma_f32_16x16x32_bf16 v[32:35], v[10:13], a[120:123], v[32:35]
    ds_read_b64_tr_b16 a[250:251], v253 offset:13856
    v_readfirstlane_b32 s33, v216
    v_mfma_f32_16x16x32_bf16 v[72:75], v[10:13], a[124:127], v[72:75]
    v_mfma_f32_16x16x32_bf16 v[72:75], v[6:9], a[84:87], v[72:75]
    v_mfma_f32_16x16x32_bf16 v[112:115], v[6:9], a[88:91], v[112:115]
    v_mfma_f32_16x16x32_bf16 v[112:115], v[10:13], a[128:131], v[112:115]
    ds_read_b64_tr_b16 a[252:253], v253 offset:24640
    v_mfma_f32_16x16x32_bf16 v[152:155], v[10:13], a[132:135], v[152:155]
    ds_read_b64_tr_b16 a[254:255], v253 offset:26176
    v_mfma_f32_16x16x32_bf16 v[152:155], v[6:9], a[92:95], v[152:155]
    v_mfma_f32_16x16x32_bf16 v[192:195], v[6:9], a[96:99], v[192:195]
    v_mfma_f32_16x16x32_bf16 v[192:195], v[10:13], a[136:139], v[192:195]
    s_waitcnt lgkmcnt(4)
    s_cmp_ge_u32 s33, 1
    s_cbranch_scc0 L_w2
L_k1:
    v_mfma_f32_16x16x32_bf16 v[196:199], a[244:247], a[136:139], v[196:199]
    s_add_u32 s3, s53, s56
    ds_read_b64_tr_b16 v[6:7], v253 offset:12328
    v_mfma_f32_16x16x32_bf16 v[196:199], a[240:243], a[96:99], v[196:199]
    s_mul_i32 s35, s3, 10240
    ds_read_b64_tr_b16 v[8:9], v253 offset:13864
    v_mfma_f32_16x16x32_bf16 v[156:159], a[240:243], a[92:95], v[156:159]
    s_add_u32 s36, s35, 4096
    v_mfma_f32_16x16x32_bf16 v[156:159], a[244:247], a[132:135], v[156:159]
    buffer_load_dwordx4 a[60:63], v0, s[44:47], s35 offen sc1
    v_mfma_f32_16x16x32_bf16 v[116:119], a[244:247], a[128:131], v[116:119]
    v_mfma_f32_16x16x32_bf16 v[116:119], a[240:243], a[88:91], v[116:119]
    ds_read_b64_tr_b16 v[10:11], v253 offset:24648
    v_mfma_f32_16x16x32_bf16 v[76:79], a[240:243], a[84:87], v[76:79]
    ds_read_b64_tr_b16 v[12:13], v253 offset:26184
    v_mfma_f32_16x16x32_bf16 v[76:79], a[244:247], a[124:127], v[76:79]
    v_mfma_f32_16x16x32_bf16 v[36:39], a[244:247], a[120:123], v[36:39]
    buffer_load_dwordx4 a[64:67], v0, s[44:47], s35 offen offset:1024 sc1
    v_mfma_f32_16x16x32_bf16 v[36:39], a[240:243], a[80:83], v[36:39]
    s_waitcnt lgkmcnt(4)
    v_mfma_f32_16x16x32_bf16 v[40:43], a[248:251], a[80:83], v[40:43]
    ds_read_b64_tr_b16 a[240:241], v254 offset:12320
    v_mfma_f32_16x16x32_bf16 v[40:43], a[252:255], a[120:123], v[40:43]
    ds_read_b64_tr_b16 a[242:243], v254 offset:13856
    v_mfma_f32_16x16x32_bf16 v[80:83], a[252:255], a[124:127], v[80:83]
    v_mfma_f32_16x16x32_bf16 v[80:83], a[248:251], a[84:87], v[80:83]
    buffer_load_dwordx4 a[68:71], v0, s[44:47], s35 offen offset:2048 sc1
    v_mfma_f32_16x16x32_bf16 v[120:123], a[248:251], a[88:91], v[120:123]
    v_mfma_f32_16x16x32_bf16 v[120:123], a[252:255], a[128:131], v[120:123]
    ds_read_b64_tr_b16 a[244:245], v254 offset:24640
    v_mfma_f32_16x16x32_bf16 v[160:163], a[252:255], a[132:135], v[160:163]
    ds_read_b64_tr_b16 a[246:247], v254 offset:26176
    v_mfma_f32_16x16x32_bf16 v[160:163], a[248:251], a[92:95], v[160:163]
    v_mfma_f32_16x16x32_bf16 v[200:203], a[248:251], a[96:99], v[200:203]
    buffer_load_dwordx4 a[72:75], v0, s[44:47], s35 offen offset:3072 sc1
    v_mfma_f32_16x16x32_bf16 v[200:203], a[252:255], a[136:139], v[200:203]
    s_waitcnt lgkmcnt(4)
    v_mfma_f32_16x16x32_bf16 v[204:207], v[10:13], a[136:139], v[204:207]
    ds_read_b64_tr_b16 a[248:249], v254 offset:12328
    v_mfma_f32_16x16x32_bf16 v[204:207], v[6:9], a[96:99], v[204:207]
    ds_read_b64_tr_b16 a[250:251], v254 offset:13864
    v_mfma_f32_16x16x32_bf16 v[164:167], v[6:9], a[92:95], v[164:167]
    v_mfma_f32_16x16x32_bf16 v[164:167], v[10:13], a[132:135], v[164:167]
    buffer_load_dwordx4 a[76:79], v0, s[44:47], s36 offen sc1
    v_mfma_f32_16x16x32_bf16 v[124:127], v[10:13], a[128:131], v[124:127]
    v_mfma_f32_16x16x32_bf16 v[124:127], v[6:9], a[88:91], v[124:127]
    s_add_u32 s3, s54, s56
    ds_read_b64_tr_b16 a[252:253], v254 offset:24648
    v_mfma_f32_16x16x32_bf16 v[84:87], v[6:9], a[84:87], v[84:87]
    s_mul_i32 s35, s3, 10240
    ds_read_b64_tr_b16 a[254:255], v254 offset:26184
    v_mfma_f32_16x16x32_bf16 v[84:87], v[10:13], a[124:127], v[84:87]
    s_add_u32 s36, s35, 4096
    v_mfma_f32_16x16x32_bf16 v[44:47], v[10:13], a[120:123], v[44:47]
    buffer_load_dwordx4 a[100:103], v0, s[44:47], s35 offen sc1
    v_mfma_f32_16x16x32_bf16 v[44:47], v[6:9], a[80:83], v[44:47]
    s_waitcnt lgkmcnt(4)
    s_waitcnt vmcnt(20)
    s_barrier
    v_mfma_f32_16x16x32_bf16 v[48:51], a[240:243], a[80:83], v[48:51]
    ds_read_b64_tr_b16 v[6:7], v250 offset:36960
    v_mfma_f32_16x16x32_bf16 v[48:51], a[244:247], a[120:123], v[48:51]
    ds_read_b64_tr_b16 v[8:9], v250 offset:38496
    v_mfma_f32_16x16x32_bf16 v[88:91], a[244:247], a[124:127], v[88:91]
    v_mfma_f32_16x16x32_bf16 v[88:91], a[240:243], a[84:87], v[88:91]
    buffer_load_dwordx4 a[104:107], v0, s[44:47], s35 offen offset:1024 sc1
    v_mfma_f32_16x16x32_bf16 v[128:131], a[240:243], a[88:91], v[128:131]
    v_mfma_f32_16x16x32_bf16 v[128:131], a[244:247], a[128:131], v[128:131]
    ds_read_b64_tr_b16 v[10:11], v250 offset:49280
    v_mfma_f32_16x16x32_bf16 v[168:171], a[244:247], a[132:135], v[168:171]
    ds_read_b64_tr_b16 v[12:13], v250 offset:50816
    v_mfma_f32_16x16x32_bf16 v[168:171], a[240:243], a[92:95], v[168:171]
    v_mfma_f32_16x16x32_bf16 v[208:211], a[240:243], a[96:99], v[208:211]
    buffer_load_dwordx4 a[108:111], v0, s[44:47], s35 offen offset:2048 sc1
    v_mfma_f32_16x16x32_bf16 v[208:211], a[244:247], a[136:139], v[208:211]
    s_waitcnt lgkmcnt(4)
    v_mfma_f32_16x16x32_bf16 v[212:215], a[252:255], a[136:139], v[212:215]
    ds_read_b64_tr_b16 a[240:241], v250 offset:36968
    v_mfma_f32_16x16x32_bf16 v[212:215], a[248:251], a[96:99], v[212:215]
    ds_read_b64_tr_b16 a[242:243], v250 offset:38504
    v_mfma_f32_16x16x32_bf16 v[172:175], a[248:251], a[92:95], v[172:175]
    v_mfma_f32_16x16x32_bf16 v[172:175], a[252:255], a[132:135], v[172:175]
    buffer_load_dwordx4 a[112:115], v0, s[44:47], s35 offen offset:3072 sc1
    v_mfma_f32_16x16x32_bf16 v[132:135], a[252:255], a[128:131], v[132:135]
    v_mfma_f32_16x16x32_bf16 v[132:135], a[248:251], a[88:91], v[132:135]
    ds_read_b64_tr_b16 a[244:245], v250 offset:49288
    v_mfma_f32_16x16x32_bf16 v[92:95], a[248:251], a[84:87], v[92:95]
    ds_read_b64_tr_b16 a[246:247], v250 offset:50824
    v_mfma_f32_16x16x32_bf16 v[92:95], a[252:255], a[124:127], v[92:95]
    v_mfma_f32_16x16x32_bf16 v[52:55], a[252:255], a[120:123], v[52:55]
    buffer_load_dwordx4 a[116:119], v0, s[44:47], s36 offen sc1
    v_mfma_f32_16x16x32_bf16 v[52:55], a[248:251], a[80:83], v[52:55]
    s_waitcnt lgkmcnt(4)
    v_mfma_f32_16x16x32_bf16 v[16:19], v[6:9], a[160:163], v[16:19]
    s_add_u32 s3, s55, s56
    ds_read_b64_tr_b16 a[248:249], v251 offset:36960
    v_mfma_f32_16x16x32_bf16 v[16:19], v[10:13], a[200:203], v[16:19]
    s_mul_i32 s35, s3, 10240
    ds_read_b64_tr_b16 a[250:251], v251 offset:38496
    v_mfma_f32_16x16x32_bf16 v[56:59], v[10:13], a[204:207], v[56:59]
    s_add_u32 s36, s35, 4096
    v_mfma_f32_16x16x32_bf16 v[56:59], v[6:9], a[164:167], v[56:59]
    buffer_load_dwordx4 a[140:143], v0, s[44:47], s35 offen sc1
    v_mfma_f32_16x16x32_bf16 v[96:99], v[6:9], a[168:171], v[96:99]
    v_mfma_f32_16x16x32_bf16 v[96:99], v[10:13], a[208:211], v[96:99]
    ds_read_b64_tr_b16 a[252:253], v251 offset:49280
    v_mfma_f32_16x16x32_bf16 v[136:139], v[10:13], a[212:215], v[136:139]
    ds_read_b64_tr_b16 a[254:255], v251 offset:50816
    v_mfma_f32_16x16x32_bf16 v[136:139], v[6:9], a[172:175], v[136:139]
    v_mfma_f32_16x16x32_bf16 v[176:179], v[6:9], a[176:179], v[176:179]
    buffer_load_dwordx4 a[144:147], v0, s[44:47], s35 offen offset:1024 sc1
    v_mfma_f32_16x16x32_bf16 v[176:179], v[10:13], a[216:219], v[176:179]
    s_waitcnt lgkmcnt(4)
    v_mfma_f32_16x16x32_bf16 v[180:183], a[244:247], a[216:219], v[180:183]
    ds_read_b64_tr_b16 v[6:7], v251 offset:36968
    v_mfma_f32_16x16x32_bf16 v[180:183], a[240:243], a[176:179], v[180:183]
    ds_read_b64_tr_b16 v[8:9], v251 offset:38504
    v_mfma_f32_16x16x32_bf16 v[140:143], a[240:243], a[172:175], v[140:143]
    v_mfma_f32_16x16x32_bf16 v[140:143], a[244:247], a[212:215], v[140:143]
    buffer_load_dwordx4 a[148:151], v0, s[44:47], s35 offen offset:2048 sc1
    v_mfma_f32_16x16x32_bf16 v[100:103], a[244:247], a[208:211], v[100:103]
    v_mfma_f32_16x16x32_bf16 v[100:103], a[240:243], a[168:171], v[100:103]
    ds_read_b64_tr_b16 v[10:11], v251 offset:49288
    v_mfma_f32_16x16x32_bf16 v[60:63], a[240:243], a[164:167], v[60:63]
    ds_read_b64_tr_b16 v[12:13], v251 offset:50824
    v_mfma_f32_16x16x32_bf16 v[60:63], a[244:247], a[204:207], v[60:63]
    v_mfma_f32_16x16x32_bf16 v[20:23], a[244:247], a[200:203], v[20:23]
    buffer_load_dwordx4 a[152:155], v0, s[44:47], s35 offen offset:3072 sc1
    v_mfma_f32_16x16x32_bf16 v[20:23], a[240:243], a[160:163], v[20:23]
    s_waitcnt lgkmcnt(4)
    v_mfma_f32_16x16x32_bf16 v[24:27], a[248:251], a[160:163], v[24:27]
    ds_read_b64_tr_b16 a[240:241], v252 offset:36960
    v_mfma_f32_16x16x32_bf16 v[24:27], a[252:255], a[200:203], v[24:27]
    ds_read_b64_tr_b16 a[242:243], v252 offset:38496
    v_mfma_f32_16x16x32_bf16 v[64:67], a[252:255], a[204:207], v[64:67]
    v_mfma_f32_16x16x32_bf16 v[64:67], a[248:251], a[164:167], v[64:67]
    buffer_load_dwordx4 a[156:159], v0, s[44:47], s36 offen sc1
    v_mfma_f32_16x16x32_bf16 v[104:107], a[248:251], a[168:171], v[104:107]
    v_mfma_f32_16x16x32_bf16 v[104:107], a[252:255], a[208:211], v[104:107]
    s_add_u32 s3, s53, s57
    ds_read_b64_tr_b16 a[244:245], v252 offset:49280
    v_mfma_f32_16x16x32_bf16 v[144:147], a[252:255], a[212:215], v[144:147]
    s_mul_i32 s35, s3, 10240
    ds_read_b64_tr_b16 a[246:247], v252 offset:50816
    v_mfma_f32_16x16x32_bf16 v[144:147], a[248:251], a[172:175], v[144:147]
    s_add_u32 s36, s35, 4096
    v_mfma_f32_16x16x32_bf16 v[184:187], a[248:251], a[176:179], v[184:187]
    buffer_load_dwordx4 a[220:223], v0, s[44:47], s35 offen sc1
    v_mfma_f32_16x16x32_bf16 v[184:187], a[252:255], a[216:219], v[184:187]
    s_waitcnt lgkmcnt(4)
    v_mfma_f32_16x16x32_bf16 v[188:191], v[10:13], a[216:219], v[188:191]
    ds_read_b64_tr_b16 a[248:249], v252 offset:36968
    v_mfma_f32_16x16x32_bf16 v[188:191], v[6:9], a[176:179], v[188:191]
    ds_read_b64_tr_b16 a[250:251], v252 offset:38504
    v_mfma_f32_16x16x32_bf16 v[148:151], v[6:9], a[172:175], v[148:151]
    v_mfma_f32_16x16x32_bf16 v[148:151], v[10:13], a[212:215], v[148:151]
    buffer_load_dwordx4 a[224:227], v0, s[44:47], s35 offen offset:1024 sc1
    v_mfma_f32_16x16x32_bf16 v[108:111], v[10:13], a[208:211], v[108:111]
    v_mfma_f32_16x16x32_bf16 v[108:111], v[6:9], a[168:171], v[108:111]
    ds_read_b64_tr_b16 a[252:253], v252 offset:49288
    v_mfma_f32_16x16x32_bf16 v[68:71], v[6:9], a[164:167], v[68:71]
    ds_read_b64_tr_b16 a[254:255], v252 offset:50824
    v_mfma_f32_16x16x32_bf16 v[68:71], v[10:13], a[204:207], v[68:71]
    v_mfma_f32_16x16x32_bf16 v[28:31], v[10:13], a[200:203], v[28:31]
    buffer_load_dwordx4 a[228:231], v0, s[44:47], s35 offen offset:2048 sc1
    v_mfma_f32_16x16x32_bf16 v[28:31], v[6:9], a[160:163], v[28:31]
    s_waitcnt lgkmcnt(4)
    v_mfma_f32_16x16x32_bf16 v[32:35], a[240:243], a[160:163], v[32:35]
    ds_read_b64_tr_b16 v[6:7], v253 offset:36960
    v_mfma_f32_16x16x32_bf16 v[32:35], a[244:247], a[200:203], v[32:35]
    ds_read_b64_tr_b16 v[8:9], v253 offset:38496
    v_mfma_f32_16x16x32_bf16 v[72:75], a[244:247], a[204:207], v[72:75]
    v_mfma_f32_16x16x32_bf16 v[72:75], a[240:243], a[164:167], v[72:75]
    buffer_load_dwordx4 a[232:235], v0, s[44:47], s35 offen offset:3072 sc1
    v_mfma_f32_16x16x32_bf16 v[112:115], a[240:243], a[168:171], v[112:115]
    v_mfma_f32_16x16x32_bf16 v[112:115], a[244:247], a[208:211], v[112:115]
    ds_read_b64_tr_b16 v[10:11], v253 offset:49280
    v_mfma_f32_16x16x32_bf16 v[152:155], a[244:247], a[212:215], v[152:155]
    ds_read_b64_tr_b16 v[12:13], v253 offset:50816
    v_mfma_f32_16x16x32_bf16 v[152:155], a[240:243], a[172:175], v[152:155]
    v_mfma_f32_16x16x32_bf16 v[192:195], a[240:243], a[176:179], v[192:195]
    buffer_load_dwordx4 a[236:239], v0, s[44:47], s36 offen sc1
    v_mfma_f32_16x16x32_bf16 v[192:195], a[244:247], a[216:219], v[192:195]
    s_waitcnt lgkmcnt(4)
    v_mfma_f32_16x16x32_bf16 v[196:199], a[252:255], a[216:219], v[196:199]
    s_add_u32 m0, s31, 49280
    ds_read_b64_tr_b16 a[240:241], v253 offset:36968
    v_mfma_f32_16x16x32_bf16 v[196:199], a[248:251], a[176:179], v[196:199]
    s_add_u32 s3, s54, s57
    ds_read_b64_tr_b16 a[242:243], v253 offset:38504
    v_mfma_f32_16x16x32_bf16 v[156:159], a[248:251], a[172:175], v[156:159]
    s_mul_i32 s32, s3, 40960
    v_mfma_f32_16x16x32_bf16 v[156:159], a[252:255], a[212:215], v[156:159]
    buffer_load_dwordx4 v242, s[64:67], s32 offen lds
    v_mfma_f32_16x16x32_bf16 v[116:119], a[252:255], a[208:211], v[116:119]
    v_mfma_f32_16x16x32_bf16 v[116:119], a[248:251], a[168:171], v[116:119]
    ds_read_b64_tr_b16 a[244:245], v253 offset:49288
    v_mfma_f32_16x16x32_bf16 v[76:79], a[248:251], a[164:167], v[76:79]
    ds_read_b64_tr_b16 a[246:247], v253 offset:50824
    v_mfma_f32_16x16x32_bf16 v[76:79], a[252:255], a[204:207], v[76:79]
    v_mfma_f32_16x16x32_bf16 v[36:39], a[252:255], a[200:203], v[36:39]
    buffer_load_dwordx4 v243, s[64:67], s32 offen offset:1024 lds
    v_mfma_f32_16x16x32_bf16 v[36:39], a[248:251], a[160:163], v[36:39]
    s_waitcnt lgkmcnt(4)
    v_mfma_f32_16x16x32_bf16 v[40:43], v[6:9], a[160:163], v[40:43]
    ds_read_b64_tr_b16 a[248:249], v254 offset:36960
    v_mfma_f32_16x16x32_bf16 v[40:43], v[10:13], a[200:203], v[40:43]
    ds_read_b64_tr_b16 a[250:251], v254 offset:38496
    v_mfma_f32_16x16x32_bf16 v[80:83], v[10:13], a[204:207], v[80:83]
    v_mfma_f32_16x16x32_bf16 v[80:83], v[6:9], a[164:167], v[80:83]
    buffer_load_dwordx4 v244, s[64:67], s32 offen offset:2048 lds
    v_mfma_f32_16x16x32_bf16 v[120:123], v[6:9], a[168:171], v[120:123]
    v_mfma_f32_16x16x32_bf16 v[120:123], v[10:13], a[208:211], v[120:123]
    s_add_u32 s3, s54, s57
    ds_read_b64_tr_b16 a[252:253], v254 offset:49280
    v_mfma_f32_16x16x32_bf16 v[160:163], v[10:13], a[212:215], v[160:163]
    s_mul_i32 s35, s3, 10240
    ds_read_b64_tr_b16 a[254:255], v254 offset:50816
    v_mfma_f32_16x16x32_bf16 v[160:163], v[6:9], a[172:175], v[160:163]
    s_add_u32 s36, s35, 4096
    v_mfma_f32_16x16x32_bf16 v[200:203], v[6:9], a[176:179], v[200:203]
    buffer_load_dwordx4 a[20:23], v0, s[44:47], s35 offen sc1
    v_mfma_f32_16x16x32_bf16 v[200:203], v[10:13], a[216:219], v[200:203]
    s_waitcnt lgkmcnt(4)
    v_mfma_f32_16x16x32_bf16 v[204:207], a[244:247], a[216:219], v[204:207]
    ds_read_b64_tr_b16 v[6:7], v254 offset:36968
    v_mfma_f32_16x16x32_bf16 v[204:207], a[240:243], a[176:179], v[204:207]
    ds_read_b64_tr_b16 v[8:9], v254 offset:38504
    v_mfma_f32_16x16x32_bf16 v[164:167], a[240:243], a[172:175], v[164:167]
    v_mfma_f32_16x16x32_bf16 v[164:167], a[244:247], a[212:215], v[164:167]
    buffer_load_dwordx4 a[24:27], v0, s[44:47], s35 offen offset:1024 sc1
    v_mfma_f32_16x16x32_bf16 v[124:127], a[244:247], a[208:211], v[124:127]
    v_mfma_f32_16x16x32_bf16 v[124:127], a[240:243], a[168:171], v[124:127]
    ds_read_b64_tr_b16 v[10:11], v254 offset:49288
    v_mfma_f32_16x16x32_bf16 v[84:87], a[240:243], a[164:167], v[84:87]
    ds_read_b64_tr_b16 v[12:13], v254 offset:50824
    v_mfma_f32_16x16x32_bf16 v[84:87], a[244:247], a[204:207], v[84:87]
    v_mfma_f32_16x16x32_bf16 v[44:47], a[244:247], a[200:203], v[44:47]
    buffer_load_dwordx4 a[28:31], v0, s[44:47], s35 offen offset:2048 sc1
    v_mfma_f32_16x16x32_bf16 v[44:47], a[240:243], a[160:163], v[44:47]
    s_waitcnt lgkmcnt(4)
    s_waitcnt vmcnt(33)
    s_barrier
    v_mfma_f32_16x16x32_bf16 v[48:51], a[248:251], a[160:163], v[48:51]
    ds_read_b64_tr_b16 a[240:241], v245 offset:0
    v_mfma_f32_16x16x32_bf16 v[48:51], a[252:255], a[200:203], v[48:51]
    ds_read_b64_tr_b16 a[242:243], v245 offset:1536
    v_mfma_f32_16x16x32_bf16 v[88:91], a[252:255], a[204:207], v[88:91]
    v_mfma_f32_16x16x32_bf16 v[88:91], a[248:251], a[164:167], v[88:91]
    buffer_load_dwordx4 a[32:35], v0, s[44:47], s35 offen offset:3072 sc1
    v_mfma_f32_16x16x32_bf16 v[128:131], a[248:251], a[168:171], v[128:131]
    v_mfma_f32_16x16x32_bf16 v[128:131], a[252:255], a[208:211], v[128:131]
    ds_read_b64_tr_b16 a[244:245], v245 offset:12320
    v_mfma_f32_16x16x32_bf16 v[168:171], a[252:255], a[212:215], v[168:171]
    ds_read_b64_tr_b16 a[246:247], v245 offset:13856
    v_mfma_f32_16x16x32_bf16 v[168:171], a[248:251], a[172:175], v[168:171]
    v_mfma_f32_16x16x32_bf16 v[208:211], a[248:251], a[176:179], v[208:211]
    buffer_load_dwordx4 a[36:39], v0, s[44:47], s36 offen sc1
    v_mfma_f32_16x16x32_bf16 v[208:211], a[252:255], a[216:219], v[208:211]
    s_waitcnt lgkmcnt(4)
    v_mfma_f32_16x16x32_bf16 v[212:215], v[10:13], a[216:219], v[212:215]
    s_add_u32 m0, s31, 61600
    ds_read_b64_tr_b16 a[248:249], v245 offset:8
    v_mfma_f32_16x16x32_bf16 v[212:215], v[6:9], a[176:179], v[212:215]
    s_add_u32 s3, s55, s57
    ds_read_b64_tr_b16 a[250:251], v245 offset:1544
    v_mfma_f32_16x16x32_bf16 v[172:175], v[6:9], a[172:175], v[172:175]
    s_mul_i32 s32, s3, 40960
    v_mfma_f32_16x16x32_bf16 v[172:175], v[10:13], a[212:215], v[172:175]
    buffer_load_dwordx4 v242, s[64:67], s32 offen lds
    v_mfma_f32_16x16x32_bf16 v[132:135], v[10:13], a[208:211], v[132:135]
    v_mfma_f32_16x16x32_bf16 v[132:135], v[6:9], a[168:171], v[132:135]
    ds_read_b64_tr_b16 a[252:253], v245 offset:12328
    v_mfma_f32_16x16x32_bf16 v[92:95], v[6:9], a[164:167], v[92:95]
    ds_read_b64_tr_b16 a[254:255], v245 offset:13864
    v_mfma_f32_16x16x32_bf16 v[92:95], v[10:13], a[204:207], v[92:95]
    v_mfma_f32_16x16x32_bf16 v[52:55], v[10:13], a[200:203], v[52:55]
    buffer_load_dwordx4 v243, s[64:67], s32 offen offset:1024 lds
    v_mfma_f32_16x16x32_bf16 v[52:55], v[6:9], a[160:163], v[52:55]
    s_waitcnt lgkmcnt(4)
    s_waitcnt vmcnt(20)
    v_mfma_f32_16x16x32_bf16 v[16:19], a[240:243], a[60:63], v[16:19]
    ds_read_b64_tr_b16 v[6:7], v246 offset:0
    v_mfma_f32_16x16x32_bf16 v[16:19], a[244:247], a[100:103], v[16:19]
    ds_read_b64_tr_b16 v[8:9], v246 offset:1536
    v_mfma_f32_16x16x32_bf16 v[56:59], a[244:247], a[104:107], v[56:59]
    v_mfma_f32_16x16x32_bf16 v[56:59], a[240:243], a[64:67], v[56:59]
    buffer_load_dwordx4 v244, s[64:67], s32 offen offset:2048 lds
    v_mfma_f32_16x16x32_bf16 v[96:99], a[240:243], a[68:71], v[96:99]
    v_mfma_f32_16x16x32_bf16 v[96:99], a[244:247], a[108:111], v[96:99]
    s_add_u32 s3, s55, s57
    ds_read_b64_tr_b16 v[10:11], v246 offset:12320
    v_mfma_f32_16x16x32_bf16 v[136:139], a[244:247], a[112:115], v[136:139]
    s_mul_i32 s35, s3, 10240
    ds_read_b64_tr_b16 v[12:13], v246 offset:13856
    v_mfma_f32_16x16x32_bf16 v[136:139], a[240:243], a[72:75], v[136:139]
    s_add_u32 s36, s35, 4096
    v_mfma_f32_16x16x32_bf16 v[176:179], a[240:243], a[76:79], v[176:179]
    buffer_load_dwordx4 a[180:183], v0, s[44:47], s35 offen sc1
    v_mfma_f32_16x16x32_bf16 v[176:179], a[244:247], a[116:119], v[176:179]
    s_waitcnt lgkmcnt(4)
    v_mfma_f32_16x16x32_bf16 v[180:183], a[252:255], a[116:119], v[180:183]
    ds_read_b64_tr_b16 a[240:241], v246 offset:8
    v_mfma_f32_16x16x32_bf16 v[180:183], a[248:251], a[76:79], v[180:183]
    ds_read_b64_tr_b16 a[242:243], v246 offset:1544
    v_mfma_f32_16x16x32_bf16 v[140:143], a[248:251], a[72:75], v[140:143]
    v_mfma_f32_16x16x32_bf16 v[140:143], a[252:255], a[112:115], v[140:143]
    buffer_load_dwordx4 a[184:187], v0, s[44:47], s35 offen offset:1024 sc1
    v_mfma_f32_16x16x32_bf16 v[100:103], a[252:255], a[108:111], v[100:103]
    v_mfma_f32_16x16x32_bf16 v[100:103], a[248:251], a[68:71], v[100:103]
    ds_read_b64_tr_b16 a[244:245], v246 offset:12328
    v_mfma_f32_16x16x32_bf16 v[60:63], a[248:251], a[64:67], v[60:63]
    ds_read_b64_tr_b16 a[246:247], v246 offset:13864
    v_mfma_f32_16x16x32_bf16 v[60:63], a[252:255], a[104:107], v[60:63]
    v_mfma_f32_16x16x32_bf16 v[20:23], a[252:255], a[100:103], v[20:23]
    buffer_load_dwordx4 a[188:191], v0, s[44:47], s35 offen offset:2048 sc1
    v_mfma_f32_16x16x32_bf16 v[20:23], a[248:251], a[60:63], v[20:23]
    s_waitcnt lgkmcnt(4)
    v_mfma_f32_16x16x32_bf16 v[24:27], v[6:9], a[60:63], v[24:27]
    ds_read_b64_tr_b16 a[248:249], v247 offset:0
    v_mfma_f32_16x16x32_bf16 v[24:27], v[10:13], a[100:103], v[24:27]
    ds_read_b64_tr_b16 a[250:251], v247 offset:1536
    v_mfma_f32_16x16x32_bf16 v[64:67], v[10:13], a[104:107], v[64:67]
    v_mfma_f32_16x16x32_bf16 v[64:67], v[6:9], a[64:67], v[64:67]
    buffer_load_dwordx4 a[192:195], v0, s[44:47], s35 offen offset:3072 sc1
    v_mfma_f32_16x16x32_bf16 v[104:107], v[6:9], a[68:71], v[104:107]
    v_mfma_f32_16x16x32_bf16 v[104:107], v[10:13], a[108:111], v[104:107]
    ds_read_b64_tr_b16 a[252:253], v247 offset:12320
    v_mfma_f32_16x16x32_bf16 v[144:147], v[10:13], a[112:115], v[144:147]
    ds_read_b64_tr_b16 a[254:255], v247 offset:13856
    v_mfma_f32_16x16x32_bf16 v[144:147], v[6:9], a[72:75], v[144:147]
    v_mfma_f32_16x16x32_bf16 v[184:187], v[6:9], a[76:79], v[184:187]
    buffer_load_dwordx4 a[196:199], v0, s[44:47], s36 offen sc1
    v_mfma_f32_16x16x32_bf16 v[184:187], v[10:13], a[116:119], v[184:187]
    s_waitcnt lgkmcnt(4)
    v_mfma_f32_16x16x32_bf16 v[188:191], a[244:247], a[116:119], v[188:191]
    s_add_u32 m0, s31, 73920
    ds_read_b64_tr_b16 v[6:7], v247 offset:8
    v_mfma_f32_16x16x32_bf16 v[188:191], a[240:243], a[76:79], v[188:191]
    s_add_u32 s3, s53, s58
    ds_read_b64_tr_b16 v[8:9], v247 offset:1544
    v_mfma_f32_16x16x32_bf16 v[148:151], a[240:243], a[72:75], v[148:151]
    s_mul_i32 s32, s3, 40960
    v_mfma_f32_16x16x32_bf16 v[148:151], a[244:247], a[112:115], v[148:151]
    buffer_load_dwordx4 v242, s[64:67], s32 offen lds
    v_mfma_f32_16x16x32_bf16 v[108:111], a[244:247], a[108:111], v[108:111]
    v_mfma_f32_16x16x32_bf16 v[108:111], a[240:243], a[68:71], v[108:111]
    ds_read_b64_tr_b16 v[10:11], v247 offset:12328
    v_mfma_f32_16x16x32_bf16 v[68:71], a[240:243], a[64:67], v[68:71]
    ds_read_b64_tr_b16 v[12:13], v247 offset:13864
    v_mfma_f32_16x16x32_bf16 v[68:71], a[244:247], a[104:107], v[68:71]
    v_mfma_f32_16x16x32_bf16 v[28:31], a[244:247], a[100:103], v[28:31]
    buffer_load_dwordx4 v243, s[64:67], s32 offen offset:1024 lds
    v_mfma_f32_16x16x32_bf16 v[28:31], a[240:243], a[60:63], v[28:31]
    s_waitcnt lgkmcnt(4)
    v_mfma_f32_16x16x32_bf16 v[32:35], a[248:251], a[60:63], v[32:35]
    ds_read_b64_tr_b16 a[240:241], v248 offset:0
    v_mfma_f32_16x16x32_bf16 v[32:35], a[252:255], a[100:103], v[32:35]
    ds_read_b64_tr_b16 a[242:243], v248 offset:1536
    v_mfma_f32_16x16x32_bf16 v[72:75], a[252:255], a[104:107], v[72:75]
    v_mfma_f32_16x16x32_bf16 v[72:75], a[248:251], a[64:67], v[72:75]
    buffer_load_dwordx4 v244, s[64:67], s32 offen offset:2048 lds
    v_mfma_f32_16x16x32_bf16 v[112:115], a[248:251], a[68:71], v[112:115]
    v_mfma_f32_16x16x32_bf16 v[112:115], a[252:255], a[108:111], v[112:115]
    s_add_u32 s3, s53, s58
    ds_read_b64_tr_b16 a[244:245], v248 offset:12320
    v_mfma_f32_16x16x32_bf16 v[152:155], a[252:255], a[112:115], v[152:155]
    s_mul_i32 s35, s3, 10240
    ds_read_b64_tr_b16 a[246:247], v248 offset:13856
    v_mfma_f32_16x16x32_bf16 v[152:155], a[248:251], a[72:75], v[152:155]
    s_add_u32 s36, s35, 4096
    v_mfma_f32_16x16x32_bf16 v[192:195], a[248:251], a[76:79], v[192:195]
    buffer_load_dwordx4 a[0:3], v0, s[44:47], s35 offen sc1
    v_mfma_f32_16x16x32_bf16 v[192:195], a[252:255], a[116:119], v[192:195]
    s_waitcnt lgkmcnt(4)
    v_mfma_f32_16x16x32_bf16 v[196:199], v[10:13], a[116:119], v[196:199]
    ds_read_b64_tr_b16 a[248:249], v248 offset:8
    v_mfma_f32_16x16x32_bf16 v[196:199], v[6:9], a[76:79], v[196:199]
    ds_read_b64_tr_b16 a[250:251], v248 offset:1544
    v_mfma_f32_16x16x32_bf16 v[156:159], v[6:9], a[72:75], v[156:159]
    v_mfma_f32_16x16x32_bf16 v[156:159], v[10:13], a[112:115], v[156:159]
    buffer_load_dwordx4 a[4:7], v0, s[44:47], s35 offen offset:1024 sc1
    v_mfma_f32_16x16x32_bf16 v[116:119], v[10:13], a[108:111], v[116:119]
    v_mfma_f32_16x16x32_bf16 v[116:119], v[6:9], a[68:71], v[116:119]
    ds_read_b64_tr_b16 a[252:253], v248 offset:12328
    v_mfma_f32_16x16x32_bf16 v[76:79], v[6:9], a[64:67], v[76:79]
    ds_read_b64_tr_b16 a[254:255], v248 offset:13864
    v_mfma_f32_16x16x32_bf16 v[76:79], v[10:13], a[104:107], v[76:79]
    v_mfma_f32_16x16x32_bf16 v[36:39], v[10:13], a[100:103], v[36:39]
    buffer_load_dwordx4 a[8:11], v0, s[44:47], s35 offen offset:2048 sc1
    v_mfma_f32_16x16x32_bf16 v[36:39], v[6:9], a[60:63], v[36:39]
    s_waitcnt lgkmcnt(4)
    v_mfma_f32_16x16x32_bf16 v[40:43], a[240:243], a[60:63], v[40:43]
    ds_read_b64_tr_b16 v[6:7], v249 offset:0
    v_mfma_f32_16x16x32_bf16 v[40:43], a[244:247], a[100:103], v[40:43]
    ds_read_b64_tr_b16 v[8:9], v249 offset:1536
    v_mfma_f32_16x16x32_bf16 v[80:83], a[244:247], a[104:107], v[80:83]
    v_mfma_f32_16x16x32_bf16 v[80:83], a[240:243], a[64:67], v[80:83]
    buffer_load_dwordx4 a[12:15], v0, s[44:47], s35 offen offset:3072 sc1
    v_mfma_f32_16x16x32_bf16 v[120:123], a[240:243], a[68:71], v[120:123]
    v_mfma_f32_16x16x32_bf16 v[120:123], a[244:247], a[108:111], v[120:123]
    ds_read_b64_tr_b16 v[10:11], v249 offset:12320
    v_mfma_f32_16x16x32_bf16 v[160:163], a[244:247], a[112:115], v[160:163]
    ds_read_b64_tr_b16 v[12:13], v249 offset:13856
    v_mfma_f32_16x16x32_bf16 v[160:163], a[240:243], a[72:75], v[160:163]
    v_mfma_f32_16x16x32_bf16 v[200:203], a[240:243], a[76:79], v[200:203]
    buffer_load_dwordx4 a[16:19], v0, s[44:47], s36 offen sc1
    v_mfma_f32_16x16x32_bf16 v[200:203], a[244:247], a[116:119], v[200:203]
    s_waitcnt lgkmcnt(4)
    v_mfma_f32_16x16x32_bf16 v[204:207], a[252:255], a[116:119], v[204:207]
    s_add_u32 m0, s31, 86240
    ds_read_b64_tr_b16 a[240:241], v249 offset:8
    v_mfma_f32_16x16x32_bf16 v[204:207], a[248:251], a[76:79], v[204:207]
    s_add_u32 s3, s54, s58
    ds_read_b64_tr_b16 a[242:243], v249 offset:1544
    v_mfma_f32_16x16x32_bf16 v[164:167], a[248:251], a[72:75], v[164:167]
    s_mul_i32 s32, s3, 40960
    v_mfma_f32_16x16x32_bf16 v[164:167], a[252:255], a[112:115], v[164:167]
    buffer_load_dwordx4 v242, s[64:67], s32 offen lds
    v_mfma_f32_16x16x32_bf16 v[124:127], a[252:255], a[108:111], v[124:127]
    v_mfma_f32_16x16x32_bf16 v[124:127], a[248:251], a[68:71], v[124:127]
    ds_read_b64_tr_b16 a[244:245], v249 offset:12328
    v_mfma_f32_16x16x32_bf16 v[84:87], a[248:251], a[64:67], v[84:87]
    ds_read_b64_tr_b16 a[246:247], v249 offset:13864
    v_mfma_f32_16x16x32_bf16 v[84:87], a[252:255], a[104:107], v[84:87]
    v_mfma_f32_16x16x32_bf16 v[44:47], a[252:255], a[100:103], v[44:47]
    buffer_load_dwordx4 v243, s[64:67], s32 offen offset:1024 lds
    v_mfma_f32_16x16x32_bf16 v[44:47], a[248:251], a[60:63], v[44:47]
    s_waitcnt lgkmcnt(4)
    s_waitcnt vmcnt(46)
    s_barrier
    v_mfma_f32_16x16x32_bf16 v[48:51], v[6:9], a[60:63], v[48:51]
    ds_read_b64_tr_b16 a[248:249], v245 offset:24640
    v_mfma_f32_16x16x32_bf16 v[48:51], v[10:13], a[100:103], v[48:51]
    ds_read_b64_tr_b16 a[250:251], v245 offset:26176
    v_mfma_f32_16x16x32_bf16 v[88:91], v[10:13], a[104:107], v[88:91]
    v_mfma_f32_16x16x32_bf16 v[88:91], v[6:9], a[64:67], v[88:91]
    buffer_load_dwordx4 v244, s[64:67], s32 offen offset:2048 lds
    v_mfma_f32_16x16x32_bf16 v[128:131], v[6:9], a[68:71], v[128:131]
    v_mfma_f32_16x16x32_bf16 v[128:131], v[10:13], a[108:111], v[128:131]
    s_add_u32 s3, s54, s58
    ds_read_b64_tr_b16 a[252:253], v245 offset:36960
    v_mfma_f32_16x16x32_bf16 v[168:171], v[10:13], a[112:115], v[168:171]
    s_mul_i32 s35, s3, 10240
    ds_read_b64_tr_b16 a[254:255], v245 offset:38496
    v_mfma_f32_16x16x32_bf16 v[168:171], v[6:9], a[72:75], v[168:171]
    s_add_u32 s36, s35, 4096
    v_mfma_f32_16x16x32_bf16 v[208:211], v[6:9], a[76:79], v[208:211]
    buffer_load_dwordx4 a[40:43], v0, s[44:47], s35 offen sc1
    v_mfma_f32_16x16x32_bf16 v[208:211], v[10:13], a[116:119], v[208:211]
    s_waitcnt lgkmcnt(4)
    v_mfma_f32_16x16x32_bf16 v[212:215], a[244:247], a[116:119], v[212:215]
    ds_read_b64_tr_b16 v[6:7], v245 offset:24648
    v_mfma_f32_16x16x32_bf16 v[212:215], a[240:243], a[76:79], v[212:215]
    ds_read_b64_tr_b16 v[8:9], v245 offset:26184
    v_mfma_f32_16x16x32_bf16 v[172:175], a[240:243], a[72:75], v[172:175]
    v_mfma_f32_16x16x32_bf16 v[172:175], a[244:247], a[112:115], v[172:175]
    buffer_load_dwordx4 a[44:47], v0, s[44:47], s35 offen offset:1024 sc1
    v_mfma_f32_16x16x32_bf16 v[132:135], a[244:247], a[108:111], v[132:135]
    v_mfma_f32_16x16x32_bf16 v[132:135], a[240:243], a[68:71], v[132:135]
    ds_read_b64_tr_b16 v[10:11], v245 offset:36968
    v_mfma_f32_16x16x32_bf16 v[92:95], a[240:243], a[64:67], v[92:95]
    ds_read_b64_tr_b16 v[12:13], v245 offset:38504
    v_mfma_f32_16x16x32_bf16 v[92:95], a[244:247], a[104:107], v[92:95]
    v_mfma_f32_16x16x32_bf16 v[52:55], a[244:247], a[100:103], v[52:55]
    buffer_load_dwordx4 a[48:51], v0, s[44:47], s35 offen offset:2048 sc1
    v_mfma_f32_16x16x32_bf16 v[52:55], a[240:243], a[60:63], v[52:55]
    s_waitcnt lgkmcnt(4)
    s_waitcnt vmcnt(30)
    v_mfma_f32_16x16x32_bf16 v[16:19], a[248:251], a[140:143], v[16:19]
    ds_read_b64_tr_b16 a[240:241], v246 offset:24640
    v_mfma_f32_16x16x32_bf16 v[16:19], a[252:255], a[220:223], v[16:19]
    ds_read_b64_tr_b16 a[242:243], v246 offset:26176
    v_mfma_f32_16x16x32_bf16 v[56:59], a[252:255], a[224:227], v[56:59]
    v_mfma_f32_16x16x32_bf16 v[56:59], a[248:251], a[144:147], v[56:59]
    buffer_load_dwordx4 a[52:55], v0, s[44:47], s35 offen offset:3072 sc1
    v_mfma_f32_16x16x32_bf16 v[96:99], a[248:251], a[148:151], v[96:99]
    v_mfma_f32_16x16x32_bf16 v[96:99], a[252:255], a[228:231], v[96:99]
    ds_read_b64_tr_b16 a[244:245], v246 offset:36960
    v_mfma_f32_16x16x32_bf16 v[136:139], a[252:255], a[232:235], v[136:139]
    ds_read_b64_tr_b16 a[246:247], v246 offset:38496
    v_mfma_f32_16x16x32_bf16 v[136:139], a[248:251], a[152:155], v[136:139]
    v_mfma_f32_16x16x32_bf16 v[176:179], a[248:251], a[156:159], v[176:179]
    buffer_load_dwordx4 a[56:59], v0, s[44:47], s36 offen sc1
    v_mfma_f32_16x16x32_bf16 v[176:179], a[252:255], a[236:239], v[176:179]
    s_waitcnt lgkmcnt(4)
    v_mfma_f32_16x16x32_bf16 v[180:183], v[10:13], a[236:239], v[180:183]
    s_add_u32 m0, s31, 98560
    ds_read_b64_tr_b16 a[248:249], v246 offset:24648
    v_mfma_f32_16x16x32_bf16 v[180:183], v[6:9], a[156:159], v[180:183]
    s_add_u32 s3, s55, s58
    ds_read_b64_tr_b16 a[250:251], v246 offset:26184
    v_mfma_f32_16x16x32_bf16 v[140:143], v[6:9], a[152:155], v[140:143]
    s_mul_i32 s32, s3, 40960
    v_mfma_f32_16x16x32_bf16 v[140:143], v[10:13], a[232:235], v[140:143]
    buffer_load_dwordx4 v242, s[64:67], s32 offen lds
    v_mfma_f32_16x16x32_bf16 v[100:103], v[10:13], a[228:231], v[100:103]
    v_mfma_f32_16x16x32_bf16 v[100:103], v[6:9], a[148:151], v[100:103]
    ds_read_b64_tr_b16 a[252:253], v246 offset:36968
    v_mfma_f32_16x16x32_bf16 v[60:63], v[6:9], a[144:147], v[60:63]
    ds_read_b64_tr_b16 a[254:255], v246 offset:38504
    v_mfma_f32_16x16x32_bf16 v[60:63], v[10:13], a[224:227], v[60:63]
    v_mfma_f32_16x16x32_bf16 v[20:23], v[10:13], a[220:223], v[20:23]
    buffer_load_dwordx4 v243, s[64:67], s32 offen offset:1024 lds
    v_mfma_f32_16x16x32_bf16 v[20:23], v[6:9], a[140:143], v[20:23]
    s_waitcnt lgkmcnt(4)
    v_mfma_f32_16x16x32_bf16 v[24:27], a[240:243], a[140:143], v[24:27]
    ds_read_b64_tr_b16 v[6:7], v247 offset:24640
    v_mfma_f32_16x16x32_bf16 v[24:27], a[244:247], a[220:223], v[24:27]
    ds_read_b64_tr_b16 v[8:9], v247 offset:26176
    v_mfma_f32_16x16x32_bf16 v[64:67], a[244:247], a[224:227], v[64:67]
    v_mfma_f32_16x16x32_bf16 v[64:67], a[240:243], a[144:147], v[64:67]
    buffer_load_dwordx4 v244, s[64:67], s32 offen offset:2048 lds
    v_mfma_f32_16x16x32_bf16 v[104:107], a[240:243], a[148:151], v[104:107]
    v_mfma_f32_16x16x32_bf16 v[104:107], a[244:247], a[228:231], v[104:107]
    s_add_u32 s3, s55, s58
    ds_read_b64_tr_b16 v[10:11], v247 offset:36960
    v_mfma_f32_16x16x32_bf16 v[144:147], a[244:247], a[232:235], v[144:147]
    s_mul_i32 s35, s3, 10240
    ds_read_b64_tr_b16 v[12:13], v247 offset:38496
    v_mfma_f32_16x16x32_bf16 v[144:147], a[240:243], a[152:155], v[144:147]
    s_add_u32 s36, s35, 4096
    v_mfma_f32_16x16x32_bf16 v[184:187], a[240:243], a[156:159], v[184:187]
    buffer_load_dwordx4 a[60:63], v0, s[44:47], s35 offen sc1
    v_mfma_f32_16x16x32_bf16 v[184:187], a[244:247], a[236:239], v[184:187]
    s_waitcnt lgkmcnt(4)
    v_mfma_f32_16x16x32_bf16 v[188:191], a[252:255], a[236:239], v[188:191]
    ds_read_b64_tr_b16 a[240:241], v247 offset:24648
    v_mfma_f32_16x16x32_bf16 v[188:191], a[248:251], a[156:159], v[188:191]
    ds_read_b64_tr_b16 a[242:243], v247 offset:26184
    v_mfma_f32_16x16x32_bf16 v[148:151], a[248:251], a[152:155], v[148:151]
    v_mfma_f32_16x16x32_bf16 v[148:151], a[252:255], a[232:235], v[148:151]
    buffer_load_dwordx4 a[64:67], v0, s[44:47], s35 offen offset:1024 sc1
    v_mfma_f32_16x16x32_bf16 v[108:111], a[252:255], a[228:231], v[108:111]
    v_mfma_f32_16x16x32_bf16 v[108:111], a[248:251], a[148:151], v[108:111]
    ds_read_b64_tr_b16 a[244:245], v247 offset:36968
    v_mfma_f32_16x16x32_bf16 v[68:71], a[248:251], a[144:147], v[68:71]
    ds_read_b64_tr_b16 a[246:247], v247 offset:38504
    v_mfma_f32_16x16x32_bf16 v[68:71], a[252:255], a[224:227], v[68:71]
    v_mfma_f32_16x16x32_bf16 v[28:31], a[252:255], a[220:223], v[28:31]
    buffer_load_dwordx4 a[68:71], v0, s[44:47], s35 offen offset:2048 sc1
    v_mfma_f32_16x16x32_bf16 v[28:31], a[248:251], a[140:143], v[28:31]
    s_waitcnt lgkmcnt(4)
    v_mfma_f32_16x16x32_bf16 v[32:35], v[6:9], a[140:143], v[32:35]
    ds_read_b64_tr_b16 a[248:249], v248 offset:24640
    v_mfma_f32_16x16x32_bf16 v[32:35], v[10:13], a[220:223], v[32:35]
    ds_read_b64_tr_b16 a[250:251], v248 offset:26176
    v_mfma_f32_16x16x32_bf16 v[72:75], v[10:13], a[224:227], v[72:75]
    v_mfma_f32_16x16x32_bf16 v[72:75], v[6:9], a[144:147], v[72:75]
    buffer_load_dwordx4 a[72:75], v0, s[44:47], s35 offen offset:3072 sc1
    v_mfma_f32_16x16x32_bf16 v[112:115], v[6:9], a[148:151], v[112:115]
    v_mfma_f32_16x16x32_bf16 v[112:115], v[10:13], a[228:231], v[112:115]
    ds_read_b64_tr_b16 a[252:253], v248 offset:36960
    v_mfma_f32_16x16x32_bf16 v[152:155], v[10:13], a[232:235], v[152:155]
    ds_read_b64_tr_b16 a[254:255], v248 offset:38496
    v_mfma_f32_16x16x32_bf16 v[152:155], v[6:9], a[152:155], v[152:155]
    v_mfma_f32_16x16x32_bf16 v[192:195], v[6:9], a[156:159], v[192:195]
    buffer_load_dwordx4 a[76:79], v0, s[44:47], s36 offen sc1
    v_mfma_f32_16x16x32_bf16 v[192:195], v[10:13], a[236:239], v[192:195]
    s_waitcnt lgkmcnt(4)
    v_mfma_f32_16x16x32_bf16 v[196:199], a[244:247], a[236:239], v[196:199]
    s_add_u32 m0, s31, 110880
    ds_read_b64_tr_b16 v[6:7], v248 offset:24648
    v_mfma_f32_16x16x32_bf16 v[196:199], a[240:243], a[156:159], v[196:199]
    s_add_u32 s3, s53, s59
    ds_read_b64_tr_b16 v[8:9], v248 offset:26184
    v_mfma_f32_16x16x32_bf16 v[156:159], a[240:243], a[152:155], v[156:159]
    s_mul_i32 s32, s3, 40960
    v_mfma_f32_16x16x32_bf16 v[156:159], a[244:247], a[232:235], v[156:159]
    buffer_load_dwordx4 v242, s[64:67], s32 offen lds
    v_mfma_f32_16x16x32_bf16 v[116:119], a[244:247], a[228:231], v[116:119]
    v_mfma_f32_16x16x32_bf16 v[116:119], a[240:243], a[148:151], v[116:119]
    ds_read_b64_tr_b16 v[10:11], v248 offset:36968
    v_mfma_f32_16x16x32_bf16 v[76:79], a[240:243], a[144:147], v[76:79]
    ds_read_b64_tr_b16 v[12:13], v248 offset:38504
    v_mfma_f32_16x16x32_bf16 v[76:79], a[244:247], a[224:227], v[76:79]
    v_mfma_f32_16x16x32_bf16 v[36:39], a[244:247], a[220:223], v[36:39]
    buffer_load_dwordx4 v243, s[64:67], s32 offen offset:1024 lds
    v_mfma_f32_16x16x32_bf16 v[36:39], a[240:243], a[140:143], v[36:39]
    s_waitcnt lgkmcnt(4)
    v_mfma_f32_16x16x32_bf16 v[40:43], a[248:251], a[140:143], v[40:43]
    ds_read_b64_tr_b16 a[240:241], v249 offset:24640
    v_mfma_f32_16x16x32_bf16 v[40:43], a[252:255], a[220:223], v[40:43]
    ds_read_b64_tr_b16 a[242:243], v249 offset:26176
    v_mfma_f32_16x16x32_bf16 v[80:83], a[252:255], a[224:227], v[80:83]
    v_mfma_f32_16x16x32_bf16 v[80:83], a[248:251], a[144:147], v[80:83]
    buffer_load_dwordx4 v244, s[64:67], s32 offen offset:2048 lds
    v_mfma_f32_16x16x32_bf16 v[120:123], a[248:251], a[148:151], v[120:123]
    v_mfma_f32_16x16x32_bf16 v[120:123], a[252:255], a[228:231], v[120:123]
    s_add_u32 s3, s53, s59
    ds_read_b64_tr_b16 a[244:245], v249 offset:36960
    v_mfma_f32_16x16x32_bf16 v[160:163], a[252:255], a[232:235], v[160:163]
    s_mul_i32 s35, s3, 10240
    ds_read_b64_tr_b16 a[246:247], v249 offset:38496
    v_mfma_f32_16x16x32_bf16 v[160:163], a[248:251], a[152:155], v[160:163]
    s_add_u32 s36, s35, 4096
    v_mfma_f32_16x16x32_bf16 v[200:203], a[248:251], a[156:159], v[200:203]
    buffer_load_dwordx4 a[100:103], v0, s[44:47], s35 offen sc1
    v_mfma_f32_16x16x32_bf16 v[200:203], a[252:255], a[236:239], v[200:203]
    s_waitcnt lgkmcnt(4)
    v_mfma_f32_16x16x32_bf16 v[204:207], v[10:13], a[236:239], v[204:207]
    ds_read_b64_tr_b16 a[248:249], v249 offset:24648
    v_mfma_f32_16x16x32_bf16 v[204:207], v[6:9], a[156:159], v[204:207]
    ds_read_b64_tr_b16 a[250:251], v249 offset:26184
    v_mfma_f32_16x16x32_bf16 v[164:167], v[6:9], a[152:155], v[164:167]
    v_mfma_f32_16x16x32_bf16 v[164:167], v[10:13], a[232:235], v[164:167]
    buffer_load_dwordx4 a[104:107], v0, s[44:47], s35 offen offset:1024 sc1
    v_mfma_f32_16x16x32_bf16 v[124:127], v[10:13], a[228:231], v[124:127]
    v_mfma_f32_16x16x32_bf16 v[124:127], v[6:9], a[148:151], v[124:127]
    ds_read_b64_tr_b16 a[252:253], v249 offset:36968
    v_mfma_f32_16x16x32_bf16 v[84:87], v[6:9], a[144:147], v[84:87]
    ds_read_b64_tr_b16 a[254:255], v249 offset:38504
    v_mfma_f32_16x16x32_bf16 v[84:87], v[10:13], a[224:227], v[84:87]
    v_mfma_f32_16x16x32_bf16 v[44:47], v[10:13], a[220:223], v[44:47]
    buffer_load_dwordx4 a[108:111], v0, s[44:47], s35 offen offset:2048 sc1
    v_mfma_f32_16x16x32_bf16 v[44:47], v[6:9], a[140:143], v[44:47]
    s_waitcnt lgkmcnt(4)
    s_waitcnt vmcnt(35)
    s_barrier
    v_mfma_f32_16x16x32_bf16 v[48:51], a[240:243], a[140:143], v[48:51]
    ds_read_b64_tr_b16 v[6:7], v245 offset:49280
    v_mfma_f32_16x16x32_bf16 v[48:51], a[244:247], a[220:223], v[48:51]
    ds_read_b64_tr_b16 v[8:9], v245 offset:50816
    v_mfma_f32_16x16x32_bf16 v[88:91], a[244:247], a[224:227], v[88:91]
    v_mfma_f32_16x16x32_bf16 v[88:91], a[240:243], a[144:147], v[88:91]
    buffer_load_dwordx4 a[112:115], v0, s[44:47], s35 offen offset:3072 sc1
    v_mfma_f32_16x16x32_bf16 v[128:131], a[240:243], a[148:151], v[128:131]
    v_mfma_f32_16x16x32_bf16 v[128:131], a[244:247], a[228:231], v[128:131]
    ds_read_b64_tr_b16 v[10:11], v250 offset:0
    v_mfma_f32_16x16x32_bf16 v[168:171], a[244:247], a[232:235], v[168:171]
    ds_read_b64_tr_b16 v[12:13], v250 offset:1536
    v_mfma_f32_16x16x32_bf16 v[168:171], a[240:243], a[152:155], v[168:171]
    v_mfma_f32_16x16x32_bf16 v[208:211], a[240:243], a[156:159], v[208:211]
    buffer_load_dwordx4 a[116:119], v0, s[44:47], s36 offen sc1
    v_mfma_f32_16x16x32_bf16 v[208:211], a[244:247], a[236:239], v[208:211]
    s_waitcnt lgkmcnt(4)
    v_mfma_f32_16x16x32_bf16 v[212:215], a[252:255], a[236:239], v[212:215]
    s_add_u32 m0, s31, 0
    ds_read_b64_tr_b16 a[240:241], v245 offset:49288
    v_mfma_f32_16x16x32_bf16 v[212:215], a[248:251], a[156:159], v[212:215]
    s_add_u32 s3, s54, s59
    ds_read_b64_tr_b16 a[242:243], v245 offset:50824
    v_mfma_f32_16x16x32_bf16 v[172:175], a[248:251], a[152:155], v[172:175]
    s_mul_i32 s32, s3, 40960
    v_mfma_f32_16x16x32_bf16 v[172:175], a[252:255], a[232:235], v[172:175]
    buffer_load_dwordx4 v242, s[64:67], s32 offen lds
    v_mfma_f32_16x16x32_bf16 v[132:135], a[252:255], a[228:231], v[132:135]
    v_mfma_f32_16x16x32_bf16 v[132:135], a[248:251], a[148:151], v[132:135]
    ds_read_b64_tr_b16 a[244:245], v250 offset:8
    v_mfma_f32_16x16x32_bf16 v[92:95], a[248:251], a[144:147], v[92:95]
    ds_read_b64_tr_b16 a[246:247], v250 offset:1544
    v_mfma_f32_16x16x32_bf16 v[92:95], a[252:255], a[224:227], v[92:95]
    v_mfma_f32_16x16x32_bf16 v[52:55], a[252:255], a[220:223], v[52:55]
    buffer_load_dwordx4 v243, s[64:67], s32 offen offset:1024 lds
    v_mfma_f32_16x16x32_bf16 v[52:55], a[248:251], a[140:143], v[52:55]
    s_waitcnt lgkmcnt(4)
    s_waitcnt vmcnt(34)
    v_mfma_f32_16x16x32_bf16 v[16:19], v[6:9], a[20:23], v[16:19]
    ds_read_b64_tr_b16 a[248:249], v246 offset:49280
    v_mfma_f32_16x16x32_bf16 v[16:19], v[10:13], a[180:183], v[16:19]
    ds_read_b64_tr_b16 a[250:251], v246 offset:50816
    v_mfma_f32_16x16x32_bf16 v[56:59], v[10:13], a[184:187], v[56:59]
    v_mfma_f32_16x16x32_bf16 v[56:59], v[6:9], a[24:27], v[56:59]
    buffer_load_dwordx4 v244, s[64:67], s32 offen offset:2048 lds
    v_mfma_f32_16x16x32_bf16 v[96:99], v[6:9], a[28:31], v[96:99]
    v_mfma_f32_16x16x32_bf16 v[96:99], v[10:13], a[188:191], v[96:99]
    s_add_u32 s3, s54, s59
    ds_read_b64_tr_b16 a[252:253], v251 offset:0
    v_mfma_f32_16x16x32_bf16 v[136:139], v[10:13], a[192:195], v[136:139]
    s_mul_i32 s35, s3, 10240
    ds_read_b64_tr_b16 a[254:255], v251 offset:1536
    v_mfma_f32_16x16x32_bf16 v[136:139], v[6:9], a[32:35], v[136:139]
    s_add_u32 s36, s35, 4096
    v_mfma_f32_16x16x32_bf16 v[176:179], v[6:9], a[36:39], v[176:179]
    buffer_load_dwordx4 a[140:143], v0, s[44:47], s35 offen sc1
    v_mfma_f32_16x16x32_bf16 v[176:179], v[10:13], a[196:199], v[176:179]
    s_waitcnt lgkmcnt(4)
    v_mfma_f32_16x16x32_bf16 v[180:183], a[244:247], a[196:199], v[180:183]
    ds_read_b64_tr_b16 v[6:7], v246 offset:49288
    v_mfma_f32_16x16x32_bf16 v[180:183], a[240:243], a[36:39], v[180:183]
    ds_read_b64_tr_b16 v[8:9], v246 offset:50824
    v_mfma_f32_16x16x32_bf16 v[140:143], a[240:243], a[32:35], v[140:143]
    v_mfma_f32_16x16x32_bf16 v[140:143], a[244:247], a[192:195], v[140:143]
    buffer_load_dwordx4 a[144:147], v0, s[44:47], s35 offen offset:1024 sc1
    v_mfma_f32_16x16x32_bf16 v[100:103], a[244:247], a[188:191], v[100:103]
    v_mfma_f32_16x16x32_bf16 v[100:103], a[240:243], a[28:31], v[100:103]
    ds_read_b64_tr_b16 v[10:11], v251 offset:8
    v_mfma_f32_16x16x32_bf16 v[60:63], a[240:243], a[24:27], v[60:63]
    ds_read_b64_tr_b16 v[12:13], v251 offset:1544
    v_mfma_f32_16x16x32_bf16 v[60:63], a[244:247], a[184:187], v[60:63]
    v_mfma_f32_16x16x32_bf16 v[20:23], a[244:247], a[180:183], v[20:23]
    buffer_load_dwordx4 a[148:151], v0, s[44:47], s35 offen offset:2048 sc1
    v_mfma_f32_16x16x32_bf16 v[20:23], a[240:243], a[20:23], v[20:23]
    s_waitcnt lgkmcnt(4)
    v_mfma_f32_16x16x32_bf16 v[24:27], a[248:251], a[20:23], v[24:27]
    ds_read_b64_tr_b16 a[240:241], v247 offset:49280
    v_mfma_f32_16x16x32_bf16 v[24:27], a[252:255], a[180:183], v[24:27]
    ds_read_b64_tr_b16 a[242:243], v247 offset:50816
    v_mfma_f32_16x16x32_bf16 v[64:67], a[252:255], a[184:187], v[64:67]
    v_mfma_f32_16x16x32_bf16 v[64:67], a[248:251], a[24:27], v[64:67]
    buffer_load_dwordx4 a[152:155], v0, s[44:47], s35 offen offset:3072 sc1
    v_mfma_f32_16x16x32_bf16 v[104:107], a[248:251], a[28:31], v[104:107]
    v_mfma_f32_16x16x32_bf16 v[104:107], a[252:255], a[188:191], v[104:107]
    ds_read_b64_tr_b16 a[244:245], v252 offset:0
    v_mfma_f32_16x16x32_bf16 v[144:147], a[252:255], a[192:195], v[144:147]
    ds_read_b64_tr_b16 a[246:247], v252 offset:1536
    v_mfma_f32_16x16x32_bf16 v[144:147], a[248:251], a[32:35], v[144:147]
    v_mfma_f32_16x16x32_bf16 v[184:187], a[248:251], a[36:39], v[184:187]
    buffer_load_dwordx4 a[156:159], v0, s[44:47], s36 offen sc1
    v_mfma_f32_16x16x32_bf16 v[184:187], a[252:255], a[196:199], v[184:187]
    s_waitcnt lgkmcnt(4)
    v_mfma_f32_16x16x32_bf16 v[188:191], v[10:13], a[196:199], v[188:191]
    s_add_u32 m0, s31, 12320
    ds_read_b64_tr_b16 a[248:249], v247 offset:49288
    v_mfma_f32_16x16x32_bf16 v[188:191], v[6:9], a[36:39], v[188:191]
    s_add_u32 s3, s55, s59
    ds_read_b64_tr_b16 a[250:251], v247 offset:50824
    v_mfma_f32_16x16x32_bf16 v[148:151], v[6:9], a[32:35], v[148:151]
    s_mul_i32 s32, s3, 40960
    v_mfma_f32_16x16x32_bf16 v[148:151], v[10:13], a[192:195], v[148:151]
    buffer_load_dwordx4 v242, s[64:67], s32 offen lds
    v_mfma_f32_16x16x32_bf16 v[108:111], v[10:13], a[188:191], v[108:111]
    v_mfma_f32_16x16x32_bf16 v[108:111], v[6:9], a[28:31], v[108:111]
    ds_read_b64_tr_b16 a[252:253], v252 offset:8
    v_mfma_f32_16x16x32_bf16 v[68:71], v[6:9], a[24:27], v[68:71]
    ds_read_b64_tr_b16 a[254:255], v252 offset:1544
    v_mfma_f32_16x16x32_bf16 v[68:71], v[10:13], a[184:187], v[68:71]
    v_mfma_f32_16x16x32_bf16 v[28:31], v[10:13], a[180:183], v[28:31]
    buffer_load_dwordx4 v243, s[64:67], s32 offen offset:1024 lds
    v_mfma_f32_16x16x32_bf16 v[28:31], v[6:9], a[20:23], v[28:31]
    s_waitcnt lgkmcnt(4)
    v_mfma_f32_16x16x32_bf16 v[32:35], a[240:243], a[20:23], v[32:35]
    ds_read_b64_tr_b16 v[6:7], v248 offset:49280
    v_mfma_f32_16x16x32_bf16 v[32:35], a[244:247], a[180:183], v[32:35]
    ds_read_b64_tr_b16 v[8:9], v248 offset:50816
    v_mfma_f32_16x16x32_bf16 v[72:75], a[244:247], a[184:187], v[72:75]
    v_mfma_f32_16x16x32_bf16 v[72:75], a[240:243], a[24:27], v[72:75]
    buffer_load_dwordx4 v244, s[64:67], s32 offen offset:2048 lds
    v_mfma_f32_16x16x32_bf16 v[112:115], a[240:243], a[28:31], v[112:115]
    v_mfma_f32_16x16x32_bf16 v[112:115], a[244:247], a[188:191], v[112:115]
    s_add_u32 s3, s55, s59
    ds_read_b64_tr_b16 v[10:11], v253 offset:0
    v_mfma_f32_16x16x32_bf16 v[152:155], a[244:247], a[192:195], v[152:155]
    s_mul_i32 s35, s3, 10240
    ds_read_b64_tr_b16 v[12:13], v253 offset:1536
    v_mfma_f32_16x16x32_bf16 v[152:155], a[240:243], a[32:35], v[152:155]
    s_add_u32 s36, s35, 4096
    v_mfma_f32_16x16x32_bf16 v[192:195], a[240:243], a[36:39], v[192:195]
    buffer_load_dwordx4 a[220:223], v0, s[44:47], s35 offen sc1
    v_mfma_f32_16x16x32_bf16 v[192:195], a[244:247], a[196:199], v[192:195]
    s_waitcnt lgkmcnt(4)
    v_mfma_f32_16x16x32_bf16 v[196:199], a[252:255], a[196:199], v[196:199]
    ds_read_b64_tr_b16 a[240:241], v248 offset:49288
    v_mfma_f32_16x16x32_bf16 v[196:199], a[248:251], a[36:39], v[196:199]
    ds_read_b64_tr_b16 a[242:243], v248 offset:50824
    v_mfma_f32_16x16x32_bf16 v[156:159], a[248:251], a[32:35], v[156:159]
    v_mfma_f32_16x16x32_bf16 v[156:159], a[252:255], a[192:195], v[156:159]
    buffer_load_dwordx4 a[224:227], v0, s[44:47], s35 offen offset:1024 sc1
    v_mfma_f32_16x16x32_bf16 v[116:119], a[252:255], a[188:191], v[116:119]
    v_mfma_f32_16x16x32_bf16 v[116:119], a[248:251], a[28:31], v[116:119]
    ds_read_b64_tr_b16 a[244:245], v253 offset:8
    v_mfma_f32_16x16x32_bf16 v[76:79], a[248:251], a[24:27], v[76:79]
    ds_read_b64_tr_b16 a[246:247], v253 offset:1544
    v_mfma_f32_16x16x32_bf16 v[76:79], a[252:255], a[184:187], v[76:79]
    v_mfma_f32_16x16x32_bf16 v[36:39], a[252:255], a[180:183], v[36:39]
    buffer_load_dwordx4 a[228:231], v0, s[44:47], s35 offen offset:2048 sc1
    v_mfma_f32_16x16x32_bf16 v[36:39], a[248:251], a[20:23], v[36:39]
    s_waitcnt lgkmcnt(4)
    v_mfma_f32_16x16x32_bf16 v[40:43], v[6:9], a[20:23], v[40:43]
    ds_read_b64_tr_b16 a[248:249], v249 offset:49280
    v_mfma_f32_16x16x32_bf16 v[40:43], v[10:13], a[180:183], v[40:43]
    ds_read_b64_tr_b16 a[250:251], v249 offset:50816
    v_mfma_f32_16x16x32_bf16 v[80:83], v[10:13], a[184:187], v[80:83]
    v_mfma_f32_16x16x32_bf16 v[80:83], v[6:9], a[24:27], v[80:83]
    buffer_load_dwordx4 a[232:235], v0, s[44:47], s35 offen offset:3072 sc1
    v_mfma_f32_16x16x32_bf16 v[120:123], v[6:9], a[28:31], v[120:123]
    v_mfma_f32_16x16x32_bf16 v[120:123], v[10:13], a[188:191], v[120:123]
    ds_read_b64_tr_b16 a[252:253], v254 offset:0
    v_mfma_f32_16x16x32_bf16 v[160:163], v[10:13], a[192:195], v[160:163]
    ds_read_b64_tr_b16 a[254:255], v254 offset:1536
    v_mfma_f32_16x16x32_bf16 v[160:163], v[6:9], a[32:35], v[160:163]
    v_mfma_f32_16x16x32_bf16 v[200:203], v[6:9], a[36:39], v[200:203]
    buffer_load_dwordx4 a[236:239], v0, s[44:47], s36 offen sc1
    v_mfma_f32_16x16x32_bf16 v[200:203], v[10:13], a[196:199], v[200:203]
    s_waitcnt lgkmcnt(4)
    v_mfma_f32_16x16x32_bf16 v[204:207], a[244:247], a[196:199], v[204:207]
    s_add_u32 s3, s53, s60
    ds_read_b64_tr_b16 v[6:7], v249 offset:49288
    v_mfma_f32_16x16x32_bf16 v[204:207], a[240:243], a[36:39], v[204:207]
    s_mul_i32 s35, s3, 10240
    ds_read_b64_tr_b16 v[8:9], v249 offset:50824
    v_mfma_f32_16x16x32_bf16 v[164:167], a[240:243], a[32:35], v[164:167]
    s_add_u32 s36, s35, 4096
    v_mfma_f32_16x16x32_bf16 v[164:167], a[244:247], a[192:195], v[164:167]
    buffer_load_dwordx4 a[80:83], v0, s[44:47], s35 offen sc1
    v_mfma_f32_16x16x32_bf16 v[124:127], a[244:247], a[188:191], v[124:127]
    v_mfma_f32_16x16x32_bf16 v[124:127], a[240:243], a[28:31], v[124:127]
    ds_read_b64_tr_b16 v[10:11], v254 offset:8
    v_mfma_f32_16x16x32_bf16 v[84:87], a[240:243], a[24:27], v[84:87]
    ds_read_b64_tr_b16 v[12:13], v254 offset:1544
    v_mfma_f32_16x16x32_bf16 v[84:87], a[244:247], a[184:187], v[84:87]
    v_mfma_f32_16x16x32_bf16 v[44:47], a[244:247], a[180:183], v[44:47]
    buffer_load_dwordx4 a[84:87], v0, s[44:47], s35 offen offset:1024 sc1
    v_mfma_f32_16x16x32_bf16 v[44:47], a[240:243], a[20:23], v[44:47]
    s_waitcnt lgkmcnt(4)
    s_waitcnt vmcnt(39)
    s_barrier
    v_mfma_f32_16x16x32_bf16 v[48:51], a[248:251], a[20:23], v[48:51]
    ds_read_b64_tr_b16 a[240:241], v250 offset:12320
    v_mfma_f32_16x16x32_bf16 v[48:51], a[252:255], a[180:183], v[48:51]
    ds_read_b64_tr_b16 a[242:243], v250 offset:13856
    v_mfma_f32_16x16x32_bf16 v[88:91], a[252:255], a[184:187], v[88:91]
    v_mfma_f32_16x16x32_bf16 v[88:91], a[248:251], a[24:27], v[88:91]
    buffer_load_dwordx4 a[88:91], v0, s[44:47], s35 offen offset:2048 sc1
    v_mfma_f32_16x16x32_bf16 v[128:131], a[248:251], a[28:31], v[128:131]
    v_mfma_f32_16x16x32_bf16 v[128:131], a[252:255], a[188:191], v[128:131]
    ds_read_b64_tr_b16 a[244:245], v250 offset:24640
    v_mfma_f32_16x16x32_bf16 v[168:171], a[252:255], a[192:195], v[168:171]
    ds_read_b64_tr_b16 a[246:247], v250 offset:26176
    v_mfma_f32_16x16x32_bf16 v[168:171], a[248:251], a[32:35], v[168:171]
    v_mfma_f32_16x16x32_bf16 v[208:211], a[248:251], a[36:39], v[208:211]
    buffer_load_dwordx4 a[92:95], v0, s[44:47], s35 offen offset:3072 sc1
    v_mfma_f32_16x16x32_bf16 v[208:211], a[252:255], a[196:199], v[208:211]
    s_waitcnt lgkmcnt(4)
    v_mfma_f32_16x16x32_bf16 v[212:215], v[10:13], a[196:199], v[212:215]
    ds_read_b64_tr_b16 a[248:249], v250 offset:12328
    v_mfma_f32_16x16x32_bf16 v[212:215], v[6:9], a[36:39], v[212:215]
    ds_read_b64_tr_b16 a[250:251], v250 offset:13864
    v_mfma_f32_16x16x32_bf16 v[172:175], v[6:9], a[32:35], v[172:175]
    v_mfma_f32_16x16x32_bf16 v[172:175], v[10:13], a[192:195], v[172:175]
    buffer_load_dwordx4 a[96:99], v0, s[44:47], s36 offen sc1
    v_mfma_f32_16x16x32_bf16 v[132:135], v[10:13], a[188:191], v[132:135]
    v_mfma_f32_16x16x32_bf16 v[132:135], v[6:9], a[28:31], v[132:135]
    s_add_u32 m0, s31, 24640
    ds_read_b64_tr_b16 a[252:253], v250 offset:24648
    v_mfma_f32_16x16x32_bf16 v[92:95], v[6:9], a[24:27], v[92:95]
    s_add_u32 s3, s53, s60
    ds_read_b64_tr_b16 a[254:255], v250 offset:26184
    v_mfma_f32_16x16x32_bf16 v[92:95], v[10:13], a[184:187], v[92:95]
    s_mul_i32 s32, s3, 40960
    v_mfma_f32_16x16x32_bf16 v[52:55], v[10:13], a[180:183], v[52:55]
    buffer_load_dwordx4 v242, s[64:67], s32 offen lds
    v_mfma_f32_16x16x32_bf16 v[52:55], v[6:9], a[20:23], v[52:55]
    s_waitcnt lgkmcnt(4)
    s_waitcnt vmcnt(38)
    v_mfma_f32_16x16x32_bf16 v[16:19], a[240:243], a[0:3], v[16:19]
    ds_read_b64_tr_b16 v[6:7], v251 offset:12320
    v_mfma_f32_16x16x32_bf16 v[16:19], a[244:247], a[40:43], v[16:19]
    ds_read_b64_tr_b16 v[8:9], v251 offset:13856
    v_mfma_f32_16x16x32_bf16 v[56:59], a[244:247], a[44:47], v[56:59]
    v_mfma_f32_16x16x32_bf16 v[56:59], a[240:243], a[4:7], v[56:59]
    buffer_load_dwordx4 v243, s[64:67], s32 offen offset:1024 lds
    v_mfma_f32_16x16x32_bf16 v[96:99], a[240:243], a[8:11], v[96:99]
    v_mfma_f32_16x16x32_bf16 v[96:99], a[244:247], a[48:51], v[96:99]
    ds_read_b64_tr_b16 v[10:11], v251 offset:24640
    v_mfma_f32_16x16x32_bf16 v[136:139], a[244:247], a[52:55], v[136:139]
    ds_read_b64_tr_b16 v[12:13], v251 offset:26176
    v_mfma_f32_16x16x32_bf16 v[136:139], a[240:243], a[12:15], v[136:139]
    v_mfma_f32_16x16x32_bf16 v[176:179], a[240:243], a[16:19], v[176:179]
    buffer_load_dwordx4 v244, s[64:67], s32 offen offset:2048 lds
    v_mfma_f32_16x16x32_bf16 v[176:179], a[244:247], a[56:59], v[176:179]
    s_waitcnt lgkmcnt(4)
    v_mfma_f32_16x16x32_bf16 v[180:183], a[252:255], a[56:59], v[180:183]
    s_add_u32 m0, s31, 36960
    ds_read_b64_tr_b16 a[240:241], v251 offset:12328
    v_mfma_f32_16x16x32_bf16 v[180:183], a[248:251], a[16:19], v[180:183]
    s_add_u32 s3, s54, s60
    ds_read_b64_tr_b16 a[242:243], v251 offset:13864
    v_mfma_f32_16x16x32_bf16 v[140:143], a[248:251], a[12:15], v[140:143]
    s_mul_i32 s32, s3, 40960
    v_mfma_f32_16x16x32_bf16 v[140:143], a[252:255], a[52:55], v[140:143]
    buffer_load_dwordx4 v242, s[64:67], s32 offen lds
    v_mfma_f32_16x16x32_bf16 v[100:103], a[252:255], a[48:51], v[100:103]
    v_mfma_f32_16x16x32_bf16 v[100:103], a[248:251], a[8:11], v[100:103]
    ds_read_b64_tr_b16 a[244:245], v251 offset:24648
    v_mfma_f32_16x16x32_bf16 v[60:63], a[248:251], a[4:7], v[60:63]
    ds_read_b64_tr_b16 a[246:247], v251 offset:26184
    v_mfma_f32_16x16x32_bf16 v[60:63], a[252:255], a[44:47], v[60:63]
    v_mfma_f32_16x16x32_bf16 v[20:23], a[252:255], a[40:43], v[20:23]
    buffer_load_dwordx4 v243, s[64:67], s32 offen offset:1024 lds
    v_mfma_f32_16x16x32_bf16 v[20:23], a[248:251], a[0:3], v[20:23]
    s_waitcnt lgkmcnt(4)
    v_mfma_f32_16x16x32_bf16 v[24:27], v[6:9], a[0:3], v[24:27]
    ds_read_b64_tr_b16 a[248:249], v252 offset:12320
    v_mfma_f32_16x16x32_bf16 v[24:27], v[10:13], a[40:43], v[24:27]
    ds_read_b64_tr_b16 a[250:251], v252 offset:13856
    v_mfma_f32_16x16x32_bf16 v[64:67], v[10:13], a[44:47], v[64:67]
    v_mfma_f32_16x16x32_bf16 v[64:67], v[6:9], a[4:7], v[64:67]
    buffer_load_dwordx4 v244, s[64:67], s32 offen offset:2048 lds
    v_mfma_f32_16x16x32_bf16 v[104:107], v[6:9], a[8:11], v[104:107]
    v_mfma_f32_16x16x32_bf16 v[104:107], v[10:13], a[48:51], v[104:107]
    s_add_u32 s3, s54, s60
    ds_read_b64_tr_b16 a[252:253], v252 offset:24640
    v_mfma_f32_16x16x32_bf16 v[144:147], v[10:13], a[52:55], v[144:147]
    s_mul_i32 s35, s3, 10240
    ds_read_b64_tr_b16 a[254:255], v252 offset:26176
    v_mfma_f32_16x16x32_bf16 v[144:147], v[6:9], a[12:15], v[144:147]
    s_add_u32 s36, s35, 4096
    v_mfma_f32_16x16x32_bf16 v[184:187], v[6:9], a[16:19], v[184:187]
    buffer_load_dwordx4 a[20:23], v0, s[44:47], s35 offen sc1
    v_mfma_f32_16x16x32_bf16 v[184:187], v[10:13], a[56:59], v[184:187]
    s_waitcnt lgkmcnt(4)
    v_mfma_f32_16x16x32_bf16 v[188:191], a[244:247], a[56:59], v[188:191]
    ds_read_b64_tr_b16 v[6:7], v252 offset:12328
    v_mfma_f32_16x16x32_bf16 v[188:191], a[240:243], a[16:19], v[188:191]
    ds_read_b64_tr_b16 v[8:9], v252 offset:13864
    v_mfma_f32_16x16x32_bf16 v[148:151], a[240:243], a[12:15], v[148:151]
    v_mfma_f32_16x16x32_bf16 v[148:151], a[244:247], a[52:55], v[148:151]
    buffer_load_dwordx4 a[24:27], v0, s[44:47], s35 offen offset:1024 sc1
    v_mfma_f32_16x16x32_bf16 v[108:111], a[244:247], a[48:51], v[108:111]
    v_mfma_f32_16x16x32_bf16 v[108:111], a[240:243], a[8:11], v[108:111]
    ds_read_b64_tr_b16 v[10:11], v252 offset:24648
    v_mfma_f32_16x16x32_bf16 v[68:71], a[240:243], a[4:7], v[68:71]
    ds_read_b64_tr_b16 v[12:13], v252 offset:26184
    v_mfma_f32_16x16x32_bf16 v[68:71], a[244:247], a[44:47], v[68:71]
    v_mfma_f32_16x16x32_bf16 v[28:31], a[244:247], a[40:43], v[28:31]
    buffer_load_dwordx4 a[28:31], v0, s[44:47], s35 offen offset:2048 sc1
    v_mfma_f32_16x16x32_bf16 v[28:31], a[240:243], a[0:3], v[28:31]
    s_waitcnt lgkmcnt(4)
    v_mfma_f32_16x16x32_bf16 v[32:35], a[248:251], a[0:3], v[32:35]
    ds_read_b64_tr_b16 a[240:241], v253 offset:12320
    v_mfma_f32_16x16x32_bf16 v[32:35], a[252:255], a[40:43], v[32:35]
    ds_read_b64_tr_b16 a[242:243], v253 offset:13856
    v_mfma_f32_16x16x32_bf16 v[72:75], a[252:255], a[44:47], v[72:75]
    v_mfma_f32_16x16x32_bf16 v[72:75], a[248:251], a[4:7], v[72:75]
    buffer_load_dwordx4 a[32:35], v0, s[44:47], s35 offen offset:3072 sc1
    v_mfma_f32_16x16x32_bf16 v[112:115], a[248:251], a[8:11], v[112:115]
    v_mfma_f32_16x16x32_bf16 v[112:115], a[252:255], a[48:51], v[112:115]
    ds_read_b64_tr_b16 a[244:245], v253 offset:24640
    v_mfma_f32_16x16x32_bf16 v[152:155], a[252:255], a[52:55], v[152:155]
    ds_read_b64_tr_b16 a[246:247], v253 offset:26176
    v_mfma_f32_16x16x32_bf16 v[152:155], a[248:251], a[12:15], v[152:155]
    v_mfma_f32_16x16x32_bf16 v[192:195], a[248:251], a[16:19], v[192:195]
    buffer_load_dwordx4 a[36:39], v0, s[44:47], s36 offen sc1
    v_mfma_f32_16x16x32_bf16 v[192:195], a[252:255], a[56:59], v[192:195]
    s_waitcnt lgkmcnt(4)
    v_mfma_f32_16x16x32_bf16 v[196:199], v[10:13], a[56:59], v[196:199]
    s_add_u32 s3, s55, s60
    ds_read_b64_tr_b16 a[248:249], v253 offset:12328
    v_mfma_f32_16x16x32_bf16 v[196:199], v[6:9], a[16:19], v[196:199]
    s_mul_i32 s35, s3, 10240
    ds_read_b64_tr_b16 a[250:251], v253 offset:13864
    v_mfma_f32_16x16x32_bf16 v[156:159], v[6:9], a[12:15], v[156:159]
    s_add_u32 s36, s35, 4096
    v_mfma_f32_16x16x32_bf16 v[156:159], v[10:13], a[52:55], v[156:159]
    buffer_load_dwordx4 a[180:183], v0, s[44:47], s35 offen sc1
    v_mfma_f32_16x16x32_bf16 v[116:119], v[10:13], a[48:51], v[116:119]
    v_mfma_f32_16x16x32_bf16 v[116:119], v[6:9], a[8:11], v[116:119]
    ds_read_b64_tr_b16 a[252:253], v253 offset:24648
    v_mfma_f32_16x16x32_bf16 v[76:79], v[6:9], a[4:7], v[76:79]
    ds_read_b64_tr_b16 a[254:255], v253 offset:26184
    v_mfma_f32_16x16x32_bf16 v[76:79], v[10:13], a[44:47], v[76:79]
    v_mfma_f32_16x16x32_bf16 v[36:39], v[10:13], a[40:43], v[36:39]
    buffer_load_dwordx4 a[184:187], v0, s[44:47], s35 offen offset:1024 sc1
    v_mfma_f32_16x16x32_bf16 v[36:39], v[6:9], a[0:3], v[36:39]
    s_waitcnt lgkmcnt(4)
    v_mfma_f32_16x16x32_bf16 v[40:43], a[240:243], a[0:3], v[40:43]
    ds_read_b64_tr_b16 v[6:7], v254 offset:12320
    v_mfma_f32_16x16x32_bf16 v[40:43], a[244:247], a[40:43], v[40:43]
    ds_read_b64_tr_b16 v[8:9], v254 offset:13856
    v_mfma_f32_16x16x32_bf16 v[80:83], a[244:247], a[44:47], v[80:83]
    v_mfma_f32_16x16x32_bf16 v[80:83], a[240:243], a[4:7], v[80:83]
    buffer_load_dwordx4 a[188:191], v0, s[44:47], s35 offen offset:2048 sc1
    v_mfma_f32_16x16x32_bf16 v[120:123], a[240:243], a[8:11], v[120:123]
    v_mfma_f32_16x16x32_bf16 v[120:123], a[244:247], a[48:51], v[120:123]
    ds_read_b64_tr_b16 v[10:11], v254 offset:24640
    v_mfma_f32_16x16x32_bf16 v[160:163], a[244:247], a[52:55], v[160:163]
    ds_read_b64_tr_b16 v[12:13], v254 offset:26176
    v_mfma_f32_16x16x32_bf16 v[160:163], a[240:243], a[12:15], v[160:163]
    v_mfma_f32_16x16x32_bf16 v[200:203], a[240:243], a[16:19], v[200:203]
    buffer_load_dwordx4 a[192:195], v0, s[44:47], s35 offen offset:3072 sc1
    v_mfma_f32_16x16x32_bf16 v[200:203], a[244:247], a[56:59], v[200:203]
    s_waitcnt lgkmcnt(4)
    v_mfma_f32_16x16x32_bf16 v[204:207], a[252:255], a[56:59], v[204:207]
    ds_read_b64_tr_b16 a[240:241], v254 offset:12328
    v_mfma_f32_16x16x32_bf16 v[204:207], a[248:251], a[16:19], v[204:207]
    ds_read_b64_tr_b16 a[242:243], v254 offset:13864
    v_mfma_f32_16x16x32_bf16 v[164:167], a[248:251], a[12:15], v[164:167]
    v_mfma_f32_16x16x32_bf16 v[164:167], a[252:255], a[52:55], v[164:167]
    buffer_load_dwordx4 a[196:199], v0, s[44:47], s36 offen sc1
    v_mfma_f32_16x16x32_bf16 v[124:127], a[252:255], a[48:51], v[124:127]
    v_mfma_f32_16x16x32_bf16 v[124:127], a[248:251], a[8:11], v[124:127]
    s_add_u32 s3, s53, s61
    ds_read_b64_tr_b16 a[244:245], v254 offset:24648
    v_mfma_f32_16x16x32_bf16 v[84:87], a[248:251], a[4:7], v[84:87]
    s_mul_i32 s35, s3, 10240
    ds_read_b64_tr_b16 a[246:247], v254 offset:26184
    v_mfma_f32_16x16x32_bf16 v[84:87], a[252:255], a[44:47], v[84:87]
    s_add_u32 s36, s35, 4096
    v_mfma_f32_16x16x32_bf16 v[44:47], a[252:255], a[40:43], v[44:47]
    buffer_load_dwordx4 a[120:123], v0, s[44:47], s35 offen sc1
    v_mfma_f32_16x16x32_bf16 v[44:47], a[248:251], a[0:3], v[44:47]
    s_waitcnt lgkmcnt(4)
    s_waitcnt vmcnt(43)
    s_barrier
    v_mfma_f32_16x16x32_bf16 v[48:51], v[6:9], a[0:3], v[48:51]
    ds_read_b64_tr_b16 a[248:249], v250 offset:36960
    v_mfma_f32_16x16x32_bf16 v[48:51], v[10:13], a[40:43], v[48:51]
    ds_read_b64_tr_b16 a[250:251], v250 offset:38496
    v_mfma_f32_16x16x32_bf16 v[88:91], v[10:13], a[44:47], v[88:91]
    v_mfma_f32_16x16x32_bf16 v[88:91], v[6:9], a[4:7], v[88:91]
    buffer_load_dwordx4 a[124:127], v0, s[44:47], s35 offen offset:1024 sc1
    v_mfma_f32_16x16x32_bf16 v[128:131], v[6:9], a[8:11], v[128:131]
    v_mfma_f32_16x16x32_bf16 v[128:131], v[10:13], a[48:51], v[128:131]
    ds_read_b64_tr_b16 a[252:253], v250 offset:49280
    v_mfma_f32_16x16x32_bf16 v[168:171], v[10:13], a[52:55], v[168:171]
    ds_read_b64_tr_b16 a[254:255], v250 offset:50816
    v_mfma_f32_16x16x32_bf16 v[168:171], v[6:9], a[12:15], v[168:171]
    v_mfma_f32_16x16x32_bf16 v[208:211], v[6:9], a[16:19], v[208:211]
    buffer_load_dwordx4 a[128:131], v0, s[44:47], s35 offen offset:2048 sc1
    v_mfma_f32_16x16x32_bf16 v[208:211], v[10:13], a[56:59], v[208:211]
    s_waitcnt lgkmcnt(4)
    v_mfma_f32_16x16x32_bf16 v[212:215], a[244:247], a[56:59], v[212:215]
    ds_read_b64_tr_b16 v[6:7], v250 offset:36968
    v_mfma_f32_16x16x32_bf16 v[212:215], a[240:243], a[16:19], v[212:215]
    ds_read_b64_tr_b16 v[8:9], v250 offset:38504
    v_mfma_f32_16x16x32_bf16 v[172:175], a[240:243], a[12:15], v[172:175]
    v_mfma_f32_16x16x32_bf16 v[172:175], a[244:247], a[52:55], v[172:175]
    buffer_load_dwordx4 a[132:135], v0, s[44:47], s35 offen offset:3072 sc1
    v_mfma_f32_16x16x32_bf16 v[132:135], a[244:247], a[48:51], v[132:135]
    v_mfma_f32_16x16x32_bf16 v[132:135], a[240:243], a[8:11], v[132:135]
    ds_read_b64_tr_b16 v[10:11], v250 offset:49288
    v_mfma_f32_16x16x32_bf16 v[92:95], a[240:243], a[4:7], v[92:95]
    ds_read_b64_tr_b16 v[12:13], v250 offset:50824
    v_mfma_f32_16x16x32_bf16 v[92:95], a[244:247], a[44:47], v[92:95]
    v_mfma_f32_16x16x32_bf16 v[52:55], a[244:247], a[40:43], v[52:55]
    buffer_load_dwordx4 a[136:139], v0, s[44:47], s36 offen sc1
    v_mfma_f32_16x16x32_bf16 v[52:55], a[240:243], a[0:3], v[52:55]
    s_waitcnt lgkmcnt(4)
    s_waitcnt vmcnt(42)
    v_mfma_f32_16x16x32_bf16 v[16:19], a[248:251], a[60:63], v[16:19]
    s_add_u32 m0, s31, 49280
    ds_read_b64_tr_b16 a[240:241], v251 offset:36960
    v_mfma_f32_16x16x32_bf16 v[16:19], a[252:255], a[100:103], v[16:19]
    s_add_u32 s3, s55, s60
    ds_read_b64_tr_b16 a[242:243], v251 offset:38496
    v_mfma_f32_16x16x32_bf16 v[56:59], a[252:255], a[104:107], v[56:59]
    s_mul_i32 s32, s3, 40960
    v_mfma_f32_16x16x32_bf16 v[56:59], a[248:251], a[64:67], v[56:59]
    buffer_load_dwordx4 v242, s[64:67], s32 offen lds
    v_mfma_f32_16x16x32_bf16 v[96:99], a[248:251], a[68:71], v[96:99]
    v_mfma_f32_16x16x32_bf16 v[96:99], a[252:255], a[108:111], v[96:99]
    ds_read_b64_tr_b16 a[244:245], v251 offset:49280
    v_mfma_f32_16x16x32_bf16 v[136:139], a[252:255], a[112:115], v[136:139]
    ds_read_b64_tr_b16 a[246:247], v251 offset:50816
    v_mfma_f32_16x16x32_bf16 v[136:139], a[248:251], a[72:75], v[136:139]
    v_mfma_f32_16x16x32_bf16 v[176:179], a[248:251], a[76:79], v[176:179]
    buffer_load_dwordx4 v243, s[64:67], s32 offen offset:1024 lds
    v_mfma_f32_16x16x32_bf16 v[176:179], a[252:255], a[116:119], v[176:179]
    s_waitcnt lgkmcnt(4)
    v_mfma_f32_16x16x32_bf16 v[180:183], v[10:13], a[116:119], v[180:183]
    ds_read_b64_tr_b16 a[248:249], v251 offset:36968
    v_mfma_f32_16x16x32_bf16 v[180:183], v[6:9], a[76:79], v[180:183]
    ds_read_b64_tr_b16 a[250:251], v251 offset:38504
    v_mfma_f32_16x16x32_bf16 v[140:143], v[6:9], a[72:75], v[140:143]
    v_mfma_f32_16x16x32_bf16 v[140:143], v[10:13], a[112:115], v[140:143]
    buffer_load_dwordx4 v244, s[64:67], s32 offen offset:2048 lds
    v_mfma_f32_16x16x32_bf16 v[100:103], v[10:13], a[108:111], v[100:103]
    v_mfma_f32_16x16x32_bf16 v[100:103], v[6:9], a[68:71], v[100:103]
    s_add_u32 m0, s31, 61600
    ds_read_b64_tr_b16 a[252:253], v251 offset:49288
    v_mfma_f32_16x16x32_bf16 v[60:63], v[6:9], a[64:67], v[60:63]
    s_add_u32 s3, s53, s61
    ds_read_b64_tr_b16 a[254:255], v251 offset:50824
    v_mfma_f32_16x16x32_bf16 v[60:63], v[10:13], a[104:107], v[60:63]
    s_mul_i32 s32, s3, 40960
    v_mfma_f32_16x16x32_bf16 v[20:23], v[10:13], a[100:103], v[20:23]
    buffer_load_dwordx4 v242, s[64:67], s32 offen lds
    v_mfma_f32_16x16x32_bf16 v[20:23], v[6:9], a[60:63], v[20:23]
    s_waitcnt lgkmcnt(4)
    s_waitcnt vmcnt(35)
    s_barrier
    v_mfma_f32_16x16x32_bf16 v[24:27], a[240:243], a[60:63], v[24:27]
    ds_read_b64_tr_b16 v[6:7], v245 offset:0
    v_mfma_f32_16x16x32_bf16 v[24:27], a[244:247], a[100:103], v[24:27]
    ds_read_b64_tr_b16 v[8:9], v245 offset:1536
    v_mfma_f32_16x16x32_bf16 v[64:67], a[244:247], a[104:107], v[64:67]
    v_mfma_f32_16x16x32_bf16 v[64:67], a[240:243], a[64:67], v[64:67]
    buffer_load_dwordx4 v243, s[64:67], s32 offen offset:1024 lds
    v_mfma_f32_16x16x32_bf16 v[104:107], a[240:243], a[68:71], v[104:107]
    v_mfma_f32_16x16x32_bf16 v[104:107], a[244:247], a[108:111], v[104:107]
    ds_read_b64_tr_b16 v[10:11], v245 offset:12320
    v_mfma_f32_16x16x32_bf16 v[144:147], a[244:247], a[112:115], v[144:147]
    ds_read_b64_tr_b16 v[12:13], v245 offset:13856
    v_mfma_f32_16x16x32_bf16 v[144:147], a[240:243], a[72:75], v[144:147]
    v_mfma_f32_16x16x32_bf16 v[184:187], a[240:243], a[76:79], v[184:187]
    buffer_load_dwordx4 v244, s[64:67], s32 offen offset:2048 lds
    v_mfma_f32_16x16x32_bf16 v[184:187], a[244:247], a[116:119], v[184:187]
    s_waitcnt lgkmcnt(4)
    v_mfma_f32_16x16x32_bf16 v[188:191], a[252:255], a[116:119], v[188:191]
    s_add_u32 m0, s31, 73920
    ds_read_b64_tr_b16 a[240:241], v245 offset:8
    v_mfma_f32_16x16x32_bf16 v[188:191], a[248:251], a[76:79], v[188:191]
    s_add_u32 s3, s54, s61
    ds_read_b64_tr_b16 a[242:243], v245 offset:1544
    v_mfma_f32_16x16x32_bf16 v[148:151], a[248:251], a[72:75], v[148:151]
    s_mul_i32 s32, s3, 40960
    v_mfma_f32_16x16x32_bf16 v[148:151], a[252:255], a[112:115], v[148:151]
    buffer_load_dwordx4 v242, s[64:67], s32 offen lds
    v_mfma_f32_16x16x32_bf16 v[108:111], a[252:255], a[108:111], v[108:111]
    v_mfma_f32_16x16x32_bf16 v[108:111], a[248:251], a[68:71], v[108:111]
    ds_read_b64_tr_b16 a[244:245], v245 offset:12328
    v_mfma_f32_16x16x32_bf16 v[68:71], a[248:251], a[64:67], v[68:71]
    ds_read_b64_tr_b16 a[246:247], v245 offset:13864
    v_mfma_f32_16x16x32_bf16 v[68:71], a[252:255], a[104:107], v[68:71]
    v_mfma_f32_16x16x32_bf16 v[28:31], a[252:255], a[100:103], v[28:31]
    buffer_load_dwordx4 v243, s[64:67], s32 offen offset:1024 lds
    v_mfma_f32_16x16x32_bf16 v[28:31], a[248:251], a[60:63], v[28:31]
    s_waitcnt lgkmcnt(4)
    s_waitcnt vmcnt(34)
    v_mfma_f32_16x16x32_bf16 v[16:19], v[6:9], a[140:143], v[16:19]
    ds_read_b64_tr_b16 a[248:249], v246 offset:0
    v_mfma_f32_16x16x32_bf16 v[16:19], v[10:13], a[220:223], v[16:19]
    ds_read_b64_tr_b16 a[250:251], v246 offset:1536
    v_mfma_f32_16x16x32_bf16 v[56:59], v[10:13], a[224:227], v[56:59]
    v_mfma_f32_16x16x32_bf16 v[56:59], v[6:9], a[144:147], v[56:59]
    buffer_load_dwordx4 v244, s[64:67], s32 offen offset:2048 lds
    v_mfma_f32_16x16x32_bf16 v[96:99], v[6:9], a[148:151], v[96:99]
    v_mfma_f32_16x16x32_bf16 v[96:99], v[10:13], a[228:231], v[96:99]
    s_add_u32 s3, s54, s61
    ds_read_b64_tr_b16 a[252:253], v246 offset:12320
    v_mfma_f32_16x16x32_bf16 v[136:139], v[10:13], a[232:235], v[136:139]
    s_mul_i32 s35, s3, 10240
    ds_read_b64_tr_b16 a[254:255], v246 offset:13856
    v_mfma_f32_16x16x32_bf16 v[136:139], v[6:9], a[152:155], v[136:139]
    s_add_u32 s36, s35, 4096
    v_mfma_f32_16x16x32_bf16 v[176:179], v[6:9], a[156:159], v[176:179]
    buffer_load_dwordx4 a[160:163], v0, s[44:47], s35 offen sc1
    v_mfma_f32_16x16x32_bf16 v[176:179], v[10:13], a[236:239], v[176:179]
    s_waitcnt lgkmcnt(4)
    v_mfma_f32_16x16x32_bf16 v[180:183], a[244:247], a[236:239], v[180:183]
    ds_read_b64_tr_b16 v[6:7], v246 offset:8
    v_mfma_f32_16x16x32_bf16 v[180:183], a[240:243], a[156:159], v[180:183]
    ds_read_b64_tr_b16 v[8:9], v246 offset:1544
    v_mfma_f32_16x16x32_bf16 v[140:143], a[240:243], a[152:155], v[140:143]
    v_mfma_f32_16x16x32_bf16 v[140:143], a[244:247], a[232:235], v[140:143]
    buffer_load_dwordx4 a[164:167], v0, s[44:47], s35 offen offset:1024 sc1
    v_mfma_f32_16x16x32_bf16 v[100:103], a[244:247], a[228:231], v[100:103]
    v_mfma_f32_16x16x32_bf16 v[100:103], a[240:243], a[148:151], v[100:103]
    ds_read_b64_tr_b16 v[10:11], v246 offset:12328
    v_mfma_f32_16x16x32_bf16 v[60:63], a[240:243], a[144:147], v[60:63]
    ds_read_b64_tr_b16 v[12:13], v246 offset:13864
    v_mfma_f32_16x16x32_bf16 v[60:63], a[244:247], a[224:227], v[60:63]
    v_mfma_f32_16x16x32_bf16 v[20:23], a[244:247], a[220:223], v[20:23]
    buffer_load_dwordx4 a[168:171], v0, s[44:47], s35 offen offset:2048 sc1
    v_mfma_f32_16x16x32_bf16 v[20:23], a[240:243], a[140:143], v[20:23]
    s_waitcnt lgkmcnt(4)
    s_waitcnt vmcnt(27)
    s_barrier
    v_mfma_f32_16x16x32_bf16 v[24:27], a[248:251], a[140:143], v[24:27]
    ds_read_b64_tr_b16 a[240:241], v245 offset:24640
    v_mfma_f32_16x16x32_bf16 v[24:27], a[252:255], a[220:223], v[24:27]
    ds_read_b64_tr_b16 a[242:243], v245 offset:26176
    v_mfma_f32_16x16x32_bf16 v[64:67], a[252:255], a[224:227], v[64:67]
    v_mfma_f32_16x16x32_bf16 v[64:67], a[248:251], a[144:147], v[64:67]
    buffer_load_dwordx4 a[172:175], v0, s[44:47], s35 offen offset:3072 sc1
    v_mfma_f32_16x16x32_bf16 v[104:107], a[248:251], a[148:151], v[104:107]
    v_mfma_f32_16x16x32_bf16 v[104:107], a[252:255], a[228:231], v[104:107]
    ds_read_b64_tr_b16 a[244:245], v245 offset:36960
    v_mfma_f32_16x16x32_bf16 v[144:147], a[252:255], a[232:235], v[144:147]
    ds_read_b64_tr_b16 a[246:247], v245 offset:38496
    v_mfma_f32_16x16x32_bf16 v[144:147], a[248:251], a[152:155], v[144:147]
    v_mfma_f32_16x16x32_bf16 v[184:187], a[248:251], a[156:159], v[184:187]
    buffer_load_dwordx4 a[176:179], v0, s[44:47], s36 offen sc1
    v_mfma_f32_16x16x32_bf16 v[184:187], a[252:255], a[236:239], v[184:187]
    s_waitcnt lgkmcnt(4)
    v_mfma_f32_16x16x32_bf16 v[188:191], v[10:13], a[236:239], v[188:191]
    s_add_u32 m0, s31, 86240
    ds_read_b64_tr_b16 a[248:249], v245 offset:24648
    v_mfma_f32_16x16x32_bf16 v[188:191], v[6:9], a[156:159], v[188:191]
    s_add_u32 s3, s55, s61
    ds_read_b64_tr_b16 a[250:251], v245 offset:26184
    v_mfma_f32_16x16x32_bf16 v[148:151], v[6:9], a[152:155], v[148:151]
    s_mul_i32 s32, s3, 40960
    v_mfma_f32_16x16x32_bf16 v[148:151], v[10:13], a[232:235], v[148:151]
    buffer_load_dwordx4 v242, s[64:67], s32 offen lds
    v_mfma_f32_16x16x32_bf16 v[108:111], v[10:13], a[228:231], v[108:111]
    v_mfma_f32_16x16x32_bf16 v[108:111], v[6:9], a[148:151], v[108:111]
    ds_read_b64_tr_b16 a[252:253], v245 offset:36968
    v_mfma_f32_16x16x32_bf16 v[68:71], v[6:9], a[144:147], v[68:71]
    ds_read_b64_tr_b16 a[254:255], v245 offset:38504
    v_mfma_f32_16x16x32_bf16 v[68:71], v[10:13], a[224:227], v[68:71]
    v_mfma_f32_16x16x32_bf16 v[28:31], v[10:13], a[220:223], v[28:31]
    buffer_load_dwordx4 v243, s[64:67], s32 offen offset:1024 lds
    v_mfma_f32_16x16x32_bf16 v[28:31], v[6:9], a[140:143], v[28:31]
    s_waitcnt lgkmcnt(4)
    s_waitcnt vmcnt(26)
    v_mfma_f32_16x16x32_bf16 v[16:19], a[240:243], a[80:83], v[16:19]
    ds_read_b64_tr_b16 v[6:7], v246 offset:24640
    v_mfma_f32_16x16x32_bf16 v[16:19], a[244:247], a[20:23], v[16:19]
    ds_read_b64_tr_b16 v[8:9], v246 offset:26176
    v_mfma_f32_16x16x32_bf16 v[56:59], a[244:247], a[24:27], v[56:59]
    v_mfma_f32_16x16x32_bf16 v[56:59], a[240:243], a[84:87], v[56:59]
    buffer_load_dwordx4 v244, s[64:67], s32 offen offset:2048 lds
    v_mfma_f32_16x16x32_bf16 v[96:99], a[240:243], a[88:91], v[96:99]
    v_mfma_f32_16x16x32_bf16 v[96:99], a[244:247], a[28:31], v[96:99]
    s_add_u32 s3, s55, s61
    ds_read_b64_tr_b16 v[10:11], v246 offset:36960
    v_mfma_f32_16x16x32_bf16 v[136:139], a[244:247], a[32:35], v[136:139]
    s_mul_i32 s35, s3, 10240
    ds_read_b64_tr_b16 v[12:13], v246 offset:38496
    v_mfma_f32_16x16x32_bf16 v[136:139], a[240:243], a[92:95], v[136:139]
    s_add_u32 s36, s35, 4096
    v_mfma_f32_16x16x32_bf16 v[176:179], a[240:243], a[96:99], v[176:179]
    buffer_load_dwordx4 a[200:203], v0, s[44:47], s35 offen sc1
    v_mfma_f32_16x16x32_bf16 v[176:179], a[244:247], a[36:39], v[176:179]
    s_waitcnt lgkmcnt(4)
    v_mfma_f32_16x16x32_bf16 v[180:183], a[252:255], a[36:39], v[180:183]
    ds_read_b64_tr_b16 a[240:241], v246 offset:24648
    v_mfma_f32_16x16x32_bf16 v[180:183], a[248:251], a[96:99], v[180:183]
    ds_read_b64_tr_b16 a[242:243], v246 offset:26184
    v_mfma_f32_16x16x32_bf16 v[140:143], a[248:251], a[92:95], v[140:143]
    v_mfma_f32_16x16x32_bf16 v[140:143], a[252:255], a[32:35], v[140:143]
    buffer_load_dwordx4 a[204:207], v0, s[44:47], s35 offen offset:1024 sc1
    v_mfma_f32_16x16x32_bf16 v[100:103], a[252:255], a[28:31], v[100:103]
    v_mfma_f32_16x16x32_bf16 v[100:103], a[248:251], a[88:91], v[100:103]
    ds_read_b64_tr_b16 a[244:245], v246 offset:36968
    v_mfma_f32_16x16x32_bf16 v[60:63], a[248:251], a[84:87], v[60:63]
    ds_read_b64_tr_b16 a[246:247], v246 offset:38504
    v_mfma_f32_16x16x32_bf16 v[60:63], a[252:255], a[24:27], v[60:63]
    v_mfma_f32_16x16x32_bf16 v[20:23], a[252:255], a[20:23], v[20:23]
    buffer_load_dwordx4 a[208:211], v0, s[44:47], s35 offen offset:2048 sc1
    v_mfma_f32_16x16x32_bf16 v[20:23], a[248:251], a[80:83], v[20:23]
    s_waitcnt lgkmcnt(4)
    s_waitcnt vmcnt(14)
    s_barrier
    v_mfma_f32_16x16x32_bf16 v[24:27], v[6:9], a[80:83], v[24:27]
    ds_read_b64_tr_b16 a[248:249], v245 offset:49280
    v_mfma_f32_16x16x32_bf16 v[24:27], v[10:13], a[20:23], v[24:27]
    ds_read_b64_tr_b16 a[250:251], v245 offset:50816
    v_mfma_f32_16x16x32_bf16 v[64:67], v[10:13], a[24:27], v[64:67]
    v_mfma_f32_16x16x32_bf16 v[64:67], v[6:9], a[84:87], v[64:67]
    buffer_load_dwordx4 a[212:215], v0, s[44:47], s35 offen offset:3072 sc1
    v_mfma_f32_16x16x32_bf16 v[104:107], v[6:9], a[88:91], v[104:107]
    v_mfma_f32_16x16x32_bf16 v[104:107], v[10:13], a[28:31], v[104:107]
    ds_read_b64_tr_b16 a[252:253], v250 offset:0
    v_mfma_f32_16x16x32_bf16 v[144:147], v[10:13], a[32:35], v[144:147]
    ds_read_b64_tr_b16 a[254:255], v250 offset:1536
    v_mfma_f32_16x16x32_bf16 v[144:147], v[6:9], a[92:95], v[144:147]
    v_mfma_f32_16x16x32_bf16 v[184:187], v[6:9], a[96:99], v[184:187]
    buffer_load_dwordx4 a[216:219], v0, s[44:47], s36 offen sc1
    v_mfma_f32_16x16x32_bf16 v[184:187], v[10:13], a[36:39], v[184:187]
    s_waitcnt lgkmcnt(4)
    v_mfma_f32_16x16x32_bf16 v[188:191], a[244:247], a[36:39], v[188:191]
    ds_read_b64_tr_b16 v[6:7], v245 offset:49288
    v_mfma_f32_16x16x32_bf16 v[188:191], a[240:243], a[96:99], v[188:191]
    ds_read_b64_tr_b16 v[8:9], v245 offset:50824
    v_mfma_f32_16x16x32_bf16 v[148:151], a[240:243], a[92:95], v[148:151]
    v_mfma_f32_16x16x32_bf16 v[148:151], a[244:247], a[32:35], v[148:151]
    v_mfma_f32_16x16x32_bf16 v[108:111], a[244:247], a[28:31], v[108:111]
    v_mfma_f32_16x16x32_bf16 v[108:111], a[240:243], a[88:91], v[108:111]
    ds_read_b64_tr_b16 v[10:11], v250 offset:8
    v_mfma_f32_16x16x32_bf16 v[68:71], a[240:243], a[84:87], v[68:71]
    ds_read_b64_tr_b16 v[12:13], v250 offset:1544
    v_mfma_f32_16x16x32_bf16 v[68:71], a[244:247], a[24:27], v[68:71]
    v_mfma_f32_16x16x32_bf16 v[28:31], a[244:247], a[20:23], v[28:31]
    v_mfma_f32_16x16x32_bf16 v[28:31], a[240:243], a[80:83], v[28:31]
    s_waitcnt lgkmcnt(4)
    s_waitcnt vmcnt(22)
    v_mfma_f32_16x16x32_bf16 v[16:19], a[248:251], a[180:183], v[16:19]
    ds_read_b64_tr_b16 a[240:241], v246 offset:49280
    v_mfma_f32_16x16x32_bf16 v[16:19], a[252:255], a[120:123], v[16:19]
    ds_read_b64_tr_b16 a[242:243], v246 offset:50816
    v_mfma_f32_16x16x32_bf16 v[56:59], a[252:255], a[124:127], v[56:59]
    v_mfma_f32_16x16x32_bf16 v[56:59], a[248:251], a[184:187], v[56:59]
    v_mfma_f32_16x16x32_bf16 v[96:99], a[248:251], a[188:191], v[96:99]
    v_mfma_f32_16x16x32_bf16 v[96:99], a[252:255], a[128:131], v[96:99]
    ds_read_b64_tr_b16 a[244:245], v251 offset:0
    v_mfma_f32_16x16x32_bf16 v[136:139], a[252:255], a[132:135], v[136:139]
    ds_read_b64_tr_b16 a[246:247], v251 offset:1536
    v_mfma_f32_16x16x32_bf16 v[136:139], a[248:251], a[192:195], v[136:139]
    v_mfma_f32_16x16x32_bf16 v[176:179], a[248:251], a[196:199], v[176:179]
    v_mfma_f32_16x16x32_bf16 v[176:179], a[252:255], a[136:139], v[176:179]
    s_waitcnt lgkmcnt(4)
    v_mfma_f32_16x16x32_bf16 v[180:183], v[10:13], a[136:139], v[180:183]
    ds_read_b64_tr_b16 a[248:249], v246 offset:49288
    v_mfma_f32_16x16x32_bf16 v[180:183], v[6:9], a[196:199], v[180:183]
    ds_read_b64_tr_b16 a[250:251], v246 offset:50824
    v_mfma_f32_16x16x32_bf16 v[140:143], v[6:9], a[192:195], v[140:143]
    v_mfma_f32_16x16x32_bf16 v[140:143], v[10:13], a[132:135], v[140:143]
    v_mfma_f32_16x16x32_bf16 v[100:103], v[10:13], a[128:131], v[100:103]
    v_mfma_f32_16x16x32_bf16 v[100:103], v[6:9], a[188:191], v[100:103]
    ds_read_b64_tr_b16 a[252:253], v251 offset:8
    v_mfma_f32_16x16x32_bf16 v[60:63], v[6:9], a[184:187], v[60:63]
    ds_read_b64_tr_b16 a[254:255], v251 offset:1544
    v_mfma_f32_16x16x32_bf16 v[60:63], v[10:13], a[124:127], v[60:63]
    v_mfma_f32_16x16x32_bf16 v[20:23], v[10:13], a[120:123], v[20:23]
    v_mfma_f32_16x16x32_bf16 v[20:23], v[6:9], a[180:183], v[20:23]
    s_waitcnt lgkmcnt(4)
    s_waitcnt vmcnt(5)
    s_barrier
    v_mfma_f32_16x16x32_bf16 v[24:27], a[240:243], a[180:183], v[24:27]
    ds_read_b64_tr_b16 v[6:7], v250 offset:12320
    v_mfma_f32_16x16x32_bf16 v[24:27], a[244:247], a[120:123], v[24:27]
    ds_read_b64_tr_b16 v[8:9], v250 offset:13856
    v_mfma_f32_16x16x32_bf16 v[64:67], a[244:247], a[124:127], v[64:67]
    v_mfma_f32_16x16x32_bf16 v[64:67], a[240:243], a[184:187], v[64:67]
    v_mfma_f32_16x16x32_bf16 v[104:107], a[240:243], a[188:191], v[104:107]
    v_mfma_f32_16x16x32_bf16 v[104:107], a[244:247], a[128:131], v[104:107]
    ds_read_b64_tr_b16 v[10:11], v250 offset:24640
    v_mfma_f32_16x16x32_bf16 v[144:147], a[244:247], a[132:135], v[144:147]
    ds_read_b64_tr_b16 v[12:13], v250 offset:26176
    v_mfma_f32_16x16x32_bf16 v[144:147], a[240:243], a[192:195], v[144:147]
    v_mfma_f32_16x16x32_bf16 v[184:187], a[240:243], a[196:199], v[184:187]
    v_mfma_f32_16x16x32_bf16 v[184:187], a[244:247], a[136:139], v[184:187]
    s_waitcnt lgkmcnt(4)
    v_mfma_f32_16x16x32_bf16 v[188:191], a[252:255], a[136:139], v[188:191]
    ds_read_b64_tr_b16 a[240:241], v250 offset:12328
    v_mfma_f32_16x16x32_bf16 v[188:191], a[248:251], a[196:199], v[188:191]
    ds_read_b64_tr_b16 a[242:243], v250 offset:13864
    v_mfma_f32_16x16x32_bf16 v[148:151], a[248:251], a[192:195], v[148:151]
    v_mfma_f32_16x16x32_bf16 v[148:151], a[252:255], a[132:135], v[148:151]
    v_mfma_f32_16x16x32_bf16 v[108:111], a[252:255], a[128:131], v[108:111]
    v_mfma_f32_16x16x32_bf16 v[108:111], a[248:251], a[188:191], v[108:111]
    ds_read_b64_tr_b16 a[244:245], v250 offset:24648
    v_mfma_f32_16x16x32_bf16 v[68:71], a[248:251], a[184:187], v[68:71]
    ds_read_b64_tr_b16 a[246:247], v250 offset:26184
    v_mfma_f32_16x16x32_bf16 v[68:71], a[252:255], a[124:127], v[68:71]
    v_mfma_f32_16x16x32_bf16 v[28:31], a[252:255], a[120:123], v[28:31]
    v_mfma_f32_16x16x32_bf16 v[28:31], a[248:251], a[180:183], v[28:31]
    s_waitcnt lgkmcnt(4)
    s_waitcnt vmcnt(0)
    v_mfma_f32_16x16x32_bf16 v[16:19], v[6:9], a[160:163], v[16:19]
    ds_read_b64_tr_b16 a[248:249], v251 offset:12320
    v_mfma_f32_16x16x32_bf16 v[16:19], v[10:13], a[200:203], v[16:19]
    ds_read_b64_tr_b16 a[250:251], v251 offset:13856
    v_mfma_f32_16x16x32_bf16 v[56:59], v[10:13], a[204:207], v[56:59]
    v_mfma_f32_16x16x32_bf16 v[56:59], v[6:9], a[164:167], v[56:59]
    v_mfma_f32_16x16x32_bf16 v[96:99], v[6:9], a[168:171], v[96:99]
    v_mfma_f32_16x16x32_bf16 v[96:99], v[10:13], a[208:211], v[96:99]
    ds_read_b64_tr_b16 a[252:253], v251 offset:24640
    v_mfma_f32_16x16x32_bf16 v[136:139], v[10:13], a[212:215], v[136:139]
    ds_read_b64_tr_b16 a[254:255], v251 offset:26176
    v_mfma_f32_16x16x32_bf16 v[136:139], v[6:9], a[172:175], v[136:139]
    v_mfma_f32_16x16x32_bf16 v[176:179], v[6:9], a[176:179], v[176:179]
    v_mfma_f32_16x16x32_bf16 v[176:179], v[10:13], a[216:219], v[176:179]
    s_waitcnt lgkmcnt(4)
    v_mfma_f32_16x16x32_bf16 v[180:183], a[244:247], a[216:219], v[180:183]
    ds_read_b64_tr_b16 v[6:7], v251 offset:12328
    v_mfma_f32_16x16x32_bf16 v[180:183], a[240:243], a[176:179], v[180:183]
    ds_read_b64_tr_b16 v[8:9], v251 offset:13864
    v_mfma_f32_16x16x32_bf16 v[140:143], a[240:243], a[172:175], v[140:143]
    v_mfma_f32_16x16x32_bf16 v[140:143], a[244:247], a[212:215], v[140:143]
    v_mfma_f32_16x16x32_bf16 v[100:103], a[244:247], a[208:211], v[100:103]
    v_mfma_f32_16x16x32_bf16 v[100:103], a[240:243], a[168:171], v[100:103]
    ds_read_b64_tr_b16 v[10:11], v251 offset:24648
    v_mfma_f32_16x16x32_bf16 v[60:63], a[240:243], a[164:167], v[60:63]
    ds_read_b64_tr_b16 v[12:13], v251 offset:26184
    v_mfma_f32_16x16x32_bf16 v[60:63], a[244:247], a[204:207], v[60:63]
    v_mfma_f32_16x16x32_bf16 v[20:23], a[244:247], a[200:203], v[20:23]
    v_mfma_f32_16x16x32_bf16 v[20:23], a[240:243], a[160:163], v[20:23]
    s_waitcnt lgkmcnt(4)
    v_mfma_f32_16x16x32_bf16 v[24:27], a[248:251], a[160:163], v[24:27]
    ds_read_b64_tr_b16 a[240:241], v252 offset:36960
    v_mfma_f32_16x16x32_bf16 v[24:27], a[252:255], a[200:203], v[24:27]
    ds_read_b64_tr_b16 a[242:243], v252 offset:38496
    v_mfma_f32_16x16x32_bf16 v[64:67], a[252:255], a[204:207], v[64:67]
    v_mfma_f32_16x16x32_bf16 v[64:67], a[248:251], a[164:167], v[64:67]
    v_mfma_f32_16x16x32_bf16 v[104:107], a[248:251], a[168:171], v[104:107]
    v_cvt_pk_bf16_f32 v56, v56, v57
    v_cvt_pk_bf16_f32 v57, v58, v59
    v_mfma_f32_16x16x32_bf16 v[104:107], a[252:255], a[208:211], v[104:107]
    s_mul_i32 s100, s9, 5
    ds_read_b64_tr_b16 a[244:245], v252 offset:49280
    v_cvt_pk_bf16_f32 v58, v60, v61
    v_mfma_f32_16x16x32_bf16 v[144:147], a[252:255], a[212:215], v[144:147]
    s_add_u32 s100, s100, s13
    ds_read_b64_tr_b16 a[246:247], v252 offset:50816
    v_cvt_pk_bf16_f32 v59, v62, v63
    v_mfma_f32_16x16x32_bf16 v[144:147], a[248:251], a[172:175], v[144:147]
    s_mul_i32 s100, s100, 1024
    v_mfma_f32_16x16x32_bf16 v[184:187], a[248:251], a[176:179], v[184:187]
    s_add_u32 s100, s100, s18
    buffer_store_dwordx4 v[56:59], v0, s[68:71], s100 offen sc1
    v_mfma_f32_16x16x32_bf16 v[184:187], a[252:255], a[216:219], v[184:187]
    s_waitcnt lgkmcnt(4)
    v_cvt_pk_bf16_f32 v96, v96, v97
    v_cvt_pk_bf16_f32 v97, v98, v99
    v_mfma_f32_16x16x32_bf16 v[188:191], v[10:13], a[216:219], v[188:191]
    s_mul_i32 s100, s10, 5
    ds_read_b64_tr_b16 a[248:249], v252 offset:36968
    v_cvt_pk_bf16_f32 v98, v100, v101
    v_mfma_f32_16x16x32_bf16 v[188:191], v[6:9], a[176:179], v[188:191]
    s_add_u32 s100, s100, s13
    ds_read_b64_tr_b16 a[250:251], v252 offset:38504
    v_cvt_pk_bf16_f32 v99, v102, v103
    v_mfma_f32_16x16x32_bf16 v[148:151], v[6:9], a[172:175], v[148:151]
    s_mul_i32 s100, s100, 1024
    v_mfma_f32_16x16x32_bf16 v[148:151], v[10:13], a[212:215], v[148:151]
    s_add_u32 s100, s100, s18
    buffer_store_dwordx4 v[96:99], v0, s[68:71], s100 offen sc1
    v_mfma_f32_16x16x32_bf16 v[108:111], v[10:13], a[208:211], v[108:111]
    v_cvt_pk_bf16_f32 v136, v136, v137
    v_cvt_pk_bf16_f32 v137, v138, v139
    v_mfma_f32_16x16x32_bf16 v[108:111], v[6:9], a[168:171], v[108:111]
    s_mul_i32 s100, s11, 5
    ds_read_b64_tr_b16 a[252:253], v252 offset:49288
    v_cvt_pk_bf16_f32 v138, v140, v141
    v_mfma_f32_16x16x32_bf16 v[68:71], v[6:9], a[164:167], v[68:71]
    s_add_u32 s100, s100, s13
    ds_read_b64_tr_b16 a[254:255], v252 offset:50824
    v_cvt_pk_bf16_f32 v139, v142, v143
    v_mfma_f32_16x16x32_bf16 v[68:71], v[10:13], a[204:207], v[68:71]
    s_mul_i32 s100, s100, 1024
    v_mfma_f32_16x16x32_bf16 v[28:31], v[10:13], a[200:203], v[28:31]
    s_add_u32 s100, s100, s18
    buffer_store_dwordx4 v[136:139], v0, s[68:71], s100 offen sc1
    v_mfma_f32_16x16x32_bf16 v[28:31], v[6:9], a[160:163], v[28:31]
    s_waitcnt lgkmcnt(4)
    v_cvt_pk_bf16_f32 v232, v176, v177
    v_cvt_pk_bf16_f32 v233, v178, v179
    v_mfma_f32_16x16x32_bf16 v[32:35], a[240:243], a[60:63], v[32:35]
    s_mul_i32 s100, s12, 5
    ds_read_b64_tr_b16 v[6:7], v247 offset:0
    v_cvt_pk_bf16_f32 v234, v180, v181
    v_mfma_f32_16x16x32_bf16 v[32:35], a[244:247], a[100:103], v[32:35]
    s_add_u32 s100, s100, s13
    ds_read_b64_tr_b16 v[8:9], v247 offset:1536
    v_cvt_pk_bf16_f32 v235, v182, v183
    v_mfma_f32_16x16x32_bf16 v[72:75], a[244:247], a[104:107], v[72:75]
    s_mul_i32 s100, s100, 1024
    v_mfma_f32_16x16x32_bf16 v[72:75], a[240:243], a[64:67], v[72:75]
    s_add_u32 s100, s100, s18
    buffer_store_dwordx4 v[232:235], v0, s[68:71], s100 offen sc1
    v_mfma_f32_16x16x32_bf16 v[112:115], a[240:243], a[68:71], v[112:115]
    v_cvt_pk_bf16_f32 v24, v24, v25
    v_cvt_pk_bf16_f32 v25, v26, v27
    v_mfma_f32_16x16x32_bf16 v[112:115], a[244:247], a[108:111], v[112:115]
    s_mul_i32 s100, s8, 5
    ds_read_b64_tr_b16 v[10:11], v247 offset:12320
    v_cvt_pk_bf16_f32 v26, v28, v29
    v_mfma_f32_16x16x32_bf16 v[152:155], a[244:247], a[112:115], v[152:155]
    s_add_u32 s100, s100, s14
    ds_read_b64_tr_b16 v[12:13], v247 offset:13856
    v_cvt_pk_bf16_f32 v27, v30, v31
    v_mfma_f32_16x16x32_bf16 v[152:155], a[240:243], a[72:75], v[152:155]
    s_mul_i32 s100, s100, 1024
    v_mfma_f32_16x16x32_bf16 v[192:195], a[240:243], a[76:79], v[192:195]
    s_add_u32 s100, s100, s18
    buffer_store_dwordx4 v[24:27], v0, s[68:71], s100 offen sc1
    v_mfma_f32_16x16x32_bf16 v[192:195], a[244:247], a[116:119], v[192:195]
    s_waitcnt lgkmcnt(4)
    v_mfma_f32_16x16x32_bf16 v[196:199], a[252:255], a[116:119], v[196:199]
    ds_read_b64_tr_b16 a[240:241], v247 offset:8
    v_mfma_f32_16x16x32_bf16 v[196:199], a[248:251], a[76:79], v[196:199]
    ds_read_b64_tr_b16 a[242:243], v247 offset:1544
    v_mfma_f32_16x16x32_bf16 v[156:159], a[248:251], a[72:75], v[156:159]
    v_mfma_f32_16x16x32_bf16 v[156:159], a[252:255], a[112:115], v[156:159]
    v_mfma_f32_16x16x32_bf16 v[116:119], a[252:255], a[108:111], v[116:119]
    v_cvt_pk_bf16_f32 v64, v64, v65
    v_cvt_pk_bf16_f32 v65, v66, v67
    v_mfma_f32_16x16x32_bf16 v[116:119], a[248:251], a[68:71], v[116:119]
    s_mul_i32 s100, s9, 5
    ds_read_b64_tr_b16 a[244:245], v247 offset:12328
    v_cvt_pk_bf16_f32 v66, v68, v69
    v_mfma_f32_16x16x32_bf16 v[76:79], a[248:251], a[64:67], v[76:79]
    s_add_u32 s100, s100, s14
    ds_read_b64_tr_b16 a[246:247], v247 offset:13864
    v_cvt_pk_bf16_f32 v67, v70, v71
    v_mfma_f32_16x16x32_bf16 v[76:79], a[252:255], a[104:107], v[76:79]
    s_mul_i32 s100, s100, 1024
    v_mfma_f32_16x16x32_bf16 v[36:39], a[252:255], a[100:103], v[36:39]
    s_add_u32 s100, s100, s18
    buffer_store_dwordx4 v[64:67], v0, s[68:71], s100 offen sc1
    v_mfma_f32_16x16x32_bf16 v[36:39], a[248:251], a[60:63], v[36:39]
    s_waitcnt lgkmcnt(4)
    v_mfma_f32_16x16x32_bf16 v[32:35], v[6:9], a[140:143], v[32:35]
    ds_read_b64_tr_b16 a[248:249], v247 offset:24640
    v_mfma_f32_16x16x32_bf16 v[32:35], v[10:13], a[220:223], v[32:35]
    ds_read_b64_tr_b16 a[250:251], v247 offset:26176
    v_mfma_f32_16x16x32_bf16 v[72:75], v[10:13], a[224:227], v[72:75]
    v_mfma_f32_16x16x32_bf16 v[72:75], v[6:9], a[144:147], v[72:75]
    v_mfma_f32_16x16x32_bf16 v[112:115], v[6:9], a[148:151], v[112:115]
    v_cvt_pk_bf16_f32 v104, v104, v105
    v_cvt_pk_bf16_f32 v105, v106, v107
    v_mfma_f32_16x16x32_bf16 v[112:115], v[10:13], a[228:231], v[112:115]
    s_mul_i32 s100, s10, 5
    ds_read_b64_tr_b16 a[252:253], v247 offset:36960
    v_cvt_pk_bf16_f32 v106, v108, v109
    v_mfma_f32_16x16x32_bf16 v[152:155], v[10:13], a[232:235], v[152:155]
    s_add_u32 s100, s100, s14
    ds_read_b64_tr_b16 a[254:255], v247 offset:38496
    v_cvt_pk_bf16_f32 v107, v110, v111
    v_mfma_f32_16x16x32_bf16 v[152:155], v[6:9], a[152:155], v[152:155]
    s_mul_i32 s100, s100, 1024
    v_mfma_f32_16x16x32_bf16 v[192:195], v[6:9], a[156:159], v[192:195]
    s_add_u32 s100, s100, s18
    buffer_store_dwordx4 v[104:107], v0, s[68:71], s100 offen sc1
    v_mfma_f32_16x16x32_bf16 v[192:195], v[10:13], a[236:239], v[192:195]
    s_waitcnt lgkmcnt(4)
    v_mfma_f32_16x16x32_bf16 v[196:199], a[244:247], a[236:239], v[196:199]
    ds_read_b64_tr_b16 v[6:7], v247 offset:24648
    v_mfma_f32_16x16x32_bf16 v[196:199], a[240:243], a[156:159], v[196:199]
    ds_read_b64_tr_b16 v[8:9], v247 offset:26184
    v_mfma_f32_16x16x32_bf16 v[156:159], a[240:243], a[152:155], v[156:159]
    v_mfma_f32_16x16x32_bf16 v[156:159], a[244:247], a[232:235], v[156:159]
    v_mfma_f32_16x16x32_bf16 v[116:119], a[244:247], a[228:231], v[116:119]
    v_cvt_pk_bf16_f32 v144, v144, v145
    v_cvt_pk_bf16_f32 v145, v146, v147
    v_mfma_f32_16x16x32_bf16 v[116:119], a[240:243], a[148:151], v[116:119]
    s_mul_i32 s100, s11, 5
    ds_read_b64_tr_b16 v[10:11], v247 offset:36968
    v_cvt_pk_bf16_f32 v146, v148, v149
    v_mfma_f32_16x16x32_bf16 v[76:79], a[240:243], a[144:147], v[76:79]
    s_add_u32 s100, s100, s14
    ds_read_b64_tr_b16 v[12:13], v247 offset:38504
    v_cvt_pk_bf16_f32 v147, v150, v151
    v_mfma_f32_16x16x32_bf16 v[76:79], a[244:247], a[224:227], v[76:79]
    s_mul_i32 s100, s100, 1024
    v_mfma_f32_16x16x32_bf16 v[36:39], a[244:247], a[220:223], v[36:39]
    s_add_u32 s100, s100, s18
    buffer_store_dwordx4 v[144:147], v0, s[68:71], s100 offen sc1
    v_mfma_f32_16x16x32_bf16 v[36:39], a[240:243], a[140:143], v[36:39]
    s_waitcnt lgkmcnt(4)
    v_mfma_f32_16x16x32_bf16 v[32:35], a[248:251], a[80:83], v[32:35]
    ds_read_b64_tr_b16 a[240:241], v247 offset:49280
    v_mfma_f32_16x16x32_bf16 v[32:35], a[252:255], a[20:23], v[32:35]
    ds_read_b64_tr_b16 a[242:243], v247 offset:50816
    v_mfma_f32_16x16x32_bf16 v[72:75], a[252:255], a[24:27], v[72:75]
    v_mfma_f32_16x16x32_bf16 v[72:75], a[248:251], a[84:87], v[72:75]
    v_mfma_f32_16x16x32_bf16 v[112:115], a[248:251], a[88:91], v[112:115]
    v_cvt_pk_bf16_f32 v184, v184, v185
    v_cvt_pk_bf16_f32 v185, v186, v187
    v_mfma_f32_16x16x32_bf16 v[112:115], a[252:255], a[28:31], v[112:115]
    s_mul_i32 s100, s12, 5
    ds_read_b64_tr_b16 a[244:245], v252 offset:0
    v_cvt_pk_bf16_f32 v186, v188, v189
    v_mfma_f32_16x16x32_bf16 v[152:155], a[252:255], a[32:35], v[152:155]
    s_add_u32 s100, s100, s14
    ds_read_b64_tr_b16 a[246:247], v252 offset:1536
    v_cvt_pk_bf16_f32 v187, v190, v191
    v_mfma_f32_16x16x32_bf16 v[152:155], a[248:251], a[92:95], v[152:155]
    s_mul_i32 s100, s100, 1024
    v_mfma_f32_16x16x32_bf16 v[192:195], a[248:251], a[96:99], v[192:195]
    s_add_u32 s100, s100, s18
    buffer_store_dwordx4 v[184:187], v0, s[68:71], s100 offen sc1
    v_mfma_f32_16x16x32_bf16 v[192:195], a[252:255], a[36:39], v[192:195]
    s_waitcnt lgkmcnt(4)
    v_mfma_f32_16x16x32_bf16 v[196:199], v[10:13], a[36:39], v[196:199]
    ds_read_b64_tr_b16 a[248:249], v247 offset:49288
    v_mfma_f32_16x16x32_bf16 v[196:199], v[6:9], a[96:99], v[196:199]
    ds_read_b64_tr_b16 a[250:251], v247 offset:50824
    v_mfma_f32_16x16x32_bf16 v[156:159], v[6:9], a[92:95], v[156:159]
    v_mfma_f32_16x16x32_bf16 v[156:159], v[10:13], a[32:35], v[156:159]
    v_mfma_f32_16x16x32_bf16 v[116:119], v[10:13], a[28:31], v[116:119]
    v_mfma_f32_16x16x32_bf16 v[116:119], v[6:9], a[88:91], v[116:119]
    ds_read_b64_tr_b16 a[252:253], v252 offset:8
    v_mfma_f32_16x16x32_bf16 v[76:79], v[6:9], a[84:87], v[76:79]
    ds_read_b64_tr_b16 a[254:255], v252 offset:1544
    v_mfma_f32_16x16x32_bf16 v[76:79], v[10:13], a[24:27], v[76:79]
    v_mfma_f32_16x16x32_bf16 v[36:39], v[10:13], a[20:23], v[36:39]
    v_mfma_f32_16x16x32_bf16 v[36:39], v[6:9], a[80:83], v[36:39]
    s_waitcnt lgkmcnt(4)
    v_mfma_f32_16x16x32_bf16 v[32:35], a[240:243], a[180:183], v[32:35]
    ds_read_b64_tr_b16 v[6:7], v252 offset:12320
    v_mfma_f32_16x16x32_bf16 v[32:35], a[244:247], a[120:123], v[32:35]
    ds_read_b64_tr_b16 v[8:9], v252 offset:13856
    v_mfma_f32_16x16x32_bf16 v[72:75], a[244:247], a[124:127], v[72:75]
    v_mfma_f32_16x16x32_bf16 v[72:75], a[240:243], a[184:187], v[72:75]
    v_mfma_f32_16x16x32_bf16 v[112:115], a[240:243], a[188:191], v[112:115]
    v_mfma_f32_16x16x32_bf16 v[112:115], a[244:247], a[128:131], v[112:115]
    ds_read_b64_tr_b16 v[10:11], v252 offset:24640
    v_mfma_f32_16x16x32_bf16 v[152:155], a[244:247], a[132:135], v[152:155]
    ds_read_b64_tr_b16 v[12:13], v252 offset:26176
    v_mfma_f32_16x16x32_bf16 v[152:155], a[240:243], a[192:195], v[152:155]
    v_mfma_f32_16x16x32_bf16 v[192:195], a[240:243], a[196:199], v[192:195]
    v_mfma_f32_16x16x32_bf16 v[192:195], a[244:247], a[136:139], v[192:195]
    s_waitcnt lgkmcnt(4)
    v_mfma_f32_16x16x32_bf16 v[196:199], a[252:255], a[136:139], v[196:199]
    ds_read_b64_tr_b16 a[240:241], v252 offset:12328
    v_mfma_f32_16x16x32_bf16 v[196:199], a[248:251], a[196:199], v[196:199]
    ds_read_b64_tr_b16 a[242:243], v252 offset:13864
    v_mfma_f32_16x16x32_bf16 v[156:159], a[248:251], a[192:195], v[156:159]
    v_mfma_f32_16x16x32_bf16 v[156:159], a[252:255], a[132:135], v[156:159]
    v_mfma_f32_16x16x32_bf16 v[116:119], a[252:255], a[128:131], v[116:119]
    v_mfma_f32_16x16x32_bf16 v[116:119], a[248:251], a[188:191], v[116:119]
    ds_read_b64_tr_b16 a[244:245], v252 offset:24648
    v_mfma_f32_16x16x32_bf16 v[76:79], a[248:251], a[184:187], v[76:79]
    ds_read_b64_tr_b16 a[246:247], v252 offset:26184
    v_mfma_f32_16x16x32_bf16 v[76:79], a[252:255], a[124:127], v[76:79]
    v_mfma_f32_16x16x32_bf16 v[36:39], a[252:255], a[120:123], v[36:39]
    v_mfma_f32_16x16x32_bf16 v[36:39], a[248:251], a[180:183], v[36:39]
    s_waitcnt lgkmcnt(4)
    v_mfma_f32_16x16x32_bf16 v[32:35], v[6:9], a[160:163], v[32:35]
    ds_read_b64_tr_b16 a[248:249], v253 offset:36960
    v_mfma_f32_16x16x32_bf16 v[32:35], v[10:13], a[200:203], v[32:35]
    ds_read_b64_tr_b16 a[250:251], v253 offset:38496
    v_mfma_f32_16x16x32_bf16 v[72:75], v[10:13], a[204:207], v[72:75]
    v_mfma_f32_16x16x32_bf16 v[72:75], v[6:9], a[164:167], v[72:75]
    v_mfma_f32_16x16x32_bf16 v[112:115], v[6:9], a[168:171], v[112:115]
    v_mfma_f32_16x16x32_bf16 v[112:115], v[10:13], a[208:211], v[112:115]
    ds_read_b64_tr_b16 a[252:253], v253 offset:49280
    v_mfma_f32_16x16x32_bf16 v[152:155], v[10:13], a[212:215], v[152:155]
    ds_read_b64_tr_b16 a[254:255], v253 offset:50816
    v_mfma_f32_16x16x32_bf16 v[152:155], v[6:9], a[172:175], v[152:155]
    v_mfma_f32_16x16x32_bf16 v[192:195], v[6:9], a[176:179], v[192:195]
    v_mfma_f32_16x16x32_bf16 v[192:195], v[10:13], a[216:219], v[192:195]
    s_waitcnt lgkmcnt(4)
    v_mfma_f32_16x16x32_bf16 v[196:199], a[244:247], a[216:219], v[196:199]
    ds_read_b64_tr_b16 v[6:7], v253 offset:36968
    v_mfma_f32_16x16x32_bf16 v[196:199], a[240:243], a[176:179], v[196:199]
    ds_read_b64_tr_b16 v[8:9], v253 offset:38504
    v_mfma_f32_16x16x32_bf16 v[156:159], a[240:243], a[172:175], v[156:159]
    v_mfma_f32_16x16x32_bf16 v[156:159], a[244:247], a[212:215], v[156:159]
    v_mfma_f32_16x16x32_bf16 v[116:119], a[244:247], a[208:211], v[116:119]
    v_mfma_f32_16x16x32_bf16 v[116:119], a[240:243], a[168:171], v[116:119]
    ds_read_b64_tr_b16 v[10:11], v253 offset:49288
    v_mfma_f32_16x16x32_bf16 v[76:79], a[240:243], a[164:167], v[76:79]
    ds_read_b64_tr_b16 v[12:13], v253 offset:50824
    v_mfma_f32_16x16x32_bf16 v[76:79], a[244:247], a[204:207], v[76:79]
    v_mfma_f32_16x16x32_bf16 v[36:39], a[244:247], a[200:203], v[36:39]
    v_mfma_f32_16x16x32_bf16 v[36:39], a[240:243], a[160:163], v[36:39]
    s_waitcnt lgkmcnt(4)
    v_mfma_f32_16x16x32_bf16 v[40:43], a[248:251], a[60:63], v[40:43]
    ds_read_b64_tr_b16 a[240:241], v248 offset:0
    v_mfma_f32_16x16x32_bf16 v[40:43], a[252:255], a[100:103], v[40:43]
    ds_read_b64_tr_b16 a[242:243], v248 offset:1536
    v_mfma_f32_16x16x32_bf16 v[80:83], a[252:255], a[104:107], v[80:83]
    v_mfma_f32_16x16x32_bf16 v[80:83], a[248:251], a[64:67], v[80:83]
    v_mfma_f32_16x16x32_bf16 v[120:123], a[248:251], a[68:71], v[120:123]
    v_cvt_pk_bf16_f32 v32, v32, v33
    v_cvt_pk_bf16_f32 v33, v34, v35
    v_mfma_f32_16x16x32_bf16 v[120:123], a[252:255], a[108:111], v[120:123]
    s_mul_i32 s100, s8, 5
    ds_read_b64_tr_b16 a[244:245], v248 offset:12320
    v_cvt_pk_bf16_f32 v34, v36, v37
    v_mfma_f32_16x16x32_bf16 v[160:163], a[252:255], a[112:115], v[160:163]
    s_add_u32 s100, s100, s15
    ds_read_b64_tr_b16 a[246:247], v248 offset:13856
    v_cvt_pk_bf16_f32 v35, v38, v39
    v_mfma_f32_16x16x32_bf16 v[160:163], a[248:251], a[72:75], v[160:163]
    s_mul_i32 s100, s100, 1024
    v_mfma_f32_16x16x32_bf16 v[200:203], a[248:251], a[76:79], v[200:203]
    s_add_u32 s100, s100, s18
    buffer_store_dwordx4 v[32:35], v0, s[68:71], s100 offen sc1
    v_mfma_f32_16x16x32_bf16 v[200:203], a[252:255], a[116:119], v[200:203]
    s_waitcnt lgkmcnt(4)
    v_mfma_f32_16x16x32_bf16 v[204:207], v[10:13], a[116:119], v[204:207]
    ds_read_b64_tr_b16 a[248:249], v248 offset:8
    v_mfma_f32_16x16x32_bf16 v[204:207], v[6:9], a[76:79], v[204:207]
    ds_read_b64_tr_b16 a[250:251], v248 offset:1544
    v_mfma_f32_16x16x32_bf16 v[164:167], v[6:9], a[72:75], v[164:167]
    v_mfma_f32_16x16x32_bf16 v[164:167], v[10:13], a[112:115], v[164:167]
    v_mfma_f32_16x16x32_bf16 v[124:127], v[10:13], a[108:111], v[124:127]
    v_cvt_pk_bf16_f32 v72, v72, v73
    v_cvt_pk_bf16_f32 v73, v74, v75
    v_mfma_f32_16x16x32_bf16 v[124:127], v[6:9], a[68:71], v[124:127]
    s_mul_i32 s100, s9, 5
    ds_read_b64_tr_b16 a[252:253], v248 offset:12328
    v_cvt_pk_bf16_f32 v74, v76, v77
    v_mfma_f32_16x16x32_bf16 v[84:87], v[6:9], a[64:67], v[84:87]
    s_add_u32 s100, s100, s15
    ds_read_b64_tr_b16 a[254:255], v248 offset:13864
    v_cvt_pk_bf16_f32 v75, v78, v79
    v_mfma_f32_16x16x32_bf16 v[84:87], v[10:13], a[104:107], v[84:87]
    s_mul_i32 s100, s100, 1024
    v_mfma_f32_16x16x32_bf16 v[44:47], v[10:13], a[100:103], v[44:47]
    s_add_u32 s100, s100, s18
    buffer_store_dwordx4 v[72:75], v0, s[68:71], s100 offen sc1
    v_mfma_f32_16x16x32_bf16 v[44:47], v[6:9], a[60:63], v[44:47]
    s_waitcnt lgkmcnt(4)
    v_mfma_f32_16x16x32_bf16 v[40:43], a[240:243], a[140:143], v[40:43]
    ds_read_b64_tr_b16 v[6:7], v248 offset:24640
    v_mfma_f32_16x16x32_bf16 v[40:43], a[244:247], a[220:223], v[40:43]
    ds_read_b64_tr_b16 v[8:9], v248 offset:26176
    v_mfma_f32_16x16x32_bf16 v[80:83], a[244:247], a[224:227], v[80:83]
    v_mfma_f32_16x16x32_bf16 v[80:83], a[240:243], a[144:147], v[80:83]
    v_mfma_f32_16x16x32_bf16 v[120:123], a[240:243], a[148:151], v[120:123]
    v_cvt_pk_bf16_f32 v112, v112, v113
    v_cvt_pk_bf16_f32 v113, v114, v115
    v_mfma_f32_16x16x32_bf16 v[120:123], a[244:247], a[228:231], v[120:123]
    s_mul_i32 s100, s10, 5
    ds_read_b64_tr_b16 v[10:11], v248 offset:36960
    v_cvt_pk_bf16_f32 v114, v116, v117
    v_mfma_f32_16x16x32_bf16 v[160:163], a[244:247], a[232:235], v[160:163]
    s_add_u32 s100, s100, s15
    ds_read_b64_tr_b16 v[12:13], v248 offset:38496
    v_cvt_pk_bf16_f32 v115, v118, v119
    v_mfma_f32_16x16x32_bf16 v[160:163], a[240:243], a[152:155], v[160:163]
    s_mul_i32 s100, s100, 1024
    v_mfma_f32_16x16x32_bf16 v[200:203], a[240:243], a[156:159], v[200:203]
    s_add_u32 s100, s100, s18
    buffer_store_dwordx4 v[112:115], v0, s[68:71], s100 offen sc1
    v_mfma_f32_16x16x32_bf16 v[200:203], a[244:247], a[236:239], v[200:203]
    s_waitcnt lgkmcnt(4)
    v_mfma_f32_16x16x32_bf16 v[204:207], a[252:255], a[236:239], v[204:207]
    ds_read_b64_tr_b16 a[240:241], v248 offset:24648
    v_mfma_f32_16x16x32_bf16 v[204:207], a[248:251], a[156:159], v[204:207]
    ds_read_b64_tr_b16 a[242:243], v248 offset:26184
    v_mfma_f32_16x16x32_bf16 v[164:167], a[248:251], a[152:155], v[164:167]
    s_lshl_b32 s101, s9, 4
    s_add_u32 s101, s101, s83
    s_add_u32 s101, s101, 4
    s_add_u32 s78, s101, 4
    v_mfma_f32_16x16x32_bf16 v[164:167], a[252:255], a[232:235], v[164:167]
    s_waitcnt vmcnt(3)
    buffer_store_dword v14, v0, s[76:79], s101 offen sc1
    v_mfma_f32_16x16x32_bf16 v[124:127], a[252:255], a[228:231], v[124:127]
    v_cvt_pk_bf16_f32 v152, v152, v153
    v_cvt_pk_bf16_f32 v153, v154, v155
    v_mfma_f32_16x16x32_bf16 v[124:127], a[248:251], a[148:151], v[124:127]
    s_mul_i32 s100, s11, 5
    ds_read_b64_tr_b16 a[244:245], v248 offset:36968
    v_cvt_pk_bf16_f32 v154, v156, v157
    v_mfma_f32_16x16x32_bf16 v[84:87], a[248:251], a[144:147], v[84:87]
    s_add_u32 s100, s100, s15
    ds_read_b64_tr_b16 a[246:247], v248 offset:38504
    v_cvt_pk_bf16_f32 v155, v158, v159
    v_mfma_f32_16x16x32_bf16 v[84:87], a[252:255], a[224:227], v[84:87]
    s_mul_i32 s100, s100, 1024
    v_mfma_f32_16x16x32_bf16 v[44:47], a[252:255], a[220:223], v[44:47]
    s_add_u32 s100, s100, s18
    buffer_store_dwordx4 v[152:155], v0, s[68:71], s100 offen sc1
    v_mfma_f32_16x16x32_bf16 v[44:47], a[248:251], a[140:143], v[44:47]
    s_waitcnt lgkmcnt(4)
    v_mfma_f32_16x16x32_bf16 v[40:43], v[6:9], a[80:83], v[40:43]
    ds_read_b64_tr_b16 a[248:249], v248 offset:49280
    v_mfma_f32_16x16x32_bf16 v[40:43], v[10:13], a[20:23], v[40:43]
    ds_read_b64_tr_b16 a[250:251], v248 offset:50816
    v_mfma_f32_16x16x32_bf16 v[80:83], v[10:13], a[24:27], v[80:83]
    v_mfma_f32_16x16x32_bf16 v[80:83], v[6:9], a[84:87], v[80:83]
    v_mfma_f32_16x16x32_bf16 v[120:123], v[6:9], a[88:91], v[120:123]
    v_cvt_pk_bf16_f32 v192, v192, v193
    v_cvt_pk_bf16_f32 v193, v194, v195
    v_mfma_f32_16x16x32_bf16 v[120:123], v[10:13], a[28:31], v[120:123]
    s_mul_i32 s100, s12, 5
    ds_read_b64_tr_b16 a[252:253], v253 offset:0
    v_cvt_pk_bf16_f32 v194, v196, v197
    v_mfma_f32_16x16x32_bf16 v[160:163], v[10:13], a[32:35], v[160:163]
    s_add_u32 s100, s100, s15
    ds_read_b64_tr_b16 a[254:255], v253 offset:1536
    v_cvt_pk_bf16_f32 v195, v198, v199
    v_mfma_f32_16x16x32_bf16 v[160:163], v[6:9], a[92:95], v[160:163]
    s_mul_i32 s100, s100, 1024
    v_mfma_f32_16x16x32_bf16 v[200:203], v[6:9], a[96:99], v[200:203]
    s_add_u32 s100, s100, s18
    buffer_store_dwordx4 v[192:195], v0, s[68:71], s100 offen sc1
    v_mfma_f32_16x16x32_bf16 v[200:203], v[10:13], a[36:39], v[200:203]
    s_waitcnt lgkmcnt(4)
    v_mfma_f32_16x16x32_bf16 v[204:207], a[244:247], a[36:39], v[204:207]
    ds_read_b64_tr_b16 v[6:7], v248 offset:49288
    v_mfma_f32_16x16x32_bf16 v[204:207], a[240:243], a[96:99], v[204:207]
    ds_read_b64_tr_b16 v[8:9], v248 offset:50824
    v_mfma_f32_16x16x32_bf16 v[164:167], a[240:243], a[92:95], v[164:167]
    v_mfma_f32_16x16x32_bf16 v[164:167], a[244:247], a[32:35], v[164:167]
    v_mfma_f32_16x16x32_bf16 v[124:127], a[244:247], a[28:31], v[124:127]
    v_mfma_f32_16x16x32_bf16 v[124:127], a[240:243], a[88:91], v[124:127]
    ds_read_b64_tr_b16 v[10:11], v253 offset:8
    v_mfma_f32_16x16x32_bf16 v[84:87], a[240:243], a[84:87], v[84:87]
    ds_read_b64_tr_b16 v[12:13], v253 offset:1544
    v_mfma_f32_16x16x32_bf16 v[84:87], a[244:247], a[24:27], v[84:87]
    v_mfma_f32_16x16x32_bf16 v[44:47], a[244:247], a[20:23], v[44:47]
    v_mfma_f32_16x16x32_bf16 v[44:47], a[240:243], a[80:83], v[44:47]
    s_waitcnt lgkmcnt(4)
    v_mfma_f32_16x16x32_bf16 v[40:43], a[248:251], a[180:183], v[40:43]
    ds_read_b64_tr_b16 a[240:241], v253 offset:12320
    v_mfma_f32_16x16x32_bf16 v[40:43], a[252:255], a[120:123], v[40:43]
    ds_read_b64_tr_b16 a[242:243], v253 offset:13856
    v_mfma_f32_16x16x32_bf16 v[80:83], a[252:255], a[124:127], v[80:83]
    v_mfma_f32_16x16x32_bf16 v[80:83], a[248:251], a[184:187], v[80:83]
    v_mfma_f32_16x16x32_bf16 v[120:123], a[248:251], a[188:191], v[120:123]
    v_mfma_f32_16x16x32_bf16 v[120:123], a[252:255], a[128:131], v[120:123]
    ds_read_b64_tr_b16 a[244:245], v253 offset:24640
    v_mfma_f32_16x16x32_bf16 v[160:163], a[252:255], a[132:135], v[160:163]
    ds_read_b64_tr_b16 a[246:247], v253 offset:26176
    v_mfma_f32_16x16x32_bf16 v[160:163], a[248:251], a[192:195], v[160:163]
    v_mfma_f32_16x16x32_bf16 v[200:203], a[248:251], a[196:199], v[200:203]
    v_mfma_f32_16x16x32_bf16 v[200:203], a[252:255], a[136:139], v[200:203]
    s_waitcnt lgkmcnt(4)
    v_mfma_f32_16x16x32_bf16 v[204:207], v[10:13], a[136:139], v[204:207]
    ds_read_b64_tr_b16 a[248:249], v253 offset:12328
    v_mfma_f32_16x16x32_bf16 v[204:207], v[6:9], a[196:199], v[204:207]
    ds_read_b64_tr_b16 a[250:251], v253 offset:13864
    v_mfma_f32_16x16x32_bf16 v[164:167], v[6:9], a[192:195], v[164:167]
    v_mfma_f32_16x16x32_bf16 v[164:167], v[10:13], a[132:135], v[164:167]
    v_mfma_f32_16x16x32_bf16 v[124:127], v[10:13], a[128:131], v[124:127]
    v_mfma_f32_16x16x32_bf16 v[124:127], v[6:9], a[188:191], v[124:127]
    ds_read_b64_tr_b16 a[252:253], v253 offset:24648
    v_mfma_f32_16x16x32_bf16 v[84:87], v[6:9], a[184:187], v[84:87]
    ds_read_b64_tr_b16 a[254:255], v253 offset:26184
    v_mfma_f32_16x16x32_bf16 v[84:87], v[10:13], a[124:127], v[84:87]
    v_mfma_f32_16x16x32_bf16 v[44:47], v[10:13], a[120:123], v[44:47]
    v_mfma_f32_16x16x32_bf16 v[44:47], v[6:9], a[180:183], v[44:47]
    s_waitcnt lgkmcnt(4)
    v_mfma_f32_16x16x32_bf16 v[40:43], a[240:243], a[160:163], v[40:43]
    ds_read_b64_tr_b16 v[6:7], v254 offset:36960
    v_mfma_f32_16x16x32_bf16 v[40:43], a[244:247], a[200:203], v[40:43]
    ds_read_b64_tr_b16 v[8:9], v254 offset:38496
    v_mfma_f32_16x16x32_bf16 v[80:83], a[244:247], a[204:207], v[80:83]
    v_mfma_f32_16x16x32_bf16 v[80:83], a[240:243], a[164:167], v[80:83]
    v_mfma_f32_16x16x32_bf16 v[120:123], a[240:243], a[168:171], v[120:123]
    v_mfma_f32_16x16x32_bf16 v[120:123], a[244:247], a[208:211], v[120:123]
    ds_read_b64_tr_b16 v[10:11], v254 offset:49280
    v_mfma_f32_16x16x32_bf16 v[160:163], a[244:247], a[212:215], v[160:163]
    ds_read_b64_tr_b16 v[12:13], v254 offset:50816
    v_mfma_f32_16x16x32_bf16 v[160:163], a[240:243], a[172:175], v[160:163]
    v_mfma_f32_16x16x32_bf16 v[200:203], a[240:243], a[176:179], v[200:203]
    v_mfma_f32_16x16x32_bf16 v[200:203], a[244:247], a[216:219], v[200:203]
    s_waitcnt lgkmcnt(4)
    v_mfma_f32_16x16x32_bf16 v[204:207], a[252:255], a[216:219], v[204:207]
    ds_read_b64_tr_b16 a[240:241], v254 offset:36968
    v_mfma_f32_16x16x32_bf16 v[204:207], a[248:251], a[176:179], v[204:207]
    ds_read_b64_tr_b16 a[242:243], v254 offset:38504
    v_mfma_f32_16x16x32_bf16 v[164:167], a[248:251], a[172:175], v[164:167]
    v_mfma_f32_16x16x32_bf16 v[164:167], a[252:255], a[212:215], v[164:167]
    v_mfma_f32_16x16x32_bf16 v[124:127], a[252:255], a[208:211], v[124:127]
    v_mfma_f32_16x16x32_bf16 v[124:127], a[248:251], a[168:171], v[124:127]
    ds_read_b64_tr_b16 a[244:245], v254 offset:49288
    v_mfma_f32_16x16x32_bf16 v[84:87], a[248:251], a[164:167], v[84:87]
    ds_read_b64_tr_b16 a[246:247], v254 offset:50824
    v_mfma_f32_16x16x32_bf16 v[84:87], a[252:255], a[204:207], v[84:87]
    v_mfma_f32_16x16x32_bf16 v[44:47], a[252:255], a[200:203], v[44:47]
    v_mfma_f32_16x16x32_bf16 v[44:47], a[248:251], a[160:163], v[44:47]
    s_waitcnt lgkmcnt(4)
    v_mfma_f32_16x16x32_bf16 v[48:51], v[6:9], a[60:63], v[48:51]
    ds_read_b64_tr_b16 a[248:249], v249 offset:0
    v_mfma_f32_16x16x32_bf16 v[48:51], v[10:13], a[100:103], v[48:51]
    ds_read_b64_tr_b16 a[250:251], v249 offset:1536
    v_mfma_f32_16x16x32_bf16 v[88:91], v[10:13], a[104:107], v[88:91]
    v_mfma_f32_16x16x32_bf16 v[88:91], v[6:9], a[64:67], v[88:91]
    v_mfma_f32_16x16x32_bf16 v[128:131], v[6:9], a[68:71], v[128:131]
    v_cvt_pk_bf16_f32 v40, v40, v41
    v_cvt_pk_bf16_f32 v41, v42, v43
    v_mfma_f32_16x16x32_bf16 v[128:131], v[10:13], a[108:111], v[128:131]
    s_mul_i32 s100, s8, 5
    ds_read_b64_tr_b16 a[252:253], v249 offset:12320
    v_cvt_pk_bf16_f32 v42, v44, v45
    v_mfma_f32_16x16x32_bf16 v[168:171], v[10:13], a[112:115], v[168:171]
    s_add_u32 s100, s100, s16
    ds_read_b64_tr_b16 a[254:255], v249 offset:13856
    v_cvt_pk_bf16_f32 v43, v46, v47
    v_mfma_f32_16x16x32_bf16 v[168:171], v[6:9], a[72:75], v[168:171]
    s_mul_i32 s100, s100, 1024
    v_mfma_f32_16x16x32_bf16 v[208:211], v[6:9], a[76:79], v[208:211]
    s_add_u32 s100, s100, s18
    buffer_store_dwordx4 v[40:43], v0, s[68:71], s100 offen sc1
    v_mfma_f32_16x16x32_bf16 v[208:211], v[10:13], a[116:119], v[208:211]
    s_waitcnt lgkmcnt(4)
    v_cvt_pk_bf16_f32 v80, v80, v81
    v_cvt_pk_bf16_f32 v81, v82, v83
    v_mfma_f32_16x16x32_bf16 v[212:215], a[244:247], a[116:119], v[212:215]
    s_mul_i32 s100, s9, 5
    ds_read_b64_tr_b16 v[6:7], v249 offset:8
    v_cvt_pk_bf16_f32 v82, v84, v85
    v_mfma_f32_16x16x32_bf16 v[212:215], a[240:243], a[76:79], v[212:215]
    s_add_u32 s100, s100, s16
    ds_read_b64_tr_b16 v[8:9], v249 offset:1544
    v_cvt_pk_bf16_f32 v83, v86, v87
    v_mfma_f32_16x16x32_bf16 v[172:175], a[240:243], a[72:75], v[172:175]
    s_mul_i32 s100, s100, 1024
    v_mfma_f32_16x16x32_bf16 v[172:175], a[244:247], a[112:115], v[172:175]
    s_add_u32 s100, s100, s18
    buffer_store_dwordx4 v[80:83], v0, s[68:71], s100 offen sc1
    v_mfma_f32_16x16x32_bf16 v[132:135], a[244:247], a[108:111], v[132:135]
    v_cvt_pk_bf16_f32 v120, v120, v121
    v_cvt_pk_bf16_f32 v121, v122, v123
    v_mfma_f32_16x16x32_bf16 v[132:135], a[240:243], a[68:71], v[132:135]
    s_mul_i32 s100, s10, 5
    ds_read_b64_tr_b16 v[10:11], v249 offset:12328
    v_cvt_pk_bf16_f32 v122, v124, v125
    v_mfma_f32_16x16x32_bf16 v[92:95], a[240:243], a[64:67], v[92:95]
    s_add_u32 s100, s100, s16
    ds_read_b64_tr_b16 v[12:13], v249 offset:13864
    v_cvt_pk_bf16_f32 v123, v126, v127
    v_mfma_f32_16x16x32_bf16 v[92:95], a[244:247], a[104:107], v[92:95]
    s_mul_i32 s100, s100, 1024
    v_mfma_f32_16x16x32_bf16 v[52:55], a[244:247], a[100:103], v[52:55]
    s_add_u32 s100, s100, s18
    buffer_store_dwordx4 v[120:123], v0, s[68:71], s100 offen sc1
    v_mfma_f32_16x16x32_bf16 v[52:55], a[240:243], a[60:63], v[52:55]
    s_waitcnt lgkmcnt(4)
    v_cvt_pk_bf16_f32 v160, v160, v161
    v_cvt_pk_bf16_f32 v161, v162, v163
    v_mfma_f32_16x16x32_bf16 v[48:51], a[248:251], a[140:143], v[48:51]
    s_mul_i32 s100, s11, 5
    ds_read_b64_tr_b16 a[240:241], v249 offset:24640
    v_cvt_pk_bf16_f32 v162, v164, v165
    v_mfma_f32_16x16x32_bf16 v[48:51], a[252:255], a[220:223], v[48:51]
    s_add_u32 s100, s100, s16
    ds_read_b64_tr_b16 a[242:243], v249 offset:26176
    v_cvt_pk_bf16_f32 v163, v166, v167
    v_mfma_f32_16x16x32_bf16 v[88:91], a[252:255], a[224:227], v[88:91]
    s_mul_i32 s100, s100, 1024
    v_mfma_f32_16x16x32_bf16 v[88:91], a[248:251], a[144:147], v[88:91]
    s_add_u32 s100, s100, s18
    buffer_store_dwordx4 v[160:163], v0, s[68:71], s100 offen sc1
    v_mfma_f32_16x16x32_bf16 v[128:131], a[248:251], a[148:151], v[128:131]
    v_cvt_pk_bf16_f32 v200, v200, v201
    v_cvt_pk_bf16_f32 v201, v202, v203
    v_mfma_f32_16x16x32_bf16 v[128:131], a[252:255], a[228:231], v[128:131]
    s_mul_i32 s100, s12, 5
    ds_read_b64_tr_b16 a[244:245], v249 offset:36960
    v_cvt_pk_bf16_f32 v202, v204, v205
    v_mfma_f32_16x16x32_bf16 v[168:171], a[252:255], a[232:235], v[168:171]
    s_add_u32 s100, s100, s16
    ds_read_b64_tr_b16 a[246:247], v249 offset:38496
    v_cvt_pk_bf16_f32 v203, v206, v207
    v_mfma_f32_16x16x32_bf16 v[168:171], a[248:251], a[152:155], v[168:171]
    s_mul_i32 s100, s100, 1024
    v_mfma_f32_16x16x32_bf16 v[208:211], a[248:251], a[156:159], v[208:211]
    s_add_u32 s100, s100, s18
    buffer_store_dwordx4 v[200:203], v0, s[68:71], s100 offen sc1
    v_mfma_f32_16x16x32_bf16 v[208:211], a[252:255], a[236:239], v[208:211]
    s_waitcnt lgkmcnt(4)
    v_mfma_f32_16x16x32_bf16 v[212:215], v[10:13], a[236:239], v[212:215]
    s_add_u32 s50, s85, 16
    ds_read_b64_tr_b16 a[248:249], v249 offset:24648
    v_mfma_f32_16x16x32_bf16 v[212:215], v[6:9], a[156:159], v[212:215]
    ds_read_b64_tr_b16 a[250:251], v249 offset:26184
    v_mfma_f32_16x16x32_bf16 v[172:175], v[6:9], a[152:155], v[172:175]
    v_mfma_f32_16x16x32_bf16 v[172:175], v[10:13], a[232:235], v[172:175]
    buffer_load_dwordx4 v[216:219], v0, s[48:51], s85 offen sc1
    v_mfma_f32_16x16x32_bf16 v[132:135], v[10:13], a[228:231], v[132:135]
    v_mfma_f32_16x16x32_bf16 v[132:135], v[6:9], a[148:151], v[132:135]
    ds_read_b64_tr_b16 a[252:253], v249 offset:36968
    v_mfma_f32_16x16x32_bf16 v[92:95], v[6:9], a[144:147], v[92:95]
    ds_read_b64_tr_b16 a[254:255], v249 offset:38504
    v_mfma_f32_16x16x32_bf16 v[92:95], v[10:13], a[224:227], v[92:95]
    s_lshl_b32 s101, s10, 4
    s_add_u32 s101, s101, s83
    s_add_u32 s101, s101, 8
    s_add_u32 s78, s101, 4
    v_mfma_f32_16x16x32_bf16 v[52:55], v[10:13], a[220:223], v[52:55]
    s_waitcnt vmcnt(6)
    buffer_store_dword v14, v0, s[76:79], s101 offen sc1
    v_mfma_f32_16x16x32_bf16 v[52:55], v[6:9], a[140:143], v[52:55]
    s_waitcnt lgkmcnt(4)
    v_mfma_f32_16x16x32_bf16 v[48:51], a[240:243], a[80:83], v[48:51]
    ds_read_b64_tr_b16 v[6:7], v249 offset:49280
    v_mfma_f32_16x16x32_bf16 v[48:51], a[244:247], a[20:23], v[48:51]
    ds_read_b64_tr_b16 v[8:9], v249 offset:50816
    v_mfma_f32_16x16x32_bf16 v[88:91], a[244:247], a[24:27], v[88:91]
    v_mfma_f32_16x16x32_bf16 v[88:91], a[240:243], a[84:87], v[88:91]
    v_mfma_f32_16x16x32_bf16 v[128:131], a[240:243], a[88:91], v[128:131]
    v_mfma_f32_16x16x32_bf16 v[128:131], a[244:247], a[28:31], v[128:131]
    ds_read_b64_tr_b16 v[10:11], v254 offset:0
    v_mfma_f32_16x16x32_bf16 v[168:171], a[244:247], a[32:35], v[168:171]
    ds_read_b64_tr_b16 v[12:13], v254 offset:1536
    v_mfma_f32_16x16x32_bf16 v[168:171], a[240:243], a[92:95], v[168:171]
    v_mfma_f32_16x16x32_bf16 v[208:211], a[240:243], a[96:99], v[208:211]
    v_mfma_f32_16x16x32_bf16 v[208:211], a[244:247], a[36:39], v[208:211]
    s_waitcnt lgkmcnt(4)
    v_mfma_f32_16x16x32_bf16 v[212:215], a[252:255], a[36:39], v[212:215]
    ds_read_b64_tr_b16 a[240:241], v249 offset:49288
    v_mfma_f32_16x16x32_bf16 v[212:215], a[248:251], a[96:99], v[212:215]
    ds_read_b64_tr_b16 a[242:243], v249 offset:50824
    v_mfma_f32_16x16x32_bf16 v[172:175], a[248:251], a[92:95], v[172:175]
    v_mfma_f32_16x16x32_bf16 v[172:175], a[252:255], a[32:35], v[172:175]
    v_mfma_f32_16x16x32_bf16 v[132:135], a[252:255], a[28:31], v[132:135]
    v_mfma_f32_16x16x32_bf16 v[132:135], a[248:251], a[88:91], v[132:135]
    ds_read_b64_tr_b16 a[244:245], v254 offset:8
    v_mfma_f32_16x16x32_bf16 v[92:95], a[248:251], a[84:87], v[92:95]
    ds_read_b64_tr_b16 a[246:247], v254 offset:1544
    v_mfma_f32_16x16x32_bf16 v[92:95], a[252:255], a[24:27], v[92:95]
    v_mfma_f32_16x16x32_bf16 v[52:55], a[252:255], a[20:23], v[52:55]
    v_mfma_f32_16x16x32_bf16 v[52:55], a[248:251], a[80:83], v[52:55]
    s_waitcnt lgkmcnt(4)
    s_lshl_b32 s36, s28, 13
    s_add_u32 s36, s36, 126976
    v_mfma_f32_16x16x32_bf16 v[48:51], v[6:9], a[180:183], v[48:51]
    ds_read_b64_tr_b16 a[248:249], v254 offset:12320
    v_add_u32 v238, s36, v0
    v_mfma_f32_16x16x32_bf16 v[48:51], v[10:13], a[120:123], v[48:51]
    ds_read_b64_tr_b16 a[250:251], v254 offset:13856
    v_lshrrev_b32 v239, 6, v0
    v_mfma_f32_16x16x32_bf16 v[88:91], v[10:13], a[124:127], v[88:91]
    v_bfe_u32 v230, v0, 4, 2
    v_lshl_add_u32 v239, v230, 4, v239
    v_mfma_f32_16x16x32_bf16 v[88:91], v[6:9], a[184:187], v[88:91]
    s_mov_b32 s23, 0xffff0000
    v_lshl_add_u32 v239, v239, 4, s36
    v_mfma_f32_16x16x32_bf16 v[128:131], v[6:9], a[188:191], v[128:131]
    s_mov_b32 s34, 0x3f80
    v_mfma_f32_16x16x32_bf16 v[128:131], v[10:13], a[128:131], v[128:131]
    s_mov_b32 s35, 0x3f800000
    ds_read_b64_tr_b16 a[252:253], v254 offset:24640
    v_mfma_f32_16x16x32_bf16 v[168:171], v[10:13], a[132:135], v[168:171]
    ds_read_b64_tr_b16 a[254:255], v254 offset:26176
    v_mfma_f32_16x16x32_bf16 v[168:171], v[6:9], a[192:195], v[168:171]
    v_mfma_f32_16x16x32_bf16 v[208:211], v[6:9], a[196:199], v[208:211]
    v_mfma_f32_16x16x32_bf16 v[208:211], v[10:13], a[136:139], v[208:211]
    s_waitcnt lgkmcnt(4)
    v_mfma_f32_16x16x32_bf16 v[212:215], a[244:247], a[136:139], v[212:215]
    ds_read_b64_tr_b16 v[6:7], v254 offset:12328
    v_mfma_f32_16x16x32_bf16 v[212:215], a[240:243], a[196:199], v[212:215]
    ds_read_b64_tr_b16 v[8:9], v254 offset:13864
    v_mfma_f32_16x16x32_bf16 v[172:175], a[240:243], a[192:195], v[172:175]
    v_mfma_f32_16x16x32_bf16 v[172:175], a[244:247], a[132:135], v[172:175]
    v_mfma_f32_16x16x32_bf16 v[132:135], a[244:247], a[128:131], v[132:135]
    v_mfma_f32_16x16x32_bf16 v[132:135], a[240:243], a[188:191], v[132:135]
    ds_read_b64_tr_b16 v[10:11], v254 offset:24648
    v_mfma_f32_16x16x32_bf16 v[92:95], a[240:243], a[184:187], v[92:95]
    ds_read_b64_tr_b16 v[12:13], v254 offset:26184
    v_mfma_f32_16x16x32_bf16 v[92:95], a[244:247], a[124:127], v[92:95]
    v_mfma_f32_16x16x32_bf16 v[52:55], a[244:247], a[120:123], v[52:55]
    v_mfma_f32_16x16x32_bf16 v[52:55], a[240:243], a[180:183], v[52:55]
    s_waitcnt lgkmcnt(4)
    v_mfma_f32_16x16x32_bf16 v[48:51], a[248:251], a[160:163], v[48:51]
    v_mfma_f32_16x16x32_bf16 v[48:51], a[252:255], a[200:203], v[48:51]
    v_mfma_f32_16x16x32_bf16 v[88:91], a[252:255], a[204:207], v[88:91]
    v_mfma_f32_16x16x32_bf16 v[88:91], a[248:251], a[164:167], v[88:91]
    v_mfma_f32_16x16x32_bf16 v[128:131], a[248:251], a[168:171], v[128:131]
    v_mfma_f32_16x16x32_bf16 v[128:131], a[252:255], a[208:211], v[128:131]
    v_mfma_f32_16x16x32_bf16 v[168:171], a[252:255], a[212:215], v[168:171]
    v_mfma_f32_16x16x32_bf16 v[168:171], a[248:251], a[172:175], v[168:171]
    v_mfma_f32_16x16x32_bf16 v[208:211], a[248:251], a[176:179], v[208:211]
    v_mfma_f32_16x16x32_bf16 v[208:211], a[252:255], a[216:219], v[208:211]
    s_waitcnt lgkmcnt(0)
    v_mfma_f32_16x16x32_bf16 v[212:215], v[10:13], a[216:219], v[212:215]
    v_mfma_f32_16x16x32_bf16 v[212:215], v[6:9], a[176:179], v[212:215]
    v_mfma_f32_16x16x32_bf16 v[172:175], v[6:9], a[172:175], v[172:175]
    s_lshl_b32 s101, s11, 4
    s_add_u32 s101, s101, s83
    s_add_u32 s101, s101, 12
    s_add_u32 s78, s101, 4
    v_mfma_f32_16x16x32_bf16 v[172:175], v[10:13], a[212:215], v[172:175]
    s_waitcnt vmcnt(2)
    buffer_store_dword v14, v0, s[76:79], s101 offen sc1
    v_mfma_f32_16x16x32_bf16 v[132:135], v[10:13], a[208:211], v[132:135]
    v_mfma_f32_16x16x32_bf16 v[132:135], v[6:9], a[168:171], v[132:135]
    v_mfma_f32_16x16x32_bf16 v[92:95], v[6:9], a[164:167], v[92:95]
    v_mfma_f32_16x16x32_bf16 v[92:95], v[10:13], a[204:207], v[92:95]
    v_mfma_f32_16x16x32_bf16 v[52:55], v[10:13], a[200:203], v[52:55]
    v_mfma_f32_16x16x32_bf16 v[52:55], v[6:9], a[160:163], v[52:55]
    s_waitcnt vmcnt(2)
    v_lshl_or_b32 v216, v218, 1, v217
    v_lshl_or_b32 v216, v219, 2, v216
    s_nop 0
    v_readfirstlane_b32 s33, v216
L_c1:
    s_nop 3
    s_bitcmp1_b32 s33, 0
    s_cbranch_scc0 L_p1
L_f1:
    buffer_load_dwordx4 v[220:223], v0, s[48:51], s85 offen sc1
    s_mul_i32 s100, s8, 5
    s_add_u32 s100, s100, s17
    s_mul_i32 s100, s100, 1024
    s_add_u32 s100, s100, s19
    buffer_load_dwordx4 v[24:27], v0, s[68:71], s100 offen sc1
    s_mul_i32 s100, s9, 5
    s_add_u32 s100, s100, s17
    s_mul_i32 s100, s100, 1024
    s_add_u32 s100, s100, s19
    buffer_load_dwordx4 v[28:31], v0, s[68:71], s100 offen sc1
    s_mul_i32 s100, s10, 5
    s_add_u32 s100, s100, s17
    s_mul_i32 s100, s100, 1024
    s_add_u32 s100, s100, s19
    buffer_load_dwordx4 v[64:67], v0, s[68:71], s100 offen sc1
    s_mul_i32 s100, s11, 5
    s_add_u32 s100, s100, s17
    s_mul_i32 s100, s100, 1024
    s_add_u32 s100, s100, s19
    buffer_load_dwordx4 v[68:71], v0, s[68:71], s100 offen sc1
    s_mul_i32 s100, s12, 5
    s_add_u32 s100, s100, s17
    s_mul_i32 s100, s100, 1024
    s_add_u32 s100, s100, s19
    buffer_load_dwordx4 v[104:107], v0, s[68:71], s100 offen sc1
    s_mul_i32 s100, s8, 5
    s_add_u32 s100, s100, s13
    s_mul_i32 s100, s100, 1024
    s_add_u32 s100, s100, s19
    buffer_load_dwordx4 v[108:111], v0, s[68:71], s100 offen sc1
    s_mul_i32 s100, s12, 5
    s_add_u32 s100, s100, s13
    s_mul_i32 s100, s100, 1024
    s_add_u32 s100, s100, s19
    s_add_u32 s100, s100, s22
    buffer_load_dwordx4 v[144:147], v0, s[68:71], s100 offen sc1
L_c2:
    s_bitcmp1_b32 s33, 1
    s_cbranch_scc0 L_u2
L_f2:
    buffer_load_dwordx4 v[224:227], v0, s[48:51], s85 offen sc1
    s_mul_i32 s100, s8, 5
    s_add_u32 s100, s100, s17
    s_mul_i32 s100, s100, 1024
    s_add_u32 s100, s100, s20
    buffer_load_dwordx4 v[148:151], v0, s[68:71], s100 offen sc1
    s_mul_i32 s100, s9, 5
    s_add_u32 s100, s100, s17
    s_mul_i32 s100, s100, 1024
    s_add_u32 s100, s100, s20
    buffer_load_dwordx4 v[184:187], v0, s[68:71], s100 offen sc1
    s_mul_i32 s100, s10, 5
    s_add_u32 s100, s100, s17
    s_mul_i32 s100, s100, 1024
    s_add_u32 s100, s100, s20
    buffer_load_dwordx4 v[188:191], v0, s[68:71], s100 offen sc1
    s_mul_i32 s100, s11, 5
    s_add_u32 s100, s100, s17
    s_mul_i32 s100, s100, 1024
    s_add_u32 s100, s100, s20
    buffer_load_dwordx4 v[32:35], v0, s[68:71], s100 offen sc1
    s_mul_i32 s100, s12, 5
    s_add_u32 s100, s100, s17
    s_mul_i32 s100, s100, 1024
    s_add_u32 s100, s100, s20
    buffer_load_dwordx4 v[36:39], v0, s[68:71], s100 offen sc1
    s_mul_i32 s100, s8, 5
    s_add_u32 s100, s100, s13
    s_mul_i32 s100, s100, 1024
    s_add_u32 s100, s100, s20
    buffer_load_dwordx4 v[72:75], v0, s[68:71], s100 offen sc1
    s_mul_i32 s100, s12, 5
    s_add_u32 s100, s100, s13
    s_mul_i32 s100, s100, 1024
    s_add_u32 s100, s100, s20
    s_add_u32 s100, s100, s22
    buffer_load_dwordx4 v[76:79], v0, s[68:71], s100 offen sc1
L_c3:
    s_bitcmp1_b32 s33, 2
    s_cbranch_scc0 L_u3
L_f3:
    s_mul_i32 s100, s8, 5
    s_add_u32 s100, s100, s17
    s_mul_i32 s100, s100, 1024
    s_add_u32 s100, s100, s21
    buffer_load_dwordx4 v[112:115], v0, s[68:71], s100 offen sc1
    s_mul_i32 s100, s9, 5
    s_add_u32 s100, s100, s17
    s_mul_i32 s100, s100, 1024
    s_add_u32 s100, s100, s21
    buffer_load_dwordx4 v[116:119], v0, s[68:71], s100 offen sc1
    s_mul_i32 s100, s10, 5
    s_add_u32 s100, s100, s17
    s_mul_i32 s100, s100, 1024
    s_add_u32 s100, s100, s21
    buffer_load_dwordx4 v[152:155], v0, s[68:71], s100 offen sc1
    s_mul_i32 s100, s11, 5
    s_add_u32 s100, s100, s17
    s_mul_i32 s100, s100, 1024
    s_add_u32 s100, s100, s21
    buffer_load_dwordx4 v[156:159], v0, s[68:71], s100 offen sc1
    s_mul_i32 s100, s12, 5
    s_add_u32 s100, s100, s17
    s_mul_i32 s100, s100, 1024
    s_add_u32 s100, s100, s21
    buffer_load_dwordx4 v[192:195], v0, s[68:71], s100 offen sc1
    s_mul_i32 s100, s8, 5
    s_add_u32 s100, s100, s13
    s_mul_i32 s100, s100, 1024
    s_add_u32 s100, s100, s21
    buffer_load_dwordx4 v[196:199], v0, s[68:71], s100 offen sc1
    s_mul_i32 s100, s12, 5
    s_add_u32 s100, s100, s13
    s_mul_i32 s100, s100, 1024
    s_add_u32 s100, s100, s21
    s_add_u32 s100, s100, s22
    buffer_load_dwordx4 v[40:43], v0, s[68:71], s100 offen sc1
L_g:
    s_waitcnt vmcnt(21)
    v_dot2c_f32_bf16 v48, s34, v24
    v_dot2c_f32_bf16 v49, s35, v24
    v_dot2c_f32_bf16 v50, s34, v25
    v_dot2c_f32_bf16 v51, s35, v25
    v_dot2c_f32_bf16 v52, s34, v26
    v_dot2c_f32_bf16 v53, s35, v26
    v_dot2c_f32_bf16 v54, s34, v27
    v_dot2c_f32_bf16 v55, s35, v27
    s_waitcnt vmcnt(20)
    v_dot2c_f32_bf16 v88, s34, v28
    v_dot2c_f32_bf16 v89, s35, v28
    v_dot2c_f32_bf16 v90, s34, v29
    v_dot2c_f32_bf16 v91, s35, v29
    v_dot2c_f32_bf16 v92, s34, v30
    v_dot2c_f32_bf16 v93, s35, v30
    v_dot2c_f32_bf16 v94, s34, v31
    v_dot2c_f32_bf16 v95, s35, v31
    s_waitcnt vmcnt(19)
    v_dot2c_f32_bf16 v128, s34, v64
    v_dot2c_f32_bf16 v129, s35, v64
    v_dot2c_f32_bf16 v130, s34, v65
    v_dot2c_f32_bf16 v131, s35, v65
    v_dot2c_f32_bf16 v132, s34, v66
    v_dot2c_f32_bf16 v133, s35, v66
    v_dot2c_f32_bf16 v134, s34, v67
    v_dot2c_f32_bf16 v135, s35, v67
    s_waitcnt vmcnt(18)
    v_dot2c_f32_bf16 v168, s34, v68
    v_dot2c_f32_bf16 v169, s35, v68
    v_dot2c_f32_bf16 v170, s34, v69
    v_dot2c_f32_bf16 v171, s35, v69
    v_dot2c_f32_bf16 v172, s34, v70
    v_dot2c_f32_bf16 v173, s35, v70
    v_dot2c_f32_bf16 v174, s34, v71
    v_dot2c_f32_bf16 v175, s35, v71
    s_waitcnt vmcnt(17)
    v_dot2c_f32_bf16 v208, s34, v104
    v_dot2c_f32_bf16 v209, s35, v104
    v_dot2c_f32_bf16 v210, s34, v105
    v_dot2c_f32_bf16 v211, s35, v105
    v_dot2c_f32_bf16 v212, s34, v106
    v_dot2c_f32_bf16 v213, s35, v106
    v_dot2c_f32_bf16 v214, s34, v107
    v_dot2c_f32_bf16 v215, s35, v107
    s_waitcnt vmcnt(16)
    v_dot2c_f32_bf16 v16, s34, v108
    v_dot2c_f32_bf16 v17, s35, v108
    v_dot2c_f32_bf16 v18, s34, v109
    v_dot2c_f32_bf16 v19, s35, v109
    v_dot2c_f32_bf16 v20, s34, v110
    v_dot2c_f32_bf16 v21, s35, v110
    v_dot2c_f32_bf16 v22, s34, v111
    v_dot2c_f32_bf16 v23, s35, v111
    s_waitcnt vmcnt(15)
    v_dot2c_f32_bf16 v176, s34, v144
    v_dot2c_f32_bf16 v177, s35, v144
    v_dot2c_f32_bf16 v178, s34, v145
    v_dot2c_f32_bf16 v179, s35, v145
    v_dot2c_f32_bf16 v180, s34, v146
    v_dot2c_f32_bf16 v181, s35, v146
    v_dot2c_f32_bf16 v182, s34, v147
    v_dot2c_f32_bf16 v183, s35, v147
    s_waitcnt vmcnt(13)
    v_dot2c_f32_bf16 v48, s34, v148
    v_dot2c_f32_bf16 v49, s35, v148
    v_dot2c_f32_bf16 v50, s34, v149
    v_dot2c_f32_bf16 v51, s35, v149
    v_dot2c_f32_bf16 v52, s34, v150
    v_dot2c_f32_bf16 v53, s35, v150
    v_dot2c_f32_bf16 v54, s34, v151
    v_dot2c_f32_bf16 v55, s35, v151
    s_waitcnt vmcnt(12)
    v_dot2c_f32_bf16 v88, s34, v184
    v_dot2c_f32_bf16 v89, s35, v184
    v_dot2c_f32_bf16 v90, s34, v185
    v_dot2c_f32_bf16 v91, s35, v185
    v_dot2c_f32_bf16 v92, s34, v186
    v_dot2c_f32_bf16 v93, s35, v186
    v_dot2c_f32_bf16 v94, s34, v187
    v_dot2c_f32_bf16 v95, s35, v187
    s_waitcnt vmcnt(11)
    v_dot2c_f32_bf16 v128, s34, v188
    v_dot2c_f32_bf16 v129, s35, v188
    v_dot2c_f32_bf16 v130, s34, v189
    v_dot2c_f32_bf16 v131, s35, v189
    v_dot2c_f32_bf16 v132, s34, v190
    v_dot2c_f32_bf16 v133, s35, v190
    v_dot2c_f32_bf16 v134, s34, v191
    v_dot2c_f32_bf16 v135, s35, v191
    s_waitcnt vmcnt(10)
    v_dot2c_f32_bf16 v168, s34, v32
    v_dot2c_f32_bf16 v169, s35, v32
    v_dot2c_f32_bf16 v170, s34, v33
    v_dot2c_f32_bf16 v171, s35, v33
    v_dot2c_f32_bf16 v172, s34, v34
    v_dot2c_f32_bf16 v173, s35, v34
    v_dot2c_f32_bf16 v174, s34, v35
    v_dot2c_f32_bf16 v175, s35, v35
    s_waitcnt vmcnt(9)
    v_dot2c_f32_bf16 v208, s34, v36
    v_dot2c_f32_bf16 v209, s35, v36
    v_dot2c_f32_bf16 v210, s34, v37
    v_dot2c_f32_bf16 v211, s35, v37
    v_dot2c_f32_bf16 v212, s34, v38
    v_dot2c_f32_bf16 v213, s35, v38
    v_dot2c_f32_bf16 v214, s34, v39
    v_dot2c_f32_bf16 v215, s35, v39
    s_waitcnt vmcnt(8)
    v_dot2c_f32_bf16 v16, s34, v72
    v_dot2c_f32_bf16 v17, s35, v72
    v_dot2c_f32_bf16 v18, s34, v73
    v_dot2c_f32_bf16 v19, s35, v73
    v_dot2c_f32_bf16 v20, s34, v74
    v_dot2c_f32_bf16 v21, s35, v74
    v_dot2c_f32_bf16 v22, s34, v75
    v_dot2c_f32_bf16 v23, s35, v75
    s_waitcnt vmcnt(7)
    v_dot2c_f32_bf16 v176, s34, v76
    v_dot2c_f32_bf16 v177, s35, v76
    v_dot2c_f32_bf16 v178, s34, v77
    v_dot2c_f32_bf16 v179, s35, v77
    v_dot2c_f32_bf16 v180, s34, v78
    v_dot2c_f32_bf16 v181, s35, v78
    v_dot2c_f32_bf16 v182, s34, v79
    v_dot2c_f32_bf16 v183, s35, v79
    s_waitcnt vmcnt(6)
    v_dot2c_f32_bf16 v48, s34, v112
    v_dot2c_f32_bf16 v49, s35, v112
    v_dot2c_f32_bf16 v50, s34, v113
    v_dot2c_f32_bf16 v51, s35, v113
    v_dot2c_f32_bf16 v52, s34, v114
    v_dot2c_f32_bf16 v53, s35, v114
    v_dot2c_f32_bf16 v54, s34, v115
    v_dot2c_f32_bf16 v55, s35, v115
    s_nop 2
    v_cvt_pk_bf16_f32 v48, v48, v49
    v_cvt_pk_bf16_f32 v49, v50, v51
    v_cvt_pk_bf16_f32 v50, v52, v53
    v_cvt_pk_bf16_f32 v51, v54, v55
    ds_write_b128 v238, v[48:51] offset:0
    ds_read_b128 v[52:55], v239 offset:0
    s_waitcnt vmcnt(5)
    v_dot2c_f32_bf16 v88, s34, v116
    v_dot2c_f32_bf16 v89, s35, v116
    v_dot2c_f32_bf16 v90, s34, v117
    v_dot2c_f32_bf16 v91, s35, v117
    v_dot2c_f32_bf16 v92, s34, v118
    v_dot2c_f32_bf16 v93, s35, v118
    v_dot2c_f32_bf16 v94, s34, v119
    v_dot2c_f32_bf16 v95, s35, v119
    s_mul_i32 s100, s8, 640
    s_add_u32 s100, s100, s17
    s_mul_i32 s100, s100, 64
    s_waitcnt lgkmcnt(0)
    buffer_store_dwordx4 v[52:55], v255, s[72:75], s100 offen nt
    s_nop 2
    v_cvt_pk_bf16_f32 v88, v88, v89
    v_cvt_pk_bf16_f32 v89, v90, v91
    v_cvt_pk_bf16_f32 v90, v92, v93
    v_cvt_pk_bf16_f32 v91, v94, v95
    ds_write_b128 v238, v[88:91] offset:1024
    ds_read_b128 v[92:95], v239 offset:1024
    s_waitcnt vmcnt(5)
    v_dot2c_f32_bf16 v128, s34, v152
    v_dot2c_f32_bf16 v129, s35, v152
    v_dot2c_f32_bf16 v130, s34, v153
    v_dot2c_f32_bf16 v131, s35, v153
    v_dot2c_f32_bf16 v132, s34, v154
    v_dot2c_f32_bf16 v133, s35, v154
    v_dot2c_f32_bf16 v134, s34, v155
    v_dot2c_f32_bf16 v135, s35, v155
    s_mul_i32 s100, s9, 640
    s_add_u32 s100, s100, s17
    s_mul_i32 s100, s100, 64
    s_waitcnt lgkmcnt(0)
    buffer_store_dwordx4 v[92:95], v255, s[72:75], s100 offen nt
    s_nop 2
    v_cvt_pk_bf16_f32 v128, v128, v129
    v_cvt_pk_bf16_f32 v129, v130, v131
    v_cvt_pk_bf16_f32 v130, v132, v133
    v_cvt_pk_bf16_f32 v131, v134, v135
    ds_write_b128 v238, v[128:131] offset:2048
    ds_read_b128 v[132:135], v239 offset:2048
    s_waitcnt vmcnt(5)
    v_dot2c_f32_bf16 v168, s34, v156
    v_dot2c_f32_bf16 v169, s35, v156
    v_dot2c_f32_bf16 v170, s34, v157
    v_dot2c_f32_bf16 v171, s35, v157
    v_dot2c_f32_bf16 v172, s34, v158
    v_dot2c_f32_bf16 v173, s35, v158
    v_dot2c_f32_bf16 v174, s34, v159
    v_dot2c_f32_bf16 v175, s35, v159
    s_mul_i32 s100, s10, 640
    s_add_u32 s100, s100, s17
    s_mul_i32 s100, s100, 64
    s_waitcnt lgkmcnt(0)
    buffer_store_dwordx4 v[132:135], v255, s[72:75], s100 offen nt
    s_nop 2
    v_cvt_pk_bf16_f32 v168, v168, v169
    v_cvt_pk_bf16_f32 v169, v170, v171
    v_cvt_pk_bf16_f32 v170, v172, v173
    v_cvt_pk_bf16_f32 v171, v174, v175
    ds_write_b128 v238, v[168:171] offset:3072
    ds_read_b128 v[172:175], v239 offset:3072
    s_waitcnt vmcnt(5)
    v_dot2c_f32_bf16 v208, s34, v192
    v_dot2c_f32_bf16 v209, s35, v192
    v_dot2c_f32_bf16 v210, s34, v193
    v_dot2c_f32_bf16 v211, s35, v193
    v_dot2c_f32_bf16 v212, s34, v194
    v_dot2c_f32_bf16 v213, s35, v194
    v_dot2c_f32_bf16 v214, s34, v195
    v_dot2c_f32_bf16 v215, s35, v195
    s_mul_i32 s100, s11, 640
    s_add_u32 s100, s100, s17
    s_mul_i32 s100, s100, 64
    s_waitcnt lgkmcnt(0)
    buffer_store_dwordx4 v[172:175], v255, s[72:75], s100 offen nt
    s_nop 2
    v_cvt_pk_bf16_f32 v208, v208, v209
    v_cvt_pk_bf16_f32 v209, v210, v211
    v_cvt_pk_bf16_f32 v210, v212, v213
    v_cvt_pk_bf16_f32 v211, v214, v215
    ds_write_b128 v238, v[208:211] offset:4096
    ds_read_b128 v[212:215], v239 offset:4096
    s_waitcnt vmcnt(5)
    v_dot2c_f32_bf16 v16, s34, v196
    v_dot2c_f32_bf16 v17, s35, v196
    v_dot2c_f32_bf16 v18, s34, v197
    v_dot2c_f32_bf16 v19, s35, v197
    v_dot2c_f32_bf16 v20, s34, v198
    v_dot2c_f32_bf16 v21, s35, v198
    v_dot2c_f32_bf16 v22, s34, v199
    v_dot2c_f32_bf16 v23, s35, v199
    s_mul_i32 s100, s12, 640
    s_add_u32 s100, s100, s17
    s_mul_i32 s100, s100, 64
    s_waitcnt lgkmcnt(0)
    buffer_store_dwordx4 v[212:215], v255, s[72:75], s100 offen nt
    s_nop 2
    v_cvt_pk_bf16_f32 v16, v16, v17
    v_cvt_pk_bf16_f32 v17, v18, v19
    v_cvt_pk_bf16_f32 v18, v20, v21
    v_cvt_pk_bf16_f32 v19, v22, v23
    ds_write_b128 v238, v[16:19] offset:5120
    ds_read_b128 v[20:23], v239 offset:5120
    s_waitcnt vmcnt(5)
    v_dot2c_f32_bf16 v176, s34, v40
    v_dot2c_f32_bf16 v177, s35, v40
    v_dot2c_f32_bf16 v178, s34, v41
    v_dot2c_f32_bf16 v179, s35, v41
    v_dot2c_f32_bf16 v180, s34, v42
    v_dot2c_f32_bf16 v181, s35, v42
    v_dot2c_f32_bf16 v182, s34, v43
    v_dot2c_f32_bf16 v183, s35, v43
    s_mul_i32 s100, s8, 640
    s_add_u32 s100, s100, s13
    s_mul_i32 s100, s100, 64
    s_waitcnt lgkmcnt(0)
    buffer_store_dwordx4 v[20:23], v255, s[72:75], s100 offen nt
    s_nop 2
    v_cvt_pk_bf16_f32 v176, v176, v177
    v_cvt_pk_bf16_f32 v177, v178, v179
    v_cvt_pk_bf16_f32 v178, v180, v181
    v_cvt_pk_bf16_f32 v179, v182, v183
    ds_write_b128 v238, v[176:179] offset:6144
    ds_read_b128 v[180:183], v239 offset:6144
    s_mul_i32 s100, s12, 640
    s_add_u32 s100, s100, s13
    s_mul_i32 s100, s100, 64
    s_add_u32 s100, s100, s22
    s_waitcnt lgkmcnt(0)
    buffer_store_dwordx4 v[180:183], v255, s[72:75], s100 offen nt
    s_endpgm
L_u2:
    s_waitcnt vmcnt(7)
    v_lshl_or_b32 v220, v222, 1, v221
    v_lshl_or_b32 v220, v223, 2, v220
    s_nop 0
    v_readfirstlane_b32 s33, v220
    s_nop 3
    s_bitcmp1_b32 s33, 1
    s_cbranch_scc1 L_f2
    s_branch L_p2
L_u3:
    s_waitcnt vmcnt(7)
    v_lshl_or_b32 v224, v226, 1, v225
    v_lshl_or_b32 v224, v227, 2, v224
    s_nop 0
    v_readfirstlane_b32 s33, v224
    s_nop 3
    s_bitcmp1_b32 s33, 2
    s_cbranch_scc1 L_f3
    s_branch L_p3
L_p1:
    s_mov_b32 s86, 0x40000
L_p1_l:
    buffer_load_dwordx4 v[216:219], v0, s[48:51], s85 offen sc1
    s_waitcnt vmcnt(0)
    v_lshl_or_b32 v216, v218, 1, v217
    v_lshl_or_b32 v216, v219, 2, v216
    s_nop 0
    v_readfirstlane_b32 s33, v216
    s_nop 3
    s_bitcmp1_b32 s33, 0
    s_cbranch_scc1 L_f1
    s_sleep 1
    s_sub_u32 s86, s86, 1
    s_cmp_lg_u32 s86, 0
    s_cbranch_scc1 L_p1_l
    s_branch L_f1
L_p2:
    s_mov_b32 s86, 0x40000
L_p2_l:
    buffer_load_dwordx4 v[216:219], v0, s[48:51], s85 offen sc1
    s_waitcnt vmcnt(0)
    v_lshl_or_b32 v216, v218, 1, v217
    v_lshl_or_b32 v216, v219, 2, v216
    s_nop 0
    v_readfirstlane_b32 s33, v216
    s_nop 3
    s_bitcmp1_b32 s33, 1
    s_cbranch_scc1 L_f2
    s_sleep 1
    s_sub_u32 s86, s86, 1
    s_cmp_lg_u32 s86, 0
    s_cbranch_scc1 L_p2_l
    s_branch L_f2
L_p3:
    s_mov_b32 s86, 0x40000
L_p3_l:
    buffer_load_dwordx4 v[216:219], v0, s[48:51], s85 offen sc1
    s_waitcnt vmcnt(0)
    v_lshl_or_b32 v216, v218, 1, v217
    v_lshl_or_b32 v216, v219, 2, v216
    s_nop 0
    v_readfirstlane_b32 s33, v216
    s_nop 3
    s_bitcmp1_b32 s33, 2
    s_cbranch_scc1 L_f3
    s_sleep 1
    s_sub_u32 s86, s86, 1
    s_cmp_lg_u32 s86, 0
    s_cbranch_scc1 L_p3_l
    s_branch L_f3
L_w1:
    s_mov_b32 s86, 0x40000
L_w1_l:
    buffer_load_dword v209, v0, s[4:7], 0 offen sc1
    s_waitcnt vmcnt(0)
    v_readfirstlane_b32 s3, v209
    s_mul_i32 s31, s28, 3080
    s_nop 2
    s_cmp_ge_u32 s3, 16
    s_cbranch_scc1 L_t2
    s_sleep 1
    s_sub_u32 s86, s86, 1
    s_cmp_lg_u32 s86, 0
    s_cbranch_scc1 L_w1_l
    s_branch L_t2
L_w2:
    s_mov_b32 s86, 0x40000
L_w2_l:
    buffer_load_dwordx4 v[216:219], v0, s[48:51], s82 offen sc1
    s_waitcnt vmcnt(0)
    v_and_b32 v216, v216, v217
    v_and_b32 v218, v218, v219
    v_and_b32 v216, v216, v218
    s_nop 0
    v_readfirstlane_b32 s33, v216
    s_nop 3
    s_cmp_ge_u32 s33, 1
    s_cbranch_scc1 L_k1
    s_sleep 1
    s_sub_u32 s86, s86, 1
    s_cmp_lg_u32 s86, 0
    s_cbranch_scc1 L_w2_l
    s_branch L_k1
.p2align 6
L_slow:
    s_waitcnt vmcnt(0) lgkmcnt(0)
    s_barrier
    s_mov_b32 s35, 0
    s_mov_b32 s29, 16
    v_mov_b32 v215, 0xff800000
    v_mov_b32 v216, 0xff800000
    v_mov_b32 v217, 0xff800000
    v_mov_b32 v218, 0xff800000
    v_mov_b32 v219, 0xff800000
L_slow1:
    s_add_u32 m0, s33, 0
    s_nop 0
    buffer_load_dwordx4 v7, s[16:19], s35 offen nt lds
    buffer_load_dwordx4 v8, s[16:19], s35 offen offset:1024 nt lds
    buffer_load_dwordx4 v9, s[16:19], s35 offen offset:2048 nt lds
    s_add_u32 s35, s35, 3072
    s_add_u32 m0, s33, 3072
    s_nop 0
    buffer_load_dwordx4 v7, s[16:19], s35 offen nt lds
    buffer_load_dwordx4 v8, s[16:19], s35 offen offset:1024 nt lds
    buffer_load_dwordx4 v9, s[16:19], s35 offen offset:2048 nt lds
    s_add_u32 s35, s35, 9216
    s_waitcnt vmcnt(0) lgkmcnt(0)
    s_barrier
    ds_read_b128 a[240:243], v10 offset:0
    s_waitcnt lgkmcnt(0)
    v_mfma_f32_16x16x32_bf16 v[156:159], a[240:243], v[16:19], 0
    v_mfma_f32_16x16x32_bf16 v[160:163], a[240:243], v[20:23], 0
    v_mfma_f32_16x16x32_bf16 v[164:167], a[240:243], v[24:27], 0
    v_mfma_f32_16x16x32_bf16 v[168:171], a[240:243], v[28:31], 0
    v_mfma_f32_16x16x32_bf16 v[172:175], a[240:243], v[32:35], 0
    ds_read_b128 a[244:247], v13 offset:0
    s_waitcnt lgkmcnt(0)
    v_mfma_f32_16x16x32_bf16 v[156:159], a[244:247], v[36:39], v[156:159]
    v_mfma_f32_16x16x32_bf16 v[160:163], a[244:247], v[40:43], v[160:163]
    v_mfma_f32_16x16x32_bf16 v[164:167], a[244:247], v[44:47], v[164:167]
    v_mfma_f32_16x16x32_bf16 v[168:171], a[244:247], v[48:51], v[168:171]
    v_mfma_f32_16x16x32_bf16 v[172:175], a[244:247], v[52:55], v[172:175]
    ds_read_b128 a[248:251], v10 offset:128
    s_waitcnt lgkmcnt(0)
    v_mfma_f32_16x16x32_bf16 v[156:159], a[248:251], v[56:59], v[156:159]
    v_mfma_f32_16x16x32_bf16 v[160:163], a[248:251], v[60:63], v[160:163]
    v_mfma_f32_16x16x32_bf16 v[164:167], a[248:251], v[64:67], v[164:167]
    v_mfma_f32_16x16x32_bf16 v[168:171], a[248:251], v[68:71], v[168:171]
    v_mfma_f32_16x16x32_bf16 v[172:175], a[248:251], v[72:75], v[172:175]
    ds_read_b128 a[252:255], v13 offset:128
    s_waitcnt lgkmcnt(0)
    v_mfma_f32_16x16x32_bf16 v[156:159], a[252:255], v[76:79], v[156:159]
    v_mfma_f32_16x16x32_bf16 v[160:163], a[252:255], v[80:83], v[160:163]
    v_mfma_f32_16x16x32_bf16 v[164:167], a[252:255], v[84:87], v[164:167]
    v_mfma_f32_16x16x32_bf16 v[168:171], a[252:255], v[88:91], v[168:171]
    v_mfma_f32_16x16x32_bf16 v[172:175], a[252:255], v[92:95], v[172:175]
    ds_read_b128 a[240:243], v10 offset:256
    s_waitcnt lgkmcnt(0)
    v_mfma_f32_16x16x32_bf16 v[156:159], a[240:243], v[96:99], v[156:159]
    v_mfma_f32_16x16x32_bf16 v[160:163], a[240:243], v[100:103], v[160:163]
    v_mfma_f32_16x16x32_bf16 v[164:167], a[240:243], v[104:107], v[164:167]
    v_mfma_f32_16x16x32_bf16 v[168:171], a[240:243], v[108:111], v[168:171]
    v_mfma_f32_16x16x32_bf16 v[172:175], a[240:243], v[112:115], v[172:175]
    ds_read_b128 a[244:247], v13 offset:256
    s_waitcnt lgkmcnt(0)
    v_mfma_f32_16x16x32_bf16 v[156:159], a[244:247], v[116:119], v[156:159]
    v_mfma_f32_16x16x32_bf16 v[160:163], a[244:247], v[120:123], v[160:163]
    v_mfma_f32_16x16x32_bf16 v[164:167], a[244:247], v[124:127], v[164:167]
    v_mfma_f32_16x16x32_bf16 v[168:171], a[244:247], v[128:131], v[168:171]
    v_mfma_f32_16x16x32_bf16 v[172:175], a[244:247], v[132:135], v[172:175]
    ds_read_b128 a[248:251], v10 offset:6144
    s_waitcnt lgkmcnt(0)
    v_mfma_f32_16x16x32_bf16 v[136:139], a[248:251], v[16:19], 0
    v_mfma_f32_16x16x32_bf16 v[140:143], a[248:251], v[20:23], 0
    v_mfma_f32_16x16x32_bf16 v[144:147], a[248:251], v[24:27], 0
    v_mfma_f32_16x16x32_bf16 v[148:151], a[248:251], v[28:31], 0
    v_mfma_f32_16x16x32_bf16 v[152:155], a[248:251], v[32:35], 0
    ds_read_b128 a[252:255], v13 offset:6144
    s_waitcnt lgkmcnt(0)
    v_mfma_f32_16x16x32_bf16 v[136:139], a[252:255], v[36:39], v[136:139]
    v_mfma_f32_16x16x32_bf16 v[140:143], a[252:255], v[40:43], v[140:143]
    v_mfma_f32_16x16x32_bf16 v[144:147], a[252:255], v[44:47], v[144:147]
    v_mfma_f32_16x16x32_bf16 v[148:151], a[252:255], v[48:51], v[148:151]
    v_mfma_f32_16x16x32_bf16 v[152:155], a[252:255], v[52:55], v[152:155]
    ds_read_b128 a[240:243], v10 offset:6272
    s_waitcnt lgkmcnt(0)
    v_mfma_f32_16x16x32_bf16 v[136:139], a[240:243], v[56:59], v[136:139]
    v_mfma_f32_16x16x32_bf16 v[140:143], a[240:243], v[60:63], v[140:143]
    v_mfma_f32_16x16x32_bf16 v[144:147], a[240:243], v[64:67], v[144:147]
    v_mfma_f32_16x16x32_bf16 v[148:151], a[240:243], v[68:71], v[148:151]
    v_mfma_f32_16x16x32_bf16 v[152:155], a[240:243], v[72:75], v[152:155]
    ds_read_b128 a[244:247], v13 offset:6272
    s_waitcnt lgkmcnt(0)
    v_mfma_f32_16x16x32_bf16 v[136:139], a[244:247], v[76:79], v[136:139]
    v_mfma_f32_16x16x32_bf16 v[140:143], a[244:247], v[80:83], v[140:143]
    v_mfma_f32_16x16x32_bf16 v[144:147], a[244:247], v[84:87], v[144:147]
    v_mfma_f32_16x16x32_bf16 v[148:151], a[244:247], v[88:91], v[148:151]
    v_mfma_f32_16x16x32_bf16 v[152:155], a[244:247], v[92:95], v[152:155]
    ds_read_b128 a[248:251], v10 offset:6400
    s_waitcnt lgkmcnt(0)
    v_mfma_f32_16x16x32_bf16 v[136:139], a[248:251], v[96:99], v[136:139]
    v_mfma_f32_16x16x32_bf16 v[140:143], a[248:251], v[100:103], v[140:143]
    v_mfma_f32_16x16x32_bf16 v[144:147], a[248:251], v[104:107], v[144:147]
    v_mfma_f32_16x16x32_bf16 v[148:151], a[248:251], v[108:111], v[148:151]
    v_mfma_f32_16x16x32_bf16 v[152:155], a[248:251], v[112:115], v[152:155]
    ds_read_b128 a[252:255], v13 offset:6400
    s_waitcnt lgkmcnt(0)
    v_mfma_f32_16x16x32_bf16 v[136:139], a[252:255], v[116:119], v[136:139]
    v_mfma_f32_16x16x32_bf16 v[140:143], a[252:255], v[120:123], v[140:143]
    v_mfma_f32_16x16x32_bf16 v[144:147], a[252:255], v[124:127], v[144:147]
    v_mfma_f32_16x16x32_bf16 v[148:151], a[252:255], v[128:131], v[148:151]
    v_mfma_f32_16x16x32_bf16 v[152:155], a[252:255], v[132:135], v[152:155]
    s_barrier
    v_max3_f32 v215, v215, v156, v157
    v_max3_f32 v215, v215, v158, v159
    s_nop 0
    v_max3_f32 v215, v215, v136, v137
    v_max3_f32 v215, v215, v138, v139
    v_max3_f32 v216, v216, v160, v161
    v_max3_f32 v216, v216, v162, v163
    v_max3_f32 v216, v216, v140, v141
    v_max3_f32 v216, v216, v142, v143
    v_max3_f32 v217, v217, v164, v165
    v_max3_f32 v217, v217, v166, v167
    v_max3_f32 v217, v217, v144, v145
    v_max3_f32 v217, v217, v146, v147
    v_max3_f32 v218, v218, v168, v169
    v_max3_f32 v218, v218, v170, v171
    v_max3_f32 v218, v218, v148, v149
    v_max3_f32 v218, v218, v150, v151
    v_max3_f32 v219, v219, v172, v173
    v_max3_f32 v219, v219, v174, v175
    v_max3_f32 v219, v219, v152, v153
    v_max3_f32 v219, v219, v154, v155
    s_sub_u32 s29, s29, 1
    s_cmp_lg_u32 s29, 0
    s_cbranch_scc1 L_slow1
L_slow2:
    v_mov_b32 v210, v215
    s_nop 1
    v_permlane32_swap_b32 v210, v215
    v_max_f32 v215, v215, v210
    v_mov_b32 v211, v216
    s_nop 1
    v_permlane32_swap_b32 v211, v216
    v_max_f32 v216, v216, v211
    v_mov_b32 v212, v217
    s_nop 1
    v_permlane32_swap_b32 v212, v217
    v_max_f32 v217, v217, v212
    v_mov_b32 v213, v218
    s_nop 1
    v_permlane32_swap_b32 v213, v218
    v_max_f32 v218, v218, v213
    v_mov_b32 v214, v219
    s_nop 1
    v_permlane32_swap_b32 v214, v219
    v_max_f32 v219, v219, v214
    v_mov_b32 v210, v215
    s_nop 1
    v_permlane16_swap_b32 v210, v215
    v_max_f32 v215, v215, v210
    v_mov_b32 v211, v216
    s_nop 1
    v_permlane16_swap_b32 v211, v216
    v_max_f32 v216, v216, v211
    v_mov_b32 v212, v217
    s_nop 1
    v_permlane16_swap_b32 v212, v217
    v_max_f32 v217, v217, v212
    v_mov_b32 v213, v218
    s_nop 1
    v_permlane16_swap_b32 v213, v218
    v_max_f32 v218, v218, v213
    v_mov_b32 v214, v219
    s_nop 1
    v_permlane16_swap_b32 v214, v219
    v_max_f32 v219, v219, v214
    v_mov_b32 v196, 0
    v_mov_b32 v197, 0
    v_mov_b32 v198, 0
    v_mov_b32 v199, 0
    v_mov_b32 v200, 0
    v_mov_b32 v201, 0
    v_mov_b32 v202, 0
    v_mov_b32 v203, 0
    v_mov_b32 v204, 0
    v_mov_b32 v205, 0
    v_accvgpr_write_b32 a0, 0
    v_accvgpr_write_b32 a1, 0
    v_accvgpr_write_b32 a2, 0
    v_accvgpr_write_b32 a3, 0
    v_accvgpr_write_b32 a4, 0
    v_accvgpr_write_b32 a5, 0
    v_accvgpr_write_b32 a6, 0
    v_accvgpr_write_b32 a7, 0
    v_accvgpr_write_b32 a8, 0
    v_accvgpr_write_b32 a9, 0
    v_accvgpr_write_b32 a10, 0
    v_accvgpr_write_b32 a11, 0
    v_accvgpr_write_b32 a12, 0
    v_accvgpr_write_b32 a13, 0
    v_accvgpr_write_b32 a14, 0
    v_accvgpr_write_b32 a15, 0
    v_accvgpr_write_b32 a16, 0
    v_accvgpr_write_b32 a17, 0
    v_accvgpr_write_b32 a18, 0
    v_accvgpr_write_b32 a19, 0
    v_accvgpr_write_b32 a20, 0
    v_accvgpr_write_b32 a21, 0
    v_accvgpr_write_b32 a22, 0
    v_accvgpr_write_b32 a23, 0
    v_accvgpr_write_b32 a24, 0
    v_accvgpr_write_b32 a25, 0
    v_accvgpr_write_b32 a26, 0
    v_accvgpr_write_b32 a27, 0
    v_accvgpr_write_b32 a28, 0
    v_accvgpr_write_b32 a29, 0
    v_accvgpr_write_b32 a30, 0
    v_accvgpr_write_b32 a31, 0
    v_accvgpr_write_b32 a32, 0
    v_accvgpr_write_b32 a33, 0
    v_accvgpr_write_b32 a34, 0
    v_accvgpr_write_b32 a35, 0
    v_accvgpr_write_b32 a36, 0
    v_accvgpr_write_b32 a37, 0
    v_accvgpr_write_b32 a38, 0
    v_accvgpr_write_b32 a39, 0
    v_accvgpr_write_b32 a40, 0
    v_accvgpr_write_b32 a41, 0
    v_accvgpr_write_b32 a42, 0
    v_accvgpr_write_b32 a43, 0
    v_accvgpr_write_b32 a44, 0
    v_accvgpr_write_b32 a45, 0
    v_accvgpr_write_b32 a46, 0
    v_accvgpr_write_b32 a47, 0
    v_accvgpr_write_b32 a48, 0
    v_accvgpr_write_b32 a49, 0
    v_accvgpr_write_b32 a50, 0
    v_accvgpr_write_b32 a51, 0
    v_accvgpr_write_b32 a52, 0
    v_accvgpr_write_b32 a53, 0
    v_accvgpr_write_b32 a54, 0
    v_accvgpr_write_b32 a55, 0
    v_accvgpr_write_b32 a56, 0
    v_accvgpr_write_b32 a57, 0
    v_accvgpr_write_b32 a58, 0
    v_accvgpr_write_b32 a59, 0
    v_accvgpr_write_b32 a60, 0
    v_accvgpr_write_b32 a61, 0
    v_accvgpr_write_b32 a62, 0
    v_accvgpr_write_b32 a63, 0
    v_accvgpr_write_b32 a64, 0
    v_accvgpr_write_b32 a65, 0
    v_accvgpr_write_b32 a66, 0
    v_accvgpr_write_b32 a67, 0
    v_accvgpr_write_b32 a68, 0
    v_accvgpr_write_b32 a69, 0
    v_accvgpr_write_b32 a70, 0
    v_accvgpr_write_b32 a71, 0
    v_accvgpr_write_b32 a72, 0
    v_accvgpr_write_b32 a73, 0
    v_accvgpr_write_b32 a74, 0
    v_accvgpr_write_b32 a75, 0
    v_accvgpr_write_b32 a76, 0
    v_accvgpr_write_b32 a77, 0
    v_accvgpr_write_b32 a78, 0
    v_accvgpr_write_b32 a79, 0
    v_accvgpr_write_b32 a80, 0
    v_accvgpr_write_b32 a81, 0
    v_accvgpr_write_b32 a82, 0
    v_accvgpr_write_b32 a83, 0
    v_accvgpr_write_b32 a84, 0
    v_accvgpr_write_b32 a85, 0
    v_accvgpr_write_b32 a86, 0
    v_accvgpr_write_b32 a87, 0
    v_accvgpr_write_b32 a88, 0
    v_accvgpr_write_b32 a89, 0
    v_accvgpr_write_b32 a90, 0
    v_accvgpr_write_b32 a91, 0
    v_accvgpr_write_b32 a92, 0
    v_accvgpr_write_b32 a93, 0
    v_accvgpr_write_b32 a94, 0
    v_accvgpr_write_b32 a95, 0
    v_accvgpr_write_b32 a96, 0
    v_accvgpr_write_b32 a97, 0
    v_accvgpr_write_b32 a98, 0
    v_accvgpr_write_b32 a99, 0
    v_accvgpr_write_b32 a100, 0
    v_accvgpr_write_b32 a101, 0
    v_accvgpr_write_b32 a102, 0
    v_accvgpr_write_b32 a103, 0
    v_accvgpr_write_b32 a104, 0
    v_accvgpr_write_b32 a105, 0
    v_accvgpr_write_b32 a106, 0
    v_accvgpr_write_b32 a107, 0
    v_accvgpr_write_b32 a108, 0
    v_accvgpr_write_b32 a109, 0
    v_accvgpr_write_b32 a110, 0
    v_accvgpr_write_b32 a111, 0
    v_accvgpr_write_b32 a112, 0
    v_accvgpr_write_b32 a113, 0
    v_accvgpr_write_b32 a114, 0
    v_accvgpr_write_b32 a115, 0
    v_accvgpr_write_b32 a116, 0
    v_accvgpr_write_b32 a117, 0
    v_accvgpr_write_b32 a118, 0
    v_accvgpr_write_b32 a119, 0
    v_accvgpr_write_b32 a120, 0
    v_accvgpr_write_b32 a121, 0
    v_accvgpr_write_b32 a122, 0
    v_accvgpr_write_b32 a123, 0
    v_accvgpr_write_b32 a124, 0
    v_accvgpr_write_b32 a125, 0
    v_accvgpr_write_b32 a126, 0
    v_accvgpr_write_b32 a127, 0
    v_accvgpr_write_b32 a128, 0
    v_accvgpr_write_b32 a129, 0
    v_accvgpr_write_b32 a130, 0
    v_accvgpr_write_b32 a131, 0
    v_accvgpr_write_b32 a132, 0
    v_accvgpr_write_b32 a133, 0
    v_accvgpr_write_b32 a134, 0
    v_accvgpr_write_b32 a135, 0
    v_accvgpr_write_b32 a136, 0
    v_accvgpr_write_b32 a137, 0
    v_accvgpr_write_b32 a138, 0
    v_accvgpr_write_b32 a139, 0
    v_accvgpr_write_b32 a140, 0
    v_accvgpr_write_b32 a141, 0
    v_accvgpr_write_b32 a142, 0
    v_accvgpr_write_b32 a143, 0
    v_accvgpr_write_b32 a144, 0
    v_accvgpr_write_b32 a145, 0
    v_accvgpr_write_b32 a146, 0
    v_accvgpr_write_b32 a147, 0
    v_accvgpr_write_b32 a148, 0
    v_accvgpr_write_b32 a149, 0
    v_accvgpr_write_b32 a150, 0
    v_accvgpr_write_b32 a151, 0
    v_accvgpr_write_b32 a152, 0
    v_accvgpr_write_b32 a153, 0
    v_accvgpr_write_b32 a154, 0
    v_accvgpr_write_b32 a155, 0
    v_accvgpr_write_b32 a156, 0
    v_accvgpr_write_b32 a157, 0
    v_accvgpr_write_b32 a158, 0
    v_accvgpr_write_b32 a159, 0
    v_accvgpr_write_b32 a160, 0
    v_accvgpr_write_b32 a161, 0
    v_accvgpr_write_b32 a162, 0
    v_accvgpr_write_b32 a163, 0
    v_accvgpr_write_b32 a164, 0
    v_accvgpr_write_b32 a165, 0
    v_accvgpr_write_b32 a166, 0
    v_accvgpr_write_b32 a167, 0
    v_accvgpr_write_b32 a168, 0
    v_accvgpr_write_b32 a169, 0
    v_accvgpr_write_b32 a170, 0
    v_accvgpr_write_b32 a171, 0
    v_accvgpr_write_b32 a172, 0
    v_accvgpr_write_b32 a173, 0
    v_accvgpr_write_b32 a174, 0
    v_accvgpr_write_b32 a175, 0
    v_accvgpr_write_b32 a176, 0
    v_accvgpr_write_b32 a177, 0
    v_accvgpr_write_b32 a178, 0
    v_accvgpr_write_b32 a179, 0
    v_accvgpr_write_b32 a180, 0
    v_accvgpr_write_b32 a181, 0
    v_accvgpr_write_b32 a182, 0
    v_accvgpr_write_b32 a183, 0
    v_accvgpr_write_b32 a184, 0
    v_accvgpr_write_b32 a185, 0
    v_accvgpr_write_b32 a186, 0
    v_accvgpr_write_b32 a187, 0
    v_accvgpr_write_b32 a188, 0
    v_accvgpr_write_b32 a189, 0
    v_accvgpr_write_b32 a190, 0
    v_accvgpr_write_b32 a191, 0
    v_accvgpr_write_b32 a192, 0
    v_accvgpr_write_b32 a193, 0
    v_accvgpr_write_b32 a194, 0
    v_accvgpr_write_b32 a195, 0
    v_accvgpr_write_b32 a196, 0
    v_accvgpr_write_b32 a197, 0
    v_accvgpr_write_b32 a198, 0
    v_accvgpr_write_b32 a199, 0
    v_accvgpr_write_b32 a200, 0
    v_accvgpr_write_b32 a201, 0
    v_accvgpr_write_b32 a202, 0
    v_accvgpr_write_b32 a203, 0
    v_accvgpr_write_b32 a204, 0
    v_accvgpr_write_b32 a205, 0
    v_accvgpr_write_b32 a206, 0
    v_accvgpr_write_b32 a207, 0
    v_accvgpr_write_b32 a208, 0
    v_accvgpr_write_b32 a209, 0
    v_accvgpr_write_b32 a210, 0
    v_accvgpr_write_b32 a211, 0
    v_accvgpr_write_b32 a212, 0
    v_accvgpr_write_b32 a213, 0
    v_accvgpr_write_b32 a214, 0
    v_accvgpr_write_b32 a215, 0
    v_accvgpr_write_b32 a216, 0
    v_accvgpr_write_b32 a217, 0
    v_accvgpr_write_b32 a218, 0
    v_accvgpr_write_b32 a219, 0
    v_accvgpr_write_b32 a220, 0
    v_accvgpr_write_b32 a221, 0
    v_accvgpr_write_b32 a222, 0
    v_accvgpr_write_b32 a223, 0
    v_accvgpr_write_b32 a224, 0
    v_accvgpr_write_b32 a225, 0
    v_accvgpr_write_b32 a226, 0
    v_accvgpr_write_b32 a227, 0
    v_accvgpr_write_b32 a228, 0
    v_accvgpr_write_b32 a229, 0
    v_accvgpr_write_b32 a230, 0
    v_accvgpr_write_b32 a231, 0
    v_accvgpr_write_b32 a232, 0
    v_accvgpr_write_b32 a233, 0
    v_accvgpr_write_b32 a234, 0
    v_accvgpr_write_b32 a235, 0
    v_accvgpr_write_b32 a236, 0
    v_accvgpr_write_b32 a237, 0
    v_accvgpr_write_b32 a238, 0
    v_accvgpr_write_b32 a239, 0
    s_mov_b32 s35, 0
    s_mov_b32 s36, 0
    s_mov_b32 s29, 16
    s_mov_b32 s40, 0
    s_mov_b32 s41, 0x7f800000
L_slow3:
    s_add_u32 m0, s33, 0
    s_nop 0
    buffer_load_dwordx4 v7, s[16:19], s35 offen nt lds
    buffer_load_dwordx4 v8, s[16:19], s35 offen offset:1024 nt lds
    buffer_load_dwordx4 v9, s[16:19], s35 offen offset:2048 nt lds
    s_add_u32 s35, s35, 3072
    s_add_u32 m0, s33, 3072
    s_nop 0
    buffer_load_dwordx4 v7, s[16:19], s35 offen nt lds
    buffer_load_dwordx4 v8, s[16:19], s35 offen offset:1024 nt lds
    buffer_load_dwordx4 v9, s[16:19], s35 offen offset:2048 nt lds
    s_add_u32 s35, s35, 9216
    s_add_u32 m0, s34, 0
    s_nop 0
    buffer_load_dwordx4 v7, s[20:23], s36 offen nt lds
    buffer_load_dwordx4 v8, s[20:23], s36 offen offset:1024 nt lds
    buffer_load_dwordx4 v9, s[20:23], s36 offen offset:2048 nt lds
    s_add_u32 s36, s36, 3072
    s_add_u32 m0, s34, 3072
    s_nop 0
    buffer_load_dwordx4 v7, s[20:23], s36 offen nt lds
    buffer_load_dwordx4 v8, s[20:23], s36 offen offset:1024 nt lds
    buffer_load_dwordx4 v9, s[20:23], s36 offen offset:2048 nt lds
    s_add_u32 s36, s36, 9216
    s_waitcnt vmcnt(0) lgkmcnt(0)
    s_barrier
    ds_read_b128 a[240:243], v10 offset:0
    s_waitcnt lgkmcnt(0)
    v_mfma_f32_16x16x32_bf16 v[156:159], a[240:243], v[16:19], 0
    v_mfma_f32_16x16x32_bf16 v[160:163], a[240:243], v[20:23], 0
    v_mfma_f32_16x16x32_bf16 v[164:167], a[240:243], v[24:27], 0
    v_mfma_f32_16x16x32_bf16 v[168:171], a[240:243], v[28:31], 0
    v_mfma_f32_16x16x32_bf16 v[172:175], a[240:243], v[32:35], 0
    ds_read_b128 a[244:247], v13 offset:0
    s_waitcnt lgkmcnt(0)
    v_mfma_f32_16x16x32_bf16 v[156:159], a[244:247], v[36:39], v[156:159]
    v_mfma_f32_16x16x32_bf16 v[160:163], a[244:247], v[40:43], v[160:163]
    v_mfma_f32_16x16x32_bf16 v[164:167], a[244:247], v[44:47], v[164:167]
    v_mfma_f32_16x16x32_bf16 v[168:171], a[244:247], v[48:51], v[168:171]
    v_mfma_f32_16x16x32_bf16 v[172:175], a[244:247], v[52:55], v[172:175]
    ds_read_b128 a[248:251], v10 offset:128
    s_waitcnt lgkmcnt(0)
    v_mfma_f32_16x16x32_bf16 v[156:159], a[248:251], v[56:59], v[156:159]
    v_mfma_f32_16x16x32_bf16 v[160:163], a[248:251], v[60:63], v[160:163]
    v_mfma_f32_16x16x32_bf16 v[164:167], a[248:251], v[64:67], v[164:167]
    v_mfma_f32_16x16x32_bf16 v[168:171], a[248:251], v[68:71], v[168:171]
    v_mfma_f32_16x16x32_bf16 v[172:175], a[248:251], v[72:75], v[172:175]
    ds_read_b128 a[252:255], v13 offset:128
    s_waitcnt lgkmcnt(0)
    v_mfma_f32_16x16x32_bf16 v[156:159], a[252:255], v[76:79], v[156:159]
    v_mfma_f32_16x16x32_bf16 v[160:163], a[252:255], v[80:83], v[160:163]
    v_mfma_f32_16x16x32_bf16 v[164:167], a[252:255], v[84:87], v[164:167]
    v_mfma_f32_16x16x32_bf16 v[168:171], a[252:255], v[88:91], v[168:171]
    v_mfma_f32_16x16x32_bf16 v[172:175], a[252:255], v[92:95], v[172:175]
    ds_read_b128 a[240:243], v10 offset:256
    s_waitcnt lgkmcnt(0)
    v_mfma_f32_16x16x32_bf16 v[156:159], a[240:243], v[96:99], v[156:159]
    v_mfma_f32_16x16x32_bf16 v[160:163], a[240:243], v[100:103], v[160:163]
    v_mfma_f32_16x16x32_bf16 v[164:167], a[240:243], v[104:107], v[164:167]
    v_mfma_f32_16x16x32_bf16 v[168:171], a[240:243], v[108:111], v[168:171]
    v_mfma_f32_16x16x32_bf16 v[172:175], a[240:243], v[112:115], v[172:175]
    ds_read_b128 a[244:247], v13 offset:256
    s_waitcnt lgkmcnt(0)
    v_mfma_f32_16x16x32_bf16 v[156:159], a[244:247], v[116:119], v[156:159]
    v_mfma_f32_16x16x32_bf16 v[160:163], a[244:247], v[120:123], v[160:163]
    v_mfma_f32_16x16x32_bf16 v[164:167], a[244:247], v[124:127], v[164:167]
    v_mfma_f32_16x16x32_bf16 v[168:171], a[244:247], v[128:131], v[168:171]
    v_mfma_f32_16x16x32_bf16 v[172:175], a[244:247], v[132:135], v[172:175]
    ds_read_b128 a[248:251], v10 offset:6144
    s_waitcnt lgkmcnt(0)
    v_mfma_f32_16x16x32_bf16 v[136:139], a[248:251], v[16:19], 0
    v_mfma_f32_16x16x32_bf16 v[140:143], a[248:251], v[20:23], 0
    v_mfma_f32_16x16x32_bf16 v[144:147], a[248:251], v[24:27], 0
    v_mfma_f32_16x16x32_bf16 v[148:151], a[248:251], v[28:31], 0
    v_mfma_f32_16x16x32_bf16 v[152:155], a[248:251], v[32:35], 0
    ds_read_b128 a[252:255], v13 offset:6144
    s_waitcnt lgkmcnt(0)
    v_mfma_f32_16x16x32_bf16 v[136:139], a[252:255], v[36:39], v[136:139]
    v_mfma_f32_16x16x32_bf16 v[140:143], a[252:255], v[40:43], v[140:143]
    v_mfma_f32_16x16x32_bf16 v[144:147], a[252:255], v[44:47], v[144:147]
    v_mfma_f32_16x16x32_bf16 v[148:151], a[252:255], v[48:51], v[148:151]
    v_mfma_f32_16x16x32_bf16 v[152:155], a[252:255], v[52:55], v[152:155]
    ds_read_b128 a[240:243], v10 offset:6272
    s_waitcnt lgkmcnt(0)
    v_mfma_f32_16x16x32_bf16 v[136:139], a[240:243], v[56:59], v[136:139]
    v_mfma_f32_16x16x32_bf16 v[140:143], a[240:243], v[60:63], v[140:143]
    v_mfma_f32_16x16x32_bf16 v[144:147], a[240:243], v[64:67], v[144:147]
    v_mfma_f32_16x16x32_bf16 v[148:151], a[240:243], v[68:71], v[148:151]
    v_mfma_f32_16x16x32_bf16 v[152:155], a[240:243], v[72:75], v[152:155]
    ds_read_b128 a[244:247], v13 offset:6272
    s_waitcnt lgkmcnt(0)
    v_mfma_f32_16x16x32_bf16 v[136:139], a[244:247], v[76:79], v[136:139]
    v_mfma_f32_16x16x32_bf16 v[140:143], a[244:247], v[80:83], v[140:143]
    v_mfma_f32_16x16x32_bf16 v[144:147], a[244:247], v[84:87], v[144:147]
    v_mfma_f32_16x16x32_bf16 v[148:151], a[244:247], v[88:91], v[148:151]
    v_mfma_f32_16x16x32_bf16 v[152:155], a[244:247], v[92:95], v[152:155]
    ds_read_b128 a[248:251], v10 offset:6400
    s_waitcnt lgkmcnt(0)
    v_mfma_f32_16x16x32_bf16 v[136:139], a[248:251], v[96:99], v[136:139]
    v_mfma_f32_16x16x32_bf16 v[140:143], a[248:251], v[100:103], v[140:143]
    v_mfma_f32_16x16x32_bf16 v[144:147], a[248:251], v[104:107], v[144:147]
    v_mfma_f32_16x16x32_bf16 v[148:151], a[248:251], v[108:111], v[148:151]
    v_mfma_f32_16x16x32_bf16 v[152:155], a[248:251], v[112:115], v[152:155]
    ds_read_b128 a[252:255], v13 offset:6400
    s_waitcnt lgkmcnt(0)
    v_mfma_f32_16x16x32_bf16 v[136:139], a[252:255], v[116:119], v[136:139]
    v_mfma_f32_16x16x32_bf16 v[140:143], a[252:255], v[120:123], v[140:143]
    v_mfma_f32_16x16x32_bf16 v[144:147], a[252:255], v[124:127], v[144:147]
    v_mfma_f32_16x16x32_bf16 v[148:151], a[252:255], v[128:131], v[148:151]
    v_mfma_f32_16x16x32_bf16 v[152:155], a[252:255], v[132:135], v[152:155]
    v_sub_f32 v156, v156, v215
    v_sub_f32 v157, v157, v215
    v_sub_f32 v158, v158, v215
    v_sub_f32 v159, v159, v215
    v_sub_f32 v136, v136, v215
    v_sub_f32 v137, v137, v215
    v_sub_f32 v138, v138, v215
    v_sub_f32 v139, v139, v215
    v_sub_f32 v160, v160, v216
    v_sub_f32 v161, v161, v216
    v_sub_f32 v162, v162, v216
    v_sub_f32 v163, v163, v216
    v_sub_f32 v140, v140, v216
    v_sub_f32 v141, v141, v216
    v_sub_f32 v142, v142, v216
    v_sub_f32 v143, v143, v216
    v_sub_f32 v164, v164, v217
    v_sub_f32 v165, v165, v217
    v_sub_f32 v166, v166, v217
    v_sub_f32 v167, v167, v217
    v_sub_f32 v144, v144, v217
    v_sub_f32 v145, v145, v217
    v_sub_f32 v146, v146, v217
    v_sub_f32 v147, v147, v217
    v_sub_f32 v168, v168, v218
    v_sub_f32 v169, v169, v218
    v_sub_f32 v170, v170, v218
    v_sub_f32 v171, v171, v218
    v_sub_f32 v148, v148, v218
    v_sub_f32 v149, v149, v218
    v_sub_f32 v150, v150, v218
    v_sub_f32 v151, v151, v218
    v_sub_f32 v172, v172, v219
    v_sub_f32 v173, v173, v219
    v_sub_f32 v174, v174, v219
    v_sub_f32 v175, v175, v219
    v_sub_f32 v152, v152, v219
    v_sub_f32 v153, v153, v219
    v_sub_f32 v154, v154, v219
    v_sub_f32 v155, v155, v219
    v_exp_f32 v156, v156
    s_nop 0
    v_add_f32 v196, v196, v156
    v_exp_f32 v157, v157
    s_nop 0
    v_add_f32 v197, v197, v157
    v_exp_f32 v158, v158
    s_nop 0
    v_add_f32 v196, v196, v158
    v_exp_f32 v159, v159
    s_nop 0
    v_add_f32 v197, v197, v159
    v_exp_f32 v160, v160
    s_nop 0
    v_add_f32 v198, v198, v160
    v_exp_f32 v161, v161
    s_nop 0
    v_add_f32 v199, v199, v161
    v_exp_f32 v162, v162
    s_nop 0
    v_add_f32 v198, v198, v162
    v_exp_f32 v163, v163
    s_nop 0
    v_add_f32 v199, v199, v163
    v_exp_f32 v164, v164
    s_nop 0
    v_add_f32 v200, v200, v164
    v_exp_f32 v165, v165
    s_nop 0
    v_add_f32 v201, v201, v165
    v_exp_f32 v166, v166
    s_nop 0
    v_add_f32 v200, v200, v166
    v_exp_f32 v167, v167
    s_nop 0
    v_add_f32 v201, v201, v167
    v_exp_f32 v168, v168
    s_nop 0
    v_add_f32 v202, v202, v168
    v_exp_f32 v169, v169
    s_nop 0
    v_add_f32 v203, v203, v169
    v_exp_f32 v170, v170
    s_nop 0
    v_add_f32 v202, v202, v170
    v_exp_f32 v171, v171
    s_nop 0
    v_add_f32 v203, v203, v171
    v_exp_f32 v172, v172
    s_nop 0
    v_add_f32 v204, v204, v172
    v_exp_f32 v173, v173
    s_nop 0
    v_add_f32 v205, v205, v173
    v_exp_f32 v174, v174
    s_nop 0
    v_add_f32 v204, v204, v174
    v_exp_f32 v175, v175
    s_nop 0
    v_add_f32 v205, v205, v175
    v_exp_f32 v136, v136
    s_nop 0
    v_add_f32 v196, v196, v136
    v_exp_f32 v137, v137
    s_nop 0
    v_add_f32 v197, v197, v137
    v_exp_f32 v138, v138
    s_nop 0
    v_add_f32 v196, v196, v138
    v_exp_f32 v139, v139
    s_nop 0
    v_add_f32 v197, v197, v139
    v_cvt_pk_bf16_f32 v139, v138, v139
    v_cvt_pk_bf16_f32 v138, v136, v137
    v_cvt_pk_bf16_f32 v136, v156, v157
    v_cvt_pk_bf16_f32 v137, v158, v159
    v_exp_f32 v140, v140
    s_nop 0
    v_add_f32 v198, v198, v140
    v_exp_f32 v141, v141
    s_nop 0
    v_add_f32 v199, v199, v141
    v_exp_f32 v142, v142
    s_nop 0
    v_add_f32 v198, v198, v142
    v_exp_f32 v143, v143
    s_nop 0
    v_add_f32 v199, v199, v143
    v_cvt_pk_bf16_f32 v143, v142, v143
    v_cvt_pk_bf16_f32 v142, v140, v141
    v_cvt_pk_bf16_f32 v140, v160, v161
    v_cvt_pk_bf16_f32 v141, v162, v163
    v_exp_f32 v144, v144
    s_nop 0
    v_add_f32 v200, v200, v144
    v_exp_f32 v145, v145
    s_nop 0
    v_add_f32 v201, v201, v145
    v_exp_f32 v146, v146
    s_nop 0
    v_add_f32 v200, v200, v146
    v_exp_f32 v147, v147
    s_nop 0
    v_add_f32 v201, v201, v147
    v_cvt_pk_bf16_f32 v147, v146, v147
    v_cvt_pk_bf16_f32 v146, v144, v145
    v_cvt_pk_bf16_f32 v144, v164, v165
    v_cvt_pk_bf16_f32 v145, v166, v167
    v_exp_f32 v148, v148
    s_nop 0
    v_add_f32 v202, v202, v148
    v_exp_f32 v149, v149
    s_nop 0
    v_add_f32 v203, v203, v149
    v_exp_f32 v150, v150
    s_nop 0
    v_add_f32 v202, v202, v150
    v_exp_f32 v151, v151
    s_nop 0
    v_add_f32 v203, v203, v151
    v_cvt_pk_bf16_f32 v151, v150, v151
    v_cvt_pk_bf16_f32 v150, v148, v149
    v_cvt_pk_bf16_f32 v148, v168, v169
    v_cvt_pk_bf16_f32 v149, v170, v171
    v_exp_f32 v152, v152
    s_nop 0
    v_add_f32 v204, v204, v152
    v_exp_f32 v153, v153
    s_nop 0
    v_add_f32 v205, v205, v153
    v_exp_f32 v154, v154
    s_nop 0
    v_add_f32 v204, v204, v154
    v_exp_f32 v155, v155
    s_nop 0
    v_add_f32 v205, v205, v155
    v_cvt_pk_bf16_f32 v155, v154, v155
    v_cvt_pk_bf16_f32 v154, v152, v153
    v_cvt_pk_bf16_f32 v152, v172, v173
    v_cvt_pk_bf16_f32 v153, v174, v175
    s_sub_u32 s29, s29, 1
    s_cmp_eq_u32 s29, 0
    s_cbranch_scc1 L_tr
    ds_read_b64_tr_b16 a[240:241], v11 offset:0
    ds_read_b64_tr_b16 a[242:243], v11 offset:6144
    s_waitcnt lgkmcnt(0)
    v_mfma_f32_16x16x32_bf16 a[0:3], a[240:243], v[136:139], a[0:3]
    v_mfma_f32_16x16x32_bf16 a[4:7], a[240:243], v[140:143], a[4:7]
    v_mfma_f32_16x16x32_bf16 a[8:11], a[240:243], v[144:147], a[8:11]
    v_mfma_f32_16x16x32_bf16 a[12:15], a[240:243], v[148:151], a[12:15]
    v_mfma_f32_16x16x32_bf16 a[16:19], a[240:243], v[152:155], a[16:19]
    ds_read_b64_tr_b16 a[244:245], v206 offset:0
    ds_read_b64_tr_b16 a[246:247], v206 offset:6144
    s_waitcnt lgkmcnt(0)
    v_mfma_f32_16x16x32_bf16 a[36:39], a[244:247], v[152:155], a[36:39]
    v_mfma_f32_16x16x32_bf16 a[32:35], a[244:247], v[148:151], a[32:35]
    v_mfma_f32_16x16x32_bf16 a[28:31], a[244:247], v[144:147], a[28:31]
    v_mfma_f32_16x16x32_bf16 a[24:27], a[244:247], v[140:143], a[24:27]
    v_mfma_f32_16x16x32_bf16 a[20:23], a[244:247], v[136:139], a[20:23]
    ds_read_b64_tr_b16 a[248:249], v207 offset:0
    ds_read_b64_tr_b16 a[250:251], v207 offset:6144
    s_waitcnt lgkmcnt(0)
    v_mfma_f32_16x16x32_bf16 a[40:43], a[248:251], v[136:139], a[40:43]
    v_mfma_f32_16x16x32_bf16 a[44:47], a[248:251], v[140:143], a[44:47]
    v_mfma_f32_16x16x32_bf16 a[48:51], a[248:251], v[144:147], a[48:51]
    v_mfma_f32_16x16x32_bf16 a[52:55], a[248:251], v[148:151], a[52:55]
    v_mfma_f32_16x16x32_bf16 a[56:59], a[248:251], v[152:155], a[56:59]
    ds_read_b64_tr_b16 a[252:253], v208 offset:0
    ds_read_b64_tr_b16 a[254:255], v208 offset:6144
    s_waitcnt lgkmcnt(0)
    v_mfma_f32_16x16x32_bf16 a[76:79], a[252:255], v[152:155], a[76:79]
    v_mfma_f32_16x16x32_bf16 a[72:75], a[252:255], v[148:151], a[72:75]
    v_mfma_f32_16x16x32_bf16 a[68:71], a[252:255], v[144:147], a[68:71]
    v_mfma_f32_16x16x32_bf16 a[64:67], a[252:255], v[140:143], a[64:67]
    v_mfma_f32_16x16x32_bf16 a[60:63], a[252:255], v[136:139], a[60:63]
    ds_read_b64_tr_b16 a[240:241], v11 offset:128
    ds_read_b64_tr_b16 a[242:243], v11 offset:6272
    s_waitcnt lgkmcnt(0)
    v_mfma_f32_16x16x32_bf16 a[80:83], a[240:243], v[136:139], a[80:83]
    v_mfma_f32_16x16x32_bf16 a[84:87], a[240:243], v[140:143], a[84:87]
    v_mfma_f32_16x16x32_bf16 a[88:91], a[240:243], v[144:147], a[88:91]
    v_mfma_f32_16x16x32_bf16 a[92:95], a[240:243], v[148:151], a[92:95]
    v_mfma_f32_16x16x32_bf16 a[96:99], a[240:243], v[152:155], a[96:99]
    ds_read_b64_tr_b16 a[244:245], v206 offset:128
    ds_read_b64_tr_b16 a[246:247], v206 offset:6272
    s_waitcnt lgkmcnt(0)
    v_mfma_f32_16x16x32_bf16 a[116:119], a[244:247], v[152:155], a[116:119]
    v_mfma_f32_16x16x32_bf16 a[112:115], a[244:247], v[148:151], a[112:115]
    v_mfma_f32_16x16x32_bf16 a[108:111], a[244:247], v[144:147], a[108:111]
    v_mfma_f32_16x16x32_bf16 a[104:107], a[244:247], v[140:143], a[104:107]
    v_mfma_f32_16x16x32_bf16 a[100:103], a[244:247], v[136:139], a[100:103]
    ds_read_b64_tr_b16 a[248:249], v207 offset:128
    ds_read_b64_tr_b16 a[250:251], v207 offset:6272
    s_waitcnt lgkmcnt(0)
    v_mfma_f32_16x16x32_bf16 a[120:123], a[248:251], v[136:139], a[120:123]
    v_mfma_f32_16x16x32_bf16 a[124:127], a[248:251], v[140:143], a[124:127]
    v_mfma_f32_16x16x32_bf16 a[128:131], a[248:251], v[144:147], a[128:131]
    v_mfma_f32_16x16x32_bf16 a[132:135], a[248:251], v[148:151], a[132:135]
    v_mfma_f32_16x16x32_bf16 a[136:139], a[248:251], v[152:155], a[136:139]
    ds_read_b64_tr_b16 a[252:253], v208 offset:128
    ds_read_b64_tr_b16 a[254:255], v208 offset:6272
    s_waitcnt lgkmcnt(0)
    v_mfma_f32_16x16x32_bf16 a[156:159], a[252:255], v[152:155], a[156:159]
    v_mfma_f32_16x16x32_bf16 a[152:155], a[252:255], v[148:151], a[152:155]
    v_mfma_f32_16x16x32_bf16 a[148:151], a[252:255], v[144:147], a[148:151]
    v_mfma_f32_16x16x32_bf16 a[144:147], a[252:255], v[140:143], a[144:147]
    v_mfma_f32_16x16x32_bf16 a[140:143], a[252:255], v[136:139], a[140:143]
    ds_read_b64_tr_b16 a[240:241], v11 offset:256
    ds_read_b64_tr_b16 a[242:243], v11 offset:6400
    s_waitcnt lgkmcnt(0)
    v_mfma_f32_16x16x32_bf16 a[160:163], a[240:243], v[136:139], a[160:163]
    v_mfma_f32_16x16x32_bf16 a[164:167], a[240:243], v[140:143], a[164:167]
    v_mfma_f32_16x16x32_bf16 a[168:171], a[240:243], v[144:147], a[168:171]
    v_mfma_f32_16x16x32_bf16 a[172:175], a[240:243], v[148:151], a[172:175]
    v_mfma_f32_16x16x32_bf16 a[176:179], a[240:243], v[152:155], a[176:179]
    ds_read_b64_tr_b16 a[244:245], v206 offset:256
    ds_read_b64_tr_b16 a[246:247], v206 offset:6400
    s_waitcnt lgkmcnt(0)
    v_mfma_f32_16x16x32_bf16 a[196:199], a[244:247], v[152:155], a[196:199]
    v_mfma_f32_16x16x32_bf16 a[192:195], a[244:247], v[148:151], a[192:195]
    v_mfma_f32_16x16x32_bf16 a[188:191], a[244:247], v[144:147], a[188:191]
    v_mfma_f32_16x16x32_bf16 a[184:187], a[244:247], v[140:143], a[184:187]
    v_mfma_f32_16x16x32_bf16 a[180:183], a[244:247], v[136:139], a[180:183]
    ds_read_b64_tr_b16 a[248:249], v207 offset:256
    ds_read_b64_tr_b16 a[250:251], v207 offset:6400
    s_waitcnt lgkmcnt(0)
    v_mfma_f32_16x16x32_bf16 a[200:203], a[248:251], v[136:139], a[200:203]
    v_mfma_f32_16x16x32_bf16 a[204:207], a[248:251], v[140:143], a[204:207]
    v_mfma_f32_16x16x32_bf16 a[208:211], a[248:251], v[144:147], a[208:211]
    v_mfma_f32_16x16x32_bf16 a[212:215], a[248:251], v[148:151], a[212:215]
    v_mfma_f32_16x16x32_bf16 a[216:219], a[248:251], v[152:155], a[216:219]
    ds_read_b64_tr_b16 a[252:253], v208 offset:256
    ds_read_b64_tr_b16 a[254:255], v208 offset:6400
    s_waitcnt lgkmcnt(0)
    v_mfma_f32_16x16x32_bf16 a[236:239], a[252:255], v[152:155], a[236:239]
    v_mfma_f32_16x16x32_bf16 a[232:235], a[252:255], v[148:151], a[232:235]
    v_mfma_f32_16x16x32_bf16 a[228:231], a[252:255], v[144:147], a[228:231]
    v_mfma_f32_16x16x32_bf16 a[224:227], a[252:255], v[140:143], a[224:227]
    v_mfma_f32_16x16x32_bf16 a[220:223], a[252:255], v[136:139], a[220:223]
    s_barrier
    s_branch L_slow3
L_end:
    s_endpgm
.section .rodata,"a"
.p2align 6
.amdhsa_kernel concat_heads__gqa_block_cached__mha_block_cached__near_ridge_kernel
  .amdhsa_next_free_vgpr 512
  .amdhsa_next_free_sgpr 102
  .amdhsa_accum_offset 256
  .amdhsa_group_segment_fixed_size 0
  .amdhsa_kernarg_size 104
  .amdhsa_user_sgpr_count 2
  .amdhsa_user_sgpr_kernarg_segment_ptr 1
  .amdhsa_system_sgpr_workgroup_id_x 1
.end_amdhsa_kernel
```
